```python
import torch

def _softmax(x, axis=-1):
    return torch.softmax(x, dim=axis)

def _gelu(x):
    return torch.nn.functional.gelu(x, approximate='tanh')

def _silu(x):
    return torch.nn.functional.silu(x)

def _sigmoid(x):
    return torch.sigmoid(x)

def _layernorm(x, axis=-1, eps=1e-05):
    m = x.mean(dim=axis, keepdim=True)
    v = x.var(dim=axis, keepdim=True, unbiased=False)
    return (x - m) / torch.sqrt(v + eps)

def _scatter_add(tgt, idx, src, axis=0):
    return tgt.clone().index_add_(axis, idx, src)

def _segment_sum(src, seg, n):
    out = torch.zeros((n,) + src.shape[1:], dtype=src.dtype)
    return out.index_add_(0, seg, src)

def _pad(x, pw):
    flat = tuple((v for pair in reversed(pw) for v in pair))
    return torch.nn.functional.pad(x, flat)
kernel_name = 'interleave_layers__memory_aug_recurrent_mem_tr__glu_gated_bilinear__prompt'

def setup_inputs():

    _w = lambda a: (lambda t: t.to(torch.bfloat16) if t.is_floating_point() else t)(torch.as_tensor(a))

    def _A_setup():
        B, S, Dm = (1, 2048, 512)
        H, Dh = (32, 128)
        M, seg = (8, 32)
        seg = min(seg, S)
        S = S // seg * seg
        return {'x': _w((lambda *s: torch.randn(*s, dtype=torch.bfloat16) * 0.05)(B, S, Dm)), 'mem0': _w((lambda *s: torch.randn(*s, dtype=torch.bfloat16) * 0.2)(B, M, Dm)), 'Wq': _w((lambda *s: torch.randn(*s, dtype=torch.bfloat16) * 1.6)(Dm, H, Dh) * Dm ** (-0.5)), 'Wk': _w((lambda *s: torch.randn(*s, dtype=torch.bfloat16) * 1.6)(Dm, H, Dh) * Dm ** (-0.5)), 'Wv': _w((lambda *s: torch.randn(*s, dtype=torch.bfloat16) * 0.2)(Dm, H, Dh) * Dm ** (-0.5)), 'Wo': _w((lambda *s: torch.randn(*s, dtype=torch.bfloat16) * 0.2)(H, Dh, Dm) * (H * Dh) ** (-0.5)), 'seg_len': seg}
    _A_in = _A_setup()

    def _B_setup():
        B, S, D, F = (1, 2048, 512, 1792)
        return {'x': _w((lambda *s: torch.randn(*s, dtype=torch.bfloat16) * 0.05)(B, S, D)), 'w_gate': _w((lambda *s: torch.randn(*s, dtype=torch.bfloat16) * 0.4)(D, F) * D ** (-0.5)), 'w_up': _w((lambda *s: torch.randn(*s, dtype=torch.bfloat16) * 0.4)(D, F) * D ** (-0.5)), 'w_down': _w((lambda *s: torch.randn(*s, dtype=torch.bfloat16) * 0.4)(F, D) * F ** (-0.5))}
    _B_in = _B_setup()
    return {'A_x': _A_in['x'], 'A_mem0': _A_in['mem0'], 'A_Wq': _A_in['Wq'], 'A_Wk': _A_in['Wk'], 'A_Wv': _A_in['Wv'], 'A_Wo': _A_in['Wo'], 'A_seg_len': _A_in['seg_len'], 'B_x': _B_in['x'], 'B_w_gate': _B_in['w_gate'], 'B_w_up': _B_in['w_up'], 'B_w_down': _B_in['w_down']}

def reference(A_x, A_mem0, A_Wq, A_Wk, A_Wv, A_Wo, A_seg_len, B_x, B_w_gate, B_w_up, B_w_down):

    def _A_ref(x, mem0, Wq, Wk, Wv, Wo, seg_len):
        B, S, Dm = x.shape
        H, Dh = (Wq.shape[1], Wq.shape[2])
        M = mem0.shape[1]
        scale = Dh ** (-0.5)
        n_seg = S // seg_len
        L = M + seg_len
        idx = torch.arange(L)
        mask = (idx[:, None] < M) | (idx[:, None] >= idx[None, :])
        mem = mem0
        outs = []
        for s in range(n_seg):
            xs = x[:, s * seg_len:(s + 1) * seg_len, :].clone()
            h = torch.concatenate([mem, xs], axis=1)
            q = torch.einsum('btd,dhe->bhte', h, Wq)
            k = torch.einsum('btd,dhe->bhte', h, Wk)
            v = torch.einsum('btd,dhe->bhte', h, Wv)
            scores = torch.einsum('bhqe,bhke->bhqk', q, k) * scale
            scores = torch.where(mask[None, None], scores, -1000000000.0)
            p = _softmax(scores, axis=-1)
            o = torch.einsum('bhqk,bhke->bhqe', p, v)
            o = torch.einsum('bhte,hed->btd', o, Wo)
            mem = o[:, :M, :].clone()
            outs.append(o[:, M:, :])
        return torch.concatenate(outs, axis=1)

    def _B_ref(x, w_gate, w_up, w_down):
        g = torch.einsum('bsd,df->bsf', x, w_gate)
        u = torch.einsum('bsd,df->bsf', x, w_up)
        h = g * u
        return torch.einsum('bsf,fd->bsd', h, w_down)
    x = A_x
    x = x + _A_ref(_layernorm(x, axis=-1), A_mem0, A_Wq, A_Wk, A_Wv, A_Wo, A_seg_len)
    x = x + _B_ref(_layernorm(x, axis=-1), B_w_gate, B_w_up, B_w_down)
    x = x + _A_ref(_layernorm(x, axis=-1), A_mem0, A_Wq, A_Wk, A_Wv, A_Wo, A_seg_len)
    x = x + _B_ref(_layernorm(x, axis=-1), B_w_gate, B_w_up, B_w_down)
    return x
```

```asm
; @launch grid=(256,1,1) block=(256,1,1) lds=163840
.amdgcn_target "amdgcn-amd-amdhsa--gfx950"
.text
.globl interleave_layers__memory_aug_recurrent_mem_tr__glu_gated_bilinear__prompt_kernel
.p2align 8
.type interleave_layers__memory_aug_recurrent_mem_tr__glu_gated_bilinear__prompt_kernel,@function
interleave_layers__memory_aug_recurrent_mem_tr__glu_gated_bilinear__prompt_kernel:
    s_cmp_ge_u32 s2, 256
    s_cbranch_scc1 L_end
    s_load_dwordx2 s[36:37], s[0:1], 104
    s_load_dwordx2 s[38:39], s[0:1], 96
    s_load_dwordx2 s[40:41], s[0:1], 8
    s_getreg_b32 s28, hwreg(HW_REG_XCC_ID, 0, 4)
    v_lshrrev_b32 v2, 6, v0
    v_and_b32 v1, 63, v0
    v_readfirstlane_b32 s30, v2
    s_mov_b32 s33, 0
    s_mov_b32 s34, 0
    s_waitcnt lgkmcnt(0)
    s_mov_b32 s4, s36
    s_and_b32 s5, s37, 0xffff
    s_mov_b32 s6, 0x10000000
    s_mov_b32 s7, 0x20000
    s_mov_b32 s24, s38
    s_and_b32 s25, s39, 0xffff
    s_mov_b32 s26, 0x100
    s_mov_b32 s27, 0x20000
    s_mov_b32 s8, s40
    s_and_b32 s9, s41, 0xffff
    s_mov_b32 s10, 0x2000
    s_mov_b32 s11, 0x20000
    s_mov_b32 s12, s36
    s_and_b32 s13, s37, 0xffff
    s_mov_b32 s14, 0x10000000
    s_mov_b32 s15, 0x20000
    s_mov_b32 s16, s36
    s_and_b32 s17, s37, 0xffff
    s_mov_b32 s18, 0x10000000
    s_mov_b32 s19, 0x20000
    s_mov_b32 s20, s36
    s_and_b32 s21, s37, 0xffff
    s_mov_b32 s22, 0x10000000
    s_mov_b32 s23, 0x20000
    v_mov_b32 v10, 1
    s_lshl_b32 s36, s28, 2
    v_mov_b32 v11, s36
    s_cmp_lg_u32 s30, 0
    s_cbranch_scc1 L_pro_noticket
    v_cmp_eq_u32 vcc, 0, v1
    s_and_saveexec_b64 s[38:39], vcc
    buffer_atomic_add v10, v11, s[24:27], 0 offen sc0
    s_mov_b64 exec, s[38:39]
    s_waitcnt vmcnt(0)
    v_mov_b32 v12, 163824
    v_cmp_eq_u32 vcc, 0, v1
    s_and_saveexec_b64 s[38:39], vcc
    ds_write_b32 v12, v10
    s_waitcnt lgkmcnt(0)
    s_mov_b64 exec, s[38:39]
L_pro_noticket:
    s_barrier
    v_mov_b32 v12, 163824
    ds_read_b32 v10, v12
    s_waitcnt lgkmcnt(0)
    v_readfirstlane_b32 s29, v10
    s_nop 3
    s_barrier
    v_mov_b32 v4, -1
    v_mov_b32 v5, -1
    v_mov_b32 v6, -1
    v_mov_b32 v7, -1
    v_lshlrev_b32 v3, 4, v0
    s_lshl_b32 s36, s2, 12
    s_add_u32 s36, s36, 0x100000
    buffer_store_dwordx4 v[4:7], v3, s[4:7], s36 offen sc1
    s_cmp_ge_u32 s2, 4
    s_cbranch_scc1 L_pro_noflag
    v_mov_b32 v8, 0
    s_cmp_lg_u32 s2, 0
    s_cbranch_scc1 L_pro_fl0
    v_cmp_gt_u32 vcc, 8, v0
    s_nop 1
    v_cndmask_b32 v8, 0, 16, vcc
L_pro_fl0:
    v_lshlrev_b32 v9, 2, v0
    s_lshl_b32 s36, s2, 10
    buffer_store_dword v8, v9, s[4:7], s36 offen sc1
L_pro_noflag:
    v_cmp_gt_u32 vcc, 16, v0
    s_and_saveexec_b64 s[38:39], vcc
    s_cbranch_execz L_pro_mbdone
    s_lshr_b32 s36, s2, 5
    s_and_b32 s36, s36, 3
    s_cmp_lg_u32 s36, 0
    s_cbranch_scc1 L_pro_mbst
    v_and_b32 v8, 7, v0
    v_lshlrev_b32 v8, 10, v8
    v_lshrrev_b32 v9, 3, v0
    v_lshlrev_b32 v9, 4, v9
    v_add_u32 v8, v8, v9
    s_and_b32 s36, s2, 31
    s_lshl_b32 s36, s36, 5
    buffer_load_dwordx4 v[12:15], v8, s[8:11], s36 offen
    s_waitcnt vmcnt(0)
    v_mov_b32 v4, v12
    v_mov_b32 v5, v13
    v_mov_b32 v6, v14
    v_mov_b32 v7, v15
L_pro_mbst:
    s_lshl_b32 s36, s2, 8
    s_add_u32 s36, s36, 0x10000
    buffer_store_dwordx4 v[4:7], v3, s[4:7], s36 offen sc1
L_pro_mbdone:
    s_mov_b64 exec, s[38:39]
    s_cmp_ge_u32 s29, 32
    s_cbranch_scc1 L_end
    s_cmp_ge_u32 s28, 2
    s_cbranch_scc1 L_worker
    s_mov_b32 s32, s28
    s_mov_b32 s31, s29
    s_branch L_chain
L_worker:
    s_sub_u32 s36, s28, 2
    s_lshl_b32 s36, s36, 5
    s_add_u32 s31, s36, s29
    s_cmp_ge_u32 s31, 128
    s_cbranch_scc1 L_no_ln0
    v_mbcnt_lo_u32_b32 v1, -1, 0
    v_mbcnt_hi_u32_b32 v1, -1, v1
    v_lshlrev_b32 v0, 4, v1
    s_mov_b32 s35, 65536
    s_lshl_b32 s36, s28, 5
    s_add_u32 s36, s36, s29
    s_lshl_b32 s36, s36, 2
    s_add_u32 s36, s36, s30
    s_lshl_b32 s36, s36, 5
    s_and_b32 s36, s36, 0x7fff
    s_add_u32 s97, s36, 0x8000
    s_load_dwordx2 s[36:37], s[0:1], 0
    s_waitcnt lgkmcnt(0)
    s_mov_b32 s8, s36
    s_and_b32 s9, s37, 0xffff
    s_mov_b32 s10, 0x200000
    s_mov_b32 s11, 0x20000
    v_and_b32 v9, 15, v1
    v_lshlrev_b32 v9, 10, v9
    v_lshrrev_b32 v5, 4, v1
    v_lshl_add_u32 v9, v5, 4, v9
    s_lshl_b32 s36, s30, 8
    v_add_u32 v9, s36, v9
    v_and_b32 v11, 15, v1
    v_lshlrev_b32 v11, 2, v11
    s_lshl_b32 s36, s30, 6
    v_add_u32 v10, s36, v11
    s_mov_b32 s94, 0x3b000000
    s_lshl_b32 s64, s31, 14
    s_lshl_b32 s37, s30, 12
    s_add_u32 s65, s64, s37
    s_add_u32 s65, s65, 0x200000
    buffer_load_dwordx4 v[16:19], v9, s[8:11], s64 offen offset:0
    buffer_load_dwordx4 v[20:23], v9, s[8:11], s64 offen offset:64
    buffer_load_dwordx4 v[24:27], v9, s[8:11], s64 offen offset:128
    buffer_load_dwordx4 v[28:31], v9, s[8:11], s64 offen offset:192
    s_waitcnt vmcnt(0)
    v_lshlrev_b32 v160, 16, v16
    v_and_b32 v161, 0xffff0000, v16
    v_lshlrev_b32 v162, 16, v17
    v_and_b32 v163, 0xffff0000, v17
    v_lshlrev_b32 v164, 16, v18
    v_and_b32 v165, 0xffff0000, v18
    v_lshlrev_b32 v166, 16, v19
    v_and_b32 v167, 0xffff0000, v19
    v_lshlrev_b32 v168, 16, v20
    v_and_b32 v169, 0xffff0000, v20
    v_lshlrev_b32 v170, 16, v21
    v_and_b32 v171, 0xffff0000, v21
    v_lshlrev_b32 v172, 16, v22
    v_and_b32 v173, 0xffff0000, v22
    v_lshlrev_b32 v174, 16, v23
    v_and_b32 v175, 0xffff0000, v23
    v_lshlrev_b32 v176, 16, v24
    v_and_b32 v177, 0xffff0000, v24
    v_lshlrev_b32 v178, 16, v25
    v_and_b32 v179, 0xffff0000, v25
    v_lshlrev_b32 v180, 16, v26
    v_and_b32 v181, 0xffff0000, v26
    v_lshlrev_b32 v182, 16, v27
    v_and_b32 v183, 0xffff0000, v27
    v_lshlrev_b32 v184, 16, v28
    v_and_b32 v185, 0xffff0000, v28
    v_lshlrev_b32 v186, 16, v29
    v_and_b32 v187, 0xffff0000, v29
    v_lshlrev_b32 v188, 16, v30
    v_and_b32 v189, 0xffff0000, v30
    v_lshlrev_b32 v190, 16, v31
    v_and_b32 v191, 0xffff0000, v31
    v_add_f32 v192, v160, v164
    v_add_f32 v192, v192, v168
    v_add_f32 v192, v192, v172
    v_add_f32 v192, v192, v176
    v_add_f32 v192, v192, v180
    v_add_f32 v192, v192, v184
    v_add_f32 v192, v192, v188
    v_add_f32 v193, v161, v165
    v_add_f32 v193, v193, v169
    v_add_f32 v193, v193, v173
    v_add_f32 v193, v193, v177
    v_add_f32 v193, v193, v181
    v_add_f32 v193, v193, v185
    v_add_f32 v193, v193, v189
    v_add_f32 v194, v162, v166
    v_add_f32 v194, v194, v170
    v_add_f32 v194, v194, v174
    v_add_f32 v194, v194, v178
    v_add_f32 v194, v194, v182
    v_add_f32 v194, v194, v186
    v_add_f32 v194, v194, v190
    v_add_f32 v195, v163, v167
    v_add_f32 v195, v195, v171
    v_add_f32 v195, v195, v175
    v_add_f32 v195, v195, v179
    v_add_f32 v195, v195, v183
    v_add_f32 v195, v195, v187
    v_add_f32 v195, v195, v191
    v_add_f32 v12, v192, v193
    v_add_f32 v12, v12, v194
    v_add_f32 v12, v12, v195
    v_mov_b32 v13, v12
    s_nop 1
    v_permlane32_swap_b32 v12, v13
    v_add_f32 v12, v12, v13
    v_mov_b32 v13, v12
    s_nop 1
    v_permlane16_swap_b32 v12, v13
    v_add_f32 v12, v12, v13
    ds_write_b32 v10, v12 offset:0
    s_waitcnt lgkmcnt(0)
    s_barrier
    ds_read_b32 v12, v11 offset:0
    ds_read_b32 v13, v11 offset:64
    ds_read_b32 v14, v11 offset:128
    ds_read_b32 v15, v11 offset:192
    s_waitcnt lgkmcnt(0)
    v_add_f32 v12, v12, v13
    v_add_f32 v14, v14, v15
    v_add_f32 v12, v12, v14
    v_mul_f32 v12, 0x3b000000, v12
    v_sub_f32 v160, v160, v12
    v_sub_f32 v161, v161, v12
    v_sub_f32 v162, v162, v12
    v_sub_f32 v163, v163, v12
    v_sub_f32 v164, v164, v12
    v_sub_f32 v165, v165, v12
    v_sub_f32 v166, v166, v12
    v_sub_f32 v167, v167, v12
    v_sub_f32 v168, v168, v12
    v_sub_f32 v169, v169, v12
    v_sub_f32 v170, v170, v12
    v_sub_f32 v171, v171, v12
    v_sub_f32 v172, v172, v12
    v_sub_f32 v173, v173, v12
    v_sub_f32 v174, v174, v12
    v_sub_f32 v175, v175, v12
    v_sub_f32 v176, v176, v12
    v_sub_f32 v177, v177, v12
    v_sub_f32 v178, v178, v12
    v_sub_f32 v179, v179, v12
    v_sub_f32 v180, v180, v12
    v_sub_f32 v181, v181, v12
    v_sub_f32 v182, v182, v12
    v_sub_f32 v183, v183, v12
    v_sub_f32 v184, v184, v12
    v_sub_f32 v185, v185, v12
    v_sub_f32 v186, v186, v12
    v_sub_f32 v187, v187, v12
    v_sub_f32 v188, v188, v12
    v_sub_f32 v189, v189, v12
    v_sub_f32 v190, v190, v12
    v_sub_f32 v191, v191, v12
    v_mul_f32 v192, v160, v160
    v_fma_f32 v192, v164, v164, v192
    v_fma_f32 v192, v168, v168, v192
    v_fma_f32 v192, v172, v172, v192
    v_fma_f32 v192, v176, v176, v192
    v_fma_f32 v192, v180, v180, v192
    v_fma_f32 v192, v184, v184, v192
    v_fma_f32 v192, v188, v188, v192
    v_mul_f32 v193, v161, v161
    v_fma_f32 v193, v165, v165, v193
    v_fma_f32 v193, v169, v169, v193
    v_fma_f32 v193, v173, v173, v193
    v_fma_f32 v193, v177, v177, v193
    v_fma_f32 v193, v181, v181, v193
    v_fma_f32 v193, v185, v185, v193
    v_fma_f32 v193, v189, v189, v193
    v_mul_f32 v194, v162, v162
    v_fma_f32 v194, v166, v166, v194
    v_fma_f32 v194, v170, v170, v194
    v_fma_f32 v194, v174, v174, v194
    v_fma_f32 v194, v178, v178, v194
    v_fma_f32 v194, v182, v182, v194
    v_fma_f32 v194, v186, v186, v194
    v_fma_f32 v194, v190, v190, v194
    v_mul_f32 v195, v163, v163
    v_fma_f32 v195, v167, v167, v195
    v_fma_f32 v195, v171, v171, v195
    v_fma_f32 v195, v175, v175, v195
    v_fma_f32 v195, v179, v179, v195
    v_fma_f32 v195, v183, v183, v195
    v_fma_f32 v195, v187, v187, v195
    v_fma_f32 v195, v191, v191, v195
    v_add_f32 v12, v192, v193
    v_add_f32 v12, v12, v194
    v_add_f32 v12, v12, v195
    v_mov_b32 v13, v12
    s_nop 1
    v_permlane32_swap_b32 v12, v13
    v_add_f32 v12, v12, v13
    v_mov_b32 v13, v12
    s_nop 1
    v_permlane16_swap_b32 v12, v13
    v_add_f32 v12, v12, v13
    ds_write_b32 v10, v12 offset:256
    s_waitcnt lgkmcnt(0)
    s_barrier
    ds_read_b32 v12, v11 offset:256
    ds_read_b32 v13, v11 offset:320
    ds_read_b32 v14, v11 offset:384
    ds_read_b32 v15, v11 offset:448
    s_waitcnt lgkmcnt(0)
    v_add_f32 v12, v12, v13
    v_add_f32 v14, v14, v15
    v_add_f32 v12, v12, v14
    v_mov_b32 v13, 0x3727c5ac
    v_fma_f32 v12, v12, s94, v13
    v_rsq_f32 v12, v12
    s_nop 0
    v_mul_f32 v160, v160, v12
    v_mul_f32 v161, v161, v12
    v_mul_f32 v162, v162, v12
    v_mul_f32 v163, v163, v12
    v_mul_f32 v164, v164, v12
    v_mul_f32 v165, v165, v12
    v_mul_f32 v166, v166, v12
    v_mul_f32 v167, v167, v12
    v_mul_f32 v168, v168, v12
    v_mul_f32 v169, v169, v12
    v_mul_f32 v170, v170, v12
    v_mul_f32 v171, v171, v12
    v_mul_f32 v172, v172, v12
    v_mul_f32 v173, v173, v12
    v_mul_f32 v174, v174, v12
    v_mul_f32 v175, v175, v12
    v_mul_f32 v176, v176, v12
    v_mul_f32 v177, v177, v12
    v_mul_f32 v178, v178, v12
    v_mul_f32 v179, v179, v12
    v_mul_f32 v180, v180, v12
    v_mul_f32 v181, v181, v12
    v_mul_f32 v182, v182, v12
    v_mul_f32 v183, v183, v12
    v_mul_f32 v184, v184, v12
    v_mul_f32 v185, v185, v12
    v_mul_f32 v186, v186, v12
    v_mul_f32 v187, v187, v12
    v_mul_f32 v188, v188, v12
    v_mul_f32 v189, v189, v12
    v_mul_f32 v190, v190, v12
    v_mul_f32 v191, v191, v12
    v_cvt_pk_bf16_f32 v32, v160, v161
    v_cvt_pk_bf16_f32 v33, v162, v163
    v_cvt_pk_bf16_f32 v34, v164, v165
    v_cvt_pk_bf16_f32 v35, v166, v167
    buffer_store_dwordx4 v[32:35], v0, s[4:7], s65 offen offset:0 sc1
    v_cvt_pk_bf16_f32 v36, v168, v169
    v_cvt_pk_bf16_f32 v37, v170, v171
    v_cvt_pk_bf16_f32 v38, v172, v173
    v_cvt_pk_bf16_f32 v39, v174, v175
    buffer_store_dwordx4 v[36:39], v0, s[4:7], s65 offen offset:1024 sc1
    v_cvt_pk_bf16_f32 v40, v176, v177
    v_cvt_pk_bf16_f32 v41, v178, v179
    v_cvt_pk_bf16_f32 v42, v180, v181
    v_cvt_pk_bf16_f32 v43, v182, v183
    buffer_store_dwordx4 v[40:43], v0, s[4:7], s65 offen offset:2048 sc1
    v_cvt_pk_bf16_f32 v44, v184, v185
    v_cvt_pk_bf16_f32 v45, v186, v187
    v_cvt_pk_bf16_f32 v46, v188, v189
    v_cvt_pk_bf16_f32 v47, v190, v191
    buffer_store_dwordx4 v[44:47], v0, s[4:7], s65 offen offset:3072 sc1
L_no_ln0:
    s_waitcnt vmcnt(0)
    s_barrier
    s_cmp_lg_u32 s30, 0
    s_cbranch_scc1 L_sd_worker
    v_mov_b32 v13, 1
    v_mov_b32 v14, 32
    s_mov_b64 exec, 1
    buffer_atomic_add v13, v14, s[24:27], 0 offen
    s_mov_b64 exec, -1
L_sd_worker:
    s_cmp_lg_u32 s30, 3
    s_cbranch_scc1 L_tlb_1
    v_mbcnt_lo_u32_b32 v124, -1, 0
    v_mbcnt_hi_u32_b32 v124, -1, v124
    s_and_b32 s36, s29, 31
    s_lshl_b32 s36, s36, 6
    v_add_u32 v124, s36, v124
    v_lshlrev_b32 v124, 17, v124
    buffer_load_dword v125, v124, s[4:7], 0 offen sc1
L_tlb_1:
    s_mov_b32 s99, s31
    s_sub_u32 s31, s99, 0
    s_cmp_lt_u32 s31, 32
    s_cbranch_scc1 L_role_kv
    s_sub_u32 s31, s99, 32
    s_cmp_lt_u32 s31, 32
    s_cbranch_scc1 L_role_q
    s_sub_u32 s31, s99, 64
    s_cmp_lt_u32 s31, 32
    s_cbranch_scc1 L_role_a
    s_sub_u32 s31, s99, 96
    s_cmp_lt_u32 s31, 32
    s_cbranch_scc1 L_role_o
    s_sub_u32 s31, s99, 128
    s_cmp_lt_u32 s31, 28
    s_cbranch_scc1 L_role_f1
    s_sub_u32 s31, s99, 160
    s_cmp_lt_u32 s31, 8
    s_cbranch_scc1 L_role_r1
    s_sub_u32 s31, s99, 168
    s_cmp_lt_u32 s31, 8
    s_cbranch_scc1 L_role_r2
    s_sub_u32 s31, s99, 176
    s_cmp_lt_u32 s31, 16
    s_cbranch_scc1 L_role_f2
    s_branch L_end
L_role_r1:
    v_mbcnt_lo_u32_b32 v1, -1, 0
    v_mbcnt_hi_u32_b32 v1, -1, v1
    v_lshlrev_b32 v0, 4, v1
    s_mov_b32 s35, 65536
    s_lshl_b32 s36, s28, 5
    s_add_u32 s36, s36, s29
    s_lshl_b32 s36, s36, 2
    s_add_u32 s36, s36, s30
    s_lshl_b32 s36, s36, 5
    s_and_b32 s36, s36, 0x7fff
    s_add_u32 s97, s36, 0x8000
    s_load_dwordx2 s[36:37], s[0:1], 0
    s_waitcnt lgkmcnt(0)
    s_mov_b32 s8, s36
    s_and_b32 s9, s37, 0xffff
    s_mov_b32 s10, 0x200000
    s_mov_b32 s11, 0x20000
    s_load_dwordx2 s[36:37], s[0:1], 88
    s_waitcnt lgkmcnt(0)
    s_mov_b32 s12, s36
    s_and_b32 s13, s37, 0xffff
    s_mov_b32 s14, 0x200000
    s_mov_b32 s15, 0x20000
    v_and_b32 v9, 15, v1
    v_lshlrev_b32 v9, 10, v9
    v_lshrrev_b32 v5, 4, v1
    v_lshl_add_u32 v9, v5, 4, v9
    s_lshl_b32 s36, s30, 8
    v_add_u32 v9, s36, v9
    v_and_b32 v11, 15, v1
    v_lshlrev_b32 v11, 2, v11
    s_lshl_b32 s36, s30, 6
    v_add_u32 v10, s36, v11
    s_mov_b32 s94, 0x3b000000
    v_and_b32 v5, 31, v1
    v_lshlrev_b32 v2, 2, v5
    v_lshrrev_b32 v5, 5, v1
    v_lshl_add_u32 v2, v5, 7, v2
    s_mov_b32 s63, 1280
    s_and_b32 s69, s31, 1
    s_cmp_lg_u32 s30, 0
    s_cbranch_scc1 L_pw_ok_idr1
    s_mov_b32 s36, 0
    v_mov_b32 v120, 32
L_pw_idr1:
    buffer_load_dword v121, v120, s[24:27], 0 offen sc1
    s_waitcnt vmcnt(0)
    v_readfirstlane_b32 s37, v121
    s_nop 3
    s_cmp_ge_u32 s37, 256
    s_cbranch_scc1 L_pw_ok_idr1
    s_sleep 4
    s_add_u32 s36, s36, 1
    s_cmp_lt_u32 s36, 65536
    s_cbranch_scc1 L_pw_idr1
    s_mov_b32 s33, 1
L_pw_ok_idr1:
    s_barrier
    s_mov_b32 s41, 0
    s_mov_b32 s42, 0
    s_mov_b32 s70, 0
    s_mov_b32 s71, 0
    s_mov_b32 s72, 0
    s_mov_b32 s51, 163328
    s_bfe_u32 s36, s31, 0x10001
    s_mul_i32 s36, s36, 1280
    s_add_u32 s36, s36, 1280
    s_add_u32 s74, s4, s36
    s_addc_u32 s75, s5, 0
    s_mov_b32 s96, 0
L_r1_top:
    s_add_u32 s36, s41, s42
    s_cmp_ge_u32 s36, 32
    s_cbranch_scc1 L_r1_fin
    s_cmp_lg_u32 s30, 0
    s_cbranch_scc1 L_r1_cwait
    s_mov_b32 s40, 0
L_r1_spin:
    s_mov_b32 s73, 1
    s_load_dwordx16 s[76:91], s[74:75], 0 glc
    s_waitcnt lgkmcnt(0)
    s_cmp_ge_u32 s41, 16
    s_cbranch_scc1 L_r1_p_no0
    s_min_u32 s76, s76, s77
    s_min_u32 s76, s76, s78
    s_min_u32 s76, s76, s79
    s_min_u32 s76, s76, s80
    s_min_u32 s76, s76, s81
    s_min_u32 s76, s76, s82
    s_min_u32 s76, s76, s83
    s_min_u32 s76, s76, s84
    s_min_u32 s76, s76, s85
    s_min_u32 s76, s76, s86
    s_min_u32 s76, s76, s87
    s_min_u32 s76, s76, s88
    s_min_u32 s76, s76, s89
    s_min_u32 s76, s76, s90
    s_min_u32 s76, s76, s91
    s_lshr_b32 s68, s31, 1
    s_lshl_b32 s36, s41, 2
    s_add_u32 s68, s68, s36
    s_lshr_b32 s37, s68, 1
    s_cmp_gt_u32 s76, s37
    s_cbranch_scc1 L_r1_got
L_r1_p_no0:
    s_mov_b32 s73, 2
    s_load_dwordx16 s[76:91], s[74:75], 128 glc
    s_waitcnt lgkmcnt(0)
    s_cmp_ge_u32 s42, 16
    s_cbranch_scc1 L_r1_p_no1
    s_min_u32 s76, s76, s77
    s_min_u32 s76, s76, s78
    s_min_u32 s76, s76, s79
    s_min_u32 s76, s76, s80
    s_min_u32 s76, s76, s81
    s_min_u32 s76, s76, s82
    s_min_u32 s76, s76, s83
    s_min_u32 s76, s76, s84
    s_min_u32 s76, s76, s85
    s_min_u32 s76, s76, s86
    s_min_u32 s76, s76, s87
    s_min_u32 s76, s76, s88
    s_min_u32 s76, s76, s89
    s_min_u32 s76, s76, s90
    s_min_u32 s76, s76, s91
    s_lshr_b32 s68, s31, 1
    s_lshl_b32 s36, s42, 2
    s_add_u32 s68, s68, s36
    s_lshr_b32 s37, s68, 1
    s_cmp_gt_u32 s76, s37
    s_cbranch_scc1 L_r1_got
L_r1_p_no1:
    s_mov_b32 s73, 0
    s_cmp_lg_u32 s70, 0
    s_cbranch_scc1 L_r1_got
    s_add_u32 s40, s40, 1
    s_cmp_lt_u32 s40, s35
    s_cbranch_scc1 L_r1_spin
    s_mov_b32 s73, 3
L_r1_got:
    v_mov_b32 v6, s73
    v_mov_b32 v5, s51
    ds_write_b32 v5, v6
    s_waitcnt lgkmcnt(0)
L_r1_cwait:
    s_barrier
    v_mov_b32 v5, s51
    ds_read_b32 v6, v5
    s_xor_b32 s51, s51, 256
    s_waitcnt lgkmcnt(0)
    v_readfirstlane_b32 s73, v6
    s_nop 3
    s_cmp_eq_u32 s73, 1
    s_cbranch_scc1 L_r1_run0
    s_cmp_eq_u32 s73, 2
    s_cbranch_scc1 L_r1_run1
    s_cmp_eq_u32 s73, 3
    s_cbranch_scc1 L_r1_fin
    s_waitcnt vmcnt(0)
    s_barrier
    s_cmp_eq_u32 s70, 0
    s_cbranch_scc1 L_r1_f_np
    s_cmp_lg_u32 s30, 0
    s_cbranch_scc1 L_r1_f_pw
    s_lshl_b32 s36, s31, 2
    s_add_u32 s36, s36, s71
    v_mov_b32 v5, s72
    v_mov_b32 v6, 0
    s_mov_b64 exec, 1
    buffer_store_dword v5, v6, s[4:7], s36 offen sc1
    s_mov_b64 exec, -1
L_r1_f_pw:
    s_mov_b32 s70, 0
L_r1_f_np:
    s_branch L_r1_top
L_r1_run0:
    s_lshr_b32 s68, s31, 1
    s_lshl_b32 s36, s41, 2
    s_add_u32 s68, s68, s36
    s_mul_i32 s36, s68, 131072
    s_lshl_b32 s37, s69, 14
    s_add_u32 s36, s36, s37
    s_lshl_b32 s37, s30, 12
    s_add_u32 s36, s36, s37
    s_add_u32 s64, s36, 0xc800000
    s_lshl_b32 s36, s68, 15
    s_lshl_b32 s37, s69, 14
    s_add_u32 s65, s36, s37
    s_lshl_b32 s36, s68, 15
    s_lshl_b32 s37, s69, 14
    s_add_u32 s36, s36, s37
    s_lshl_b32 s37, s30, 12
    s_add_u32 s36, s36, s37
    s_add_u32 s66, s36, 0xa00000
    s_lshl_b32 s36, s68, 15
    s_lshl_b32 s37, s69, 14
    s_add_u32 s36, s36, s37
    s_lshl_b32 s37, s30, 12
    s_add_u32 s36, s36, s37
    s_add_u32 s67, s36, 0x600000
    buffer_load_dwordx4 v[16:19], v9, s[8:11], s65 offen offset:0
    buffer_load_dwordx4 v[20:23], v9, s[8:11], s65 offen offset:64
    buffer_load_dwordx4 v[24:27], v9, s[8:11], s65 offen offset:128
    buffer_load_dwordx4 v[28:31], v9, s[8:11], s65 offen offset:192
    s_add_u32 s36, s64, 0
    buffer_load_dwordx4 v[32:35], v0, s[4:7], s36 offen offset:0 sc1
    buffer_load_dwordx4 v[36:39], v0, s[4:7], s36 offen offset:1024 sc1
    buffer_load_dwordx4 v[40:43], v0, s[4:7], s36 offen offset:2048 sc1
    buffer_load_dwordx4 v[44:47], v0, s[4:7], s36 offen offset:3072 sc1
    s_add_u32 s36, s64, 32768
    buffer_load_dwordx4 v[48:51], v0, s[4:7], s36 offen offset:0 sc1
    buffer_load_dwordx4 v[52:55], v0, s[4:7], s36 offen offset:1024 sc1
    buffer_load_dwordx4 v[56:59], v0, s[4:7], s36 offen offset:2048 sc1
    buffer_load_dwordx4 v[60:63], v0, s[4:7], s36 offen offset:3072 sc1
    s_add_u32 s36, s64, 65536
    buffer_load_dwordx4 v[64:67], v0, s[4:7], s36 offen offset:0 sc1
    buffer_load_dwordx4 v[68:71], v0, s[4:7], s36 offen offset:1024 sc1
    buffer_load_dwordx4 v[72:75], v0, s[4:7], s36 offen offset:2048 sc1
    buffer_load_dwordx4 v[76:79], v0, s[4:7], s36 offen offset:3072 sc1
    s_add_u32 s36, s64, 98304
    buffer_load_dwordx4 v[80:83], v0, s[4:7], s36 offen offset:0 sc1
    buffer_load_dwordx4 v[84:87], v0, s[4:7], s36 offen offset:1024 sc1
    buffer_load_dwordx4 v[88:91], v0, s[4:7], s36 offen offset:2048 sc1
    buffer_load_dwordx4 v[92:95], v0, s[4:7], s36 offen offset:3072 sc1
    s_cmp_eq_u32 s70, 0
    s_cbranch_scc1 L_r1_al0
    s_waitcnt vmcnt(20)
    s_barrier
L_r1_al0:
    s_lshl_b32 s36, s31, 2
    s_add_u32 s36, s36, s71
    s_cmp_lg_u32 s70, 0
    s_cselect_b32 s37, 1, 0
    s_cmp_eq_u32 s30, 0
    s_cselect_b32 s37, s37, 0
    v_mov_b32 v5, s72
    v_mov_b32 v6, 0
    s_mov_b64 exec, 1
    s_cmp_eq_u32 s37, 1
    s_cbranch_scc1 L_r1_alp0
    buffer_store_dword v5, v6, s[4:7], s97 offen
    s_branch L_r1_ale0
L_r1_alp0:
    buffer_store_dword v5, v6, s[4:7], s36 offen sc1
L_r1_ale0:
    s_mov_b64 exec, -1
    s_mov_b32 s70, 0
    s_waitcnt vmcnt(17)
    v_lshlrev_b32 v160, 16, v16
    v_and_b32 v161, 0xffff0000, v16
    v_lshlrev_b32 v162, 16, v17
    v_and_b32 v163, 0xffff0000, v17
    v_lshlrev_b32 v164, 16, v18
    v_and_b32 v165, 0xffff0000, v18
    v_lshlrev_b32 v166, 16, v19
    v_and_b32 v167, 0xffff0000, v19
    v_lshlrev_b32 v168, 16, v20
    v_and_b32 v169, 0xffff0000, v20
    v_lshlrev_b32 v170, 16, v21
    v_and_b32 v171, 0xffff0000, v21
    v_lshlrev_b32 v172, 16, v22
    v_and_b32 v173, 0xffff0000, v22
    v_lshlrev_b32 v174, 16, v23
    v_and_b32 v175, 0xffff0000, v23
    v_lshlrev_b32 v176, 16, v24
    v_and_b32 v177, 0xffff0000, v24
    v_lshlrev_b32 v178, 16, v25
    v_and_b32 v179, 0xffff0000, v25
    v_lshlrev_b32 v180, 16, v26
    v_and_b32 v181, 0xffff0000, v26
    v_lshlrev_b32 v182, 16, v27
    v_and_b32 v183, 0xffff0000, v27
    v_lshlrev_b32 v184, 16, v28
    v_and_b32 v185, 0xffff0000, v28
    v_lshlrev_b32 v186, 16, v29
    v_and_b32 v187, 0xffff0000, v29
    v_lshlrev_b32 v188, 16, v30
    v_and_b32 v189, 0xffff0000, v30
    v_lshlrev_b32 v190, 16, v31
    v_and_b32 v191, 0xffff0000, v31
    s_waitcnt vmcnt(13)
    v_lshlrev_b32 v128, 16, v32
    v_and_b32 v129, 0xffff0000, v32
    v_lshlrev_b32 v130, 16, v33
    v_and_b32 v131, 0xffff0000, v33
    v_lshlrev_b32 v132, 16, v34
    v_and_b32 v133, 0xffff0000, v34
    v_lshlrev_b32 v134, 16, v35
    v_and_b32 v135, 0xffff0000, v35
    v_lshlrev_b32 v136, 16, v36
    v_and_b32 v137, 0xffff0000, v36
    v_lshlrev_b32 v138, 16, v37
    v_and_b32 v139, 0xffff0000, v37
    v_lshlrev_b32 v140, 16, v38
    v_and_b32 v141, 0xffff0000, v38
    v_lshlrev_b32 v142, 16, v39
    v_and_b32 v143, 0xffff0000, v39
    v_lshlrev_b32 v144, 16, v40
    v_and_b32 v145, 0xffff0000, v40
    v_lshlrev_b32 v146, 16, v41
    v_and_b32 v147, 0xffff0000, v41
    v_lshlrev_b32 v148, 16, v42
    v_and_b32 v149, 0xffff0000, v42
    v_lshlrev_b32 v150, 16, v43
    v_and_b32 v151, 0xffff0000, v43
    v_lshlrev_b32 v152, 16, v44
    v_and_b32 v153, 0xffff0000, v44
    v_lshlrev_b32 v154, 16, v45
    v_and_b32 v155, 0xffff0000, v45
    v_lshlrev_b32 v156, 16, v46
    v_and_b32 v157, 0xffff0000, v46
    v_lshlrev_b32 v158, 16, v47
    v_and_b32 v159, 0xffff0000, v47
    s_waitcnt vmcnt(9)
    v_lshlrev_b32 v12, 16, v48
    v_and_b32 v13, 0xffff0000, v48
    v_pk_add_f32 v[128:129], v[128:129], v[12:13]
    v_lshlrev_b32 v12, 16, v49
    v_and_b32 v13, 0xffff0000, v49
    v_pk_add_f32 v[130:131], v[130:131], v[12:13]
    v_lshlrev_b32 v12, 16, v50
    v_and_b32 v13, 0xffff0000, v50
    v_pk_add_f32 v[132:133], v[132:133], v[12:13]
    v_lshlrev_b32 v12, 16, v51
    v_and_b32 v13, 0xffff0000, v51
    v_pk_add_f32 v[134:135], v[134:135], v[12:13]
    v_lshlrev_b32 v12, 16, v52
    v_and_b32 v13, 0xffff0000, v52
    v_pk_add_f32 v[136:137], v[136:137], v[12:13]
    v_lshlrev_b32 v12, 16, v53
    v_and_b32 v13, 0xffff0000, v53
    v_pk_add_f32 v[138:139], v[138:139], v[12:13]
    v_lshlrev_b32 v12, 16, v54
    v_and_b32 v13, 0xffff0000, v54
    v_pk_add_f32 v[140:141], v[140:141], v[12:13]
    v_lshlrev_b32 v12, 16, v55
    v_and_b32 v13, 0xffff0000, v55
    v_pk_add_f32 v[142:143], v[142:143], v[12:13]
    v_lshlrev_b32 v12, 16, v56
    v_and_b32 v13, 0xffff0000, v56
    v_pk_add_f32 v[144:145], v[144:145], v[12:13]
    v_lshlrev_b32 v12, 16, v57
    v_and_b32 v13, 0xffff0000, v57
    v_pk_add_f32 v[146:147], v[146:147], v[12:13]
    v_lshlrev_b32 v12, 16, v58
    v_and_b32 v13, 0xffff0000, v58
    v_pk_add_f32 v[148:149], v[148:149], v[12:13]
    v_lshlrev_b32 v12, 16, v59
    v_and_b32 v13, 0xffff0000, v59
    v_pk_add_f32 v[150:151], v[150:151], v[12:13]
    v_lshlrev_b32 v12, 16, v60
    v_and_b32 v13, 0xffff0000, v60
    v_pk_add_f32 v[152:153], v[152:153], v[12:13]
    v_lshlrev_b32 v12, 16, v61
    v_and_b32 v13, 0xffff0000, v61
    v_pk_add_f32 v[154:155], v[154:155], v[12:13]
    v_lshlrev_b32 v12, 16, v62
    v_and_b32 v13, 0xffff0000, v62
    v_pk_add_f32 v[156:157], v[156:157], v[12:13]
    v_lshlrev_b32 v12, 16, v63
    v_and_b32 v13, 0xffff0000, v63
    v_pk_add_f32 v[158:159], v[158:159], v[12:13]
    s_waitcnt vmcnt(5)
    v_lshlrev_b32 v12, 16, v64
    v_and_b32 v13, 0xffff0000, v64
    v_pk_add_f32 v[128:129], v[128:129], v[12:13]
    v_lshlrev_b32 v12, 16, v65
    v_and_b32 v13, 0xffff0000, v65
    v_pk_add_f32 v[130:131], v[130:131], v[12:13]
    v_lshlrev_b32 v12, 16, v66
    v_and_b32 v13, 0xffff0000, v66
    v_pk_add_f32 v[132:133], v[132:133], v[12:13]
    v_lshlrev_b32 v12, 16, v67
    v_and_b32 v13, 0xffff0000, v67
    v_pk_add_f32 v[134:135], v[134:135], v[12:13]
    v_lshlrev_b32 v12, 16, v68
    v_and_b32 v13, 0xffff0000, v68
    v_pk_add_f32 v[136:137], v[136:137], v[12:13]
    v_lshlrev_b32 v12, 16, v69
    v_and_b32 v13, 0xffff0000, v69
    v_pk_add_f32 v[138:139], v[138:139], v[12:13]
    v_lshlrev_b32 v12, 16, v70
    v_and_b32 v13, 0xffff0000, v70
    v_pk_add_f32 v[140:141], v[140:141], v[12:13]
    v_lshlrev_b32 v12, 16, v71
    v_and_b32 v13, 0xffff0000, v71
    v_pk_add_f32 v[142:143], v[142:143], v[12:13]
    v_lshlrev_b32 v12, 16, v72
    v_and_b32 v13, 0xffff0000, v72
    v_pk_add_f32 v[144:145], v[144:145], v[12:13]
    v_lshlrev_b32 v12, 16, v73
    v_and_b32 v13, 0xffff0000, v73
    v_pk_add_f32 v[146:147], v[146:147], v[12:13]
    v_lshlrev_b32 v12, 16, v74
    v_and_b32 v13, 0xffff0000, v74
    v_pk_add_f32 v[148:149], v[148:149], v[12:13]
    v_lshlrev_b32 v12, 16, v75
    v_and_b32 v13, 0xffff0000, v75
    v_pk_add_f32 v[150:151], v[150:151], v[12:13]
    v_lshlrev_b32 v12, 16, v76
    v_and_b32 v13, 0xffff0000, v76
    v_pk_add_f32 v[152:153], v[152:153], v[12:13]
    v_lshlrev_b32 v12, 16, v77
    v_and_b32 v13, 0xffff0000, v77
    v_pk_add_f32 v[154:155], v[154:155], v[12:13]
    v_lshlrev_b32 v12, 16, v78
    v_and_b32 v13, 0xffff0000, v78
    v_pk_add_f32 v[156:157], v[156:157], v[12:13]
    v_lshlrev_b32 v12, 16, v79
    v_and_b32 v13, 0xffff0000, v79
    v_pk_add_f32 v[158:159], v[158:159], v[12:13]
    s_waitcnt vmcnt(1)
    v_lshlrev_b32 v12, 16, v80
    v_and_b32 v13, 0xffff0000, v80
    v_pk_add_f32 v[128:129], v[128:129], v[12:13]
    v_lshlrev_b32 v12, 16, v81
    v_and_b32 v13, 0xffff0000, v81
    v_pk_add_f32 v[130:131], v[130:131], v[12:13]
    v_lshlrev_b32 v12, 16, v82
    v_and_b32 v13, 0xffff0000, v82
    v_pk_add_f32 v[132:133], v[132:133], v[12:13]
    v_lshlrev_b32 v12, 16, v83
    v_and_b32 v13, 0xffff0000, v83
    v_pk_add_f32 v[134:135], v[134:135], v[12:13]
    v_lshlrev_b32 v12, 16, v84
    v_and_b32 v13, 0xffff0000, v84
    v_pk_add_f32 v[136:137], v[136:137], v[12:13]
    v_lshlrev_b32 v12, 16, v85
    v_and_b32 v13, 0xffff0000, v85
    v_pk_add_f32 v[138:139], v[138:139], v[12:13]
    v_lshlrev_b32 v12, 16, v86
    v_and_b32 v13, 0xffff0000, v86
    v_pk_add_f32 v[140:141], v[140:141], v[12:13]
    v_lshlrev_b32 v12, 16, v87
    v_and_b32 v13, 0xffff0000, v87
    v_pk_add_f32 v[142:143], v[142:143], v[12:13]
    v_lshlrev_b32 v12, 16, v88
    v_and_b32 v13, 0xffff0000, v88
    v_pk_add_f32 v[144:145], v[144:145], v[12:13]
    v_lshlrev_b32 v12, 16, v89
    v_and_b32 v13, 0xffff0000, v89
    v_pk_add_f32 v[146:147], v[146:147], v[12:13]
    v_lshlrev_b32 v12, 16, v90
    v_and_b32 v13, 0xffff0000, v90
    v_pk_add_f32 v[148:149], v[148:149], v[12:13]
    v_lshlrev_b32 v12, 16, v91
    v_and_b32 v13, 0xffff0000, v91
    v_pk_add_f32 v[150:151], v[150:151], v[12:13]
    v_lshlrev_b32 v12, 16, v92
    v_and_b32 v13, 0xffff0000, v92
    v_pk_add_f32 v[152:153], v[152:153], v[12:13]
    v_lshlrev_b32 v12, 16, v93
    v_and_b32 v13, 0xffff0000, v93
    v_pk_add_f32 v[154:155], v[154:155], v[12:13]
    v_lshlrev_b32 v12, 16, v94
    v_and_b32 v13, 0xffff0000, v94
    v_pk_add_f32 v[156:157], v[156:157], v[12:13]
    v_lshlrev_b32 v12, 16, v95
    v_and_b32 v13, 0xffff0000, v95
    v_pk_add_f32 v[158:159], v[158:159], v[12:13]
    v_pk_add_f32 v[160:161], v[160:161], v[128:129]
    v_pk_add_f32 v[162:163], v[162:163], v[130:131]
    v_pk_add_f32 v[164:165], v[164:165], v[132:133]
    v_pk_add_f32 v[166:167], v[166:167], v[134:135]
    v_pk_add_f32 v[168:169], v[168:169], v[136:137]
    v_pk_add_f32 v[170:171], v[170:171], v[138:139]
    v_pk_add_f32 v[172:173], v[172:173], v[140:141]
    v_pk_add_f32 v[174:175], v[174:175], v[142:143]
    v_pk_add_f32 v[176:177], v[176:177], v[144:145]
    v_pk_add_f32 v[178:179], v[178:179], v[146:147]
    v_pk_add_f32 v[180:181], v[180:181], v[148:149]
    v_pk_add_f32 v[182:183], v[182:183], v[150:151]
    v_pk_add_f32 v[184:185], v[184:185], v[152:153]
    v_pk_add_f32 v[186:187], v[186:187], v[154:155]
    v_pk_add_f32 v[188:189], v[188:189], v[156:157]
    v_pk_add_f32 v[190:191], v[190:191], v[158:159]
    v_cvt_pk_bf16_f32 v16, v160, v161
    v_cvt_pk_bf16_f32 v17, v162, v163
    v_cvt_pk_bf16_f32 v18, v164, v165
    v_cvt_pk_bf16_f32 v19, v166, v167
    v_cvt_pk_bf16_f32 v20, v168, v169
    v_cvt_pk_bf16_f32 v21, v170, v171
    v_cvt_pk_bf16_f32 v22, v172, v173
    v_cvt_pk_bf16_f32 v23, v174, v175
    v_cvt_pk_bf16_f32 v24, v176, v177
    v_cvt_pk_bf16_f32 v25, v178, v179
    v_cvt_pk_bf16_f32 v26, v180, v181
    v_cvt_pk_bf16_f32 v27, v182, v183
    v_cvt_pk_bf16_f32 v28, v184, v185
    v_cvt_pk_bf16_f32 v29, v186, v187
    v_cvt_pk_bf16_f32 v30, v188, v189
    v_cvt_pk_bf16_f32 v31, v190, v191
    buffer_store_dwordx4 v[16:19], v0, s[4:7], s66 offen offset:0 sc1
    buffer_store_dwordx4 v[20:23], v0, s[4:7], s66 offen offset:1024 sc1
    buffer_store_dwordx4 v[24:27], v0, s[4:7], s66 offen offset:2048 sc1
    buffer_store_dwordx4 v[28:31], v0, s[4:7], s66 offen offset:3072 sc1
    v_lshlrev_b32 v160, 16, v16
    v_and_b32 v161, 0xffff0000, v16
    v_lshlrev_b32 v162, 16, v17
    v_and_b32 v163, 0xffff0000, v17
    v_lshlrev_b32 v164, 16, v18
    v_and_b32 v165, 0xffff0000, v18
    v_lshlrev_b32 v166, 16, v19
    v_and_b32 v167, 0xffff0000, v19
    v_lshlrev_b32 v168, 16, v20
    v_and_b32 v169, 0xffff0000, v20
    v_lshlrev_b32 v170, 16, v21
    v_and_b32 v171, 0xffff0000, v21
    v_lshlrev_b32 v172, 16, v22
    v_and_b32 v173, 0xffff0000, v22
    v_lshlrev_b32 v174, 16, v23
    v_and_b32 v175, 0xffff0000, v23
    v_lshlrev_b32 v176, 16, v24
    v_and_b32 v177, 0xffff0000, v24
    v_lshlrev_b32 v178, 16, v25
    v_and_b32 v179, 0xffff0000, v25
    v_lshlrev_b32 v180, 16, v26
    v_and_b32 v181, 0xffff0000, v26
    v_lshlrev_b32 v182, 16, v27
    v_and_b32 v183, 0xffff0000, v27
    v_lshlrev_b32 v184, 16, v28
    v_and_b32 v185, 0xffff0000, v28
    v_lshlrev_b32 v186, 16, v29
    v_and_b32 v187, 0xffff0000, v29
    v_lshlrev_b32 v188, 16, v30
    v_and_b32 v189, 0xffff0000, v30
    v_lshlrev_b32 v190, 16, v31
    v_and_b32 v191, 0xffff0000, v31
    v_add_f32 v192, v160, v164
    v_add_f32 v192, v192, v168
    v_add_f32 v192, v192, v172
    v_add_f32 v192, v192, v176
    v_add_f32 v192, v192, v180
    v_add_f32 v192, v192, v184
    v_add_f32 v192, v192, v188
    v_add_f32 v193, v161, v165
    v_add_f32 v193, v193, v169
    v_add_f32 v193, v193, v173
    v_add_f32 v193, v193, v177
    v_add_f32 v193, v193, v181
    v_add_f32 v193, v193, v185
    v_add_f32 v193, v193, v189
    v_add_f32 v194, v162, v166
    v_add_f32 v194, v194, v170
    v_add_f32 v194, v194, v174
    v_add_f32 v194, v194, v178
    v_add_f32 v194, v194, v182
    v_add_f32 v194, v194, v186
    v_add_f32 v194, v194, v190
    v_add_f32 v195, v163, v167
    v_add_f32 v195, v195, v171
    v_add_f32 v195, v195, v175
    v_add_f32 v195, v195, v179
    v_add_f32 v195, v195, v183
    v_add_f32 v195, v195, v187
    v_add_f32 v195, v195, v191
    v_add_f32 v12, v192, v193
    v_add_f32 v12, v12, v194
    v_add_f32 v12, v12, v195
    v_mov_b32 v13, v12
    s_nop 1
    v_permlane32_swap_b32 v12, v13
    v_add_f32 v12, v12, v13
    v_mov_b32 v13, v12
    s_nop 1
    v_permlane16_swap_b32 v12, v13
    v_add_f32 v12, v12, v13
    ds_write_b32 v10, v12 offset:0
    s_waitcnt lgkmcnt(0)
    s_barrier
    ds_read_b32 v12, v11 offset:0
    ds_read_b32 v13, v11 offset:64
    ds_read_b32 v14, v11 offset:128
    ds_read_b32 v15, v11 offset:192
    s_waitcnt lgkmcnt(0)
    v_add_f32 v12, v12, v13
    v_add_f32 v14, v14, v15
    v_add_f32 v12, v12, v14
    v_mul_f32 v12, 0x3b000000, v12
    v_sub_f32 v160, v160, v12
    v_sub_f32 v161, v161, v12
    v_sub_f32 v162, v162, v12
    v_sub_f32 v163, v163, v12
    v_sub_f32 v164, v164, v12
    v_sub_f32 v165, v165, v12
    v_sub_f32 v166, v166, v12
    v_sub_f32 v167, v167, v12
    v_sub_f32 v168, v168, v12
    v_sub_f32 v169, v169, v12
    v_sub_f32 v170, v170, v12
    v_sub_f32 v171, v171, v12
    v_sub_f32 v172, v172, v12
    v_sub_f32 v173, v173, v12
    v_sub_f32 v174, v174, v12
    v_sub_f32 v175, v175, v12
    v_sub_f32 v176, v176, v12
    v_sub_f32 v177, v177, v12
    v_sub_f32 v178, v178, v12
    v_sub_f32 v179, v179, v12
    v_sub_f32 v180, v180, v12
    v_sub_f32 v181, v181, v12
    v_sub_f32 v182, v182, v12
    v_sub_f32 v183, v183, v12
    v_sub_f32 v184, v184, v12
    v_sub_f32 v185, v185, v12
    v_sub_f32 v186, v186, v12
    v_sub_f32 v187, v187, v12
    v_sub_f32 v188, v188, v12
    v_sub_f32 v189, v189, v12
    v_sub_f32 v190, v190, v12
    v_sub_f32 v191, v191, v12
    v_mul_f32 v192, v160, v160
    v_fma_f32 v192, v164, v164, v192
    v_fma_f32 v192, v168, v168, v192
    v_fma_f32 v192, v172, v172, v192
    v_fma_f32 v192, v176, v176, v192
    v_fma_f32 v192, v180, v180, v192
    v_fma_f32 v192, v184, v184, v192
    v_fma_f32 v192, v188, v188, v192
    v_mul_f32 v193, v161, v161
    v_fma_f32 v193, v165, v165, v193
    v_fma_f32 v193, v169, v169, v193
    v_fma_f32 v193, v173, v173, v193
    v_fma_f32 v193, v177, v177, v193
    v_fma_f32 v193, v181, v181, v193
    v_fma_f32 v193, v185, v185, v193
    v_fma_f32 v193, v189, v189, v193
    v_mul_f32 v194, v162, v162
    v_fma_f32 v194, v166, v166, v194
    v_fma_f32 v194, v170, v170, v194
    v_fma_f32 v194, v174, v174, v194
    v_fma_f32 v194, v178, v178, v194
    v_fma_f32 v194, v182, v182, v194
    v_fma_f32 v194, v186, v186, v194
    v_fma_f32 v194, v190, v190, v194
    v_mul_f32 v195, v163, v163
    v_fma_f32 v195, v167, v167, v195
    v_fma_f32 v195, v171, v171, v195
    v_fma_f32 v195, v175, v175, v195
    v_fma_f32 v195, v179, v179, v195
    v_fma_f32 v195, v183, v183, v195
    v_fma_f32 v195, v187, v187, v195
    v_fma_f32 v195, v191, v191, v195
    v_add_f32 v12, v192, v193
    v_add_f32 v12, v12, v194
    v_add_f32 v12, v12, v195
    v_mov_b32 v13, v12
    s_nop 1
    v_permlane32_swap_b32 v12, v13
    v_add_f32 v12, v12, v13
    v_mov_b32 v13, v12
    s_nop 1
    v_permlane16_swap_b32 v12, v13
    v_add_f32 v12, v12, v13
    ds_write_b32 v10, v12 offset:256
    s_waitcnt lgkmcnt(0)
    s_barrier
    ds_read_b32 v12, v11 offset:256
    ds_read_b32 v13, v11 offset:320
    ds_read_b32 v14, v11 offset:384
    ds_read_b32 v15, v11 offset:448
    s_waitcnt lgkmcnt(0)
    v_add_f32 v12, v12, v13
    v_add_f32 v14, v14, v15
    v_add_f32 v12, v12, v14
    v_mov_b32 v13, 0x3727c5ac
    v_fma_f32 v12, v12, s94, v13
    v_rsq_f32 v12, v12
    s_nop 0
    v_mul_f32 v160, v160, v12
    v_mul_f32 v161, v161, v12
    v_mul_f32 v162, v162, v12
    v_mul_f32 v163, v163, v12
    v_mul_f32 v164, v164, v12
    v_mul_f32 v165, v165, v12
    v_mul_f32 v166, v166, v12
    v_mul_f32 v167, v167, v12
    v_mul_f32 v168, v168, v12
    v_mul_f32 v169, v169, v12
    v_mul_f32 v170, v170, v12
    v_mul_f32 v171, v171, v12
    v_mul_f32 v172, v172, v12
    v_mul_f32 v173, v173, v12
    v_mul_f32 v174, v174, v12
    v_mul_f32 v175, v175, v12
    v_mul_f32 v176, v176, v12
    v_mul_f32 v177, v177, v12
    v_mul_f32 v178, v178, v12
    v_mul_f32 v179, v179, v12
    v_mul_f32 v180, v180, v12
    v_mul_f32 v181, v181, v12
    v_mul_f32 v182, v182, v12
    v_mul_f32 v183, v183, v12
    v_mul_f32 v184, v184, v12
    v_mul_f32 v185, v185, v12
    v_mul_f32 v186, v186, v12
    v_mul_f32 v187, v187, v12
    v_mul_f32 v188, v188, v12
    v_mul_f32 v189, v189, v12
    v_mul_f32 v190, v190, v12
    v_mul_f32 v191, v191, v12
    v_cvt_pk_bf16_f32 v32, v160, v161
    v_cvt_pk_bf16_f32 v33, v162, v163
    v_cvt_pk_bf16_f32 v34, v164, v165
    v_cvt_pk_bf16_f32 v35, v166, v167
    buffer_store_dwordx4 v[32:35], v0, s[4:7], s67 offen offset:0 sc1
    v_cvt_pk_bf16_f32 v36, v168, v169
    v_cvt_pk_bf16_f32 v37, v170, v171
    v_cvt_pk_bf16_f32 v38, v172, v173
    v_cvt_pk_bf16_f32 v39, v174, v175
    buffer_store_dwordx4 v[36:39], v0, s[4:7], s67 offen offset:1024 sc1
    v_cvt_pk_bf16_f32 v40, v176, v177
    v_cvt_pk_bf16_f32 v41, v178, v179
    v_cvt_pk_bf16_f32 v42, v180, v181
    v_cvt_pk_bf16_f32 v43, v182, v183
    buffer_store_dwordx4 v[40:43], v0, s[4:7], s67 offen offset:2048 sc1
    v_cvt_pk_bf16_f32 v44, v184, v185
    v_cvt_pk_bf16_f32 v45, v186, v187
    v_cvt_pk_bf16_f32 v46, v188, v189
    v_cvt_pk_bf16_f32 v47, v190, v191
    buffer_store_dwordx4 v[44:47], v0, s[4:7], s67 offen offset:3072 sc1
    s_add_u32 s41, s41, 1
    s_mov_b32 s71, 1536
    s_mov_b32 s72, s41
    s_mov_b32 s70, 1
    s_branch L_r1_top
L_r1_run1:
    s_lshr_b32 s68, s31, 1
    s_lshl_b32 s36, s42, 2
    s_add_u32 s68, s68, s36
    s_mul_i32 s36, s68, 131072
    s_lshl_b32 s37, s69, 14
    s_add_u32 s36, s36, s37
    s_lshl_b32 s37, s30, 12
    s_add_u32 s36, s36, s37
    s_add_u32 s64, s36, 0xd800000
    s_lshl_b32 s36, s68, 15
    s_lshl_b32 s37, s69, 14
    s_add_u32 s36, s36, s37
    s_lshl_b32 s37, s30, 12
    s_add_u32 s36, s36, s37
    s_add_u32 s65, s36, 0xc00000
    s_lshl_b32 s36, s68, 15
    s_lshl_b32 s37, s69, 14
    s_add_u32 s36, s36, s37
    s_lshl_b32 s37, s30, 12
    s_add_u32 s36, s36, s37
    s_add_u32 s66, s36, 0xe00000
    s_lshl_b32 s36, s68, 15
    s_lshl_b32 s37, s69, 14
    s_add_u32 s36, s36, s37
    s_lshl_b32 s37, s30, 12
    s_add_u32 s36, s36, s37
    s_add_u32 s67, s36, 0x800000
    buffer_load_dwordx4 v[16:19], v0, s[4:7], s65 offen offset:0 sc1
    buffer_load_dwordx4 v[20:23], v0, s[4:7], s65 offen offset:1024 sc1
    buffer_load_dwordx4 v[24:27], v0, s[4:7], s65 offen offset:2048 sc1
    buffer_load_dwordx4 v[28:31], v0, s[4:7], s65 offen offset:3072 sc1
    s_add_u32 s36, s64, 0
    buffer_load_dwordx4 v[32:35], v0, s[4:7], s36 offen offset:0 sc1
    buffer_load_dwordx4 v[36:39], v0, s[4:7], s36 offen offset:1024 sc1
    buffer_load_dwordx4 v[40:43], v0, s[4:7], s36 offen offset:2048 sc1
    buffer_load_dwordx4 v[44:47], v0, s[4:7], s36 offen offset:3072 sc1
    s_add_u32 s36, s64, 32768
    buffer_load_dwordx4 v[48:51], v0, s[4:7], s36 offen offset:0 sc1
    buffer_load_dwordx4 v[52:55], v0, s[4:7], s36 offen offset:1024 sc1
    buffer_load_dwordx4 v[56:59], v0, s[4:7], s36 offen offset:2048 sc1
    buffer_load_dwordx4 v[60:63], v0, s[4:7], s36 offen offset:3072 sc1
    s_add_u32 s36, s64, 65536
    buffer_load_dwordx4 v[64:67], v0, s[4:7], s36 offen offset:0 sc1
    buffer_load_dwordx4 v[68:71], v0, s[4:7], s36 offen offset:1024 sc1
    buffer_load_dwordx4 v[72:75], v0, s[4:7], s36 offen offset:2048 sc1
    buffer_load_dwordx4 v[76:79], v0, s[4:7], s36 offen offset:3072 sc1
    s_add_u32 s36, s64, 98304
    buffer_load_dwordx4 v[80:83], v0, s[4:7], s36 offen offset:0 sc1
    buffer_load_dwordx4 v[84:87], v0, s[4:7], s36 offen offset:1024 sc1
    buffer_load_dwordx4 v[88:91], v0, s[4:7], s36 offen offset:2048 sc1
    buffer_load_dwordx4 v[92:95], v0, s[4:7], s36 offen offset:3072 sc1
    s_cmp_eq_u32 s70, 0
    s_cbranch_scc1 L_r1_al1
    s_waitcnt vmcnt(20)
    s_barrier
L_r1_al1:
    s_lshl_b32 s36, s31, 2
    s_add_u32 s36, s36, s71
    s_cmp_lg_u32 s70, 0
    s_cselect_b32 s37, 1, 0
    s_cmp_eq_u32 s30, 0
    s_cselect_b32 s37, s37, 0
    v_mov_b32 v5, s72
    v_mov_b32 v6, 0
    s_mov_b64 exec, 1
    s_cmp_eq_u32 s37, 1
    s_cbranch_scc1 L_r1_alp1
    buffer_store_dword v5, v6, s[4:7], s97 offen
    s_branch L_r1_ale1
L_r1_alp1:
    buffer_store_dword v5, v6, s[4:7], s36 offen sc1
L_r1_ale1:
    s_mov_b64 exec, -1
    s_mov_b32 s70, 0
    s_waitcnt vmcnt(17)
    v_lshlrev_b32 v160, 16, v16
    v_and_b32 v161, 0xffff0000, v16
    v_lshlrev_b32 v162, 16, v17
    v_and_b32 v163, 0xffff0000, v17
    v_lshlrev_b32 v164, 16, v18
    v_and_b32 v165, 0xffff0000, v18
    v_lshlrev_b32 v166, 16, v19
    v_and_b32 v167, 0xffff0000, v19
    v_lshlrev_b32 v168, 16, v20
    v_and_b32 v169, 0xffff0000, v20
    v_lshlrev_b32 v170, 16, v21
    v_and_b32 v171, 0xffff0000, v21
    v_lshlrev_b32 v172, 16, v22
    v_and_b32 v173, 0xffff0000, v22
    v_lshlrev_b32 v174, 16, v23
    v_and_b32 v175, 0xffff0000, v23
    v_lshlrev_b32 v176, 16, v24
    v_and_b32 v177, 0xffff0000, v24
    v_lshlrev_b32 v178, 16, v25
    v_and_b32 v179, 0xffff0000, v25
    v_lshlrev_b32 v180, 16, v26
    v_and_b32 v181, 0xffff0000, v26
    v_lshlrev_b32 v182, 16, v27
    v_and_b32 v183, 0xffff0000, v27
    v_lshlrev_b32 v184, 16, v28
    v_and_b32 v185, 0xffff0000, v28
    v_lshlrev_b32 v186, 16, v29
    v_and_b32 v187, 0xffff0000, v29
    v_lshlrev_b32 v188, 16, v30
    v_and_b32 v189, 0xffff0000, v30
    v_lshlrev_b32 v190, 16, v31
    v_and_b32 v191, 0xffff0000, v31
    s_waitcnt vmcnt(13)
    v_lshlrev_b32 v128, 16, v32
    v_and_b32 v129, 0xffff0000, v32
    v_lshlrev_b32 v130, 16, v33
    v_and_b32 v131, 0xffff0000, v33
    v_lshlrev_b32 v132, 16, v34
    v_and_b32 v133, 0xffff0000, v34
    v_lshlrev_b32 v134, 16, v35
    v_and_b32 v135, 0xffff0000, v35
    v_lshlrev_b32 v136, 16, v36
    v_and_b32 v137, 0xffff0000, v36
    v_lshlrev_b32 v138, 16, v37
    v_and_b32 v139, 0xffff0000, v37
    v_lshlrev_b32 v140, 16, v38
    v_and_b32 v141, 0xffff0000, v38
    v_lshlrev_b32 v142, 16, v39
    v_and_b32 v143, 0xffff0000, v39
    v_lshlrev_b32 v144, 16, v40
    v_and_b32 v145, 0xffff0000, v40
    v_lshlrev_b32 v146, 16, v41
    v_and_b32 v147, 0xffff0000, v41
    v_lshlrev_b32 v148, 16, v42
    v_and_b32 v149, 0xffff0000, v42
    v_lshlrev_b32 v150, 16, v43
    v_and_b32 v151, 0xffff0000, v43
    v_lshlrev_b32 v152, 16, v44
    v_and_b32 v153, 0xffff0000, v44
    v_lshlrev_b32 v154, 16, v45
    v_and_b32 v155, 0xffff0000, v45
    v_lshlrev_b32 v156, 16, v46
    v_and_b32 v157, 0xffff0000, v46
    v_lshlrev_b32 v158, 16, v47
    v_and_b32 v159, 0xffff0000, v47
    s_waitcnt vmcnt(9)
    v_lshlrev_b32 v12, 16, v48
    v_and_b32 v13, 0xffff0000, v48
    v_pk_add_f32 v[128:129], v[128:129], v[12:13]
    v_lshlrev_b32 v12, 16, v49
    v_and_b32 v13, 0xffff0000, v49
    v_pk_add_f32 v[130:131], v[130:131], v[12:13]
    v_lshlrev_b32 v12, 16, v50
    v_and_b32 v13, 0xffff0000, v50
    v_pk_add_f32 v[132:133], v[132:133], v[12:13]
    v_lshlrev_b32 v12, 16, v51
    v_and_b32 v13, 0xffff0000, v51
    v_pk_add_f32 v[134:135], v[134:135], v[12:13]
    v_lshlrev_b32 v12, 16, v52
    v_and_b32 v13, 0xffff0000, v52
    v_pk_add_f32 v[136:137], v[136:137], v[12:13]
    v_lshlrev_b32 v12, 16, v53
    v_and_b32 v13, 0xffff0000, v53
    v_pk_add_f32 v[138:139], v[138:139], v[12:13]
    v_lshlrev_b32 v12, 16, v54
    v_and_b32 v13, 0xffff0000, v54
    v_pk_add_f32 v[140:141], v[140:141], v[12:13]
    v_lshlrev_b32 v12, 16, v55
    v_and_b32 v13, 0xffff0000, v55
    v_pk_add_f32 v[142:143], v[142:143], v[12:13]
    v_lshlrev_b32 v12, 16, v56
    v_and_b32 v13, 0xffff0000, v56
    v_pk_add_f32 v[144:145], v[144:145], v[12:13]
    v_lshlrev_b32 v12, 16, v57
    v_and_b32 v13, 0xffff0000, v57
    v_pk_add_f32 v[146:147], v[146:147], v[12:13]
    v_lshlrev_b32 v12, 16, v58
    v_and_b32 v13, 0xffff0000, v58
    v_pk_add_f32 v[148:149], v[148:149], v[12:13]
    v_lshlrev_b32 v12, 16, v59
    v_and_b32 v13, 0xffff0000, v59
    v_pk_add_f32 v[150:151], v[150:151], v[12:13]
    v_lshlrev_b32 v12, 16, v60
    v_and_b32 v13, 0xffff0000, v60
    v_pk_add_f32 v[152:153], v[152:153], v[12:13]
    v_lshlrev_b32 v12, 16, v61
    v_and_b32 v13, 0xffff0000, v61
    v_pk_add_f32 v[154:155], v[154:155], v[12:13]
    v_lshlrev_b32 v12, 16, v62
    v_and_b32 v13, 0xffff0000, v62
    v_pk_add_f32 v[156:157], v[156:157], v[12:13]
    v_lshlrev_b32 v12, 16, v63
    v_and_b32 v13, 0xffff0000, v63
    v_pk_add_f32 v[158:159], v[158:159], v[12:13]
    s_waitcnt vmcnt(5)
    v_lshlrev_b32 v12, 16, v64
    v_and_b32 v13, 0xffff0000, v64
    v_pk_add_f32 v[128:129], v[128:129], v[12:13]
    v_lshlrev_b32 v12, 16, v65
    v_and_b32 v13, 0xffff0000, v65
    v_pk_add_f32 v[130:131], v[130:131], v[12:13]
    v_lshlrev_b32 v12, 16, v66
    v_and_b32 v13, 0xffff0000, v66
    v_pk_add_f32 v[132:133], v[132:133], v[12:13]
    v_lshlrev_b32 v12, 16, v67
    v_and_b32 v13, 0xffff0000, v67
    v_pk_add_f32 v[134:135], v[134:135], v[12:13]
    v_lshlrev_b32 v12, 16, v68
    v_and_b32 v13, 0xffff0000, v68
    v_pk_add_f32 v[136:137], v[136:137], v[12:13]
    v_lshlrev_b32 v12, 16, v69
    v_and_b32 v13, 0xffff0000, v69
    v_pk_add_f32 v[138:139], v[138:139], v[12:13]
    v_lshlrev_b32 v12, 16, v70
    v_and_b32 v13, 0xffff0000, v70
    v_pk_add_f32 v[140:141], v[140:141], v[12:13]
    v_lshlrev_b32 v12, 16, v71
    v_and_b32 v13, 0xffff0000, v71
    v_pk_add_f32 v[142:143], v[142:143], v[12:13]
    v_lshlrev_b32 v12, 16, v72
    v_and_b32 v13, 0xffff0000, v72
    v_pk_add_f32 v[144:145], v[144:145], v[12:13]
    v_lshlrev_b32 v12, 16, v73
    v_and_b32 v13, 0xffff0000, v73
    v_pk_add_f32 v[146:147], v[146:147], v[12:13]
    v_lshlrev_b32 v12, 16, v74
    v_and_b32 v13, 0xffff0000, v74
    v_pk_add_f32 v[148:149], v[148:149], v[12:13]
    v_lshlrev_b32 v12, 16, v75
    v_and_b32 v13, 0xffff0000, v75
    v_pk_add_f32 v[150:151], v[150:151], v[12:13]
    v_lshlrev_b32 v12, 16, v76
    v_and_b32 v13, 0xffff0000, v76
    v_pk_add_f32 v[152:153], v[152:153], v[12:13]
    v_lshlrev_b32 v12, 16, v77
    v_and_b32 v13, 0xffff0000, v77
    v_pk_add_f32 v[154:155], v[154:155], v[12:13]
    v_lshlrev_b32 v12, 16, v78
    v_and_b32 v13, 0xffff0000, v78
    v_pk_add_f32 v[156:157], v[156:157], v[12:13]
    v_lshlrev_b32 v12, 16, v79
    v_and_b32 v13, 0xffff0000, v79
    v_pk_add_f32 v[158:159], v[158:159], v[12:13]
    s_waitcnt vmcnt(1)
    v_lshlrev_b32 v12, 16, v80
    v_and_b32 v13, 0xffff0000, v80
    v_pk_add_f32 v[128:129], v[128:129], v[12:13]
    v_lshlrev_b32 v12, 16, v81
    v_and_b32 v13, 0xffff0000, v81
    v_pk_add_f32 v[130:131], v[130:131], v[12:13]
    v_lshlrev_b32 v12, 16, v82
    v_and_b32 v13, 0xffff0000, v82
    v_pk_add_f32 v[132:133], v[132:133], v[12:13]
    v_lshlrev_b32 v12, 16, v83
    v_and_b32 v13, 0xffff0000, v83
    v_pk_add_f32 v[134:135], v[134:135], v[12:13]
    v_lshlrev_b32 v12, 16, v84
    v_and_b32 v13, 0xffff0000, v84
    v_pk_add_f32 v[136:137], v[136:137], v[12:13]
    v_lshlrev_b32 v12, 16, v85
    v_and_b32 v13, 0xffff0000, v85
    v_pk_add_f32 v[138:139], v[138:139], v[12:13]
    v_lshlrev_b32 v12, 16, v86
    v_and_b32 v13, 0xffff0000, v86
    v_pk_add_f32 v[140:141], v[140:141], v[12:13]
    v_lshlrev_b32 v12, 16, v87
    v_and_b32 v13, 0xffff0000, v87
    v_pk_add_f32 v[142:143], v[142:143], v[12:13]
    v_lshlrev_b32 v12, 16, v88
    v_and_b32 v13, 0xffff0000, v88
    v_pk_add_f32 v[144:145], v[144:145], v[12:13]
    v_lshlrev_b32 v12, 16, v89
    v_and_b32 v13, 0xffff0000, v89
    v_pk_add_f32 v[146:147], v[146:147], v[12:13]
    v_lshlrev_b32 v12, 16, v90
    v_and_b32 v13, 0xffff0000, v90
    v_pk_add_f32 v[148:149], v[148:149], v[12:13]
    v_lshlrev_b32 v12, 16, v91
    v_and_b32 v13, 0xffff0000, v91
    v_pk_add_f32 v[150:151], v[150:151], v[12:13]
    v_lshlrev_b32 v12, 16, v92
    v_and_b32 v13, 0xffff0000, v92
    v_pk_add_f32 v[152:153], v[152:153], v[12:13]
    v_lshlrev_b32 v12, 16, v93
    v_and_b32 v13, 0xffff0000, v93
    v_pk_add_f32 v[154:155], v[154:155], v[12:13]
    v_lshlrev_b32 v12, 16, v94
    v_and_b32 v13, 0xffff0000, v94
    v_pk_add_f32 v[156:157], v[156:157], v[12:13]
    v_lshlrev_b32 v12, 16, v95
    v_and_b32 v13, 0xffff0000, v95
    v_pk_add_f32 v[158:159], v[158:159], v[12:13]
    v_pk_add_f32 v[160:161], v[160:161], v[128:129]
    v_pk_add_f32 v[162:163], v[162:163], v[130:131]
    v_pk_add_f32 v[164:165], v[164:165], v[132:133]
    v_pk_add_f32 v[166:167], v[166:167], v[134:135]
    v_pk_add_f32 v[168:169], v[168:169], v[136:137]
    v_pk_add_f32 v[170:171], v[170:171], v[138:139]
    v_pk_add_f32 v[172:173], v[172:173], v[140:141]
    v_pk_add_f32 v[174:175], v[174:175], v[142:143]
    v_pk_add_f32 v[176:177], v[176:177], v[144:145]
    v_pk_add_f32 v[178:179], v[178:179], v[146:147]
    v_pk_add_f32 v[180:181], v[180:181], v[148:149]
    v_pk_add_f32 v[182:183], v[182:183], v[150:151]
    v_pk_add_f32 v[184:185], v[184:185], v[152:153]
    v_pk_add_f32 v[186:187], v[186:187], v[154:155]
    v_pk_add_f32 v[188:189], v[188:189], v[156:157]
    v_pk_add_f32 v[190:191], v[190:191], v[158:159]
    v_cvt_pk_bf16_f32 v16, v160, v161
    v_cvt_pk_bf16_f32 v17, v162, v163
    v_cvt_pk_bf16_f32 v18, v164, v165
    v_cvt_pk_bf16_f32 v19, v166, v167
    v_cvt_pk_bf16_f32 v20, v168, v169
    v_cvt_pk_bf16_f32 v21, v170, v171
    v_cvt_pk_bf16_f32 v22, v172, v173
    v_cvt_pk_bf16_f32 v23, v174, v175
    v_cvt_pk_bf16_f32 v24, v176, v177
    v_cvt_pk_bf16_f32 v25, v178, v179
    v_cvt_pk_bf16_f32 v26, v180, v181
    v_cvt_pk_bf16_f32 v27, v182, v183
    v_cvt_pk_bf16_f32 v28, v184, v185
    v_cvt_pk_bf16_f32 v29, v186, v187
    v_cvt_pk_bf16_f32 v30, v188, v189
    v_cvt_pk_bf16_f32 v31, v190, v191
    buffer_store_dwordx4 v[16:19], v0, s[4:7], s66 offen offset:0 sc1
    buffer_store_dwordx4 v[20:23], v0, s[4:7], s66 offen offset:1024 sc1
    buffer_store_dwordx4 v[24:27], v0, s[4:7], s66 offen offset:2048 sc1
    buffer_store_dwordx4 v[28:31], v0, s[4:7], s66 offen offset:3072 sc1
    v_lshlrev_b32 v160, 16, v16
    v_and_b32 v161, 0xffff0000, v16
    v_lshlrev_b32 v162, 16, v17
    v_and_b32 v163, 0xffff0000, v17
    v_lshlrev_b32 v164, 16, v18
    v_and_b32 v165, 0xffff0000, v18
    v_lshlrev_b32 v166, 16, v19
    v_and_b32 v167, 0xffff0000, v19
    v_lshlrev_b32 v168, 16, v20
    v_and_b32 v169, 0xffff0000, v20
    v_lshlrev_b32 v170, 16, v21
    v_and_b32 v171, 0xffff0000, v21
    v_lshlrev_b32 v172, 16, v22
    v_and_b32 v173, 0xffff0000, v22
    v_lshlrev_b32 v174, 16, v23
    v_and_b32 v175, 0xffff0000, v23
    v_lshlrev_b32 v176, 16, v24
    v_and_b32 v177, 0xffff0000, v24
    v_lshlrev_b32 v178, 16, v25
    v_and_b32 v179, 0xffff0000, v25
    v_lshlrev_b32 v180, 16, v26
    v_and_b32 v181, 0xffff0000, v26
    v_lshlrev_b32 v182, 16, v27
    v_and_b32 v183, 0xffff0000, v27
    v_lshlrev_b32 v184, 16, v28
    v_and_b32 v185, 0xffff0000, v28
    v_lshlrev_b32 v186, 16, v29
    v_and_b32 v187, 0xffff0000, v29
    v_lshlrev_b32 v188, 16, v30
    v_and_b32 v189, 0xffff0000, v30
    v_lshlrev_b32 v190, 16, v31
    v_and_b32 v191, 0xffff0000, v31
    v_add_f32 v192, v160, v164
    v_add_f32 v192, v192, v168
    v_add_f32 v192, v192, v172
    v_add_f32 v192, v192, v176
    v_add_f32 v192, v192, v180
    v_add_f32 v192, v192, v184
    v_add_f32 v192, v192, v188
    v_add_f32 v193, v161, v165
    v_add_f32 v193, v193, v169
    v_add_f32 v193, v193, v173
    v_add_f32 v193, v193, v177
    v_add_f32 v193, v193, v181
    v_add_f32 v193, v193, v185
    v_add_f32 v193, v193, v189
    v_add_f32 v194, v162, v166
    v_add_f32 v194, v194, v170
    v_add_f32 v194, v194, v174
    v_add_f32 v194, v194, v178
    v_add_f32 v194, v194, v182
    v_add_f32 v194, v194, v186
    v_add_f32 v194, v194, v190
    v_add_f32 v195, v163, v167
    v_add_f32 v195, v195, v171
    v_add_f32 v195, v195, v175
    v_add_f32 v195, v195, v179
    v_add_f32 v195, v195, v183
    v_add_f32 v195, v195, v187
    v_add_f32 v195, v195, v191
    v_add_f32 v12, v192, v193
    v_add_f32 v12, v12, v194
    v_add_f32 v12, v12, v195
    v_mov_b32 v13, v12
    s_nop 1
    v_permlane32_swap_b32 v12, v13
    v_add_f32 v12, v12, v13
    v_mov_b32 v13, v12
    s_nop 1
    v_permlane16_swap_b32 v12, v13
    v_add_f32 v12, v12, v13
    ds_write_b32 v10, v12 offset:0
    s_waitcnt lgkmcnt(0)
    s_barrier
    ds_read_b32 v12, v11 offset:0
    ds_read_b32 v13, v11 offset:64
    ds_read_b32 v14, v11 offset:128
    ds_read_b32 v15, v11 offset:192
    s_waitcnt lgkmcnt(0)
    v_add_f32 v12, v12, v13
    v_add_f32 v14, v14, v15
    v_add_f32 v12, v12, v14
    v_mul_f32 v12, 0x3b000000, v12
    v_sub_f32 v160, v160, v12
    v_sub_f32 v161, v161, v12
    v_sub_f32 v162, v162, v12
    v_sub_f32 v163, v163, v12
    v_sub_f32 v164, v164, v12
    v_sub_f32 v165, v165, v12
    v_sub_f32 v166, v166, v12
    v_sub_f32 v167, v167, v12
    v_sub_f32 v168, v168, v12
    v_sub_f32 v169, v169, v12
    v_sub_f32 v170, v170, v12
    v_sub_f32 v171, v171, v12
    v_sub_f32 v172, v172, v12
    v_sub_f32 v173, v173, v12
    v_sub_f32 v174, v174, v12
    v_sub_f32 v175, v175, v12
    v_sub_f32 v176, v176, v12
    v_sub_f32 v177, v177, v12
    v_sub_f32 v178, v178, v12
    v_sub_f32 v179, v179, v12
    v_sub_f32 v180, v180, v12
    v_sub_f32 v181, v181, v12
    v_sub_f32 v182, v182, v12
    v_sub_f32 v183, v183, v12
    v_sub_f32 v184, v184, v12
    v_sub_f32 v185, v185, v12
    v_sub_f32 v186, v186, v12
    v_sub_f32 v187, v187, v12
    v_sub_f32 v188, v188, v12
    v_sub_f32 v189, v189, v12
    v_sub_f32 v190, v190, v12
    v_sub_f32 v191, v191, v12
    v_mul_f32 v192, v160, v160
    v_fma_f32 v192, v164, v164, v192
    v_fma_f32 v192, v168, v168, v192
    v_fma_f32 v192, v172, v172, v192
    v_fma_f32 v192, v176, v176, v192
    v_fma_f32 v192, v180, v180, v192
    v_fma_f32 v192, v184, v184, v192
    v_fma_f32 v192, v188, v188, v192
    v_mul_f32 v193, v161, v161
    v_fma_f32 v193, v165, v165, v193
    v_fma_f32 v193, v169, v169, v193
    v_fma_f32 v193, v173, v173, v193
    v_fma_f32 v193, v177, v177, v193
    v_fma_f32 v193, v181, v181, v193
    v_fma_f32 v193, v185, v185, v193
    v_fma_f32 v193, v189, v189, v193
    v_mul_f32 v194, v162, v162
    v_fma_f32 v194, v166, v166, v194
    v_fma_f32 v194, v170, v170, v194
    v_fma_f32 v194, v174, v174, v194
    v_fma_f32 v194, v178, v178, v194
    v_fma_f32 v194, v182, v182, v194
    v_fma_f32 v194, v186, v186, v194
    v_fma_f32 v194, v190, v190, v194
    v_mul_f32 v195, v163, v163
    v_fma_f32 v195, v167, v167, v195
    v_fma_f32 v195, v171, v171, v195
    v_fma_f32 v195, v175, v175, v195
    v_fma_f32 v195, v179, v179, v195
    v_fma_f32 v195, v183, v183, v195
    v_fma_f32 v195, v187, v187, v195
    v_fma_f32 v195, v191, v191, v195
    v_add_f32 v12, v192, v193
    v_add_f32 v12, v12, v194
    v_add_f32 v12, v12, v195
    v_mov_b32 v13, v12
    s_nop 1
    v_permlane32_swap_b32 v12, v13
    v_add_f32 v12, v12, v13
    v_mov_b32 v13, v12
    s_nop 1
    v_permlane16_swap_b32 v12, v13
    v_add_f32 v12, v12, v13
    ds_write_b32 v10, v12 offset:256
    s_waitcnt lgkmcnt(0)
    s_barrier
    ds_read_b32 v12, v11 offset:256
    ds_read_b32 v13, v11 offset:320
    ds_read_b32 v14, v11 offset:384
    ds_read_b32 v15, v11 offset:448
    s_waitcnt lgkmcnt(0)
    v_add_f32 v12, v12, v13
    v_add_f32 v14, v14, v15
    v_add_f32 v12, v12, v14
    v_mov_b32 v13, 0x3727c5ac
    v_fma_f32 v12, v12, s94, v13
    v_rsq_f32 v12, v12
    s_nop 0
    v_mul_f32 v160, v160, v12
    v_mul_f32 v161, v161, v12
    v_mul_f32 v162, v162, v12
    v_mul_f32 v163, v163, v12
    v_mul_f32 v164, v164, v12
    v_mul_f32 v165, v165, v12
    v_mul_f32 v166, v166, v12
    v_mul_f32 v167, v167, v12
    v_mul_f32 v168, v168, v12
    v_mul_f32 v169, v169, v12
    v_mul_f32 v170, v170, v12
    v_mul_f32 v171, v171, v12
    v_mul_f32 v172, v172, v12
    v_mul_f32 v173, v173, v12
    v_mul_f32 v174, v174, v12
    v_mul_f32 v175, v175, v12
    v_mul_f32 v176, v176, v12
    v_mul_f32 v177, v177, v12
    v_mul_f32 v178, v178, v12
    v_mul_f32 v179, v179, v12
    v_mul_f32 v180, v180, v12
    v_mul_f32 v181, v181, v12
    v_mul_f32 v182, v182, v12
    v_mul_f32 v183, v183, v12
    v_mul_f32 v184, v184, v12
    v_mul_f32 v185, v185, v12
    v_mul_f32 v186, v186, v12
    v_mul_f32 v187, v187, v12
    v_mul_f32 v188, v188, v12
    v_mul_f32 v189, v189, v12
    v_mul_f32 v190, v190, v12
    v_mul_f32 v191, v191, v12
    v_cvt_pk_bf16_f32 v32, v160, v161
    v_cvt_pk_bf16_f32 v33, v162, v163
    v_cvt_pk_bf16_f32 v34, v164, v165
    v_cvt_pk_bf16_f32 v35, v166, v167
    buffer_store_dwordx4 v[32:35], v0, s[4:7], s67 offen offset:0 sc1
    v_cvt_pk_bf16_f32 v36, v168, v169
    v_cvt_pk_bf16_f32 v37, v170, v171
    v_cvt_pk_bf16_f32 v38, v172, v173
    v_cvt_pk_bf16_f32 v39, v174, v175
    buffer_store_dwordx4 v[36:39], v0, s[4:7], s67 offen offset:1024 sc1
    v_cvt_pk_bf16_f32 v40, v176, v177
    v_cvt_pk_bf16_f32 v41, v178, v179
    v_cvt_pk_bf16_f32 v42, v180, v181
    v_cvt_pk_bf16_f32 v43, v182, v183
    buffer_store_dwordx4 v[40:43], v0, s[4:7], s67 offen offset:2048 sc1
    v_cvt_pk_bf16_f32 v44, v184, v185
    v_cvt_pk_bf16_f32 v45, v186, v187
    v_cvt_pk_bf16_f32 v46, v188, v189
    v_cvt_pk_bf16_f32 v47, v190, v191
    buffer_store_dwordx4 v[44:47], v0, s[4:7], s67 offen offset:3072 sc1
    s_add_u32 s42, s42, 1
    s_mov_b32 s71, 1664
    s_mov_b32 s72, s42
    s_mov_b32 s70, 1
    s_branch L_r1_top
L_r1_fin:
    s_waitcnt vmcnt(0)
    s_barrier
    s_cmp_eq_u32 s70, 0
    s_cbranch_scc1 L_r1_e_np
    s_cmp_lg_u32 s30, 0
    s_cbranch_scc1 L_r1_e_pw
    s_lshl_b32 s36, s31, 2
    s_add_u32 s36, s36, s71
    v_mov_b32 v5, s72
    v_mov_b32 v6, 0
    s_mov_b64 exec, 1
    buffer_store_dword v5, v6, s[4:7], s36 offen sc1
    s_mov_b64 exec, -1
L_r1_e_pw:
    s_mov_b32 s70, 0
L_r1_e_np:
    s_waitcnt vmcnt(0)
    s_branch L_end
L_role_r2:
    v_mbcnt_lo_u32_b32 v1, -1, 0
    v_mbcnt_hi_u32_b32 v1, -1, v1
    v_lshlrev_b32 v0, 4, v1
    s_mov_b32 s35, 65536
    s_lshl_b32 s36, s28, 5
    s_add_u32 s36, s36, s29
    s_lshl_b32 s36, s36, 2
    s_add_u32 s36, s36, s30
    s_lshl_b32 s36, s36, 5
    s_and_b32 s36, s36, 0x7fff
    s_add_u32 s97, s36, 0x8000
    s_load_dwordx2 s[36:37], s[0:1], 0
    s_waitcnt lgkmcnt(0)
    s_mov_b32 s8, s36
    s_and_b32 s9, s37, 0xffff
    s_mov_b32 s10, 0x200000
    s_mov_b32 s11, 0x20000
    s_load_dwordx2 s[36:37], s[0:1], 88
    s_waitcnt lgkmcnt(0)
    s_mov_b32 s12, s36
    s_and_b32 s13, s37, 0xffff
    s_mov_b32 s14, 0x200000
    s_mov_b32 s15, 0x20000
    v_and_b32 v9, 15, v1
    v_lshlrev_b32 v9, 10, v9
    v_lshrrev_b32 v5, 4, v1
    v_lshl_add_u32 v9, v5, 4, v9
    s_lshl_b32 s36, s30, 8
    v_add_u32 v9, s36, v9
    v_and_b32 v11, 15, v1
    v_lshlrev_b32 v11, 2, v11
    s_lshl_b32 s36, s30, 6
    v_add_u32 v10, s36, v11
    s_mov_b32 s94, 0x3b000000
    v_and_b32 v5, 31, v1
    v_lshlrev_b32 v2, 2, v5
    v_lshrrev_b32 v5, 5, v1
    v_lshl_add_u32 v2, v5, 7, v2
    s_mov_b32 s63, 2048
    s_and_b32 s69, s31, 1
    s_cmp_lg_u32 s30, 0
    s_cbranch_scc1 L_pw_ok_idr2
    s_mov_b32 s36, 0
    v_mov_b32 v120, 32
L_pw_idr2:
    buffer_load_dword v121, v120, s[24:27], 0 offen sc1
    s_waitcnt vmcnt(0)
    v_readfirstlane_b32 s37, v121
    s_nop 3
    s_cmp_ge_u32 s37, 256
    s_cbranch_scc1 L_pw_ok_idr2
    s_sleep 4
    s_add_u32 s36, s36, 1
    s_cmp_lt_u32 s36, 65536
    s_cbranch_scc1 L_pw_idr2
    s_mov_b32 s33, 1
L_pw_ok_idr2:
    s_barrier
    s_mov_b32 s41, 0
    s_mov_b32 s42, 0
    s_mov_b32 s70, 0
    s_mov_b32 s71, 0
    s_mov_b32 s72, 0
    s_mov_b32 s51, 163328
    s_bfe_u32 s36, s31, 0x10001
    s_mul_i32 s36, s36, 768
    s_add_u32 s36, s36, 2048
    s_add_u32 s74, s4, s36
    s_addc_u32 s75, s5, 0
    s_mov_b32 s96, 0
L_r2_top:
    s_add_u32 s36, s41, s42
    s_cmp_ge_u32 s36, 32
    s_cbranch_scc1 L_r2_fin
    s_cmp_lg_u32 s30, 0
    s_cbranch_scc1 L_r2_cwait
    s_mov_b32 s40, 0
L_r2_spin:
    s_mov_b32 s73, 1
    s_load_dwordx8 s[76:83], s[74:75], 0 glc
    s_waitcnt lgkmcnt(0)
    s_cmp_ge_u32 s41, 16
    s_cbranch_scc1 L_r2_p_no0
    s_min_u32 s76, s76, s77
    s_min_u32 s76, s76, s78
    s_min_u32 s76, s76, s79
    s_min_u32 s76, s76, s80
    s_min_u32 s76, s76, s81
    s_min_u32 s76, s76, s82
    s_min_u32 s76, s76, s83
    s_lshr_b32 s68, s31, 1
    s_lshl_b32 s36, s41, 2
    s_add_u32 s68, s68, s36
    s_lshr_b32 s37, s68, 1
    s_cmp_gt_u32 s76, s37
    s_cbranch_scc1 L_r2_got
L_r2_p_no0:
    s_mov_b32 s73, 2
    s_load_dwordx8 s[76:83], s[74:75], 128 glc
    s_waitcnt lgkmcnt(0)
    s_cmp_ge_u32 s42, 16
    s_cbranch_scc1 L_r2_p_no1
    s_min_u32 s76, s76, s77
    s_min_u32 s76, s76, s78
    s_min_u32 s76, s76, s79
    s_min_u32 s76, s76, s80
    s_min_u32 s76, s76, s81
    s_min_u32 s76, s76, s82
    s_min_u32 s76, s76, s83
    s_lshr_b32 s68, s31, 1
    s_lshl_b32 s36, s42, 2
    s_add_u32 s68, s68, s36
    s_lshr_b32 s37, s68, 1
    s_cmp_gt_u32 s76, s37
    s_cbranch_scc1 L_r2_got
L_r2_p_no1:
    s_mov_b32 s73, 0
    s_cmp_lg_u32 s70, 0
    s_cbranch_scc1 L_r2_got
    s_add_u32 s40, s40, 1
    s_cmp_lt_u32 s40, s35
    s_cbranch_scc1 L_r2_spin
    s_mov_b32 s73, 3
L_r2_got:
    v_mov_b32 v6, s73
    v_mov_b32 v5, s51
    ds_write_b32 v5, v6
    s_waitcnt lgkmcnt(0)
L_r2_cwait:
    s_barrier
    v_mov_b32 v5, s51
    ds_read_b32 v6, v5
    s_xor_b32 s51, s51, 256
    s_waitcnt lgkmcnt(0)
    v_readfirstlane_b32 s73, v6
    s_nop 3
    s_cmp_eq_u32 s73, 1
    s_cbranch_scc1 L_r2_run0
    s_cmp_eq_u32 s73, 2
    s_cbranch_scc1 L_r2_run1
    s_cmp_eq_u32 s73, 3
    s_cbranch_scc1 L_r2_fin
    s_waitcnt vmcnt(0)
    s_barrier
    s_cmp_eq_u32 s70, 0
    s_cbranch_scc1 L_r2_f_np
    s_cmp_lg_u32 s30, 0
    s_cbranch_scc1 L_r2_f_pw
    s_lshl_b32 s36, s31, 2
    s_add_u32 s36, s36, s71
    v_mov_b32 v5, s72
    v_mov_b32 v6, 0
    s_mov_b64 exec, 1
    buffer_store_dword v5, v6, s[4:7], s36 offen sc1
    s_mov_b64 exec, -1
L_r2_f_pw:
    s_mov_b32 s70, 0
L_r2_f_np:
    s_branch L_r2_top
L_r2_run0:
    s_lshr_b32 s68, s31, 1
    s_lshl_b32 s36, s41, 2
    s_add_u32 s68, s68, s36
    s_mul_i32 s36, s68, 65536
    s_lshl_b32 s37, s69, 14
    s_add_u32 s36, s36, s37
    s_lshl_b32 s37, s30, 12
    s_add_u32 s36, s36, s37
    s_add_u32 s64, s36, 0x9800000
    s_lshl_b32 s36, s68, 15
    s_lshl_b32 s37, s69, 14
    s_add_u32 s36, s36, s37
    s_lshl_b32 s37, s30, 12
    s_add_u32 s36, s36, s37
    s_add_u32 s65, s36, 0xa00000
    s_lshl_b32 s36, s68, 15
    s_lshl_b32 s37, s69, 14
    s_add_u32 s36, s36, s37
    s_lshl_b32 s37, s30, 12
    s_add_u32 s36, s36, s37
    s_add_u32 s66, s36, 0xc00000
    s_lshl_b32 s36, s68, 15
    s_lshl_b32 s37, s69, 14
    s_add_u32 s36, s36, s37
    s_lshl_b32 s37, s30, 12
    s_add_u32 s36, s36, s37
    s_add_u32 s67, s36, 0x400000
    buffer_load_dwordx4 v[16:19], v0, s[4:7], s65 offen offset:0 sc1
    buffer_load_dwordx4 v[20:23], v0, s[4:7], s65 offen offset:1024 sc1
    buffer_load_dwordx4 v[24:27], v0, s[4:7], s65 offen offset:2048 sc1
    buffer_load_dwordx4 v[28:31], v0, s[4:7], s65 offen offset:3072 sc1
    s_add_u32 s36, s64, 0
    buffer_load_dwordx4 v[32:35], v0, s[4:7], s36 offen offset:0 sc1
    buffer_load_dwordx4 v[36:39], v0, s[4:7], s36 offen offset:1024 sc1
    buffer_load_dwordx4 v[40:43], v0, s[4:7], s36 offen offset:2048 sc1
    buffer_load_dwordx4 v[44:47], v0, s[4:7], s36 offen offset:3072 sc1
    s_add_u32 s36, s64, 32768
    buffer_load_dwordx4 v[48:51], v0, s[4:7], s36 offen offset:0 sc1
    buffer_load_dwordx4 v[52:55], v0, s[4:7], s36 offen offset:1024 sc1
    buffer_load_dwordx4 v[56:59], v0, s[4:7], s36 offen offset:2048 sc1
    buffer_load_dwordx4 v[60:63], v0, s[4:7], s36 offen offset:3072 sc1
    s_cmp_eq_u32 s70, 0
    s_cbranch_scc1 L_r2_al0
    s_waitcnt vmcnt(12)
    s_barrier
L_r2_al0:
    s_lshl_b32 s36, s31, 2
    s_add_u32 s36, s36, s71
    s_cmp_lg_u32 s70, 0
    s_cselect_b32 s37, 1, 0
    s_cmp_eq_u32 s30, 0
    s_cselect_b32 s37, s37, 0
    v_mov_b32 v5, s72
    v_mov_b32 v6, 0
    s_mov_b64 exec, 1
    s_cmp_eq_u32 s37, 1
    s_cbranch_scc1 L_r2_alp0
    buffer_store_dword v5, v6, s[4:7], s97 offen
    s_branch L_r2_ale0
L_r2_alp0:
    buffer_store_dword v5, v6, s[4:7], s36 offen sc1
L_r2_ale0:
    s_mov_b64 exec, -1
    s_mov_b32 s70, 0
    s_waitcnt vmcnt(9)
    v_lshlrev_b32 v160, 16, v16
    v_and_b32 v161, 0xffff0000, v16
    v_lshlrev_b32 v162, 16, v17
    v_and_b32 v163, 0xffff0000, v17
    v_lshlrev_b32 v164, 16, v18
    v_and_b32 v165, 0xffff0000, v18
    v_lshlrev_b32 v166, 16, v19
    v_and_b32 v167, 0xffff0000, v19
    v_lshlrev_b32 v168, 16, v20
    v_and_b32 v169, 0xffff0000, v20
    v_lshlrev_b32 v170, 16, v21
    v_and_b32 v171, 0xffff0000, v21
    v_lshlrev_b32 v172, 16, v22
    v_and_b32 v173, 0xffff0000, v22
    v_lshlrev_b32 v174, 16, v23
    v_and_b32 v175, 0xffff0000, v23
    v_lshlrev_b32 v176, 16, v24
    v_and_b32 v177, 0xffff0000, v24
    v_lshlrev_b32 v178, 16, v25
    v_and_b32 v179, 0xffff0000, v25
    v_lshlrev_b32 v180, 16, v26
    v_and_b32 v181, 0xffff0000, v26
    v_lshlrev_b32 v182, 16, v27
    v_and_b32 v183, 0xffff0000, v27
    v_lshlrev_b32 v184, 16, v28
    v_and_b32 v185, 0xffff0000, v28
    v_lshlrev_b32 v186, 16, v29
    v_and_b32 v187, 0xffff0000, v29
    v_lshlrev_b32 v188, 16, v30
    v_and_b32 v189, 0xffff0000, v30
    v_lshlrev_b32 v190, 16, v31
    v_and_b32 v191, 0xffff0000, v31
    s_waitcnt vmcnt(5)
    v_lshlrev_b32 v128, 16, v32
    v_and_b32 v129, 0xffff0000, v32
    v_lshlrev_b32 v130, 16, v33
    v_and_b32 v131, 0xffff0000, v33
    v_lshlrev_b32 v132, 16, v34
    v_and_b32 v133, 0xffff0000, v34
    v_lshlrev_b32 v134, 16, v35
    v_and_b32 v135, 0xffff0000, v35
    v_lshlrev_b32 v136, 16, v36
    v_and_b32 v137, 0xffff0000, v36
    v_lshlrev_b32 v138, 16, v37
    v_and_b32 v139, 0xffff0000, v37
    v_lshlrev_b32 v140, 16, v38
    v_and_b32 v141, 0xffff0000, v38
    v_lshlrev_b32 v142, 16, v39
    v_and_b32 v143, 0xffff0000, v39
    v_lshlrev_b32 v144, 16, v40
    v_and_b32 v145, 0xffff0000, v40
    v_lshlrev_b32 v146, 16, v41
    v_and_b32 v147, 0xffff0000, v41
    v_lshlrev_b32 v148, 16, v42
    v_and_b32 v149, 0xffff0000, v42
    v_lshlrev_b32 v150, 16, v43
    v_and_b32 v151, 0xffff0000, v43
    v_lshlrev_b32 v152, 16, v44
    v_and_b32 v153, 0xffff0000, v44
    v_lshlrev_b32 v154, 16, v45
    v_and_b32 v155, 0xffff0000, v45
    v_lshlrev_b32 v156, 16, v46
    v_and_b32 v157, 0xffff0000, v46
    v_lshlrev_b32 v158, 16, v47
    v_and_b32 v159, 0xffff0000, v47
    s_waitcnt vmcnt(1)
    v_lshlrev_b32 v12, 16, v48
    v_and_b32 v13, 0xffff0000, v48
    v_pk_add_f32 v[128:129], v[128:129], v[12:13]
    v_lshlrev_b32 v12, 16, v49
    v_and_b32 v13, 0xffff0000, v49
    v_pk_add_f32 v[130:131], v[130:131], v[12:13]
    v_lshlrev_b32 v12, 16, v50
    v_and_b32 v13, 0xffff0000, v50
    v_pk_add_f32 v[132:133], v[132:133], v[12:13]
    v_lshlrev_b32 v12, 16, v51
    v_and_b32 v13, 0xffff0000, v51
    v_pk_add_f32 v[134:135], v[134:135], v[12:13]
    v_lshlrev_b32 v12, 16, v52
    v_and_b32 v13, 0xffff0000, v52
    v_pk_add_f32 v[136:137], v[136:137], v[12:13]
    v_lshlrev_b32 v12, 16, v53
    v_and_b32 v13, 0xffff0000, v53
    v_pk_add_f32 v[138:139], v[138:139], v[12:13]
    v_lshlrev_b32 v12, 16, v54
    v_and_b32 v13, 0xffff0000, v54
    v_pk_add_f32 v[140:141], v[140:141], v[12:13]
    v_lshlrev_b32 v12, 16, v55
    v_and_b32 v13, 0xffff0000, v55
    v_pk_add_f32 v[142:143], v[142:143], v[12:13]
    v_lshlrev_b32 v12, 16, v56
    v_and_b32 v13, 0xffff0000, v56
    v_pk_add_f32 v[144:145], v[144:145], v[12:13]
    v_lshlrev_b32 v12, 16, v57
    v_and_b32 v13, 0xffff0000, v57
    v_pk_add_f32 v[146:147], v[146:147], v[12:13]
    v_lshlrev_b32 v12, 16, v58
    v_and_b32 v13, 0xffff0000, v58
    v_pk_add_f32 v[148:149], v[148:149], v[12:13]
    v_lshlrev_b32 v12, 16, v59
    v_and_b32 v13, 0xffff0000, v59
    v_pk_add_f32 v[150:151], v[150:151], v[12:13]
    v_lshlrev_b32 v12, 16, v60
    v_and_b32 v13, 0xffff0000, v60
    v_pk_add_f32 v[152:153], v[152:153], v[12:13]
    v_lshlrev_b32 v12, 16, v61
    v_and_b32 v13, 0xffff0000, v61
    v_pk_add_f32 v[154:155], v[154:155], v[12:13]
    v_lshlrev_b32 v12, 16, v62
    v_and_b32 v13, 0xffff0000, v62
    v_pk_add_f32 v[156:157], v[156:157], v[12:13]
    v_lshlrev_b32 v12, 16, v63
    v_and_b32 v13, 0xffff0000, v63
    v_pk_add_f32 v[158:159], v[158:159], v[12:13]
    v_pk_add_f32 v[160:161], v[160:161], v[128:129]
    v_pk_add_f32 v[162:163], v[162:163], v[130:131]
    v_pk_add_f32 v[164:165], v[164:165], v[132:133]
    v_pk_add_f32 v[166:167], v[166:167], v[134:135]
    v_pk_add_f32 v[168:169], v[168:169], v[136:137]
    v_pk_add_f32 v[170:171], v[170:171], v[138:139]
    v_pk_add_f32 v[172:173], v[172:173], v[140:141]
    v_pk_add_f32 v[174:175], v[174:175], v[142:143]
    v_pk_add_f32 v[176:177], v[176:177], v[144:145]
    v_pk_add_f32 v[178:179], v[178:179], v[146:147]
    v_pk_add_f32 v[180:181], v[180:181], v[148:149]
    v_pk_add_f32 v[182:183], v[182:183], v[150:151]
    v_pk_add_f32 v[184:185], v[184:185], v[152:153]
    v_pk_add_f32 v[186:187], v[186:187], v[154:155]
    v_pk_add_f32 v[188:189], v[188:189], v[156:157]
    v_pk_add_f32 v[190:191], v[190:191], v[158:159]
    v_cvt_pk_bf16_f32 v16, v160, v161
    v_cvt_pk_bf16_f32 v17, v162, v163
    v_cvt_pk_bf16_f32 v18, v164, v165
    v_cvt_pk_bf16_f32 v19, v166, v167
    v_cvt_pk_bf16_f32 v20, v168, v169
    v_cvt_pk_bf16_f32 v21, v170, v171
    v_cvt_pk_bf16_f32 v22, v172, v173
    v_cvt_pk_bf16_f32 v23, v174, v175
    v_cvt_pk_bf16_f32 v24, v176, v177
    v_cvt_pk_bf16_f32 v25, v178, v179
    v_cvt_pk_bf16_f32 v26, v180, v181
    v_cvt_pk_bf16_f32 v27, v182, v183
    v_cvt_pk_bf16_f32 v28, v184, v185
    v_cvt_pk_bf16_f32 v29, v186, v187
    v_cvt_pk_bf16_f32 v30, v188, v189
    v_cvt_pk_bf16_f32 v31, v190, v191
    buffer_store_dwordx4 v[16:19], v0, s[4:7], s66 offen offset:0 sc1
    buffer_store_dwordx4 v[20:23], v0, s[4:7], s66 offen offset:1024 sc1
    buffer_store_dwordx4 v[24:27], v0, s[4:7], s66 offen offset:2048 sc1
    buffer_store_dwordx4 v[28:31], v0, s[4:7], s66 offen offset:3072 sc1
    v_lshlrev_b32 v160, 16, v16
    v_and_b32 v161, 0xffff0000, v16
    v_lshlrev_b32 v162, 16, v17
    v_and_b32 v163, 0xffff0000, v17
    v_lshlrev_b32 v164, 16, v18
    v_and_b32 v165, 0xffff0000, v18
    v_lshlrev_b32 v166, 16, v19
    v_and_b32 v167, 0xffff0000, v19
    v_lshlrev_b32 v168, 16, v20
    v_and_b32 v169, 0xffff0000, v20
    v_lshlrev_b32 v170, 16, v21
    v_and_b32 v171, 0xffff0000, v21
    v_lshlrev_b32 v172, 16, v22
    v_and_b32 v173, 0xffff0000, v22
    v_lshlrev_b32 v174, 16, v23
    v_and_b32 v175, 0xffff0000, v23
    v_lshlrev_b32 v176, 16, v24
    v_and_b32 v177, 0xffff0000, v24
    v_lshlrev_b32 v178, 16, v25
    v_and_b32 v179, 0xffff0000, v25
    v_lshlrev_b32 v180, 16, v26
    v_and_b32 v181, 0xffff0000, v26
    v_lshlrev_b32 v182, 16, v27
    v_and_b32 v183, 0xffff0000, v27
    v_lshlrev_b32 v184, 16, v28
    v_and_b32 v185, 0xffff0000, v28
    v_lshlrev_b32 v186, 16, v29
    v_and_b32 v187, 0xffff0000, v29
    v_lshlrev_b32 v188, 16, v30
    v_and_b32 v189, 0xffff0000, v30
    v_lshlrev_b32 v190, 16, v31
    v_and_b32 v191, 0xffff0000, v31
    v_add_f32 v192, v160, v164
    v_add_f32 v192, v192, v168
    v_add_f32 v192, v192, v172
    v_add_f32 v192, v192, v176
    v_add_f32 v192, v192, v180
    v_add_f32 v192, v192, v184
    v_add_f32 v192, v192, v188
    v_add_f32 v193, v161, v165
    v_add_f32 v193, v193, v169
    v_add_f32 v193, v193, v173
    v_add_f32 v193, v193, v177
    v_add_f32 v193, v193, v181
    v_add_f32 v193, v193, v185
    v_add_f32 v193, v193, v189
    v_add_f32 v194, v162, v166
    v_add_f32 v194, v194, v170
    v_add_f32 v194, v194, v174
    v_add_f32 v194, v194, v178
    v_add_f32 v194, v194, v182
    v_add_f32 v194, v194, v186
    v_add_f32 v194, v194, v190
    v_add_f32 v195, v163, v167
    v_add_f32 v195, v195, v171
    v_add_f32 v195, v195, v175
    v_add_f32 v195, v195, v179
    v_add_f32 v195, v195, v183
    v_add_f32 v195, v195, v187
    v_add_f32 v195, v195, v191
    v_add_f32 v12, v192, v193
    v_add_f32 v12, v12, v194
    v_add_f32 v12, v12, v195
    v_mov_b32 v13, v12
    s_nop 1
    v_permlane32_swap_b32 v12, v13
    v_add_f32 v12, v12, v13
    v_mov_b32 v13, v12
    s_nop 1
    v_permlane16_swap_b32 v12, v13
    v_add_f32 v12, v12, v13
    ds_write_b32 v10, v12 offset:0
    s_waitcnt lgkmcnt(0)
    s_barrier
    ds_read_b32 v12, v11 offset:0
    ds_read_b32 v13, v11 offset:64
    ds_read_b32 v14, v11 offset:128
    ds_read_b32 v15, v11 offset:192
    s_waitcnt lgkmcnt(0)
    v_add_f32 v12, v12, v13
    v_add_f32 v14, v14, v15
    v_add_f32 v12, v12, v14
    v_mul_f32 v12, 0x3b000000, v12
    v_sub_f32 v160, v160, v12
    v_sub_f32 v161, v161, v12
    v_sub_f32 v162, v162, v12
    v_sub_f32 v163, v163, v12
    v_sub_f32 v164, v164, v12
    v_sub_f32 v165, v165, v12
    v_sub_f32 v166, v166, v12
    v_sub_f32 v167, v167, v12
    v_sub_f32 v168, v168, v12
    v_sub_f32 v169, v169, v12
    v_sub_f32 v170, v170, v12
    v_sub_f32 v171, v171, v12
    v_sub_f32 v172, v172, v12
    v_sub_f32 v173, v173, v12
    v_sub_f32 v174, v174, v12
    v_sub_f32 v175, v175, v12
    v_sub_f32 v176, v176, v12
    v_sub_f32 v177, v177, v12
    v_sub_f32 v178, v178, v12
    v_sub_f32 v179, v179, v12
    v_sub_f32 v180, v180, v12
    v_sub_f32 v181, v181, v12
    v_sub_f32 v182, v182, v12
    v_sub_f32 v183, v183, v12
    v_sub_f32 v184, v184, v12
    v_sub_f32 v185, v185, v12
    v_sub_f32 v186, v186, v12
    v_sub_f32 v187, v187, v12
    v_sub_f32 v188, v188, v12
    v_sub_f32 v189, v189, v12
    v_sub_f32 v190, v190, v12
    v_sub_f32 v191, v191, v12
    v_mul_f32 v192, v160, v160
    v_fma_f32 v192, v164, v164, v192
    v_fma_f32 v192, v168, v168, v192
    v_fma_f32 v192, v172, v172, v192
    v_fma_f32 v192, v176, v176, v192
    v_fma_f32 v192, v180, v180, v192
    v_fma_f32 v192, v184, v184, v192
    v_fma_f32 v192, v188, v188, v192
    v_mul_f32 v193, v161, v161
    v_fma_f32 v193, v165, v165, v193
    v_fma_f32 v193, v169, v169, v193
    v_fma_f32 v193, v173, v173, v193
    v_fma_f32 v193, v177, v177, v193
    v_fma_f32 v193, v181, v181, v193
    v_fma_f32 v193, v185, v185, v193
    v_fma_f32 v193, v189, v189, v193
    v_mul_f32 v194, v162, v162
    v_fma_f32 v194, v166, v166, v194
    v_fma_f32 v194, v170, v170, v194
    v_fma_f32 v194, v174, v174, v194
    v_fma_f32 v194, v178, v178, v194
    v_fma_f32 v194, v182, v182, v194
    v_fma_f32 v194, v186, v186, v194
    v_fma_f32 v194, v190, v190, v194
    v_mul_f32 v195, v163, v163
    v_fma_f32 v195, v167, v167, v195
    v_fma_f32 v195, v171, v171, v195
    v_fma_f32 v195, v175, v175, v195
    v_fma_f32 v195, v179, v179, v195
    v_fma_f32 v195, v183, v183, v195
    v_fma_f32 v195, v187, v187, v195
    v_fma_f32 v195, v191, v191, v195
    v_add_f32 v12, v192, v193
    v_add_f32 v12, v12, v194
    v_add_f32 v12, v12, v195
    v_mov_b32 v13, v12
    s_nop 1
    v_permlane32_swap_b32 v12, v13
    v_add_f32 v12, v12, v13
    v_mov_b32 v13, v12
    s_nop 1
    v_permlane16_swap_b32 v12, v13
    v_add_f32 v12, v12, v13
    ds_write_b32 v10, v12 offset:256
    s_waitcnt lgkmcnt(0)
    s_barrier
    ds_read_b32 v12, v11 offset:256
    ds_read_b32 v13, v11 offset:320
    ds_read_b32 v14, v11 offset:384
    ds_read_b32 v15, v11 offset:448
    s_waitcnt lgkmcnt(0)
    v_add_f32 v12, v12, v13
    v_add_f32 v14, v14, v15
    v_add_f32 v12, v12, v14
    v_mov_b32 v13, 0x3727c5ac
    v_fma_f32 v12, v12, s94, v13
    v_rsq_f32 v12, v12
    s_nop 0
    v_mul_f32 v160, v160, v12
    v_mul_f32 v161, v161, v12
    v_mul_f32 v162, v162, v12
    v_mul_f32 v163, v163, v12
    v_mul_f32 v164, v164, v12
    v_mul_f32 v165, v165, v12
    v_mul_f32 v166, v166, v12
    v_mul_f32 v167, v167, v12
    v_mul_f32 v168, v168, v12
    v_mul_f32 v169, v169, v12
    v_mul_f32 v170, v170, v12
    v_mul_f32 v171, v171, v12
    v_mul_f32 v172, v172, v12
    v_mul_f32 v173, v173, v12
    v_mul_f32 v174, v174, v12
    v_mul_f32 v175, v175, v12
    v_mul_f32 v176, v176, v12
    v_mul_f32 v177, v177, v12
    v_mul_f32 v178, v178, v12
    v_mul_f32 v179, v179, v12
    v_mul_f32 v180, v180, v12
    v_mul_f32 v181, v181, v12
    v_mul_f32 v182, v182, v12
    v_mul_f32 v183, v183, v12
    v_mul_f32 v184, v184, v12
    v_mul_f32 v185, v185, v12
    v_mul_f32 v186, v186, v12
    v_mul_f32 v187, v187, v12
    v_mul_f32 v188, v188, v12
    v_mul_f32 v189, v189, v12
    v_mul_f32 v190, v190, v12
    v_mul_f32 v191, v191, v12
    v_cvt_pk_bf16_f32 v32, v160, v161
    v_cvt_pk_bf16_f32 v33, v162, v163
    v_cvt_pk_bf16_f32 v34, v164, v165
    v_cvt_pk_bf16_f32 v35, v166, v167
    buffer_store_dwordx4 v[32:35], v0, s[4:7], s67 offen offset:0 sc1
    v_cvt_pk_bf16_f32 v36, v168, v169
    v_cvt_pk_bf16_f32 v37, v170, v171
    v_cvt_pk_bf16_f32 v38, v172, v173
    v_cvt_pk_bf16_f32 v39, v174, v175
    buffer_store_dwordx4 v[36:39], v0, s[4:7], s67 offen offset:1024 sc1
    v_cvt_pk_bf16_f32 v40, v176, v177
    v_cvt_pk_bf16_f32 v41, v178, v179
    v_cvt_pk_bf16_f32 v42, v180, v181
    v_cvt_pk_bf16_f32 v43, v182, v183
    buffer_store_dwordx4 v[40:43], v0, s[4:7], s67 offen offset:2048 sc1
    v_cvt_pk_bf16_f32 v44, v184, v185
    v_cvt_pk_bf16_f32 v45, v186, v187
    v_cvt_pk_bf16_f32 v46, v188, v189
    v_cvt_pk_bf16_f32 v47, v190, v191
    buffer_store_dwordx4 v[44:47], v0, s[4:7], s67 offen offset:3072 sc1
    s_add_u32 s41, s41, 1
    s_mov_b32 s71, 128
    s_mov_b32 s72, s41
    s_mov_b32 s70, 1
    s_branch L_r2_top
L_r2_run1:
    s_lshr_b32 s68, s31, 1
    s_lshl_b32 s36, s42, 2
    s_add_u32 s68, s68, s36
    s_mul_i32 s36, s68, 65536
    s_lshl_b32 s37, s69, 14
    s_add_u32 s36, s36, s37
    s_lshl_b32 s37, s30, 12
    s_add_u32 s36, s36, s37
    s_add_u32 s64, s36, 0xa000000
    s_lshl_b32 s36, s68, 15
    s_lshl_b32 s37, s69, 14
    s_add_u32 s36, s36, s37
    s_lshl_b32 s37, s30, 12
    s_add_u32 s36, s36, s37
    s_add_u32 s65, s36, 0xe00000
    s_lshl_b32 s36, s68, 15
    s_lshl_b32 s37, s69, 14
    s_add_u32 s67, s36, s37
    buffer_load_dwordx4 v[16:19], v0, s[4:7], s65 offen offset:0 sc1
    buffer_load_dwordx4 v[20:23], v0, s[4:7], s65 offen offset:1024 sc1
    buffer_load_dwordx4 v[24:27], v0, s[4:7], s65 offen offset:2048 sc1
    buffer_load_dwordx4 v[28:31], v0, s[4:7], s65 offen offset:3072 sc1
    s_add_u32 s36, s64, 0
    buffer_load_dwordx4 v[32:35], v0, s[4:7], s36 offen offset:0 sc1
    buffer_load_dwordx4 v[36:39], v0, s[4:7], s36 offen offset:1024 sc1
    buffer_load_dwordx4 v[40:43], v0, s[4:7], s36 offen offset:2048 sc1
    buffer_load_dwordx4 v[44:47], v0, s[4:7], s36 offen offset:3072 sc1
    s_add_u32 s36, s64, 32768
    buffer_load_dwordx4 v[48:51], v0, s[4:7], s36 offen offset:0 sc1
    buffer_load_dwordx4 v[52:55], v0, s[4:7], s36 offen offset:1024 sc1
    buffer_load_dwordx4 v[56:59], v0, s[4:7], s36 offen offset:2048 sc1
    buffer_load_dwordx4 v[60:63], v0, s[4:7], s36 offen offset:3072 sc1
    s_cmp_eq_u32 s70, 0
    s_cbranch_scc1 L_r2_al1
    s_waitcnt vmcnt(12)
    s_barrier
L_r2_al1:
    s_lshl_b32 s36, s31, 2
    s_add_u32 s36, s36, s71
    s_cmp_lg_u32 s70, 0
    s_cselect_b32 s37, 1, 0
    s_cmp_eq_u32 s30, 0
    s_cselect_b32 s37, s37, 0
    v_mov_b32 v5, s72
    v_mov_b32 v6, 0
    s_mov_b64 exec, 1
    s_cmp_eq_u32 s37, 1
    s_cbranch_scc1 L_r2_alp1
    buffer_store_dword v5, v6, s[4:7], s97 offen
    s_branch L_r2_ale1
L_r2_alp1:
    buffer_store_dword v5, v6, s[4:7], s36 offen sc1
L_r2_ale1:
    s_mov_b64 exec, -1
    s_mov_b32 s70, 0
    s_waitcnt vmcnt(9)
    v_lshlrev_b32 v160, 16, v16
    v_and_b32 v161, 0xffff0000, v16
    v_lshlrev_b32 v162, 16, v17
    v_and_b32 v163, 0xffff0000, v17
    v_lshlrev_b32 v164, 16, v18
    v_and_b32 v165, 0xffff0000, v18
    v_lshlrev_b32 v166, 16, v19
    v_and_b32 v167, 0xffff0000, v19
    v_lshlrev_b32 v168, 16, v20
    v_and_b32 v169, 0xffff0000, v20
    v_lshlrev_b32 v170, 16, v21
    v_and_b32 v171, 0xffff0000, v21
    v_lshlrev_b32 v172, 16, v22
    v_and_b32 v173, 0xffff0000, v22
    v_lshlrev_b32 v174, 16, v23
    v_and_b32 v175, 0xffff0000, v23
    v_lshlrev_b32 v176, 16, v24
    v_and_b32 v177, 0xffff0000, v24
    v_lshlrev_b32 v178, 16, v25
    v_and_b32 v179, 0xffff0000, v25
    v_lshlrev_b32 v180, 16, v26
    v_and_b32 v181, 0xffff0000, v26
    v_lshlrev_b32 v182, 16, v27
    v_and_b32 v183, 0xffff0000, v27
    v_lshlrev_b32 v184, 16, v28
    v_and_b32 v185, 0xffff0000, v28
    v_lshlrev_b32 v186, 16, v29
    v_and_b32 v187, 0xffff0000, v29
    v_lshlrev_b32 v188, 16, v30
    v_and_b32 v189, 0xffff0000, v30
    v_lshlrev_b32 v190, 16, v31
    v_and_b32 v191, 0xffff0000, v31
    s_waitcnt vmcnt(5)
    v_lshlrev_b32 v128, 16, v32
    v_and_b32 v129, 0xffff0000, v32
    v_lshlrev_b32 v130, 16, v33
    v_and_b32 v131, 0xffff0000, v33
    v_lshlrev_b32 v132, 16, v34
    v_and_b32 v133, 0xffff0000, v34
    v_lshlrev_b32 v134, 16, v35
    v_and_b32 v135, 0xffff0000, v35
    v_lshlrev_b32 v136, 16, v36
    v_and_b32 v137, 0xffff0000, v36
    v_lshlrev_b32 v138, 16, v37
    v_and_b32 v139, 0xffff0000, v37
    v_lshlrev_b32 v140, 16, v38
    v_and_b32 v141, 0xffff0000, v38
    v_lshlrev_b32 v142, 16, v39
    v_and_b32 v143, 0xffff0000, v39
    v_lshlrev_b32 v144, 16, v40
    v_and_b32 v145, 0xffff0000, v40
    v_lshlrev_b32 v146, 16, v41
    v_and_b32 v147, 0xffff0000, v41
    v_lshlrev_b32 v148, 16, v42
    v_and_b32 v149, 0xffff0000, v42
    v_lshlrev_b32 v150, 16, v43
    v_and_b32 v151, 0xffff0000, v43
    v_lshlrev_b32 v152, 16, v44
    v_and_b32 v153, 0xffff0000, v44
    v_lshlrev_b32 v154, 16, v45
    v_and_b32 v155, 0xffff0000, v45
    v_lshlrev_b32 v156, 16, v46
    v_and_b32 v157, 0xffff0000, v46
    v_lshlrev_b32 v158, 16, v47
    v_and_b32 v159, 0xffff0000, v47
    s_waitcnt vmcnt(1)
    v_lshlrev_b32 v12, 16, v48
    v_and_b32 v13, 0xffff0000, v48
    v_pk_add_f32 v[128:129], v[128:129], v[12:13]
    v_lshlrev_b32 v12, 16, v49
    v_and_b32 v13, 0xffff0000, v49
    v_pk_add_f32 v[130:131], v[130:131], v[12:13]
    v_lshlrev_b32 v12, 16, v50
    v_and_b32 v13, 0xffff0000, v50
    v_pk_add_f32 v[132:133], v[132:133], v[12:13]
    v_lshlrev_b32 v12, 16, v51
    v_and_b32 v13, 0xffff0000, v51
    v_pk_add_f32 v[134:135], v[134:135], v[12:13]
    v_lshlrev_b32 v12, 16, v52
    v_and_b32 v13, 0xffff0000, v52
    v_pk_add_f32 v[136:137], v[136:137], v[12:13]
    v_lshlrev_b32 v12, 16, v53
    v_and_b32 v13, 0xffff0000, v53
    v_pk_add_f32 v[138:139], v[138:139], v[12:13]
    v_lshlrev_b32 v12, 16, v54
    v_and_b32 v13, 0xffff0000, v54
    v_pk_add_f32 v[140:141], v[140:141], v[12:13]
    v_lshlrev_b32 v12, 16, v55
    v_and_b32 v13, 0xffff0000, v55
    v_pk_add_f32 v[142:143], v[142:143], v[12:13]
    v_lshlrev_b32 v12, 16, v56
    v_and_b32 v13, 0xffff0000, v56
    v_pk_add_f32 v[144:145], v[144:145], v[12:13]
    v_lshlrev_b32 v12, 16, v57
    v_and_b32 v13, 0xffff0000, v57
    v_pk_add_f32 v[146:147], v[146:147], v[12:13]
    v_lshlrev_b32 v12, 16, v58
    v_and_b32 v13, 0xffff0000, v58
    v_pk_add_f32 v[148:149], v[148:149], v[12:13]
    v_lshlrev_b32 v12, 16, v59
    v_and_b32 v13, 0xffff0000, v59
    v_pk_add_f32 v[150:151], v[150:151], v[12:13]
    v_lshlrev_b32 v12, 16, v60
    v_and_b32 v13, 0xffff0000, v60
    v_pk_add_f32 v[152:153], v[152:153], v[12:13]
    v_lshlrev_b32 v12, 16, v61
    v_and_b32 v13, 0xffff0000, v61
    v_pk_add_f32 v[154:155], v[154:155], v[12:13]
    v_lshlrev_b32 v12, 16, v62
    v_and_b32 v13, 0xffff0000, v62
    v_pk_add_f32 v[156:157], v[156:157], v[12:13]
    v_lshlrev_b32 v12, 16, v63
    v_and_b32 v13, 0xffff0000, v63
    v_pk_add_f32 v[158:159], v[158:159], v[12:13]
    v_pk_add_f32 v[160:161], v[160:161], v[128:129]
    v_pk_add_f32 v[162:163], v[162:163], v[130:131]
    v_pk_add_f32 v[164:165], v[164:165], v[132:133]
    v_pk_add_f32 v[166:167], v[166:167], v[134:135]
    v_pk_add_f32 v[168:169], v[168:169], v[136:137]
    v_pk_add_f32 v[170:171], v[170:171], v[138:139]
    v_pk_add_f32 v[172:173], v[172:173], v[140:141]
    v_pk_add_f32 v[174:175], v[174:175], v[142:143]
    v_pk_add_f32 v[176:177], v[176:177], v[144:145]
    v_pk_add_f32 v[178:179], v[178:179], v[146:147]
    v_pk_add_f32 v[180:181], v[180:181], v[148:149]
    v_pk_add_f32 v[182:183], v[182:183], v[150:151]
    v_pk_add_f32 v[184:185], v[184:185], v[152:153]
    v_pk_add_f32 v[186:187], v[186:187], v[154:155]
    v_pk_add_f32 v[188:189], v[188:189], v[156:157]
    v_pk_add_f32 v[190:191], v[190:191], v[158:159]
    v_cvt_pk_bf16_f32 v16, v160, v161
    v_cvt_pk_bf16_f32 v17, v162, v163
    v_cvt_pk_bf16_f32 v18, v164, v165
    v_cvt_pk_bf16_f32 v19, v166, v167
    v_cvt_pk_bf16_f32 v20, v168, v169
    v_cvt_pk_bf16_f32 v21, v170, v171
    v_cvt_pk_bf16_f32 v22, v172, v173
    v_cvt_pk_bf16_f32 v23, v174, v175
    v_cvt_pk_bf16_f32 v24, v176, v177
    v_cvt_pk_bf16_f32 v25, v178, v179
    v_cvt_pk_bf16_f32 v26, v180, v181
    v_cvt_pk_bf16_f32 v27, v182, v183
    v_cvt_pk_bf16_f32 v28, v184, v185
    v_cvt_pk_bf16_f32 v29, v186, v187
    v_cvt_pk_bf16_f32 v30, v188, v189
    v_cvt_pk_bf16_f32 v31, v190, v191
    buffer_store_dwordx4 v[16:19], v9, s[12:15], s67 offen offset:0
    buffer_store_dwordx4 v[20:23], v9, s[12:15], s67 offen offset:64
    buffer_store_dwordx4 v[24:27], v9, s[12:15], s67 offen offset:128
    buffer_store_dwordx4 v[28:31], v9, s[12:15], s67 offen offset:192
    s_add_u32 s42, s42, 1
    s_branch L_r2_top
L_r2_fin:
    s_waitcnt vmcnt(0)
    s_barrier
    s_cmp_eq_u32 s70, 0
    s_cbranch_scc1 L_r2_e_np
    s_cmp_lg_u32 s30, 0
    s_cbranch_scc1 L_r2_e_pw
    s_lshl_b32 s36, s31, 2
    s_add_u32 s36, s36, s71
    v_mov_b32 v5, s72
    v_mov_b32 v6, 0
    s_mov_b64 exec, 1
    buffer_store_dword v5, v6, s[4:7], s36 offen sc1
    s_mov_b64 exec, -1
L_r2_e_pw:
    s_mov_b32 s70, 0
L_r2_e_np:
    s_waitcnt vmcnt(0)
    s_branch L_end
L_role_kv:
    v_mbcnt_lo_u32_b32 v1, -1, 0
    v_mbcnt_hi_u32_b32 v1, -1, v1
    v_lshlrev_b32 v0, 4, v1
    s_mov_b32 s35, 65536
    s_lshl_b32 s36, s28, 5
    s_add_u32 s36, s36, s29
    s_lshl_b32 s36, s36, 2
    s_add_u32 s36, s36, s30
    s_lshl_b32 s36, s36, 5
    s_and_b32 s36, s36, 0x7fff
    s_add_u32 s97, s36, 0x8000
    s_load_dwordx2 s[36:37], s[0:1], 24
    s_waitcnt lgkmcnt(0)
    s_mov_b32 s8, s36
    s_and_b32 s9, s37, 0xffff
    s_mov_b32 s10, 0x400000
    s_mov_b32 s11, 0x20000
    s_lshl_b32 s64, s31, 8
    v_lshrrev_b32 v10, 4, v1
    s_mov_b32 s36, 8192
    v_mul_lo_u32 v8, v10, s36
    v_and_b32 v10, 15, v1
    v_lshl_add_u32 v8, v10, 4, v8
    v_lshrrev_b32 v10, 4, v1
    v_lshlrev_b32 v10, 3, v10
    v_bfe_u32 v11, v1, 2, 2
    v_add_u32 v10, v10, v11
    v_mul_u32_u24 v9, 256, v10
    v_and_b32 v10, 3, v1
    v_lshlrev_b32 v10, 4, v10
    s_lshl_b32 s36, s30, 6
    v_add_u32 v10, s36, v10
    v_add_u32 v9, v9, v10
    s_mul_i32 s37, s30, 524288
    s_add_u32 s37, s37, s64
    s_add_u32 s37, s37, 0
    s_mul_i32 s38, s30, 16384
    s_add_u32 s38, s38, 0
    s_mov_b32 m0, s38
    s_add_u32 s38, s38, 1024
    buffer_load_dwordx4 v8, s[8:11], s37 offen lds
    s_add_u32 s37, s37, 32768
    s_mov_b32 m0, s38
    s_add_u32 s38, s38, 1024
    buffer_load_dwordx4 v8, s[8:11], s37 offen lds
    s_add_u32 s37, s37, 32768
    s_mov_b32 m0, s38
    s_add_u32 s38, s38, 1024
    buffer_load_dwordx4 v8, s[8:11], s37 offen lds
    s_add_u32 s37, s37, 32768
    s_mov_b32 m0, s38
    s_add_u32 s38, s38, 1024
    buffer_load_dwordx4 v8, s[8:11], s37 offen lds
    s_add_u32 s37, s37, 32768
    s_mov_b32 m0, s38
    s_add_u32 s38, s38, 1024
    buffer_load_dwordx4 v8, s[8:11], s37 offen lds
    s_add_u32 s37, s37, 32768
    s_mov_b32 m0, s38
    s_add_u32 s38, s38, 1024
    buffer_load_dwordx4 v8, s[8:11], s37 offen lds
    s_add_u32 s37, s37, 32768
    s_mov_b32 m0, s38
    s_add_u32 s38, s38, 1024
    buffer_load_dwordx4 v8, s[8:11], s37 offen lds
    s_add_u32 s37, s37, 32768
    s_mov_b32 m0, s38
    s_add_u32 s38, s38, 1024
    buffer_load_dwordx4 v8, s[8:11], s37 offen lds
    s_add_u32 s37, s37, 32768
    s_mov_b32 m0, s38
    s_add_u32 s38, s38, 1024
    buffer_load_dwordx4 v8, s[8:11], s37 offen lds
    s_add_u32 s37, s37, 32768
    s_mov_b32 m0, s38
    s_add_u32 s38, s38, 1024
    buffer_load_dwordx4 v8, s[8:11], s37 offen lds
    s_add_u32 s37, s37, 32768
    s_mov_b32 m0, s38
    s_add_u32 s38, s38, 1024
    buffer_load_dwordx4 v8, s[8:11], s37 offen lds
    s_add_u32 s37, s37, 32768
    s_mov_b32 m0, s38
    s_add_u32 s38, s38, 1024
    buffer_load_dwordx4 v8, s[8:11], s37 offen lds
    s_add_u32 s37, s37, 32768
    s_mov_b32 m0, s38
    s_add_u32 s38, s38, 1024
    buffer_load_dwordx4 v8, s[8:11], s37 offen lds
    s_add_u32 s37, s37, 32768
    s_mov_b32 m0, s38
    s_add_u32 s38, s38, 1024
    buffer_load_dwordx4 v8, s[8:11], s37 offen lds
    s_add_u32 s37, s37, 32768
    s_mov_b32 m0, s38
    s_add_u32 s38, s38, 1024
    buffer_load_dwordx4 v8, s[8:11], s37 offen lds
    s_add_u32 s37, s37, 32768
    s_mov_b32 m0, s38
    s_add_u32 s38, s38, 1024
    buffer_load_dwordx4 v8, s[8:11], s37 offen lds
    s_add_u32 s37, s37, 32768
    s_mul_i32 s37, s30, 524288
    s_add_u32 s37, s37, s64
    s_add_u32 s37, s37, 2097152
    s_mul_i32 s38, s30, 16384
    s_add_u32 s38, s38, 65536
    s_mov_b32 m0, s38
    s_add_u32 s38, s38, 1024
    buffer_load_dwordx4 v8, s[8:11], s37 offen lds
    s_add_u32 s37, s37, 32768
    s_mov_b32 m0, s38
    s_add_u32 s38, s38, 1024
    buffer_load_dwordx4 v8, s[8:11], s37 offen lds
    s_add_u32 s37, s37, 32768
    s_mov_b32 m0, s38
    s_add_u32 s38, s38, 1024
    buffer_load_dwordx4 v8, s[8:11], s37 offen lds
    s_add_u32 s37, s37, 32768
    s_mov_b32 m0, s38
    s_add_u32 s38, s38, 1024
    buffer_load_dwordx4 v8, s[8:11], s37 offen lds
    s_add_u32 s37, s37, 32768
    s_mov_b32 m0, s38
    s_add_u32 s38, s38, 1024
    buffer_load_dwordx4 v8, s[8:11], s37 offen lds
    s_add_u32 s37, s37, 32768
    s_mov_b32 m0, s38
    s_add_u32 s38, s38, 1024
    buffer_load_dwordx4 v8, s[8:11], s37 offen lds
    s_add_u32 s37, s37, 32768
    s_mov_b32 m0, s38
    s_add_u32 s38, s38, 1024
    buffer_load_dwordx4 v8, s[8:11], s37 offen lds
    s_add_u32 s37, s37, 32768
    s_mov_b32 m0, s38
    s_add_u32 s38, s38, 1024
    buffer_load_dwordx4 v8, s[8:11], s37 offen lds
    s_add_u32 s37, s37, 32768
    s_mov_b32 m0, s38
    s_add_u32 s38, s38, 1024
    buffer_load_dwordx4 v8, s[8:11], s37 offen lds
    s_add_u32 s37, s37, 32768
    s_mov_b32 m0, s38
    s_add_u32 s38, s38, 1024
    buffer_load_dwordx4 v8, s[8:11], s37 offen lds
    s_add_u32 s37, s37, 32768
    s_mov_b32 m0, s38
    s_add_u32 s38, s38, 1024
    buffer_load_dwordx4 v8, s[8:11], s37 offen lds
    s_add_u32 s37, s37, 32768
    s_mov_b32 m0, s38
    s_add_u32 s38, s38, 1024
    buffer_load_dwordx4 v8, s[8:11], s37 offen lds
    s_add_u32 s37, s37, 32768
    s_mov_b32 m0, s38
    s_add_u32 s38, s38, 1024
    buffer_load_dwordx4 v8, s[8:11], s37 offen lds
    s_add_u32 s37, s37, 32768
    s_mov_b32 m0, s38
    s_add_u32 s38, s38, 1024
    buffer_load_dwordx4 v8, s[8:11], s37 offen lds
    s_add_u32 s37, s37, 32768
    s_mov_b32 m0, s38
    s_add_u32 s38, s38, 1024
    buffer_load_dwordx4 v8, s[8:11], s37 offen lds
    s_add_u32 s37, s37, 32768
    s_mov_b32 m0, s38
    s_add_u32 s38, s38, 1024
    buffer_load_dwordx4 v8, s[8:11], s37 offen lds
    s_add_u32 s37, s37, 32768
    s_waitcnt vmcnt(16)
    s_barrier
    v_add_u32 v11, 0, v9
    ds_read_b64_tr_b16 a[0:1], v11 offset:0
    ds_read_b64_tr_b16 a[2:3], v11 offset:1024
    ds_read_b64_tr_b16 a[64:65], v11 offset:8
    ds_read_b64_tr_b16 a[66:67], v11 offset:1032
    ds_read_b64_tr_b16 a[4:5], v11 offset:8192
    ds_read_b64_tr_b16 a[6:7], v11 offset:9216
    ds_read_b64_tr_b16 a[68:69], v11 offset:8200
    ds_read_b64_tr_b16 a[70:71], v11 offset:9224
    ds_read_b64_tr_b16 a[8:9], v11 offset:16384
    ds_read_b64_tr_b16 a[10:11], v11 offset:17408
    ds_read_b64_tr_b16 a[72:73], v11 offset:16392
    ds_read_b64_tr_b16 a[74:75], v11 offset:17416
    ds_read_b64_tr_b16 a[12:13], v11 offset:24576
    ds_read_b64_tr_b16 a[14:15], v11 offset:25600
    s_waitcnt lgkmcnt(0)
    ds_read_b64_tr_b16 a[76:77], v11 offset:24584
    ds_read_b64_tr_b16 a[78:79], v11 offset:25608
    ds_read_b64_tr_b16 a[16:17], v11 offset:32768
    ds_read_b64_tr_b16 a[18:19], v11 offset:33792
    ds_read_b64_tr_b16 a[80:81], v11 offset:32776
    ds_read_b64_tr_b16 a[82:83], v11 offset:33800
    ds_read_b64_tr_b16 a[20:21], v11 offset:40960
    ds_read_b64_tr_b16 a[22:23], v11 offset:41984
    ds_read_b64_tr_b16 a[84:85], v11 offset:40968
    ds_read_b64_tr_b16 a[86:87], v11 offset:41992
    ds_read_b64_tr_b16 a[24:25], v11 offset:49152
    ds_read_b64_tr_b16 a[26:27], v11 offset:50176
    ds_read_b64_tr_b16 a[88:89], v11 offset:49160
    ds_read_b64_tr_b16 a[90:91], v11 offset:50184
    s_waitcnt lgkmcnt(0)
    ds_read_b64_tr_b16 a[28:29], v11 offset:57344
    ds_read_b64_tr_b16 a[30:31], v11 offset:58368
    ds_read_b64_tr_b16 a[92:93], v11 offset:57352
    ds_read_b64_tr_b16 a[94:95], v11 offset:58376
    s_waitcnt lgkmcnt(0)
    s_barrier
    s_waitcnt vmcnt(0)
    s_barrier
    v_add_u32 v11, 65536, v9
    ds_read_b64_tr_b16 a[32:33], v11 offset:0
    ds_read_b64_tr_b16 a[34:35], v11 offset:1024
    ds_read_b64_tr_b16 a[96:97], v11 offset:8
    ds_read_b64_tr_b16 a[98:99], v11 offset:1032
    ds_read_b64_tr_b16 a[36:37], v11 offset:8192
    ds_read_b64_tr_b16 a[38:39], v11 offset:9216
    ds_read_b64_tr_b16 a[100:101], v11 offset:8200
    ds_read_b64_tr_b16 a[102:103], v11 offset:9224
    ds_read_b64_tr_b16 a[40:41], v11 offset:16384
    ds_read_b64_tr_b16 a[42:43], v11 offset:17408
    ds_read_b64_tr_b16 a[104:105], v11 offset:16392
    ds_read_b64_tr_b16 a[106:107], v11 offset:17416
    ds_read_b64_tr_b16 a[44:45], v11 offset:24576
    ds_read_b64_tr_b16 a[46:47], v11 offset:25600
    s_waitcnt lgkmcnt(0)
    ds_read_b64_tr_b16 a[108:109], v11 offset:24584
    ds_read_b64_tr_b16 a[110:111], v11 offset:25608
    ds_read_b64_tr_b16 a[48:49], v11 offset:32768
    ds_read_b64_tr_b16 a[50:51], v11 offset:33792
    ds_read_b64_tr_b16 a[112:113], v11 offset:32776
    ds_read_b64_tr_b16 a[114:115], v11 offset:33800
    ds_read_b64_tr_b16 a[52:53], v11 offset:40960
    ds_read_b64_tr_b16 a[54:55], v11 offset:41984
    ds_read_b64_tr_b16 a[116:117], v11 offset:40968
    ds_read_b64_tr_b16 a[118:119], v11 offset:41992
    ds_read_b64_tr_b16 a[56:57], v11 offset:49152
    ds_read_b64_tr_b16 a[58:59], v11 offset:50176
    ds_read_b64_tr_b16 a[120:121], v11 offset:49160
    ds_read_b64_tr_b16 a[122:123], v11 offset:50184
    s_waitcnt lgkmcnt(0)
    ds_read_b64_tr_b16 a[60:61], v11 offset:57344
    ds_read_b64_tr_b16 a[62:63], v11 offset:58368
    ds_read_b64_tr_b16 a[124:125], v11 offset:57352
    ds_read_b64_tr_b16 a[126:127], v11 offset:58376
    s_waitcnt lgkmcnt(0)
    s_barrier
    s_load_dwordx2 s[36:37], s[0:1], 32
    s_waitcnt lgkmcnt(0)
    s_mov_b32 s8, s36
    s_and_b32 s9, s37, 0xffff
    s_mov_b32 s10, 0x400000
    s_mov_b32 s11, 0x20000
    s_lshl_b32 s64, s31, 8
    v_lshrrev_b32 v10, 4, v1
    s_mov_b32 s36, 8192
    v_mul_lo_u32 v8, v10, s36
    v_and_b32 v10, 15, v1
    v_lshl_add_u32 v8, v10, 4, v8
    v_lshrrev_b32 v10, 4, v1
    v_lshlrev_b32 v10, 3, v10
    v_bfe_u32 v11, v1, 2, 2
    v_add_u32 v10, v10, v11
    v_mul_u32_u24 v9, 256, v10
    v_and_b32 v10, 3, v1
    v_lshlrev_b32 v10, 4, v10
    s_lshl_b32 s36, s30, 6
    v_add_u32 v10, s36, v10
    v_add_u32 v9, v9, v10
    s_mul_i32 s37, s30, 524288
    s_add_u32 s37, s37, s64
    s_add_u32 s37, s37, 0
    s_mul_i32 s38, s30, 16384
    s_add_u32 s38, s38, 0
    s_mov_b32 m0, s38
    s_add_u32 s38, s38, 1024
    buffer_load_dwordx4 v8, s[8:11], s37 offen lds
    s_add_u32 s37, s37, 32768
    s_mov_b32 m0, s38
    s_add_u32 s38, s38, 1024
    buffer_load_dwordx4 v8, s[8:11], s37 offen lds
    s_add_u32 s37, s37, 32768
    s_mov_b32 m0, s38
    s_add_u32 s38, s38, 1024
    buffer_load_dwordx4 v8, s[8:11], s37 offen lds
    s_add_u32 s37, s37, 32768
    s_mov_b32 m0, s38
    s_add_u32 s38, s38, 1024
    buffer_load_dwordx4 v8, s[8:11], s37 offen lds
    s_add_u32 s37, s37, 32768
    s_mov_b32 m0, s38
    s_add_u32 s38, s38, 1024
    buffer_load_dwordx4 v8, s[8:11], s37 offen lds
    s_add_u32 s37, s37, 32768
    s_mov_b32 m0, s38
    s_add_u32 s38, s38, 1024
    buffer_load_dwordx4 v8, s[8:11], s37 offen lds
    s_add_u32 s37, s37, 32768
    s_mov_b32 m0, s38
    s_add_u32 s38, s38, 1024
    buffer_load_dwordx4 v8, s[8:11], s37 offen lds
    s_add_u32 s37, s37, 32768
    s_mov_b32 m0, s38
    s_add_u32 s38, s38, 1024
    buffer_load_dwordx4 v8, s[8:11], s37 offen lds
    s_add_u32 s37, s37, 32768
    s_mov_b32 m0, s38
    s_add_u32 s38, s38, 1024
    buffer_load_dwordx4 v8, s[8:11], s37 offen lds
    s_add_u32 s37, s37, 32768
    s_mov_b32 m0, s38
    s_add_u32 s38, s38, 1024
    buffer_load_dwordx4 v8, s[8:11], s37 offen lds
    s_add_u32 s37, s37, 32768
    s_mov_b32 m0, s38
    s_add_u32 s38, s38, 1024
    buffer_load_dwordx4 v8, s[8:11], s37 offen lds
    s_add_u32 s37, s37, 32768
    s_mov_b32 m0, s38
    s_add_u32 s38, s38, 1024
    buffer_load_dwordx4 v8, s[8:11], s37 offen lds
    s_add_u32 s37, s37, 32768
    s_mov_b32 m0, s38
    s_add_u32 s38, s38, 1024
    buffer_load_dwordx4 v8, s[8:11], s37 offen lds
    s_add_u32 s37, s37, 32768
    s_mov_b32 m0, s38
    s_add_u32 s38, s38, 1024
    buffer_load_dwordx4 v8, s[8:11], s37 offen lds
    s_add_u32 s37, s37, 32768
    s_mov_b32 m0, s38
    s_add_u32 s38, s38, 1024
    buffer_load_dwordx4 v8, s[8:11], s37 offen lds
    s_add_u32 s37, s37, 32768
    s_mov_b32 m0, s38
    s_add_u32 s38, s38, 1024
    buffer_load_dwordx4 v8, s[8:11], s37 offen lds
    s_add_u32 s37, s37, 32768
    s_mul_i32 s37, s30, 524288
    s_add_u32 s37, s37, s64
    s_add_u32 s37, s37, 2097152
    s_mul_i32 s38, s30, 16384
    s_add_u32 s38, s38, 65536
    s_mov_b32 m0, s38
    s_add_u32 s38, s38, 1024
    buffer_load_dwordx4 v8, s[8:11], s37 offen lds
    s_add_u32 s37, s37, 32768
    s_mov_b32 m0, s38
    s_add_u32 s38, s38, 1024
    buffer_load_dwordx4 v8, s[8:11], s37 offen lds
    s_add_u32 s37, s37, 32768
    s_mov_b32 m0, s38
    s_add_u32 s38, s38, 1024
    buffer_load_dwordx4 v8, s[8:11], s37 offen lds
    s_add_u32 s37, s37, 32768
    s_mov_b32 m0, s38
    s_add_u32 s38, s38, 1024
    buffer_load_dwordx4 v8, s[8:11], s37 offen lds
    s_add_u32 s37, s37, 32768
    s_mov_b32 m0, s38
    s_add_u32 s38, s38, 1024
    buffer_load_dwordx4 v8, s[8:11], s37 offen lds
    s_add_u32 s37, s37, 32768
    s_mov_b32 m0, s38
    s_add_u32 s38, s38, 1024
    buffer_load_dwordx4 v8, s[8:11], s37 offen lds
    s_add_u32 s37, s37, 32768
    s_mov_b32 m0, s38
    s_add_u32 s38, s38, 1024
    buffer_load_dwordx4 v8, s[8:11], s37 offen lds
    s_add_u32 s37, s37, 32768
    s_mov_b32 m0, s38
    s_add_u32 s38, s38, 1024
    buffer_load_dwordx4 v8, s[8:11], s37 offen lds
    s_add_u32 s37, s37, 32768
    s_mov_b32 m0, s38
    s_add_u32 s38, s38, 1024
    buffer_load_dwordx4 v8, s[8:11], s37 offen lds
    s_add_u32 s37, s37, 32768
    s_mov_b32 m0, s38
    s_add_u32 s38, s38, 1024
    buffer_load_dwordx4 v8, s[8:11], s37 offen lds
    s_add_u32 s37, s37, 32768
    s_mov_b32 m0, s38
    s_add_u32 s38, s38, 1024
    buffer_load_dwordx4 v8, s[8:11], s37 offen lds
    s_add_u32 s37, s37, 32768
    s_mov_b32 m0, s38
    s_add_u32 s38, s38, 1024
    buffer_load_dwordx4 v8, s[8:11], s37 offen lds
    s_add_u32 s37, s37, 32768
    s_mov_b32 m0, s38
    s_add_u32 s38, s38, 1024
    buffer_load_dwordx4 v8, s[8:11], s37 offen lds
    s_add_u32 s37, s37, 32768
    s_mov_b32 m0, s38
    s_add_u32 s38, s38, 1024
    buffer_load_dwordx4 v8, s[8:11], s37 offen lds
    s_add_u32 s37, s37, 32768
    s_mov_b32 m0, s38
    s_add_u32 s38, s38, 1024
    buffer_load_dwordx4 v8, s[8:11], s37 offen lds
    s_add_u32 s37, s37, 32768
    s_mov_b32 m0, s38
    s_add_u32 s38, s38, 1024
    buffer_load_dwordx4 v8, s[8:11], s37 offen lds
    s_add_u32 s37, s37, 32768
    s_waitcnt vmcnt(16)
    s_barrier
    v_add_u32 v11, 0, v9
    ds_read_b64_tr_b16 a[128:129], v11 offset:0
    ds_read_b64_tr_b16 a[130:131], v11 offset:1024
    ds_read_b64_tr_b16 a[132:133], v11 offset:8192
    ds_read_b64_tr_b16 a[134:135], v11 offset:9216
    ds_read_b64_tr_b16 a[136:137], v11 offset:16384
    ds_read_b64_tr_b16 a[138:139], v11 offset:17408
    ds_read_b64_tr_b16 a[140:141], v11 offset:24576
    ds_read_b64_tr_b16 a[142:143], v11 offset:25600
    ds_read_b64_tr_b16 a[144:145], v11 offset:32768
    ds_read_b64_tr_b16 a[146:147], v11 offset:33792
    ds_read_b64_tr_b16 a[148:149], v11 offset:40960
    ds_read_b64_tr_b16 a[150:151], v11 offset:41984
    ds_read_b64_tr_b16 a[152:153], v11 offset:49152
    ds_read_b64_tr_b16 a[154:155], v11 offset:50176
    s_waitcnt lgkmcnt(0)
    ds_read_b64_tr_b16 a[156:157], v11 offset:57344
    ds_read_b64_tr_b16 a[158:159], v11 offset:58368
    s_waitcnt lgkmcnt(0)
    s_barrier
    s_waitcnt vmcnt(0)
    s_barrier
    v_add_u32 v11, 65536, v9
    ds_read_b64_tr_b16 a[160:161], v11 offset:0
    ds_read_b64_tr_b16 a[162:163], v11 offset:1024
    ds_read_b64_tr_b16 a[164:165], v11 offset:8192
    ds_read_b64_tr_b16 a[166:167], v11 offset:9216
    ds_read_b64_tr_b16 a[168:169], v11 offset:16384
    ds_read_b64_tr_b16 a[170:171], v11 offset:17408
    ds_read_b64_tr_b16 a[172:173], v11 offset:24576
    ds_read_b64_tr_b16 a[174:175], v11 offset:25600
    ds_read_b64_tr_b16 a[176:177], v11 offset:32768
    ds_read_b64_tr_b16 a[178:179], v11 offset:33792
    ds_read_b64_tr_b16 a[180:181], v11 offset:40960
    ds_read_b64_tr_b16 a[182:183], v11 offset:41984
    ds_read_b64_tr_b16 a[184:185], v11 offset:49152
    ds_read_b64_tr_b16 a[186:187], v11 offset:50176
    s_waitcnt lgkmcnt(0)
    ds_read_b64_tr_b16 a[188:189], v11 offset:57344
    ds_read_b64_tr_b16 a[190:191], v11 offset:58368
    s_waitcnt lgkmcnt(0)
    s_barrier
    v_and_b32 v5, 31, v1
    v_lshlrev_b32 v2, 2, v5
    v_lshrrev_b32 v5, 5, v1
    v_lshl_add_u32 v2, v5, 7, v2
    s_mov_b32 s63, 0
    s_lshl_b32 s36, s31, 2
    s_add_u32 s62, s36, 256
    s_cmp_lg_u32 s30, 0
    s_cbranch_scc1 L_pw_ok_idpvk
    s_mov_b32 s36, 0
    v_mov_b32 v120, 32
L_pw_idpvk:
    buffer_load_dword v121, v120, s[24:27], 0 offen sc1
    s_waitcnt vmcnt(0)
    v_readfirstlane_b32 s37, v121
    s_nop 3
    s_cmp_ge_u32 s37, 256
    s_cbranch_scc1 L_pw_ok_idpvk
    s_sleep 4
    s_add_u32 s36, s36, 1
    s_cmp_lt_u32 s36, 65536
    s_cbranch_scc1 L_pw_idpvk
    s_mov_b32 s33, 1
L_pw_ok_idpvk:
    s_barrier
    s_mov_b32 s41, 0
    s_mov_b32 s58, 0
    s_mov_b32 s42, 0
    s_mov_b32 s59, 0
    s_mov_b32 s49, 0
    s_mov_b32 s50, 0
    s_mov_b32 s52, 0
    s_mov_b32 s53, 0
    s_mov_b32 s43, 0
    s_mov_b32 s44, 0
    s_mov_b32 s47, 0
    s_mov_b32 s48, 0
    s_mov_b32 s51, 163328
    v_cmp_lt_u32 s[88:89], 31, v1
    v_and_b32 v14, 31, v1
    s_mov_b32 s96, 0
L_pvk_cold:
    s_waitcnt vmcnt(0)
    s_barrier
    s_cmp_eq_u32 s43, s52
    s_cbranch_scc1 L_pvk_nopub2
    v_mov_b32 v5, s44
    v_mov_b32 v6, 0
    s_mov_b64 exec, 1
    s_cmp_lg_u32 s30, 0
    s_cbranch_scc1 L_pub_2_d
    s_lshl_b32 s36, s43, 7
    s_add_u32 s36, s36, s62
    buffer_store_dword v5, v6, s[4:7], s36 offen sc1
    s_branch L_pub_2_e
L_pub_2_d:
    buffer_store_dword v5, v6, s[4:7], s97 offen
L_pub_2_e:
    s_mov_b64 exec, -1
L_pvk_nopub2:
    v_mov_b32 v5, s53
    v_mov_b32 v6, 0
    s_mov_b64 exec, 1
    s_cmp_lg_u32 s30, 0
    s_cbranch_scc1 L_pub_3_d
    s_lshl_b32 s36, s52, 7
    s_add_u32 s36, s36, s62
    buffer_store_dword v5, v6, s[4:7], s36 offen sc1
    s_branch L_pub_3_e
L_pub_3_d:
    buffer_store_dword v5, v6, s[4:7], s97 offen
L_pub_3_e:
    s_mov_b64 exec, -1
    s_mov_b32 s43, s52
    s_mov_b32 s44, s53
    s_mov_b32 s40, 0
    s_add_u32 s36, s41, s42
    s_cmp_ge_u32 s36, 128
    s_cbranch_scc1 L_pvk_exit
    s_cmp_lg_u32 s30, 0
    s_cbranch_scc1 L_pvk_cwait
    s_waitcnt vmcnt(0)
    buffer_load_dword v12, v2, s[4:7], s63 offen sc1
    s_nop 15
    s_nop 15
    s_nop 15
    s_nop 15
    s_nop 15
    s_nop 15
L_pvk_w0spin:
    buffer_load_dword v13, v2, s[4:7], s63 offen sc1
    s_waitcnt vmcnt(1)
    v_mov_b32 v4, v12
    s_cmp_ge_u32 s42, 64
    s_cbranch_scc1 L_pvk_p_try1
    s_mov_b32 s48, s42
    s_and_b32 s36, s48, 3
    s_lshl_b32 s36, s36, 1
    s_add_u32 s36, s36, 32
    s_lshr_b32 s37, s48, 2
    s_add_u32 s37, s37, 1
    v_subrev_u32 v7, s36, v1
    v_cmp_gt_u32 vcc, 2, v7
    v_mov_b32 v6, s37
    s_nop 0
    v_cndmask_b32 v7, 0, v6, vcc
    v_cmp_lt_u32 vcc, v4, v7
    s_nop 1
    s_cmp_eq_u64 vcc, 0
    s_cbranch_scc1 L_pvk_p_done
L_pvk_p_try1:
    s_cmp_ge_u32 s41, 64
    s_cbranch_scc1 L_pvk_p_try2
    s_mov_b32 s48, s41
    s_and_b32 s36, s48, 3
    s_lshl_b32 s36, s36, 1
    s_add_u32 s36, s36, 0
    s_lshr_b32 s37, s48, 2
    s_add_u32 s37, s37, 1
    v_subrev_u32 v7, s36, v1
    v_cmp_gt_u32 vcc, 2, v7
    v_mov_b32 v6, s37
    s_nop 0
    v_cndmask_b32 v7, 0, v6, vcc
    v_cmp_lt_u32 vcc, v4, v7
    s_nop 1
    s_cmp_eq_u64 vcc, 0
    s_cbranch_scc1 L_pvk_p_done
L_pvk_p_try2:
    s_cmp_lg_u32 s47, s47
L_pvk_p_done:
    s_cbranch_scc1 L_pvk_w0got
    buffer_load_dword v12, v2, s[4:7], s63 offen sc1
    s_waitcnt vmcnt(1)
    v_mov_b32 v4, v13
    s_cmp_ge_u32 s42, 64
    s_cbranch_scc1 L_pvk_q_try1
    s_mov_b32 s48, s42
    s_and_b32 s36, s48, 3
    s_lshl_b32 s36, s36, 1
    s_add_u32 s36, s36, 32
    s_lshr_b32 s37, s48, 2
    s_add_u32 s37, s37, 1
    v_subrev_u32 v7, s36, v1
    v_cmp_gt_u32 vcc, 2, v7
    v_mov_b32 v6, s37
    s_nop 0
    v_cndmask_b32 v7, 0, v6, vcc
    v_cmp_lt_u32 vcc, v4, v7
    s_nop 1
    s_cmp_eq_u64 vcc, 0
    s_cbranch_scc1 L_pvk_q_done
L_pvk_q_try1:
    s_cmp_ge_u32 s41, 64
    s_cbranch_scc1 L_pvk_q_try2
    s_mov_b32 s48, s41
    s_and_b32 s36, s48, 3
    s_lshl_b32 s36, s36, 1
    s_add_u32 s36, s36, 0
    s_lshr_b32 s37, s48, 2
    s_add_u32 s37, s37, 1
    v_subrev_u32 v7, s36, v1
    v_cmp_gt_u32 vcc, 2, v7
    v_mov_b32 v6, s37
    s_nop 0
    v_cndmask_b32 v7, 0, v6, vcc
    v_cmp_lt_u32 vcc, v4, v7
    s_nop 1
    s_cmp_eq_u64 vcc, 0
    s_cbranch_scc1 L_pvk_q_done
L_pvk_q_try2:
    s_cmp_lg_u32 s47, s47
L_pvk_q_done:
    s_cbranch_scc1 L_pvk_w0got
    s_add_u32 s40, s40, 1
    s_cmp_lt_u32 s40, s35
    s_cbranch_scc1 L_pvk_w0spin
L_pvk_w0got:
    v_lshlrev_b32 v5, 2, v1
    v_add_u32 v5, s51, v5
    ds_write_b32 v5, v4
    s_waitcnt lgkmcnt(0)
L_pvk_cwait:
    s_barrier
    v_lshlrev_b32 v5, 2, v1
    v_add_u32 v5, s51, v5
    ds_read_b32 v4, v5
    s_xor_b32 s51, s51, 256
    s_waitcnt lgkmcnt(0)
    s_cmp_ge_u32 s42, 64
    s_cbranch_scc1 L_pvk_c_try1
    s_mov_b32 s48, s42
    s_and_b32 s36, s48, 3
    s_lshl_b32 s36, s36, 1
    s_add_u32 s36, s36, 32
    s_lshr_b32 s37, s48, 2
    s_add_u32 s37, s37, 1
    v_subrev_u32 v7, s36, v1
    v_cmp_gt_u32 vcc, 2, v7
    v_mov_b32 v6, s37
    s_nop 0
    v_cndmask_b32 v7, 0, v6, vcc
    v_cmp_lt_u32 vcc, v4, v7
    s_nop 1
    s_cmp_eq_u64 vcc, 0
    s_cbranch_scc0 L_pvk_c_try1
    s_mov_b32 s47, 1
    s_add_u32 s42, s42, 1
    s_cmp_eq_u32 s47, s47
    s_branch L_pvk_c_done
L_pvk_c_try1:
    s_cmp_ge_u32 s41, 64
    s_cbranch_scc1 L_pvk_c_try2
    s_mov_b32 s48, s41
    s_and_b32 s36, s48, 3
    s_lshl_b32 s36, s36, 1
    s_add_u32 s36, s36, 0
    s_lshr_b32 s37, s48, 2
    s_add_u32 s37, s37, 1
    v_subrev_u32 v7, s36, v1
    v_cmp_gt_u32 vcc, 2, v7
    v_mov_b32 v6, s37
    s_nop 0
    v_cndmask_b32 v7, 0, v6, vcc
    v_cmp_lt_u32 vcc, v4, v7
    s_nop 1
    s_cmp_eq_u64 vcc, 0
    s_cbranch_scc0 L_pvk_c_try2
    s_mov_b32 s47, 0
    s_add_u32 s41, s41, 1
    s_cmp_eq_u32 s47, s47
    s_branch L_pvk_c_done
L_pvk_c_try2:
    s_cmp_lg_u32 s47, s47
L_pvk_c_done:
    s_cbranch_scc1 L_pvk_got
    s_mov_b32 s33, 1
    s_branch L_pvk_exit
L_pvk_got:
    s_lshl_b32 s36, s47, 21
    s_lshl_b32 s37, s48, 15
    s_add_u32 s36, s36, s37
    s_lshl_b32 s37, s30, 13
    s_add_u32 s36, s36, s37
    s_add_u32 s60, s36, 0x200000
    s_add_u32 s61, s37, s50
    s_mov_b32 m0, s61
    s_add_u32 s61, s61, 1024
    buffer_load_dwordx4 v0, s[4:7], s60 offen sc1 lds
    s_add_u32 s60, s60, 1024
    s_mov_b32 m0, s61
    s_add_u32 s61, s61, 1024
    buffer_load_dwordx4 v0, s[4:7], s60 offen sc1 lds
    s_add_u32 s60, s60, 1024
    s_mov_b32 m0, s61
    s_add_u32 s61, s61, 1024
    buffer_load_dwordx4 v0, s[4:7], s60 offen sc1 lds
    s_add_u32 s60, s60, 1024
    s_mov_b32 m0, s61
    s_add_u32 s61, s61, 1024
    buffer_load_dwordx4 v0, s[4:7], s60 offen sc1 lds
    s_add_u32 s60, s60, 1024
    s_mov_b32 m0, s61
    s_add_u32 s61, s61, 1024
    buffer_load_dwordx4 v0, s[4:7], s60 offen sc1 lds
    s_add_u32 s60, s60, 1024
    s_mov_b32 m0, s61
    s_add_u32 s61, s61, 1024
    buffer_load_dwordx4 v0, s[4:7], s60 offen sc1 lds
    s_add_u32 s60, s60, 1024
    s_mov_b32 m0, s61
    s_add_u32 s61, s61, 1024
    buffer_load_dwordx4 v0, s[4:7], s60 offen sc1 lds
    s_add_u32 s60, s60, 1024
    s_mov_b32 m0, s61
    s_add_u32 s61, s61, 1024
    buffer_load_dwordx4 v0, s[4:7], s60 offen sc1 lds
    s_add_u32 s60, s60, 1024
    s_mov_b32 m0, s51
    s_nop 0
    buffer_load_dword v2, s[4:7], s63 offen sc1 lds
    s_mov_b32 s45, s47
    s_mov_b32 s46, s48
    s_waitcnt vmcnt(0)
    s_barrier
    v_add_u32 v8, s50, v0
    ds_read_b128 v[48:51], v8 offset:0
    ds_read_b128 v[52:55], v8 offset:16384
    ds_read_b128 v[56:59], v8 offset:1024
    ds_read_b128 v[60:63], v8 offset:17408
    v_lshlrev_b32 v5, 2, v1
    v_add_u32 v5, s51, v5
    ds_read_b32 v4, v5
    s_xor_b32 s51, s51, 256
L_pvk_main:
    s_waitcnt lgkmcnt(3)
    v_mfma_f32_16x16x32_bf16 v[16:19], a[0:3], v[48:51], 0
    ds_read_b128 v[64:67], v8 offset:2048
    v_mfma_f32_16x16x32_bf16 v[20:23], a[64:67], v[48:51], 0
    ds_read_b128 v[68:71], v8 offset:18432
    v_mfma_f32_16x16x32_bf16 v[24:27], v[48:51], a[128:131], 0
    s_mov_b32 s86, s41
    v_mfma_f32_16x16x32_bf16 v[28:31], a[0:3], v[52:55], 0
    s_mov_b32 s87, s42
    v_mfma_f32_16x16x32_bf16 v[32:35], a[64:67], v[52:55], 0
    v_mfma_f32_16x16x32_bf16 v[36:39], v[52:55], a[128:131], 0
    s_waitcnt lgkmcnt(3)
    v_mfma_f32_16x16x32_bf16 v[16:19], a[4:7], v[56:59], v[16:19]
    ds_read_b128 v[48:51], v8 offset:3072
    v_mfma_f32_16x16x32_bf16 v[20:23], a[68:71], v[56:59], v[20:23]
    ds_read_b128 v[52:55], v8 offset:19456
    v_mfma_f32_16x16x32_bf16 v[24:27], v[56:59], a[132:135], v[24:27]
    v_mfma_f32_16x16x32_bf16 v[28:31], a[4:7], v[60:63], v[28:31]
    v_mfma_f32_16x16x32_bf16 v[32:35], a[68:71], v[60:63], v[32:35]
    v_mfma_f32_16x16x32_bf16 v[36:39], v[60:63], a[132:135], v[36:39]
    s_waitcnt lgkmcnt(2)
    v_mfma_f32_16x16x32_bf16 v[16:19], a[8:11], v[64:67], v[16:19]
    ds_read_b128 v[56:59], v8 offset:4096
    ds_read_b128 v[60:63], v8 offset:20480
    v_mov_b32 v6, s86
    v_mfma_f32_16x16x32_bf16 v[20:23], a[72:75], v[64:67], v[20:23]
    v_mov_b32 v7, s87
    v_cndmask_b32 v6, v6, v7, s[88:89]
    v_and_b32 v7, 3, v6
    v_mfma_f32_16x16x32_bf16 v[24:27], v[64:67], a[136:139], v[24:27]
    v_lshlrev_b32 v7, 1, v7
    v_sub_u32 v7, v14, v7
    v_lshrrev_b32 v6, 2, v6
    v_mfma_f32_16x16x32_bf16 v[28:31], a[8:11], v[68:71], v[28:31]
    v_add_u32 v6, 1, v6
    v_cmp_gt_u32 vcc, 2, v7
    s_nop 1
    v_mfma_f32_16x16x32_bf16 v[32:35], a[72:75], v[68:71], v[32:35]
    v_cndmask_b32 v7, 0, v6, vcc
    v_cmp_lt_u32 vcc, v4, v7
    v_mfma_f32_16x16x32_bf16 v[36:39], v[68:71], a[136:139], v[36:39]
    s_waitcnt lgkmcnt(2)
    v_mfma_f32_16x16x32_bf16 v[16:19], a[12:15], v[48:51], v[16:19]
    ds_read_b128 v[64:67], v8 offset:5120
    v_mfma_f32_16x16x32_bf16 v[20:23], a[76:79], v[48:51], v[20:23]
    ds_read_b128 v[68:71], v8 offset:21504
    v_mfma_f32_16x16x32_bf16 v[24:27], v[48:51], a[140:143], v[24:27]
    v_mfma_f32_16x16x32_bf16 v[28:31], a[12:15], v[52:55], v[28:31]
    v_mfma_f32_16x16x32_bf16 v[32:35], a[76:79], v[52:55], v[32:35]
    v_mfma_f32_16x16x32_bf16 v[36:39], v[52:55], a[140:143], v[36:39]
    s_cmp_eq_u32 vcc_hi, 0
    s_cselect_b32 s54, 1, 0
    s_cmp_lt_u32 s42, 64
    s_cselect_b32 s54, s54, 0
    s_cmp_eq_u32 vcc_lo, 0
    s_cselect_b32 s55, 1, 0
    s_cmp_lt_u32 s41, 64
    s_cselect_b32 s55, s55, 0
    s_or_b32 s49, s54, s55
    s_cmp_eq_u32 s54, 1
    s_cselect_b32 s47, 1, 0
    s_cselect_b32 s48, s87, s86
    s_cselect_b32 s55, 0, s55
    s_add_u32 s42, s42, s54
    s_add_u32 s41, s41, s55
    s_cmp_eq_u32 s49, 0
    s_cbranch_scc1 L_pvk_nopf
    s_xor_b32 s57, s50, 32768
    s_lshl_b32 s36, s47, 21
    s_lshl_b32 s37, s48, 15
    s_add_u32 s36, s36, s37
    s_lshl_b32 s37, s30, 13
    s_add_u32 s36, s36, s37
    s_add_u32 s60, s36, 0x200000
    s_add_u32 s61, s37, s57
    s_waitcnt lgkmcnt(2)
    v_mfma_f32_16x16x32_bf16 v[16:19], a[16:19], v[56:59], v[16:19]
    ds_read_b128 v[48:51], v8 offset:6144
    v_mfma_f32_16x16x32_bf16 v[20:23], a[80:83], v[56:59], v[20:23]
    ds_read_b128 v[52:55], v8 offset:22528
    v_mfma_f32_16x16x32_bf16 v[24:27], v[56:59], a[144:147], v[24:27]
    s_mov_b32 m0, s61
    v_mfma_f32_16x16x32_bf16 v[28:31], a[16:19], v[60:63], v[28:31]
    s_add_u32 s61, s61, 1024
    v_mfma_f32_16x16x32_bf16 v[32:35], a[80:83], v[60:63], v[32:35]
    buffer_load_dwordx4 v0, s[4:7], s60 offen sc1 lds
    v_mfma_f32_16x16x32_bf16 v[36:39], v[60:63], a[144:147], v[36:39]
    s_add_u32 s60, s60, 1024
    s_waitcnt lgkmcnt(2)
    v_mfma_f32_16x16x32_bf16 v[16:19], a[20:23], v[64:67], v[16:19]
    ds_read_b128 v[56:59], v8 offset:7168
    v_mfma_f32_16x16x32_bf16 v[20:23], a[84:87], v[64:67], v[20:23]
    ds_read_b128 v[60:63], v8 offset:23552
    v_mfma_f32_16x16x32_bf16 v[24:27], v[64:67], a[148:151], v[24:27]
    s_mov_b32 m0, s61
    v_mfma_f32_16x16x32_bf16 v[28:31], a[20:23], v[68:71], v[28:31]
    s_add_u32 s61, s61, 1024
    v_mfma_f32_16x16x32_bf16 v[32:35], a[84:87], v[68:71], v[32:35]
    buffer_load_dwordx4 v0, s[4:7], s60 offen sc1 lds
    v_mfma_f32_16x16x32_bf16 v[36:39], v[68:71], a[148:151], v[36:39]
    s_add_u32 s60, s60, 1024
    s_waitcnt lgkmcnt(2)
    v_mfma_f32_16x16x32_bf16 v[16:19], a[24:27], v[48:51], v[16:19]
    ds_read_b128 v[64:67], v8 offset:8192
    v_mfma_f32_16x16x32_bf16 v[20:23], a[88:91], v[48:51], v[20:23]
    ds_read_b128 v[68:71], v8 offset:24576
    v_mfma_f32_16x16x32_bf16 v[24:27], v[48:51], a[152:155], v[24:27]
    s_mov_b32 m0, s61
    v_mfma_f32_16x16x32_bf16 v[28:31], a[24:27], v[52:55], v[28:31]
    s_add_u32 s61, s61, 1024
    v_mfma_f32_16x16x32_bf16 v[32:35], a[88:91], v[52:55], v[32:35]
    buffer_load_dwordx4 v0, s[4:7], s60 offen sc1 lds
    v_mfma_f32_16x16x32_bf16 v[36:39], v[52:55], a[152:155], v[36:39]
    s_add_u32 s60, s60, 1024
    s_waitcnt lgkmcnt(2)
    v_mfma_f32_16x16x32_bf16 v[16:19], a[28:31], v[56:59], v[16:19]
    ds_read_b128 v[48:51], v8 offset:9216
    v_mfma_f32_16x16x32_bf16 v[20:23], a[92:95], v[56:59], v[20:23]
    ds_read_b128 v[52:55], v8 offset:25600
    v_mfma_f32_16x16x32_bf16 v[24:27], v[56:59], a[156:159], v[24:27]
    s_mov_b32 m0, s61
    v_mfma_f32_16x16x32_bf16 v[28:31], a[28:31], v[60:63], v[28:31]
    s_add_u32 s61, s61, 1024
    v_mfma_f32_16x16x32_bf16 v[32:35], a[92:95], v[60:63], v[32:35]
    buffer_load_dwordx4 v0, s[4:7], s60 offen sc1 lds
    v_mfma_f32_16x16x32_bf16 v[36:39], v[60:63], a[156:159], v[36:39]
    s_add_u32 s60, s60, 1024
    s_waitcnt lgkmcnt(2)
    v_mfma_f32_16x16x32_bf16 v[16:19], a[32:35], v[64:67], v[16:19]
    ds_read_b128 v[56:59], v8 offset:10240
    v_mfma_f32_16x16x32_bf16 v[20:23], a[96:99], v[64:67], v[20:23]
    ds_read_b128 v[60:63], v8 offset:26624
    v_mfma_f32_16x16x32_bf16 v[24:27], v[64:67], a[160:163], v[24:27]
    s_mov_b32 m0, s61
    v_mfma_f32_16x16x32_bf16 v[28:31], a[32:35], v[68:71], v[28:31]
    s_add_u32 s61, s61, 1024
    v_mfma_f32_16x16x32_bf16 v[32:35], a[96:99], v[68:71], v[32:35]
    buffer_load_dwordx4 v0, s[4:7], s60 offen sc1 lds
    v_mfma_f32_16x16x32_bf16 v[36:39], v[68:71], a[160:163], v[36:39]
    s_add_u32 s60, s60, 1024
    s_waitcnt lgkmcnt(2)
    v_mfma_f32_16x16x32_bf16 v[16:19], a[36:39], v[48:51], v[16:19]
    ds_read_b128 v[64:67], v8 offset:11264
    v_mfma_f32_16x16x32_bf16 v[20:23], a[100:103], v[48:51], v[20:23]
    ds_read_b128 v[68:71], v8 offset:27648
    v_mfma_f32_16x16x32_bf16 v[24:27], v[48:51], a[164:167], v[24:27]
    s_mov_b32 m0, s61
    v_mfma_f32_16x16x32_bf16 v[28:31], a[36:39], v[52:55], v[28:31]
    s_add_u32 s61, s61, 1024
    v_mfma_f32_16x16x32_bf16 v[32:35], a[100:103], v[52:55], v[32:35]
    buffer_load_dwordx4 v0, s[4:7], s60 offen sc1 lds
    v_mfma_f32_16x16x32_bf16 v[36:39], v[52:55], a[164:167], v[36:39]
    s_add_u32 s60, s60, 1024
    s_waitcnt lgkmcnt(2)
    v_mfma_f32_16x16x32_bf16 v[16:19], a[40:43], v[56:59], v[16:19]
    ds_read_b128 v[48:51], v8 offset:12288
    v_mfma_f32_16x16x32_bf16 v[20:23], a[104:107], v[56:59], v[20:23]
    ds_read_b128 v[52:55], v8 offset:28672
    v_mfma_f32_16x16x32_bf16 v[24:27], v[56:59], a[168:171], v[24:27]
    s_mov_b32 m0, s61
    v_mfma_f32_16x16x32_bf16 v[28:31], a[40:43], v[60:63], v[28:31]
    s_add_u32 s61, s61, 1024
    v_mfma_f32_16x16x32_bf16 v[32:35], a[104:107], v[60:63], v[32:35]
    buffer_load_dwordx4 v0, s[4:7], s60 offen sc1 lds
    v_mfma_f32_16x16x32_bf16 v[36:39], v[60:63], a[168:171], v[36:39]
    s_add_u32 s60, s60, 1024
    s_waitcnt lgkmcnt(2)
    v_mfma_f32_16x16x32_bf16 v[16:19], a[44:47], v[64:67], v[16:19]
    ds_read_b128 v[56:59], v8 offset:13312
    ds_read_b128 v[60:63], v8 offset:29696
    v_mfma_f32_16x16x32_bf16 v[20:23], a[108:111], v[64:67], v[20:23]
    s_mov_b32 m0, s61
    s_add_u32 s61, s61, 1024
    v_mfma_f32_16x16x32_bf16 v[24:27], v[64:67], a[172:175], v[24:27]
    buffer_load_dwordx4 v0, s[4:7], s60 offen sc1 lds
    s_add_u32 s60, s60, 1024
    v_mfma_f32_16x16x32_bf16 v[28:31], a[44:47], v[68:71], v[28:31]
    s_mov_b32 m0, s51
    s_nop 0
    v_mfma_f32_16x16x32_bf16 v[32:35], a[108:111], v[68:71], v[32:35]
    buffer_load_dword v2, s[4:7], s63 offen sc1 lds
    v_mfma_f32_16x16x32_bf16 v[36:39], v[68:71], a[172:175], v[36:39]
    s_waitcnt lgkmcnt(2)
    v_mfma_f32_16x16x32_bf16 v[16:19], a[48:51], v[48:51], v[16:19]
    ds_read_b128 v[64:67], v8 offset:14336
    v_mfma_f32_16x16x32_bf16 v[20:23], a[112:115], v[48:51], v[20:23]
    ds_read_b128 v[68:71], v8 offset:30720
    v_mfma_f32_16x16x32_bf16 v[24:27], v[48:51], a[176:179], v[24:27]
    v_mfma_f32_16x16x32_bf16 v[28:31], a[48:51], v[52:55], v[28:31]
    v_mfma_f32_16x16x32_bf16 v[32:35], a[112:115], v[52:55], v[32:35]
    v_mfma_f32_16x16x32_bf16 v[36:39], v[52:55], a[176:179], v[36:39]
    s_waitcnt vmcnt(9)
    s_barrier
    v_mov_b32 v5, s53
    v_mov_b32 v6, 0
    s_mov_b64 exec, 1
    s_cmp_lg_u32 s30, 0
    s_cbranch_scc1 L_pub_4_d
    s_lshl_b32 s36, s52, 7
    s_add_u32 s36, s36, s62
    buffer_store_dword v5, v6, s[4:7], s36 offen sc1
    s_branch L_pub_4_e
L_pub_4_d:
    buffer_store_dword v5, v6, s[4:7], s97 offen
L_pub_4_e:
    s_mov_b64 exec, -1
    s_waitcnt lgkmcnt(2)
    v_mfma_f32_16x16x32_bf16 v[16:19], a[52:55], v[56:59], v[16:19]
    ds_read_b128 v[48:51], v8 offset:15360
    v_mfma_f32_16x16x32_bf16 v[20:23], a[116:119], v[56:59], v[20:23]
    ds_read_b128 v[52:55], v8 offset:31744
    v_mfma_f32_16x16x32_bf16 v[24:27], v[56:59], a[180:183], v[24:27]
    v_mfma_f32_16x16x32_bf16 v[28:31], a[52:55], v[60:63], v[28:31]
    v_mfma_f32_16x16x32_bf16 v[32:35], a[116:119], v[60:63], v[32:35]
    v_mfma_f32_16x16x32_bf16 v[36:39], v[60:63], a[180:183], v[36:39]
    s_waitcnt lgkmcnt(2)
    v_mfma_f32_16x16x32_bf16 v[16:19], a[56:59], v[64:67], v[16:19]
    s_lshl_b32 s92, s45, 24
    s_lshl_b32 s91, s31, 13
    v_mfma_f32_16x16x32_bf16 v[20:23], a[120:123], v[64:67], v[20:23]
    s_add_u32 s92, s92, s91
    s_lshl_b32 s91, s46, 18
    v_mfma_f32_16x16x32_bf16 v[24:27], v[64:67], a[184:187], v[24:27]
    s_add_u32 s92, s92, s91
    s_lshl_b32 s91, s30, 10
    v_mfma_f32_16x16x32_bf16 v[28:31], a[56:59], v[68:71], v[28:31]
    s_add_u32 s90, s92, s91
    s_add_u32 s90, s90, 0x1000000
    v_mfma_f32_16x16x32_bf16 v[32:35], a[120:123], v[68:71], v[32:35]
    s_lshl_b32 s91, s30, 11
    s_add_u32 s92, s92, s91
    v_mfma_f32_16x16x32_bf16 v[36:39], v[68:71], a[184:187], v[36:39]
    s_add_u32 s92, s92, 0x3000000
    s_add_u32 s91, s90, 4096
    s_waitcnt lgkmcnt(0)
    v_mfma_f32_16x16x32_bf16 v[16:19], a[60:63], v[48:51], v[16:19]
    v_mfma_f32_16x16x32_bf16 v[20:23], a[124:127], v[48:51], v[20:23]
    v_mfma_f32_16x16x32_bf16 v[24:27], v[48:51], a[188:191], v[24:27]
    v_mfma_f32_16x16x32_bf16 v[28:31], a[60:63], v[52:55], v[28:31]
    v_mfma_f32_16x16x32_bf16 v[32:35], a[124:127], v[52:55], v[32:35]
    v_mfma_f32_16x16x32_bf16 v[36:39], v[52:55], a[188:191], v[36:39]
    s_waitcnt vmcnt(1)
    s_barrier
    s_xor_b32 s50, s50, 32768
    v_add_u32 v8, s50, v0
    ds_read_b128 v[48:51], v8 offset:0
    ds_read_b128 v[52:55], v8 offset:16384
    ds_read_b128 v[56:59], v8 offset:1024
    ds_read_b128 v[60:63], v8 offset:17408
    v_lshlrev_b32 v5, 2, v1
    v_add_u32 v5, s51, v5
    ds_read_b32 v4, v5
    s_xor_b32 s51, s51, 256
    v_cvt_pk_bf16_f32 v72, v16, v17
    v_cvt_pk_bf16_f32 v73, v18, v19
    v_cvt_pk_bf16_f32 v74, v20, v21
    v_cvt_pk_bf16_f32 v75, v22, v23
    buffer_store_dwordx4 v[72:75], v0, s[4:7], s90 offen sc1
    v_cvt_pk_bf16_f32 v76, v24, v25
    v_cvt_pk_bf16_f32 v77, v26, v27
    v_cvt_pk_bf16_f32 v78, v36, v37
    v_cvt_pk_bf16_f32 v79, v38, v39
    buffer_store_dwordx4 v[76:79], v0, s[4:7], s92 offen sc1
    v_cvt_pk_bf16_f32 v80, v28, v29
    v_cvt_pk_bf16_f32 v81, v30, v31
    v_cvt_pk_bf16_f32 v82, v32, v33
    v_cvt_pk_bf16_f32 v83, v34, v35
    buffer_store_dwordx4 v[80:83], v0, s[4:7], s91 offen sc1
    s_mov_b32 s43, s52
    s_mov_b32 s44, s53
    s_cmp_eq_u32 s45, 0
    s_cselect_b32 s36, s58, s59
    s_add_u32 s53, s36, 1
    s_mov_b32 s52, s45
    s_cmp_eq_u32 s45, 0
    s_cselect_b32 s58, s53, s58
    s_cselect_b32 s59, s59, s53
    s_mov_b32 s45, s47
    s_mov_b32 s46, s48
    s_branch L_pvk_main
L_pvk_nopf:
    s_waitcnt lgkmcnt(2)
    v_mfma_f32_16x16x32_bf16 v[16:19], a[16:19], v[56:59], v[16:19]
    ds_read_b128 v[48:51], v8 offset:6144
    v_mfma_f32_16x16x32_bf16 v[20:23], a[80:83], v[56:59], v[20:23]
    ds_read_b128 v[52:55], v8 offset:22528
    v_mfma_f32_16x16x32_bf16 v[24:27], v[56:59], a[144:147], v[24:27]
    v_mfma_f32_16x16x32_bf16 v[28:31], a[16:19], v[60:63], v[28:31]
    v_mfma_f32_16x16x32_bf16 v[32:35], a[80:83], v[60:63], v[32:35]
    v_mfma_f32_16x16x32_bf16 v[36:39], v[60:63], a[144:147], v[36:39]
    s_waitcnt lgkmcnt(2)
    v_mfma_f32_16x16x32_bf16 v[16:19], a[20:23], v[64:67], v[16:19]
    ds_read_b128 v[56:59], v8 offset:7168
    v_mfma_f32_16x16x32_bf16 v[20:23], a[84:87], v[64:67], v[20:23]
    ds_read_b128 v[60:63], v8 offset:23552
    v_mfma_f32_16x16x32_bf16 v[24:27], v[64:67], a[148:151], v[24:27]
    v_mfma_f32_16x16x32_bf16 v[28:31], a[20:23], v[68:71], v[28:31]
    v_mfma_f32_16x16x32_bf16 v[32:35], a[84:87], v[68:71], v[32:35]
    v_mfma_f32_16x16x32_bf16 v[36:39], v[68:71], a[148:151], v[36:39]
    s_waitcnt lgkmcnt(2)
    v_mfma_f32_16x16x32_bf16 v[16:19], a[24:27], v[48:51], v[16:19]
    ds_read_b128 v[64:67], v8 offset:8192
    v_mfma_f32_16x16x32_bf16 v[20:23], a[88:91], v[48:51], v[20:23]
    ds_read_b128 v[68:71], v8 offset:24576
    v_mfma_f32_16x16x32_bf16 v[24:27], v[48:51], a[152:155], v[24:27]
    v_mfma_f32_16x16x32_bf16 v[28:31], a[24:27], v[52:55], v[28:31]
    v_mfma_f32_16x16x32_bf16 v[32:35], a[88:91], v[52:55], v[32:35]
    v_mfma_f32_16x16x32_bf16 v[36:39], v[52:55], a[152:155], v[36:39]
    s_waitcnt lgkmcnt(2)
    v_mfma_f32_16x16x32_bf16 v[16:19], a[28:31], v[56:59], v[16:19]
    ds_read_b128 v[48:51], v8 offset:9216
    v_mfma_f32_16x16x32_bf16 v[20:23], a[92:95], v[56:59], v[20:23]
    ds_read_b128 v[52:55], v8 offset:25600
    v_mfma_f32_16x16x32_bf16 v[24:27], v[56:59], a[156:159], v[24:27]
    v_mfma_f32_16x16x32_bf16 v[28:31], a[28:31], v[60:63], v[28:31]
    v_mfma_f32_16x16x32_bf16 v[32:35], a[92:95], v[60:63], v[32:35]
    v_mfma_f32_16x16x32_bf16 v[36:39], v[60:63], a[156:159], v[36:39]
    s_waitcnt lgkmcnt(2)
    v_mfma_f32_16x16x32_bf16 v[16:19], a[32:35], v[64:67], v[16:19]
    ds_read_b128 v[56:59], v8 offset:10240
    v_mfma_f32_16x16x32_bf16 v[20:23], a[96:99], v[64:67], v[20:23]
    ds_read_b128 v[60:63], v8 offset:26624
    v_mfma_f32_16x16x32_bf16 v[24:27], v[64:67], a[160:163], v[24:27]
    v_mfma_f32_16x16x32_bf16 v[28:31], a[32:35], v[68:71], v[28:31]
    v_mfma_f32_16x16x32_bf16 v[32:35], a[96:99], v[68:71], v[32:35]
    v_mfma_f32_16x16x32_bf16 v[36:39], v[68:71], a[160:163], v[36:39]
    s_waitcnt lgkmcnt(2)
    v_mfma_f32_16x16x32_bf16 v[16:19], a[36:39], v[48:51], v[16:19]
    ds_read_b128 v[64:67], v8 offset:11264
    v_mfma_f32_16x16x32_bf16 v[20:23], a[100:103], v[48:51], v[20:23]
    ds_read_b128 v[68:71], v8 offset:27648
    v_mfma_f32_16x16x32_bf16 v[24:27], v[48:51], a[164:167], v[24:27]
    v_mfma_f32_16x16x32_bf16 v[28:31], a[36:39], v[52:55], v[28:31]
    v_mfma_f32_16x16x32_bf16 v[32:35], a[100:103], v[52:55], v[32:35]
    v_mfma_f32_16x16x32_bf16 v[36:39], v[52:55], a[164:167], v[36:39]
    s_waitcnt lgkmcnt(2)
    v_mfma_f32_16x16x32_bf16 v[16:19], a[40:43], v[56:59], v[16:19]
    ds_read_b128 v[48:51], v8 offset:12288
    v_mfma_f32_16x16x32_bf16 v[20:23], a[104:107], v[56:59], v[20:23]
    ds_read_b128 v[52:55], v8 offset:28672
    v_mfma_f32_16x16x32_bf16 v[24:27], v[56:59], a[168:171], v[24:27]
    v_mfma_f32_16x16x32_bf16 v[28:31], a[40:43], v[60:63], v[28:31]
    v_mfma_f32_16x16x32_bf16 v[32:35], a[104:107], v[60:63], v[32:35]
    v_mfma_f32_16x16x32_bf16 v[36:39], v[60:63], a[168:171], v[36:39]
    s_waitcnt lgkmcnt(2)
    v_mfma_f32_16x16x32_bf16 v[16:19], a[44:47], v[64:67], v[16:19]
    ds_read_b128 v[56:59], v8 offset:13312
    v_mfma_f32_16x16x32_bf16 v[20:23], a[108:111], v[64:67], v[20:23]
    ds_read_b128 v[60:63], v8 offset:29696
    v_mfma_f32_16x16x32_bf16 v[24:27], v[64:67], a[172:175], v[24:27]
    s_mov_b32 m0, s51
    v_mfma_f32_16x16x32_bf16 v[28:31], a[44:47], v[68:71], v[28:31]
    s_nop 0
    v_mfma_f32_16x16x32_bf16 v[32:35], a[108:111], v[68:71], v[32:35]
    buffer_load_dword v2, s[4:7], s63 offen sc1 lds
    v_mfma_f32_16x16x32_bf16 v[36:39], v[68:71], a[172:175], v[36:39]
    s_waitcnt lgkmcnt(2)
    v_mfma_f32_16x16x32_bf16 v[16:19], a[48:51], v[48:51], v[16:19]
    ds_read_b128 v[64:67], v8 offset:14336
    v_mfma_f32_16x16x32_bf16 v[20:23], a[112:115], v[48:51], v[20:23]
    ds_read_b128 v[68:71], v8 offset:30720
    v_mfma_f32_16x16x32_bf16 v[24:27], v[48:51], a[176:179], v[24:27]
    v_mfma_f32_16x16x32_bf16 v[28:31], a[48:51], v[52:55], v[28:31]
    v_mfma_f32_16x16x32_bf16 v[32:35], a[112:115], v[52:55], v[32:35]
    v_mfma_f32_16x16x32_bf16 v[36:39], v[52:55], a[176:179], v[36:39]
    s_waitcnt vmcnt(1)
    s_barrier
    v_mov_b32 v5, s53
    v_mov_b32 v6, 0
    s_mov_b64 exec, 1
    s_cmp_lg_u32 s30, 0
    s_cbranch_scc1 L_pub_5_d
    s_lshl_b32 s36, s52, 7
    s_add_u32 s36, s36, s62
    buffer_store_dword v5, v6, s[4:7], s36 offen sc1
    s_branch L_pub_5_e
L_pub_5_d:
    buffer_store_dword v5, v6, s[4:7], s97 offen
L_pub_5_e:
    s_mov_b64 exec, -1
    s_waitcnt lgkmcnt(2)
    v_mfma_f32_16x16x32_bf16 v[16:19], a[52:55], v[56:59], v[16:19]
    ds_read_b128 v[48:51], v8 offset:15360
    v_mfma_f32_16x16x32_bf16 v[20:23], a[116:119], v[56:59], v[20:23]
    ds_read_b128 v[52:55], v8 offset:31744
    v_mfma_f32_16x16x32_bf16 v[24:27], v[56:59], a[180:183], v[24:27]
    v_mfma_f32_16x16x32_bf16 v[28:31], a[52:55], v[60:63], v[28:31]
    v_mfma_f32_16x16x32_bf16 v[32:35], a[116:119], v[60:63], v[32:35]
    v_mfma_f32_16x16x32_bf16 v[36:39], v[60:63], a[180:183], v[36:39]
    s_waitcnt lgkmcnt(2)
    v_mfma_f32_16x16x32_bf16 v[16:19], a[56:59], v[64:67], v[16:19]
    s_lshl_b32 s92, s45, 24
    s_lshl_b32 s91, s31, 13
    v_mfma_f32_16x16x32_bf16 v[20:23], a[120:123], v[64:67], v[20:23]
    s_add_u32 s92, s92, s91
    s_lshl_b32 s91, s46, 18
    v_mfma_f32_16x16x32_bf16 v[24:27], v[64:67], a[184:187], v[24:27]
    s_add_u32 s92, s92, s91
    s_lshl_b32 s91, s30, 10
    v_mfma_f32_16x16x32_bf16 v[28:31], a[56:59], v[68:71], v[28:31]
    s_add_u32 s90, s92, s91
    s_add_u32 s90, s90, 0x1000000
    v_mfma_f32_16x16x32_bf16 v[32:35], a[120:123], v[68:71], v[32:35]
    s_lshl_b32 s91, s30, 11
    s_add_u32 s92, s92, s91
    v_mfma_f32_16x16x32_bf16 v[36:39], v[68:71], a[184:187], v[36:39]
    s_add_u32 s92, s92, 0x3000000
    s_add_u32 s91, s90, 4096
    s_waitcnt lgkmcnt(0)
    v_mfma_f32_16x16x32_bf16 v[16:19], a[60:63], v[48:51], v[16:19]
    v_mfma_f32_16x16x32_bf16 v[20:23], a[124:127], v[48:51], v[20:23]
    v_mfma_f32_16x16x32_bf16 v[24:27], v[48:51], a[188:191], v[24:27]
    v_mfma_f32_16x16x32_bf16 v[28:31], a[60:63], v[52:55], v[28:31]
    v_mfma_f32_16x16x32_bf16 v[32:35], a[124:127], v[52:55], v[32:35]
    v_mfma_f32_16x16x32_bf16 v[36:39], v[52:55], a[188:191], v[36:39]
    s_nop 7
    v_cvt_pk_bf16_f32 v72, v16, v17
    v_cvt_pk_bf16_f32 v73, v18, v19
    v_cvt_pk_bf16_f32 v74, v20, v21
    v_cvt_pk_bf16_f32 v75, v22, v23
    buffer_store_dwordx4 v[72:75], v0, s[4:7], s90 offen sc1
    v_cvt_pk_bf16_f32 v76, v24, v25
    v_cvt_pk_bf16_f32 v77, v26, v27
    v_cvt_pk_bf16_f32 v78, v36, v37
    v_cvt_pk_bf16_f32 v79, v38, v39
    buffer_store_dwordx4 v[76:79], v0, s[4:7], s92 offen sc1
    v_cvt_pk_bf16_f32 v80, v28, v29
    v_cvt_pk_bf16_f32 v81, v30, v31
    v_cvt_pk_bf16_f32 v82, v32, v33
    v_cvt_pk_bf16_f32 v83, v34, v35
    buffer_store_dwordx4 v[80:83], v0, s[4:7], s91 offen sc1
    s_mov_b32 s43, s52
    s_mov_b32 s44, s53
    s_cmp_eq_u32 s45, 0
    s_cselect_b32 s36, s58, s59
    s_add_u32 s53, s36, 1
    s_mov_b32 s52, s45
    s_cmp_eq_u32 s45, 0
    s_cselect_b32 s58, s53, s58
    s_cselect_b32 s59, s59, s53
    s_waitcnt vmcnt(4)
    s_barrier
    v_lshlrev_b32 v5, 2, v1
    v_add_u32 v5, s51, v5
    ds_read_b32 v4, v5
    s_xor_b32 s51, s51, 256
    s_waitcnt lgkmcnt(0)
    s_cmp_ge_u32 s42, 64
    s_cbranch_scc1 L_pvk_w_try1
    s_mov_b32 s48, s42
    s_and_b32 s36, s48, 3
    s_lshl_b32 s36, s36, 1
    s_add_u32 s36, s36, 32
    s_lshr_b32 s37, s48, 2
    s_add_u32 s37, s37, 1
    v_subrev_u32 v7, s36, v1
    v_cmp_gt_u32 vcc, 2, v7
    v_mov_b32 v6, s37
    s_nop 0
    v_cndmask_b32 v7, 0, v6, vcc
    v_cmp_lt_u32 vcc, v4, v7
    s_nop 1
    s_cmp_eq_u64 vcc, 0
    s_cbranch_scc0 L_pvk_w_try1
    s_mov_b32 s47, 1
    s_add_u32 s42, s42, 1
    s_cmp_eq_u32 s47, s47
    s_branch L_pvk_w_done
L_pvk_w_try1:
    s_cmp_ge_u32 s41, 64
    s_cbranch_scc1 L_pvk_w_try2
    s_mov_b32 s48, s41
    s_and_b32 s36, s48, 3
    s_lshl_b32 s36, s36, 1
    s_add_u32 s36, s36, 0
    s_lshr_b32 s37, s48, 2
    s_add_u32 s37, s37, 1
    v_subrev_u32 v7, s36, v1
    v_cmp_gt_u32 vcc, 2, v7
    v_mov_b32 v6, s37
    s_nop 0
    v_cndmask_b32 v7, 0, v6, vcc
    v_cmp_lt_u32 vcc, v4, v7
    s_nop 1
    s_cmp_eq_u64 vcc, 0
    s_cbranch_scc0 L_pvk_w_try2
    s_mov_b32 s47, 0
    s_add_u32 s41, s41, 1
    s_cmp_eq_u32 s47, s47
    s_branch L_pvk_w_done
L_pvk_w_try2:
    s_cmp_lg_u32 s47, s47
L_pvk_w_done:
    s_cbranch_scc0 L_pvk_cold
    s_xor_b32 s50, s50, 32768
    s_mov_b32 m0, s51
    s_nop 0
    buffer_load_dword v2, s[4:7], s63 offen sc1 lds
    s_lshl_b32 s36, s47, 21
    s_lshl_b32 s37, s48, 15
    s_add_u32 s36, s36, s37
    s_lshl_b32 s37, s30, 13
    s_add_u32 s36, s36, s37
    s_add_u32 s60, s36, 0x200000
    s_add_u32 s61, s37, s50
    s_mov_b32 m0, s61
    s_add_u32 s61, s61, 1024
    buffer_load_dwordx4 v0, s[4:7], s60 offen sc1 lds
    s_add_u32 s60, s60, 1024
    s_mov_b32 m0, s61
    s_add_u32 s61, s61, 1024
    buffer_load_dwordx4 v0, s[4:7], s60 offen sc1 lds
    s_add_u32 s60, s60, 1024
    s_mov_b32 m0, s61
    s_add_u32 s61, s61, 1024
    buffer_load_dwordx4 v0, s[4:7], s60 offen sc1 lds
    s_add_u32 s60, s60, 1024
    s_mov_b32 m0, s61
    s_add_u32 s61, s61, 1024
    buffer_load_dwordx4 v0, s[4:7], s60 offen sc1 lds
    s_add_u32 s60, s60, 1024
    s_mov_b32 m0, s61
    s_add_u32 s61, s61, 1024
    buffer_load_dwordx4 v0, s[4:7], s60 offen sc1 lds
    s_add_u32 s60, s60, 1024
    s_mov_b32 m0, s61
    s_add_u32 s61, s61, 1024
    buffer_load_dwordx4 v0, s[4:7], s60 offen sc1 lds
    s_add_u32 s60, s60, 1024
    s_mov_b32 m0, s61
    s_add_u32 s61, s61, 1024
    buffer_load_dwordx4 v0, s[4:7], s60 offen sc1 lds
    s_add_u32 s60, s60, 1024
    s_mov_b32 m0, s61
    s_add_u32 s61, s61, 1024
    buffer_load_dwordx4 v0, s[4:7], s60 offen sc1 lds
    s_add_u32 s60, s60, 1024
    s_mov_b32 s45, s47
    s_mov_b32 s46, s48
    s_waitcnt vmcnt(9)
    s_barrier
    s_cmp_eq_u32 s43, s52
    s_cbranch_scc1 L_pvk_wnopub2
    v_mov_b32 v5, s44
    v_mov_b32 v6, 0
    s_mov_b64 exec, 1
    s_cmp_lg_u32 s30, 0
    s_cbranch_scc1 L_pub_6_d
    s_lshl_b32 s36, s43, 7
    s_add_u32 s36, s36, s62
    buffer_store_dword v5, v6, s[4:7], s36 offen sc1
    s_branch L_pub_6_e
L_pub_6_d:
    buffer_store_dword v5, v6, s[4:7], s97 offen
L_pub_6_e:
    s_mov_b64 exec, -1
L_pvk_wnopub2:
    v_mov_b32 v5, s53
    v_mov_b32 v6, 0
    s_mov_b64 exec, 1
    s_cmp_lg_u32 s30, 0
    s_cbranch_scc1 L_pub_7_d
    s_lshl_b32 s36, s52, 7
    s_add_u32 s36, s36, s62
    buffer_store_dword v5, v6, s[4:7], s36 offen sc1
    s_branch L_pub_7_e
L_pub_7_d:
    buffer_store_dword v5, v6, s[4:7], s97 offen
L_pub_7_e:
    s_mov_b64 exec, -1
    s_mov_b32 s43, s52
    s_mov_b32 s44, s53
    s_waitcnt vmcnt(1)
    s_barrier
    v_add_u32 v8, s50, v0
    ds_read_b128 v[48:51], v8 offset:0
    ds_read_b128 v[52:55], v8 offset:16384
    ds_read_b128 v[56:59], v8 offset:1024
    ds_read_b128 v[60:63], v8 offset:17408
    v_lshlrev_b32 v5, 2, v1
    v_add_u32 v5, s51, v5
    ds_read_b32 v4, v5
    s_xor_b32 s51, s51, 256
    s_branch L_pvk_main
L_pvk_exit:
    s_waitcnt vmcnt(0)
    s_branch L_end
L_role_q:
    v_mbcnt_lo_u32_b32 v1, -1, 0
    v_mbcnt_hi_u32_b32 v1, -1, v1
    v_lshlrev_b32 v0, 4, v1
    s_mov_b32 s35, 65536
    s_lshl_b32 s36, s28, 5
    s_add_u32 s36, s36, s29
    s_lshl_b32 s36, s36, 2
    s_add_u32 s36, s36, s30
    s_lshl_b32 s36, s36, 5
    s_and_b32 s36, s36, 0x7fff
    s_add_u32 s97, s36, 0x8000
    s_load_dwordx2 s[36:37], s[0:1], 16
    s_waitcnt lgkmcnt(0)
    s_mov_b32 s8, s36
    s_and_b32 s9, s37, 0xffff
    s_mov_b32 s10, 0x400000
    s_mov_b32 s11, 0x20000
    s_lshl_b32 s64, s31, 8
    v_lshrrev_b32 v10, 4, v1
    s_mov_b32 s36, 8192
    v_mul_lo_u32 v8, v10, s36
    v_and_b32 v10, 15, v1
    v_lshl_add_u32 v8, v10, 4, v8
    v_lshrrev_b32 v10, 4, v1
    v_lshlrev_b32 v10, 3, v10
    v_bfe_u32 v11, v1, 2, 2
    v_add_u32 v10, v10, v11
    v_mul_u32_u24 v9, 256, v10
    v_and_b32 v10, 3, v1
    v_lshlrev_b32 v10, 4, v10
    s_lshl_b32 s36, s30, 6
    v_add_u32 v10, s36, v10
    v_add_u32 v9, v9, v10
    s_mul_i32 s37, s30, 524288
    s_add_u32 s37, s37, s64
    s_add_u32 s37, s37, 0
    s_mul_i32 s38, s30, 16384
    s_add_u32 s38, s38, 0
    s_mov_b32 m0, s38
    s_add_u32 s38, s38, 1024
    buffer_load_dwordx4 v8, s[8:11], s37 offen lds
    s_add_u32 s37, s37, 32768
    s_mov_b32 m0, s38
    s_add_u32 s38, s38, 1024
    buffer_load_dwordx4 v8, s[8:11], s37 offen lds
    s_add_u32 s37, s37, 32768
    s_mov_b32 m0, s38
    s_add_u32 s38, s38, 1024
    buffer_load_dwordx4 v8, s[8:11], s37 offen lds
    s_add_u32 s37, s37, 32768
    s_mov_b32 m0, s38
    s_add_u32 s38, s38, 1024
    buffer_load_dwordx4 v8, s[8:11], s37 offen lds
    s_add_u32 s37, s37, 32768
    s_mov_b32 m0, s38
    s_add_u32 s38, s38, 1024
    buffer_load_dwordx4 v8, s[8:11], s37 offen lds
    s_add_u32 s37, s37, 32768
    s_mov_b32 m0, s38
    s_add_u32 s38, s38, 1024
    buffer_load_dwordx4 v8, s[8:11], s37 offen lds
    s_add_u32 s37, s37, 32768
    s_mov_b32 m0, s38
    s_add_u32 s38, s38, 1024
    buffer_load_dwordx4 v8, s[8:11], s37 offen lds
    s_add_u32 s37, s37, 32768
    s_mov_b32 m0, s38
    s_add_u32 s38, s38, 1024
    buffer_load_dwordx4 v8, s[8:11], s37 offen lds
    s_add_u32 s37, s37, 32768
    s_mov_b32 m0, s38
    s_add_u32 s38, s38, 1024
    buffer_load_dwordx4 v8, s[8:11], s37 offen lds
    s_add_u32 s37, s37, 32768
    s_mov_b32 m0, s38
    s_add_u32 s38, s38, 1024
    buffer_load_dwordx4 v8, s[8:11], s37 offen lds
    s_add_u32 s37, s37, 32768
    s_mov_b32 m0, s38
    s_add_u32 s38, s38, 1024
    buffer_load_dwordx4 v8, s[8:11], s37 offen lds
    s_add_u32 s37, s37, 32768
    s_mov_b32 m0, s38
    s_add_u32 s38, s38, 1024
    buffer_load_dwordx4 v8, s[8:11], s37 offen lds
    s_add_u32 s37, s37, 32768
    s_mov_b32 m0, s38
    s_add_u32 s38, s38, 1024
    buffer_load_dwordx4 v8, s[8:11], s37 offen lds
    s_add_u32 s37, s37, 32768
    s_mov_b32 m0, s38
    s_add_u32 s38, s38, 1024
    buffer_load_dwordx4 v8, s[8:11], s37 offen lds
    s_add_u32 s37, s37, 32768
    s_mov_b32 m0, s38
    s_add_u32 s38, s38, 1024
    buffer_load_dwordx4 v8, s[8:11], s37 offen lds
    s_add_u32 s37, s37, 32768
    s_mov_b32 m0, s38
    s_add_u32 s38, s38, 1024
    buffer_load_dwordx4 v8, s[8:11], s37 offen lds
    s_add_u32 s37, s37, 32768
    s_mul_i32 s37, s30, 524288
    s_add_u32 s37, s37, s64
    s_add_u32 s37, s37, 2097152
    s_mul_i32 s38, s30, 16384
    s_add_u32 s38, s38, 65536
    s_mov_b32 m0, s38
    s_add_u32 s38, s38, 1024
    buffer_load_dwordx4 v8, s[8:11], s37 offen lds
    s_add_u32 s37, s37, 32768
    s_mov_b32 m0, s38
    s_add_u32 s38, s38, 1024
    buffer_load_dwordx4 v8, s[8:11], s37 offen lds
    s_add_u32 s37, s37, 32768
    s_mov_b32 m0, s38
    s_add_u32 s38, s38, 1024
    buffer_load_dwordx4 v8, s[8:11], s37 offen lds
    s_add_u32 s37, s37, 32768
    s_mov_b32 m0, s38
    s_add_u32 s38, s38, 1024
    buffer_load_dwordx4 v8, s[8:11], s37 offen lds
    s_add_u32 s37, s37, 32768
    s_mov_b32 m0, s38
    s_add_u32 s38, s38, 1024
    buffer_load_dwordx4 v8, s[8:11], s37 offen lds
    s_add_u32 s37, s37, 32768
    s_mov_b32 m0, s38
    s_add_u32 s38, s38, 1024
    buffer_load_dwordx4 v8, s[8:11], s37 offen lds
    s_add_u32 s37, s37, 32768
    s_mov_b32 m0, s38
    s_add_u32 s38, s38, 1024
    buffer_load_dwordx4 v8, s[8:11], s37 offen lds
    s_add_u32 s37, s37, 32768
    s_mov_b32 m0, s38
    s_add_u32 s38, s38, 1024
    buffer_load_dwordx4 v8, s[8:11], s37 offen lds
    s_add_u32 s37, s37, 32768
    s_mov_b32 m0, s38
    s_add_u32 s38, s38, 1024
    buffer_load_dwordx4 v8, s[8:11], s37 offen lds
    s_add_u32 s37, s37, 32768
    s_mov_b32 m0, s38
    s_add_u32 s38, s38, 1024
    buffer_load_dwordx4 v8, s[8:11], s37 offen lds
    s_add_u32 s37, s37, 32768
    s_mov_b32 m0, s38
    s_add_u32 s38, s38, 1024
    buffer_load_dwordx4 v8, s[8:11], s37 offen lds
    s_add_u32 s37, s37, 32768
    s_mov_b32 m0, s38
    s_add_u32 s38, s38, 1024
    buffer_load_dwordx4 v8, s[8:11], s37 offen lds
    s_add_u32 s37, s37, 32768
    s_mov_b32 m0, s38
    s_add_u32 s38, s38, 1024
    buffer_load_dwordx4 v8, s[8:11], s37 offen lds
    s_add_u32 s37, s37, 32768
    s_mov_b32 m0, s38
    s_add_u32 s38, s38, 1024
    buffer_load_dwordx4 v8, s[8:11], s37 offen lds
    s_add_u32 s37, s37, 32768
    s_mov_b32 m0, s38
    s_add_u32 s38, s38, 1024
    buffer_load_dwordx4 v8, s[8:11], s37 offen lds
    s_add_u32 s37, s37, 32768
    s_mov_b32 m0, s38
    s_add_u32 s38, s38, 1024
    buffer_load_dwordx4 v8, s[8:11], s37 offen lds
    s_add_u32 s37, s37, 32768
    s_waitcnt vmcnt(16)
    s_barrier
    v_add_u32 v11, 0, v9
    ds_read_b64_tr_b16 a[0:1], v11 offset:0
    ds_read_b64_tr_b16 a[2:3], v11 offset:1024
    ds_read_b64_tr_b16 a[64:65], v11 offset:8
    ds_read_b64_tr_b16 a[66:67], v11 offset:1032
    ds_read_b64_tr_b16 a[4:5], v11 offset:8192
    ds_read_b64_tr_b16 a[6:7], v11 offset:9216
    ds_read_b64_tr_b16 a[68:69], v11 offset:8200
    ds_read_b64_tr_b16 a[70:71], v11 offset:9224
    ds_read_b64_tr_b16 a[8:9], v11 offset:16384
    ds_read_b64_tr_b16 a[10:11], v11 offset:17408
    ds_read_b64_tr_b16 a[72:73], v11 offset:16392
    ds_read_b64_tr_b16 a[74:75], v11 offset:17416
    ds_read_b64_tr_b16 a[12:13], v11 offset:24576
    ds_read_b64_tr_b16 a[14:15], v11 offset:25600
    s_waitcnt lgkmcnt(0)
    ds_read_b64_tr_b16 a[76:77], v11 offset:24584
    ds_read_b64_tr_b16 a[78:79], v11 offset:25608
    ds_read_b64_tr_b16 a[16:17], v11 offset:32768
    ds_read_b64_tr_b16 a[18:19], v11 offset:33792
    ds_read_b64_tr_b16 a[80:81], v11 offset:32776
    ds_read_b64_tr_b16 a[82:83], v11 offset:33800
    ds_read_b64_tr_b16 a[20:21], v11 offset:40960
    ds_read_b64_tr_b16 a[22:23], v11 offset:41984
    ds_read_b64_tr_b16 a[84:85], v11 offset:40968
    ds_read_b64_tr_b16 a[86:87], v11 offset:41992
    ds_read_b64_tr_b16 a[24:25], v11 offset:49152
    ds_read_b64_tr_b16 a[26:27], v11 offset:50176
    ds_read_b64_tr_b16 a[88:89], v11 offset:49160
    ds_read_b64_tr_b16 a[90:91], v11 offset:50184
    s_waitcnt lgkmcnt(0)
    ds_read_b64_tr_b16 a[28:29], v11 offset:57344
    ds_read_b64_tr_b16 a[30:31], v11 offset:58368
    ds_read_b64_tr_b16 a[92:93], v11 offset:57352
    ds_read_b64_tr_b16 a[94:95], v11 offset:58376
    s_waitcnt lgkmcnt(0)
    s_barrier
    s_waitcnt vmcnt(0)
    s_barrier
    v_add_u32 v11, 65536, v9
    ds_read_b64_tr_b16 a[32:33], v11 offset:0
    ds_read_b64_tr_b16 a[34:35], v11 offset:1024
    ds_read_b64_tr_b16 a[96:97], v11 offset:8
    ds_read_b64_tr_b16 a[98:99], v11 offset:1032
    ds_read_b64_tr_b16 a[36:37], v11 offset:8192
    ds_read_b64_tr_b16 a[38:39], v11 offset:9216
    ds_read_b64_tr_b16 a[100:101], v11 offset:8200
    ds_read_b64_tr_b16 a[102:103], v11 offset:9224
    ds_read_b64_tr_b16 a[40:41], v11 offset:16384
    ds_read_b64_tr_b16 a[42:43], v11 offset:17408
    ds_read_b64_tr_b16 a[104:105], v11 offset:16392
    ds_read_b64_tr_b16 a[106:107], v11 offset:17416
    ds_read_b64_tr_b16 a[44:45], v11 offset:24576
    ds_read_b64_tr_b16 a[46:47], v11 offset:25600
    s_waitcnt lgkmcnt(0)
    ds_read_b64_tr_b16 a[108:109], v11 offset:24584
    ds_read_b64_tr_b16 a[110:111], v11 offset:25608
    ds_read_b64_tr_b16 a[48:49], v11 offset:32768
    ds_read_b64_tr_b16 a[50:51], v11 offset:33792
    ds_read_b64_tr_b16 a[112:113], v11 offset:32776
    ds_read_b64_tr_b16 a[114:115], v11 offset:33800
    ds_read_b64_tr_b16 a[52:53], v11 offset:40960
    ds_read_b64_tr_b16 a[54:55], v11 offset:41984
    ds_read_b64_tr_b16 a[116:117], v11 offset:40968
    ds_read_b64_tr_b16 a[118:119], v11 offset:41992
    ds_read_b64_tr_b16 a[56:57], v11 offset:49152
    ds_read_b64_tr_b16 a[58:59], v11 offset:50176
    ds_read_b64_tr_b16 a[120:121], v11 offset:49160
    ds_read_b64_tr_b16 a[122:123], v11 offset:50184
    s_waitcnt lgkmcnt(0)
    ds_read_b64_tr_b16 a[60:61], v11 offset:57344
    ds_read_b64_tr_b16 a[62:63], v11 offset:58368
    ds_read_b64_tr_b16 a[124:125], v11 offset:57352
    ds_read_b64_tr_b16 a[126:127], v11 offset:58376
    s_waitcnt lgkmcnt(0)
    s_barrier
    s_load_dwordx2 s[36:37], s[0:1], 32
    s_waitcnt lgkmcnt(0)
    s_mov_b32 s8, s36
    s_and_b32 s9, s37, 0xffff
    s_mov_b32 s10, 0x400000
    s_mov_b32 s11, 0x20000
    s_lshl_b32 s64, s31, 8
    v_lshrrev_b32 v10, 4, v1
    s_mov_b32 s36, 8192
    v_mul_lo_u32 v8, v10, s36
    v_and_b32 v10, 15, v1
    v_lshl_add_u32 v8, v10, 4, v8
    v_lshrrev_b32 v10, 4, v1
    v_lshlrev_b32 v10, 3, v10
    v_bfe_u32 v11, v1, 2, 2
    v_add_u32 v10, v10, v11
    v_mul_u32_u24 v9, 256, v10
    v_and_b32 v10, 3, v1
    v_lshlrev_b32 v10, 4, v10
    s_lshl_b32 s36, s30, 6
    v_add_u32 v10, s36, v10
    v_add_u32 v9, v9, v10
    s_mul_i32 s37, s30, 524288
    s_add_u32 s37, s37, s64
    s_add_u32 s37, s37, 0
    s_mul_i32 s38, s30, 16384
    s_add_u32 s38, s38, 0
    s_mov_b32 m0, s38
    s_add_u32 s38, s38, 1024
    buffer_load_dwordx4 v8, s[8:11], s37 offen lds
    s_add_u32 s37, s37, 32768
    s_mov_b32 m0, s38
    s_add_u32 s38, s38, 1024
    buffer_load_dwordx4 v8, s[8:11], s37 offen lds
    s_add_u32 s37, s37, 32768
    s_mov_b32 m0, s38
    s_add_u32 s38, s38, 1024
    buffer_load_dwordx4 v8, s[8:11], s37 offen lds
    s_add_u32 s37, s37, 32768
    s_mov_b32 m0, s38
    s_add_u32 s38, s38, 1024
    buffer_load_dwordx4 v8, s[8:11], s37 offen lds
    s_add_u32 s37, s37, 32768
    s_mov_b32 m0, s38
    s_add_u32 s38, s38, 1024
    buffer_load_dwordx4 v8, s[8:11], s37 offen lds
    s_add_u32 s37, s37, 32768
    s_mov_b32 m0, s38
    s_add_u32 s38, s38, 1024
    buffer_load_dwordx4 v8, s[8:11], s37 offen lds
    s_add_u32 s37, s37, 32768
    s_mov_b32 m0, s38
    s_add_u32 s38, s38, 1024
    buffer_load_dwordx4 v8, s[8:11], s37 offen lds
    s_add_u32 s37, s37, 32768
    s_mov_b32 m0, s38
    s_add_u32 s38, s38, 1024
    buffer_load_dwordx4 v8, s[8:11], s37 offen lds
    s_add_u32 s37, s37, 32768
    s_mov_b32 m0, s38
    s_add_u32 s38, s38, 1024
    buffer_load_dwordx4 v8, s[8:11], s37 offen lds
    s_add_u32 s37, s37, 32768
    s_mov_b32 m0, s38
    s_add_u32 s38, s38, 1024
    buffer_load_dwordx4 v8, s[8:11], s37 offen lds
    s_add_u32 s37, s37, 32768
    s_mov_b32 m0, s38
    s_add_u32 s38, s38, 1024
    buffer_load_dwordx4 v8, s[8:11], s37 offen lds
    s_add_u32 s37, s37, 32768
    s_mov_b32 m0, s38
    s_add_u32 s38, s38, 1024
    buffer_load_dwordx4 v8, s[8:11], s37 offen lds
    s_add_u32 s37, s37, 32768
    s_mov_b32 m0, s38
    s_add_u32 s38, s38, 1024
    buffer_load_dwordx4 v8, s[8:11], s37 offen lds
    s_add_u32 s37, s37, 32768
    s_mov_b32 m0, s38
    s_add_u32 s38, s38, 1024
    buffer_load_dwordx4 v8, s[8:11], s37 offen lds
    s_add_u32 s37, s37, 32768
    s_mov_b32 m0, s38
    s_add_u32 s38, s38, 1024
    buffer_load_dwordx4 v8, s[8:11], s37 offen lds
    s_add_u32 s37, s37, 32768
    s_mov_b32 m0, s38
    s_add_u32 s38, s38, 1024
    buffer_load_dwordx4 v8, s[8:11], s37 offen lds
    s_add_u32 s37, s37, 32768
    s_mul_i32 s37, s30, 524288
    s_add_u32 s37, s37, s64
    s_add_u32 s37, s37, 2097152
    s_mul_i32 s38, s30, 16384
    s_add_u32 s38, s38, 65536
    s_mov_b32 m0, s38
    s_add_u32 s38, s38, 1024
    buffer_load_dwordx4 v8, s[8:11], s37 offen lds
    s_add_u32 s37, s37, 32768
    s_mov_b32 m0, s38
    s_add_u32 s38, s38, 1024
    buffer_load_dwordx4 v8, s[8:11], s37 offen lds
    s_add_u32 s37, s37, 32768
    s_mov_b32 m0, s38
    s_add_u32 s38, s38, 1024
    buffer_load_dwordx4 v8, s[8:11], s37 offen lds
    s_add_u32 s37, s37, 32768
    s_mov_b32 m0, s38
    s_add_u32 s38, s38, 1024
    buffer_load_dwordx4 v8, s[8:11], s37 offen lds
    s_add_u32 s37, s37, 32768
    s_mov_b32 m0, s38
    s_add_u32 s38, s38, 1024
    buffer_load_dwordx4 v8, s[8:11], s37 offen lds
    s_add_u32 s37, s37, 32768
    s_mov_b32 m0, s38
    s_add_u32 s38, s38, 1024
    buffer_load_dwordx4 v8, s[8:11], s37 offen lds
    s_add_u32 s37, s37, 32768
    s_mov_b32 m0, s38
    s_add_u32 s38, s38, 1024
    buffer_load_dwordx4 v8, s[8:11], s37 offen lds
    s_add_u32 s37, s37, 32768
    s_mov_b32 m0, s38
    s_add_u32 s38, s38, 1024
    buffer_load_dwordx4 v8, s[8:11], s37 offen lds
    s_add_u32 s37, s37, 32768
    s_mov_b32 m0, s38
    s_add_u32 s38, s38, 1024
    buffer_load_dwordx4 v8, s[8:11], s37 offen lds
    s_add_u32 s37, s37, 32768
    s_mov_b32 m0, s38
    s_add_u32 s38, s38, 1024
    buffer_load_dwordx4 v8, s[8:11], s37 offen lds
    s_add_u32 s37, s37, 32768
    s_mov_b32 m0, s38
    s_add_u32 s38, s38, 1024
    buffer_load_dwordx4 v8, s[8:11], s37 offen lds
    s_add_u32 s37, s37, 32768
    s_mov_b32 m0, s38
    s_add_u32 s38, s38, 1024
    buffer_load_dwordx4 v8, s[8:11], s37 offen lds
    s_add_u32 s37, s37, 32768
    s_mov_b32 m0, s38
    s_add_u32 s38, s38, 1024
    buffer_load_dwordx4 v8, s[8:11], s37 offen lds
    s_add_u32 s37, s37, 32768
    s_mov_b32 m0, s38
    s_add_u32 s38, s38, 1024
    buffer_load_dwordx4 v8, s[8:11], s37 offen lds
    s_add_u32 s37, s37, 32768
    s_mov_b32 m0, s38
    s_add_u32 s38, s38, 1024
    buffer_load_dwordx4 v8, s[8:11], s37 offen lds
    s_add_u32 s37, s37, 32768
    s_mov_b32 m0, s38
    s_add_u32 s38, s38, 1024
    buffer_load_dwordx4 v8, s[8:11], s37 offen lds
    s_add_u32 s37, s37, 32768
    s_waitcnt vmcnt(16)
    s_barrier
    v_add_u32 v11, 0, v9
    ds_read_b64_tr_b16 a[128:129], v11 offset:8
    ds_read_b64_tr_b16 a[130:131], v11 offset:1032
    ds_read_b64_tr_b16 a[132:133], v11 offset:8200
    ds_read_b64_tr_b16 a[134:135], v11 offset:9224
    ds_read_b64_tr_b16 a[136:137], v11 offset:16392
    ds_read_b64_tr_b16 a[138:139], v11 offset:17416
    ds_read_b64_tr_b16 a[140:141], v11 offset:24584
    ds_read_b64_tr_b16 a[142:143], v11 offset:25608
    ds_read_b64_tr_b16 a[144:145], v11 offset:32776
    ds_read_b64_tr_b16 a[146:147], v11 offset:33800
    ds_read_b64_tr_b16 a[148:149], v11 offset:40968
    ds_read_b64_tr_b16 a[150:151], v11 offset:41992
    ds_read_b64_tr_b16 a[152:153], v11 offset:49160
    ds_read_b64_tr_b16 a[154:155], v11 offset:50184
    s_waitcnt lgkmcnt(0)
    ds_read_b64_tr_b16 a[156:157], v11 offset:57352
    ds_read_b64_tr_b16 a[158:159], v11 offset:58376
    s_waitcnt lgkmcnt(0)
    s_barrier
    s_waitcnt vmcnt(0)
    s_barrier
    v_add_u32 v11, 65536, v9
    ds_read_b64_tr_b16 a[160:161], v11 offset:8
    ds_read_b64_tr_b16 a[162:163], v11 offset:1032
    ds_read_b64_tr_b16 a[164:165], v11 offset:8200
    ds_read_b64_tr_b16 a[166:167], v11 offset:9224
    ds_read_b64_tr_b16 a[168:169], v11 offset:16392
    ds_read_b64_tr_b16 a[170:171], v11 offset:17416
    ds_read_b64_tr_b16 a[172:173], v11 offset:24584
    ds_read_b64_tr_b16 a[174:175], v11 offset:25608
    ds_read_b64_tr_b16 a[176:177], v11 offset:32776
    ds_read_b64_tr_b16 a[178:179], v11 offset:33800
    ds_read_b64_tr_b16 a[180:181], v11 offset:40968
    ds_read_b64_tr_b16 a[182:183], v11 offset:41992
    ds_read_b64_tr_b16 a[184:185], v11 offset:49160
    ds_read_b64_tr_b16 a[186:187], v11 offset:50184
    s_waitcnt lgkmcnt(0)
    ds_read_b64_tr_b16 a[188:189], v11 offset:57352
    ds_read_b64_tr_b16 a[190:191], v11 offset:58376
    s_waitcnt lgkmcnt(0)
    s_barrier
    v_and_b32 v5, 31, v1
    v_lshlrev_b32 v2, 2, v5
    v_lshrrev_b32 v5, 5, v1
    v_lshl_add_u32 v2, v5, 7, v2
    s_mov_b32 s63, 0
    s_lshl_b32 s36, s31, 2
    s_add_u32 s62, s36, 2304
    s_cmp_lg_u32 s30, 0
    s_cbranch_scc1 L_pw_ok_idpvq
    s_mov_b32 s36, 0
    v_mov_b32 v120, 32
L_pw_idpvq:
    buffer_load_dword v121, v120, s[24:27], 0 offen sc1
    s_waitcnt vmcnt(0)
    v_readfirstlane_b32 s37, v121
    s_nop 3
    s_cmp_ge_u32 s37, 256
    s_cbranch_scc1 L_pw_ok_idpvq
    s_sleep 4
    s_add_u32 s36, s36, 1
    s_cmp_lt_u32 s36, 65536
    s_cbranch_scc1 L_pw_idpvq
    s_mov_b32 s33, 1
L_pw_ok_idpvq:
    s_barrier
    s_mov_b32 s41, 0
    s_mov_b32 s58, 0
    s_mov_b32 s42, 0
    s_mov_b32 s59, 0
    s_mov_b32 s49, 0
    s_mov_b32 s50, 0
    s_mov_b32 s52, 0
    s_mov_b32 s53, 0
    s_mov_b32 s43, 0
    s_mov_b32 s44, 0
    s_mov_b32 s47, 0
    s_mov_b32 s48, 0
    s_mov_b32 s51, 163328
    v_cmp_lt_u32 s[88:89], 31, v1
    v_and_b32 v14, 31, v1
    s_mov_b32 s96, 0
L_pvq_cold:
    s_waitcnt vmcnt(0)
    s_barrier
    s_cmp_eq_u32 s43, s52
    s_cbranch_scc1 L_pvq_nopub2
    v_mov_b32 v5, s44
    v_mov_b32 v6, 0
    s_mov_b64 exec, 1
    s_cmp_lg_u32 s30, 0
    s_cbranch_scc1 L_pub_8_d
    s_lshl_b32 s36, s43, 7
    s_add_u32 s36, s36, s62
    buffer_store_dword v5, v6, s[4:7], s36 offen sc1
    s_branch L_pub_8_e
L_pub_8_d:
    buffer_store_dword v5, v6, s[4:7], s97 offen
L_pub_8_e:
    s_mov_b64 exec, -1
L_pvq_nopub2:
    v_mov_b32 v5, s53
    v_mov_b32 v6, 0
    s_mov_b64 exec, 1
    s_cmp_lg_u32 s30, 0
    s_cbranch_scc1 L_pub_9_d
    s_lshl_b32 s36, s52, 7
    s_add_u32 s36, s36, s62
    buffer_store_dword v5, v6, s[4:7], s36 offen sc1
    s_branch L_pub_9_e
L_pub_9_d:
    buffer_store_dword v5, v6, s[4:7], s97 offen
L_pub_9_e:
    s_mov_b64 exec, -1
    s_mov_b32 s43, s52
    s_mov_b32 s44, s53
    s_mov_b32 s40, 0
    s_add_u32 s36, s41, s42
    s_cmp_ge_u32 s36, 128
    s_cbranch_scc1 L_pvq_exit
    s_cmp_lg_u32 s30, 0
    s_cbranch_scc1 L_pvq_cwait
    s_waitcnt vmcnt(0)
    buffer_load_dword v12, v2, s[4:7], s63 offen sc1
    s_nop 15
    s_nop 15
    s_nop 15
    s_nop 15
    s_nop 15
    s_nop 15
L_pvq_w0spin:
    buffer_load_dword v13, v2, s[4:7], s63 offen sc1
    s_waitcnt vmcnt(1)
    v_mov_b32 v4, v12
    s_cmp_ge_u32 s42, 64
    s_cbranch_scc1 L_pvq_p_try1
    s_mov_b32 s48, s42
    s_and_b32 s36, s48, 3
    s_lshl_b32 s36, s36, 1
    s_add_u32 s36, s36, 32
    s_lshr_b32 s37, s48, 2
    s_add_u32 s37, s37, 1
    v_subrev_u32 v7, s36, v1
    v_cmp_gt_u32 vcc, 2, v7
    v_mov_b32 v6, s37
    s_nop 0
    v_cndmask_b32 v7, 0, v6, vcc
    v_cmp_lt_u32 vcc, v4, v7
    s_nop 1
    s_cmp_eq_u64 vcc, 0
    s_cbranch_scc1 L_pvq_p_done
L_pvq_p_try1:
    s_cmp_ge_u32 s41, 64
    s_cbranch_scc1 L_pvq_p_try2
    s_mov_b32 s48, s41
    s_and_b32 s36, s48, 3
    s_lshl_b32 s36, s36, 1
    s_add_u32 s36, s36, 0
    s_lshr_b32 s37, s48, 2
    s_add_u32 s37, s37, 1
    v_subrev_u32 v7, s36, v1
    v_cmp_gt_u32 vcc, 2, v7
    v_mov_b32 v6, s37
    s_nop 0
    v_cndmask_b32 v7, 0, v6, vcc
    v_cmp_lt_u32 vcc, v4, v7
    s_nop 1
    s_cmp_eq_u64 vcc, 0
    s_cbranch_scc1 L_pvq_p_done
L_pvq_p_try2:
    s_cmp_lg_u32 s47, s47
L_pvq_p_done:
    s_cbranch_scc1 L_pvq_w0got
    buffer_load_dword v12, v2, s[4:7], s63 offen sc1
    s_waitcnt vmcnt(1)
    v_mov_b32 v4, v13
    s_cmp_ge_u32 s42, 64
    s_cbranch_scc1 L_pvq_q_try1
    s_mov_b32 s48, s42
    s_and_b32 s36, s48, 3
    s_lshl_b32 s36, s36, 1
    s_add_u32 s36, s36, 32
    s_lshr_b32 s37, s48, 2
    s_add_u32 s37, s37, 1
    v_subrev_u32 v7, s36, v1
    v_cmp_gt_u32 vcc, 2, v7
    v_mov_b32 v6, s37
    s_nop 0
    v_cndmask_b32 v7, 0, v6, vcc
    v_cmp_lt_u32 vcc, v4, v7
    s_nop 1
    s_cmp_eq_u64 vcc, 0
    s_cbranch_scc1 L_pvq_q_done
L_pvq_q_try1:
    s_cmp_ge_u32 s41, 64
    s_cbranch_scc1 L_pvq_q_try2
    s_mov_b32 s48, s41
    s_and_b32 s36, s48, 3
    s_lshl_b32 s36, s36, 1
    s_add_u32 s36, s36, 0
    s_lshr_b32 s37, s48, 2
    s_add_u32 s37, s37, 1
    v_subrev_u32 v7, s36, v1
    v_cmp_gt_u32 vcc, 2, v7
    v_mov_b32 v6, s37
    s_nop 0
    v_cndmask_b32 v7, 0, v6, vcc
    v_cmp_lt_u32 vcc, v4, v7
    s_nop 1
    s_cmp_eq_u64 vcc, 0
    s_cbranch_scc1 L_pvq_q_done
L_pvq_q_try2:
    s_cmp_lg_u32 s47, s47
L_pvq_q_done:
    s_cbranch_scc1 L_pvq_w0got
    s_add_u32 s40, s40, 1
    s_cmp_lt_u32 s40, s35
    s_cbranch_scc1 L_pvq_w0spin
L_pvq_w0got:
    v_lshlrev_b32 v5, 2, v1
    v_add_u32 v5, s51, v5
    ds_write_b32 v5, v4
    s_waitcnt lgkmcnt(0)
L_pvq_cwait:
    s_barrier
    v_lshlrev_b32 v5, 2, v1
    v_add_u32 v5, s51, v5
    ds_read_b32 v4, v5
    s_xor_b32 s51, s51, 256
    s_waitcnt lgkmcnt(0)
    s_cmp_ge_u32 s42, 64
    s_cbranch_scc1 L_pvq_c_try1
    s_mov_b32 s48, s42
    s_and_b32 s36, s48, 3
    s_lshl_b32 s36, s36, 1
    s_add_u32 s36, s36, 32
    s_lshr_b32 s37, s48, 2
    s_add_u32 s37, s37, 1
    v_subrev_u32 v7, s36, v1
    v_cmp_gt_u32 vcc, 2, v7
    v_mov_b32 v6, s37
    s_nop 0
    v_cndmask_b32 v7, 0, v6, vcc
    v_cmp_lt_u32 vcc, v4, v7
    s_nop 1
    s_cmp_eq_u64 vcc, 0
    s_cbranch_scc0 L_pvq_c_try1
    s_mov_b32 s47, 1
    s_add_u32 s42, s42, 1
    s_cmp_eq_u32 s47, s47
    s_branch L_pvq_c_done
L_pvq_c_try1:
    s_cmp_ge_u32 s41, 64
    s_cbranch_scc1 L_pvq_c_try2
    s_mov_b32 s48, s41
    s_and_b32 s36, s48, 3
    s_lshl_b32 s36, s36, 1
    s_add_u32 s36, s36, 0
    s_lshr_b32 s37, s48, 2
    s_add_u32 s37, s37, 1
    v_subrev_u32 v7, s36, v1
    v_cmp_gt_u32 vcc, 2, v7
    v_mov_b32 v6, s37
    s_nop 0
    v_cndmask_b32 v7, 0, v6, vcc
    v_cmp_lt_u32 vcc, v4, v7
    s_nop 1
    s_cmp_eq_u64 vcc, 0
    s_cbranch_scc0 L_pvq_c_try2
    s_mov_b32 s47, 0
    s_add_u32 s41, s41, 1
    s_cmp_eq_u32 s47, s47
    s_branch L_pvq_c_done
L_pvq_c_try2:
    s_cmp_lg_u32 s47, s47
L_pvq_c_done:
    s_cbranch_scc1 L_pvq_got
    s_mov_b32 s33, 1
    s_branch L_pvq_exit
L_pvq_got:
    s_lshl_b32 s36, s47, 21
    s_lshl_b32 s37, s48, 15
    s_add_u32 s36, s36, s37
    s_lshl_b32 s37, s30, 13
    s_add_u32 s36, s36, s37
    s_add_u32 s60, s36, 0x200000
    s_add_u32 s61, s37, s50
    s_mov_b32 m0, s61
    s_add_u32 s61, s61, 1024
    buffer_load_dwordx4 v0, s[4:7], s60 offen sc1 lds
    s_add_u32 s60, s60, 1024
    s_mov_b32 m0, s61
    s_add_u32 s61, s61, 1024
    buffer_load_dwordx4 v0, s[4:7], s60 offen sc1 lds
    s_add_u32 s60, s60, 1024
    s_mov_b32 m0, s61
    s_add_u32 s61, s61, 1024
    buffer_load_dwordx4 v0, s[4:7], s60 offen sc1 lds
    s_add_u32 s60, s60, 1024
    s_mov_b32 m0, s61
    s_add_u32 s61, s61, 1024
    buffer_load_dwordx4 v0, s[4:7], s60 offen sc1 lds
    s_add_u32 s60, s60, 1024
    s_mov_b32 m0, s61
    s_add_u32 s61, s61, 1024
    buffer_load_dwordx4 v0, s[4:7], s60 offen sc1 lds
    s_add_u32 s60, s60, 1024
    s_mov_b32 m0, s61
    s_add_u32 s61, s61, 1024
    buffer_load_dwordx4 v0, s[4:7], s60 offen sc1 lds
    s_add_u32 s60, s60, 1024
    s_mov_b32 m0, s61
    s_add_u32 s61, s61, 1024
    buffer_load_dwordx4 v0, s[4:7], s60 offen sc1 lds
    s_add_u32 s60, s60, 1024
    s_mov_b32 m0, s61
    s_add_u32 s61, s61, 1024
    buffer_load_dwordx4 v0, s[4:7], s60 offen sc1 lds
    s_add_u32 s60, s60, 1024
    s_mov_b32 m0, s51
    s_nop 0
    buffer_load_dword v2, s[4:7], s63 offen sc1 lds
    s_mov_b32 s45, s47
    s_mov_b32 s46, s48
    s_waitcnt vmcnt(0)
    s_barrier
    v_add_u32 v8, s50, v0
    ds_read_b128 v[48:51], v8 offset:0
    ds_read_b128 v[52:55], v8 offset:16384
    ds_read_b128 v[56:59], v8 offset:1024
    ds_read_b128 v[60:63], v8 offset:17408
    v_lshlrev_b32 v5, 2, v1
    v_add_u32 v5, s51, v5
    ds_read_b32 v4, v5
    s_xor_b32 s51, s51, 256
L_pvq_main:
    s_waitcnt lgkmcnt(3)
    v_mfma_f32_16x16x32_bf16 v[16:19], a[0:3], v[48:51], 0
    ds_read_b128 v[64:67], v8 offset:2048
    v_mfma_f32_16x16x32_bf16 v[20:23], a[64:67], v[48:51], 0
    ds_read_b128 v[68:71], v8 offset:18432
    v_mfma_f32_16x16x32_bf16 v[24:27], v[48:51], a[128:131], 0
    s_mov_b32 s86, s41
    v_mfma_f32_16x16x32_bf16 v[28:31], a[0:3], v[52:55], 0
    s_mov_b32 s87, s42
    v_mfma_f32_16x16x32_bf16 v[32:35], a[64:67], v[52:55], 0
    v_mfma_f32_16x16x32_bf16 v[36:39], v[52:55], a[128:131], 0
    s_waitcnt lgkmcnt(3)
    v_mfma_f32_16x16x32_bf16 v[16:19], a[4:7], v[56:59], v[16:19]
    ds_read_b128 v[48:51], v8 offset:3072
    v_mfma_f32_16x16x32_bf16 v[20:23], a[68:71], v[56:59], v[20:23]
    ds_read_b128 v[52:55], v8 offset:19456
    v_mfma_f32_16x16x32_bf16 v[24:27], v[56:59], a[132:135], v[24:27]
    v_mfma_f32_16x16x32_bf16 v[28:31], a[4:7], v[60:63], v[28:31]
    v_mfma_f32_16x16x32_bf16 v[32:35], a[68:71], v[60:63], v[32:35]
    v_mfma_f32_16x16x32_bf16 v[36:39], v[60:63], a[132:135], v[36:39]
    s_waitcnt lgkmcnt(2)
    v_mfma_f32_16x16x32_bf16 v[16:19], a[8:11], v[64:67], v[16:19]
    ds_read_b128 v[56:59], v8 offset:4096
    ds_read_b128 v[60:63], v8 offset:20480
    v_mov_b32 v6, s86
    v_mfma_f32_16x16x32_bf16 v[20:23], a[72:75], v[64:67], v[20:23]
    v_mov_b32 v7, s87
    v_cndmask_b32 v6, v6, v7, s[88:89]
    v_and_b32 v7, 3, v6
    v_mfma_f32_16x16x32_bf16 v[24:27], v[64:67], a[136:139], v[24:27]
    v_lshlrev_b32 v7, 1, v7
    v_sub_u32 v7, v14, v7
    v_lshrrev_b32 v6, 2, v6
    v_mfma_f32_16x16x32_bf16 v[28:31], a[8:11], v[68:71], v[28:31]
    v_add_u32 v6, 1, v6
    v_cmp_gt_u32 vcc, 2, v7
    s_nop 1
    v_mfma_f32_16x16x32_bf16 v[32:35], a[72:75], v[68:71], v[32:35]
    v_cndmask_b32 v7, 0, v6, vcc
    v_cmp_lt_u32 vcc, v4, v7
    v_mfma_f32_16x16x32_bf16 v[36:39], v[68:71], a[136:139], v[36:39]
    s_waitcnt lgkmcnt(2)
    v_mfma_f32_16x16x32_bf16 v[16:19], a[12:15], v[48:51], v[16:19]
    ds_read_b128 v[64:67], v8 offset:5120
    v_mfma_f32_16x16x32_bf16 v[20:23], a[76:79], v[48:51], v[20:23]
    ds_read_b128 v[68:71], v8 offset:21504
    v_mfma_f32_16x16x32_bf16 v[24:27], v[48:51], a[140:143], v[24:27]
    v_mfma_f32_16x16x32_bf16 v[28:31], a[12:15], v[52:55], v[28:31]
    v_mfma_f32_16x16x32_bf16 v[32:35], a[76:79], v[52:55], v[32:35]
    v_mfma_f32_16x16x32_bf16 v[36:39], v[52:55], a[140:143], v[36:39]
    s_cmp_eq_u32 vcc_hi, 0
    s_cselect_b32 s54, 1, 0
    s_cmp_lt_u32 s42, 64
    s_cselect_b32 s54, s54, 0
    s_cmp_eq_u32 vcc_lo, 0
    s_cselect_b32 s55, 1, 0
    s_cmp_lt_u32 s41, 64
    s_cselect_b32 s55, s55, 0
    s_or_b32 s49, s54, s55
    s_cmp_eq_u32 s54, 1
    s_cselect_b32 s47, 1, 0
    s_cselect_b32 s48, s87, s86
    s_cselect_b32 s55, 0, s55
    s_add_u32 s42, s42, s54
    s_add_u32 s41, s41, s55
    s_cmp_eq_u32 s49, 0
    s_cbranch_scc1 L_pvq_nopf
    s_xor_b32 s57, s50, 32768
    s_lshl_b32 s36, s47, 21
    s_lshl_b32 s37, s48, 15
    s_add_u32 s36, s36, s37
    s_lshl_b32 s37, s30, 13
    s_add_u32 s36, s36, s37
    s_add_u32 s60, s36, 0x200000
    s_add_u32 s61, s37, s57
    s_waitcnt lgkmcnt(2)
    v_mfma_f32_16x16x32_bf16 v[16:19], a[16:19], v[56:59], v[16:19]
    ds_read_b128 v[48:51], v8 offset:6144
    v_mfma_f32_16x16x32_bf16 v[20:23], a[80:83], v[56:59], v[20:23]
    ds_read_b128 v[52:55], v8 offset:22528
    v_mfma_f32_16x16x32_bf16 v[24:27], v[56:59], a[144:147], v[24:27]
    s_mov_b32 m0, s61
    v_mfma_f32_16x16x32_bf16 v[28:31], a[16:19], v[60:63], v[28:31]
    s_add_u32 s61, s61, 1024
    v_mfma_f32_16x16x32_bf16 v[32:35], a[80:83], v[60:63], v[32:35]
    buffer_load_dwordx4 v0, s[4:7], s60 offen sc1 lds
    v_mfma_f32_16x16x32_bf16 v[36:39], v[60:63], a[144:147], v[36:39]
    s_add_u32 s60, s60, 1024
    s_waitcnt lgkmcnt(2)
    v_mfma_f32_16x16x32_bf16 v[16:19], a[20:23], v[64:67], v[16:19]
    ds_read_b128 v[56:59], v8 offset:7168
    v_mfma_f32_16x16x32_bf16 v[20:23], a[84:87], v[64:67], v[20:23]
    ds_read_b128 v[60:63], v8 offset:23552
    v_mfma_f32_16x16x32_bf16 v[24:27], v[64:67], a[148:151], v[24:27]
    s_mov_b32 m0, s61
    v_mfma_f32_16x16x32_bf16 v[28:31], a[20:23], v[68:71], v[28:31]
    s_add_u32 s61, s61, 1024
    v_mfma_f32_16x16x32_bf16 v[32:35], a[84:87], v[68:71], v[32:35]
    buffer_load_dwordx4 v0, s[4:7], s60 offen sc1 lds
    v_mfma_f32_16x16x32_bf16 v[36:39], v[68:71], a[148:151], v[36:39]
    s_add_u32 s60, s60, 1024
    s_waitcnt lgkmcnt(2)
    v_mfma_f32_16x16x32_bf16 v[16:19], a[24:27], v[48:51], v[16:19]
    ds_read_b128 v[64:67], v8 offset:8192
    v_mfma_f32_16x16x32_bf16 v[20:23], a[88:91], v[48:51], v[20:23]
    ds_read_b128 v[68:71], v8 offset:24576
    v_mfma_f32_16x16x32_bf16 v[24:27], v[48:51], a[152:155], v[24:27]
    s_mov_b32 m0, s61
    v_mfma_f32_16x16x32_bf16 v[28:31], a[24:27], v[52:55], v[28:31]
    s_add_u32 s61, s61, 1024
    v_mfma_f32_16x16x32_bf16 v[32:35], a[88:91], v[52:55], v[32:35]
    buffer_load_dwordx4 v0, s[4:7], s60 offen sc1 lds
    v_mfma_f32_16x16x32_bf16 v[36:39], v[52:55], a[152:155], v[36:39]
    s_add_u32 s60, s60, 1024
    s_waitcnt lgkmcnt(2)
    v_mfma_f32_16x16x32_bf16 v[16:19], a[28:31], v[56:59], v[16:19]
    ds_read_b128 v[48:51], v8 offset:9216
    v_mfma_f32_16x16x32_bf16 v[20:23], a[92:95], v[56:59], v[20:23]
    ds_read_b128 v[52:55], v8 offset:25600
    v_mfma_f32_16x16x32_bf16 v[24:27], v[56:59], a[156:159], v[24:27]
    s_mov_b32 m0, s61
    v_mfma_f32_16x16x32_bf16 v[28:31], a[28:31], v[60:63], v[28:31]
    s_add_u32 s61, s61, 1024
    v_mfma_f32_16x16x32_bf16 v[32:35], a[92:95], v[60:63], v[32:35]
    buffer_load_dwordx4 v0, s[4:7], s60 offen sc1 lds
    v_mfma_f32_16x16x32_bf16 v[36:39], v[60:63], a[156:159], v[36:39]
    s_add_u32 s60, s60, 1024
    s_waitcnt lgkmcnt(2)
    v_mfma_f32_16x16x32_bf16 v[16:19], a[32:35], v[64:67], v[16:19]
    ds_read_b128 v[56:59], v8 offset:10240
    v_mfma_f32_16x16x32_bf16 v[20:23], a[96:99], v[64:67], v[20:23]
    ds_read_b128 v[60:63], v8 offset:26624
    v_mfma_f32_16x16x32_bf16 v[24:27], v[64:67], a[160:163], v[24:27]
    s_mov_b32 m0, s61
    v_mfma_f32_16x16x32_bf16 v[28:31], a[32:35], v[68:71], v[28:31]
    s_add_u32 s61, s61, 1024
    v_mfma_f32_16x16x32_bf16 v[32:35], a[96:99], v[68:71], v[32:35]
    buffer_load_dwordx4 v0, s[4:7], s60 offen sc1 lds
    v_mfma_f32_16x16x32_bf16 v[36:39], v[68:71], a[160:163], v[36:39]
    s_add_u32 s60, s60, 1024
    s_waitcnt lgkmcnt(2)
    v_mfma_f32_16x16x32_bf16 v[16:19], a[36:39], v[48:51], v[16:19]
    ds_read_b128 v[64:67], v8 offset:11264
    v_mfma_f32_16x16x32_bf16 v[20:23], a[100:103], v[48:51], v[20:23]
    ds_read_b128 v[68:71], v8 offset:27648
    v_mfma_f32_16x16x32_bf16 v[24:27], v[48:51], a[164:167], v[24:27]
    s_mov_b32 m0, s61
    v_mfma_f32_16x16x32_bf16 v[28:31], a[36:39], v[52:55], v[28:31]
    s_add_u32 s61, s61, 1024
    v_mfma_f32_16x16x32_bf16 v[32:35], a[100:103], v[52:55], v[32:35]
    buffer_load_dwordx4 v0, s[4:7], s60 offen sc1 lds
    v_mfma_f32_16x16x32_bf16 v[36:39], v[52:55], a[164:167], v[36:39]
    s_add_u32 s60, s60, 1024
    s_waitcnt lgkmcnt(2)
    v_mfma_f32_16x16x32_bf16 v[16:19], a[40:43], v[56:59], v[16:19]
    ds_read_b128 v[48:51], v8 offset:12288
    v_mfma_f32_16x16x32_bf16 v[20:23], a[104:107], v[56:59], v[20:23]
    ds_read_b128 v[52:55], v8 offset:28672
    v_mfma_f32_16x16x32_bf16 v[24:27], v[56:59], a[168:171], v[24:27]
    s_mov_b32 m0, s61
    v_mfma_f32_16x16x32_bf16 v[28:31], a[40:43], v[60:63], v[28:31]
    s_add_u32 s61, s61, 1024
    v_mfma_f32_16x16x32_bf16 v[32:35], a[104:107], v[60:63], v[32:35]
    buffer_load_dwordx4 v0, s[4:7], s60 offen sc1 lds
    v_mfma_f32_16x16x32_bf16 v[36:39], v[60:63], a[168:171], v[36:39]
    s_add_u32 s60, s60, 1024
    s_waitcnt lgkmcnt(2)
    v_mfma_f32_16x16x32_bf16 v[16:19], a[44:47], v[64:67], v[16:19]
    ds_read_b128 v[56:59], v8 offset:13312
    ds_read_b128 v[60:63], v8 offset:29696
    v_mfma_f32_16x16x32_bf16 v[20:23], a[108:111], v[64:67], v[20:23]
    s_mov_b32 m0, s61
    s_add_u32 s61, s61, 1024
    v_mfma_f32_16x16x32_bf16 v[24:27], v[64:67], a[172:175], v[24:27]
    buffer_load_dwordx4 v0, s[4:7], s60 offen sc1 lds
    s_add_u32 s60, s60, 1024
    v_mfma_f32_16x16x32_bf16 v[28:31], a[44:47], v[68:71], v[28:31]
    s_mov_b32 m0, s51
    s_nop 0
    v_mfma_f32_16x16x32_bf16 v[32:35], a[108:111], v[68:71], v[32:35]
    buffer_load_dword v2, s[4:7], s63 offen sc1 lds
    v_mfma_f32_16x16x32_bf16 v[36:39], v[68:71], a[172:175], v[36:39]
    s_waitcnt lgkmcnt(2)
    v_mfma_f32_16x16x32_bf16 v[16:19], a[48:51], v[48:51], v[16:19]
    ds_read_b128 v[64:67], v8 offset:14336
    v_mfma_f32_16x16x32_bf16 v[20:23], a[112:115], v[48:51], v[20:23]
    ds_read_b128 v[68:71], v8 offset:30720
    v_mfma_f32_16x16x32_bf16 v[24:27], v[48:51], a[176:179], v[24:27]
    v_mfma_f32_16x16x32_bf16 v[28:31], a[48:51], v[52:55], v[28:31]
    v_mfma_f32_16x16x32_bf16 v[32:35], a[112:115], v[52:55], v[32:35]
    v_mfma_f32_16x16x32_bf16 v[36:39], v[52:55], a[176:179], v[36:39]
    s_waitcnt vmcnt(9)
    s_barrier
    v_mov_b32 v5, s53
    v_mov_b32 v6, 0
    s_mov_b64 exec, 1
    s_cmp_lg_u32 s30, 0
    s_cbranch_scc1 L_pub_10_d
    s_lshl_b32 s36, s52, 7
    s_add_u32 s36, s36, s62
    buffer_store_dword v5, v6, s[4:7], s36 offen sc1
    s_branch L_pub_10_e
L_pub_10_d:
    buffer_store_dword v5, v6, s[4:7], s97 offen
L_pub_10_e:
    s_mov_b64 exec, -1
    s_waitcnt lgkmcnt(2)
    v_mfma_f32_16x16x32_bf16 v[16:19], a[52:55], v[56:59], v[16:19]
    ds_read_b128 v[48:51], v8 offset:15360
    v_mfma_f32_16x16x32_bf16 v[20:23], a[116:119], v[56:59], v[20:23]
    ds_read_b128 v[52:55], v8 offset:31744
    v_mfma_f32_16x16x32_bf16 v[24:27], v[56:59], a[180:183], v[24:27]
    v_mfma_f32_16x16x32_bf16 v[28:31], a[52:55], v[60:63], v[28:31]
    v_mfma_f32_16x16x32_bf16 v[32:35], a[116:119], v[60:63], v[32:35]
    v_mfma_f32_16x16x32_bf16 v[36:39], v[60:63], a[180:183], v[36:39]
    s_waitcnt lgkmcnt(2)
    v_mfma_f32_16x16x32_bf16 v[16:19], a[56:59], v[64:67], v[16:19]
    s_lshl_b32 s92, s45, 24
    s_lshl_b32 s91, s31, 13
    v_mfma_f32_16x16x32_bf16 v[20:23], a[120:123], v[64:67], v[20:23]
    s_add_u32 s92, s92, s91
    s_lshl_b32 s91, s46, 18
    v_mfma_f32_16x16x32_bf16 v[24:27], v[64:67], a[184:187], v[24:27]
    s_add_u32 s92, s92, s91
    s_lshl_b32 s91, s30, 10
    v_mfma_f32_16x16x32_bf16 v[28:31], a[56:59], v[68:71], v[28:31]
    s_add_u32 s90, s92, s91
    s_add_u32 s90, s90, 0x5000000
    v_mfma_f32_16x16x32_bf16 v[32:35], a[120:123], v[68:71], v[32:35]
    s_lshl_b32 s91, s30, 11
    s_add_u32 s92, s92, s91
    v_mfma_f32_16x16x32_bf16 v[36:39], v[68:71], a[184:187], v[36:39]
    s_add_u32 s92, s92, 0x3000400
    s_add_u32 s91, s90, 4096
    s_waitcnt lgkmcnt(0)
    v_mfma_f32_16x16x32_bf16 v[16:19], a[60:63], v[48:51], v[16:19]
    v_mfma_f32_16x16x32_bf16 v[20:23], a[124:127], v[48:51], v[20:23]
    v_mfma_f32_16x16x32_bf16 v[24:27], v[48:51], a[188:191], v[24:27]
    v_mfma_f32_16x16x32_bf16 v[28:31], a[60:63], v[52:55], v[28:31]
    v_mfma_f32_16x16x32_bf16 v[32:35], a[124:127], v[52:55], v[32:35]
    v_mfma_f32_16x16x32_bf16 v[36:39], v[52:55], a[188:191], v[36:39]
    s_waitcnt vmcnt(1)
    s_barrier
    s_xor_b32 s50, s50, 32768
    v_add_u32 v8, s50, v0
    ds_read_b128 v[48:51], v8 offset:0
    ds_read_b128 v[52:55], v8 offset:16384
    ds_read_b128 v[56:59], v8 offset:1024
    ds_read_b128 v[60:63], v8 offset:17408
    v_lshlrev_b32 v5, 2, v1
    v_add_u32 v5, s51, v5
    ds_read_b32 v4, v5
    s_xor_b32 s51, s51, 256
    v_cvt_pk_bf16_f32 v72, v16, v17
    v_cvt_pk_bf16_f32 v73, v18, v19
    v_cvt_pk_bf16_f32 v74, v20, v21
    v_cvt_pk_bf16_f32 v75, v22, v23
    buffer_store_dwordx4 v[72:75], v0, s[4:7], s90 offen sc1
    v_cvt_pk_bf16_f32 v76, v24, v25
    v_cvt_pk_bf16_f32 v77, v26, v27
    v_cvt_pk_bf16_f32 v78, v36, v37
    v_cvt_pk_bf16_f32 v79, v38, v39
    buffer_store_dwordx4 v[76:79], v0, s[4:7], s92 offen sc1
    v_cvt_pk_bf16_f32 v80, v28, v29
    v_cvt_pk_bf16_f32 v81, v30, v31
    v_cvt_pk_bf16_f32 v82, v32, v33
    v_cvt_pk_bf16_f32 v83, v34, v35
    buffer_store_dwordx4 v[80:83], v0, s[4:7], s91 offen sc1
    s_mov_b32 s43, s52
    s_mov_b32 s44, s53
    s_cmp_eq_u32 s45, 0
    s_cselect_b32 s36, s58, s59
    s_add_u32 s53, s36, 1
    s_mov_b32 s52, s45
    s_cmp_eq_u32 s45, 0
    s_cselect_b32 s58, s53, s58
    s_cselect_b32 s59, s59, s53
    s_mov_b32 s45, s47
    s_mov_b32 s46, s48
    s_branch L_pvq_main
L_pvq_nopf:
    s_waitcnt lgkmcnt(2)
    v_mfma_f32_16x16x32_bf16 v[16:19], a[16:19], v[56:59], v[16:19]
    ds_read_b128 v[48:51], v8 offset:6144
    v_mfma_f32_16x16x32_bf16 v[20:23], a[80:83], v[56:59], v[20:23]
    ds_read_b128 v[52:55], v8 offset:22528
    v_mfma_f32_16x16x32_bf16 v[24:27], v[56:59], a[144:147], v[24:27]
    v_mfma_f32_16x16x32_bf16 v[28:31], a[16:19], v[60:63], v[28:31]
    v_mfma_f32_16x16x32_bf16 v[32:35], a[80:83], v[60:63], v[32:35]
    v_mfma_f32_16x16x32_bf16 v[36:39], v[60:63], a[144:147], v[36:39]
    s_waitcnt lgkmcnt(2)
    v_mfma_f32_16x16x32_bf16 v[16:19], a[20:23], v[64:67], v[16:19]
    ds_read_b128 v[56:59], v8 offset:7168
    v_mfma_f32_16x16x32_bf16 v[20:23], a[84:87], v[64:67], v[20:23]
    ds_read_b128 v[60:63], v8 offset:23552
    v_mfma_f32_16x16x32_bf16 v[24:27], v[64:67], a[148:151], v[24:27]
    v_mfma_f32_16x16x32_bf16 v[28:31], a[20:23], v[68:71], v[28:31]
    v_mfma_f32_16x16x32_bf16 v[32:35], a[84:87], v[68:71], v[32:35]
    v_mfma_f32_16x16x32_bf16 v[36:39], v[68:71], a[148:151], v[36:39]
    s_waitcnt lgkmcnt(2)
    v_mfma_f32_16x16x32_bf16 v[16:19], a[24:27], v[48:51], v[16:19]
    ds_read_b128 v[64:67], v8 offset:8192
    v_mfma_f32_16x16x32_bf16 v[20:23], a[88:91], v[48:51], v[20:23]
    ds_read_b128 v[68:71], v8 offset:24576
    v_mfma_f32_16x16x32_bf16 v[24:27], v[48:51], a[152:155], v[24:27]
    v_mfma_f32_16x16x32_bf16 v[28:31], a[24:27], v[52:55], v[28:31]
    v_mfma_f32_16x16x32_bf16 v[32:35], a[88:91], v[52:55], v[32:35]
    v_mfma_f32_16x16x32_bf16 v[36:39], v[52:55], a[152:155], v[36:39]
    s_waitcnt lgkmcnt(2)
    v_mfma_f32_16x16x32_bf16 v[16:19], a[28:31], v[56:59], v[16:19]
    ds_read_b128 v[48:51], v8 offset:9216
    v_mfma_f32_16x16x32_bf16 v[20:23], a[92:95], v[56:59], v[20:23]
    ds_read_b128 v[52:55], v8 offset:25600
    v_mfma_f32_16x16x32_bf16 v[24:27], v[56:59], a[156:159], v[24:27]
    v_mfma_f32_16x16x32_bf16 v[28:31], a[28:31], v[60:63], v[28:31]
    v_mfma_f32_16x16x32_bf16 v[32:35], a[92:95], v[60:63], v[32:35]
    v_mfma_f32_16x16x32_bf16 v[36:39], v[60:63], a[156:159], v[36:39]
    s_waitcnt lgkmcnt(2)
    v_mfma_f32_16x16x32_bf16 v[16:19], a[32:35], v[64:67], v[16:19]
    ds_read_b128 v[56:59], v8 offset:10240
    v_mfma_f32_16x16x32_bf16 v[20:23], a[96:99], v[64:67], v[20:23]
    ds_read_b128 v[60:63], v8 offset:26624
    v_mfma_f32_16x16x32_bf16 v[24:27], v[64:67], a[160:163], v[24:27]
    v_mfma_f32_16x16x32_bf16 v[28:31], a[32:35], v[68:71], v[28:31]
    v_mfma_f32_16x16x32_bf16 v[32:35], a[96:99], v[68:71], v[32:35]
    v_mfma_f32_16x16x32_bf16 v[36:39], v[68:71], a[160:163], v[36:39]
    s_waitcnt lgkmcnt(2)
    v_mfma_f32_16x16x32_bf16 v[16:19], a[36:39], v[48:51], v[16:19]
    ds_read_b128 v[64:67], v8 offset:11264
    v_mfma_f32_16x16x32_bf16 v[20:23], a[100:103], v[48:51], v[20:23]
    ds_read_b128 v[68:71], v8 offset:27648
    v_mfma_f32_16x16x32_bf16 v[24:27], v[48:51], a[164:167], v[24:27]
    v_mfma_f32_16x16x32_bf16 v[28:31], a[36:39], v[52:55], v[28:31]
    v_mfma_f32_16x16x32_bf16 v[32:35], a[100:103], v[52:55], v[32:35]
    v_mfma_f32_16x16x32_bf16 v[36:39], v[52:55], a[164:167], v[36:39]
    s_waitcnt lgkmcnt(2)
    v_mfma_f32_16x16x32_bf16 v[16:19], a[40:43], v[56:59], v[16:19]
    ds_read_b128 v[48:51], v8 offset:12288
    v_mfma_f32_16x16x32_bf16 v[20:23], a[104:107], v[56:59], v[20:23]
    ds_read_b128 v[52:55], v8 offset:28672
    v_mfma_f32_16x16x32_bf16 v[24:27], v[56:59], a[168:171], v[24:27]
    v_mfma_f32_16x16x32_bf16 v[28:31], a[40:43], v[60:63], v[28:31]
    v_mfma_f32_16x16x32_bf16 v[32:35], a[104:107], v[60:63], v[32:35]
    v_mfma_f32_16x16x32_bf16 v[36:39], v[60:63], a[168:171], v[36:39]
    s_waitcnt lgkmcnt(2)
    v_mfma_f32_16x16x32_bf16 v[16:19], a[44:47], v[64:67], v[16:19]
    ds_read_b128 v[56:59], v8 offset:13312
    v_mfma_f32_16x16x32_bf16 v[20:23], a[108:111], v[64:67], v[20:23]
    ds_read_b128 v[60:63], v8 offset:29696
    v_mfma_f32_16x16x32_bf16 v[24:27], v[64:67], a[172:175], v[24:27]
    s_mov_b32 m0, s51
    v_mfma_f32_16x16x32_bf16 v[28:31], a[44:47], v[68:71], v[28:31]
    s_nop 0
    v_mfma_f32_16x16x32_bf16 v[32:35], a[108:111], v[68:71], v[32:35]
    buffer_load_dword v2, s[4:7], s63 offen sc1 lds
    v_mfma_f32_16x16x32_bf16 v[36:39], v[68:71], a[172:175], v[36:39]
    s_waitcnt lgkmcnt(2)
    v_mfma_f32_16x16x32_bf16 v[16:19], a[48:51], v[48:51], v[16:19]
    ds_read_b128 v[64:67], v8 offset:14336
    v_mfma_f32_16x16x32_bf16 v[20:23], a[112:115], v[48:51], v[20:23]
    ds_read_b128 v[68:71], v8 offset:30720
    v_mfma_f32_16x16x32_bf16 v[24:27], v[48:51], a[176:179], v[24:27]
    v_mfma_f32_16x16x32_bf16 v[28:31], a[48:51], v[52:55], v[28:31]
    v_mfma_f32_16x16x32_bf16 v[32:35], a[112:115], v[52:55], v[32:35]
    v_mfma_f32_16x16x32_bf16 v[36:39], v[52:55], a[176:179], v[36:39]
    s_waitcnt vmcnt(1)
    s_barrier
    v_mov_b32 v5, s53
    v_mov_b32 v6, 0
    s_mov_b64 exec, 1
    s_cmp_lg_u32 s30, 0
    s_cbranch_scc1 L_pub_11_d
    s_lshl_b32 s36, s52, 7
    s_add_u32 s36, s36, s62
    buffer_store_dword v5, v6, s[4:7], s36 offen sc1
    s_branch L_pub_11_e
L_pub_11_d:
    buffer_store_dword v5, v6, s[4:7], s97 offen
L_pub_11_e:
    s_mov_b64 exec, -1
    s_waitcnt lgkmcnt(2)
    v_mfma_f32_16x16x32_bf16 v[16:19], a[52:55], v[56:59], v[16:19]
    ds_read_b128 v[48:51], v8 offset:15360
    v_mfma_f32_16x16x32_bf16 v[20:23], a[116:119], v[56:59], v[20:23]
    ds_read_b128 v[52:55], v8 offset:31744
    v_mfma_f32_16x16x32_bf16 v[24:27], v[56:59], a[180:183], v[24:27]
    v_mfma_f32_16x16x32_bf16 v[28:31], a[52:55], v[60:63], v[28:31]
    v_mfma_f32_16x16x32_bf16 v[32:35], a[116:119], v[60:63], v[32:35]
    v_mfma_f32_16x16x32_bf16 v[36:39], v[60:63], a[180:183], v[36:39]
    s_waitcnt lgkmcnt(2)
    v_mfma_f32_16x16x32_bf16 v[16:19], a[56:59], v[64:67], v[16:19]
    s_lshl_b32 s92, s45, 24
    s_lshl_b32 s91, s31, 13
    v_mfma_f32_16x16x32_bf16 v[20:23], a[120:123], v[64:67], v[20:23]
    s_add_u32 s92, s92, s91
    s_lshl_b32 s91, s46, 18
    v_mfma_f32_16x16x32_bf16 v[24:27], v[64:67], a[184:187], v[24:27]
    s_add_u32 s92, s92, s91
    s_lshl_b32 s91, s30, 10
    v_mfma_f32_16x16x32_bf16 v[28:31], a[56:59], v[68:71], v[28:31]
    s_add_u32 s90, s92, s91
    s_add_u32 s90, s90, 0x5000000
    v_mfma_f32_16x16x32_bf16 v[32:35], a[120:123], v[68:71], v[32:35]
    s_lshl_b32 s91, s30, 11
    s_add_u32 s92, s92, s91
    v_mfma_f32_16x16x32_bf16 v[36:39], v[68:71], a[184:187], v[36:39]
    s_add_u32 s92, s92, 0x3000400
    s_add_u32 s91, s90, 4096
    s_waitcnt lgkmcnt(0)
    v_mfma_f32_16x16x32_bf16 v[16:19], a[60:63], v[48:51], v[16:19]
    v_mfma_f32_16x16x32_bf16 v[20:23], a[124:127], v[48:51], v[20:23]
    v_mfma_f32_16x16x32_bf16 v[24:27], v[48:51], a[188:191], v[24:27]
    v_mfma_f32_16x16x32_bf16 v[28:31], a[60:63], v[52:55], v[28:31]
    v_mfma_f32_16x16x32_bf16 v[32:35], a[124:127], v[52:55], v[32:35]
    v_mfma_f32_16x16x32_bf16 v[36:39], v[52:55], a[188:191], v[36:39]
    s_nop 7
    v_cvt_pk_bf16_f32 v72, v16, v17
    v_cvt_pk_bf16_f32 v73, v18, v19
    v_cvt_pk_bf16_f32 v74, v20, v21
    v_cvt_pk_bf16_f32 v75, v22, v23
    buffer_store_dwordx4 v[72:75], v0, s[4:7], s90 offen sc1
    v_cvt_pk_bf16_f32 v76, v24, v25
    v_cvt_pk_bf16_f32 v77, v26, v27
    v_cvt_pk_bf16_f32 v78, v36, v37
    v_cvt_pk_bf16_f32 v79, v38, v39
    buffer_store_dwordx4 v[76:79], v0, s[4:7], s92 offen sc1
    v_cvt_pk_bf16_f32 v80, v28, v29
    v_cvt_pk_bf16_f32 v81, v30, v31
    v_cvt_pk_bf16_f32 v82, v32, v33
    v_cvt_pk_bf16_f32 v83, v34, v35
    buffer_store_dwordx4 v[80:83], v0, s[4:7], s91 offen sc1
    s_mov_b32 s43, s52
    s_mov_b32 s44, s53
    s_cmp_eq_u32 s45, 0
    s_cselect_b32 s36, s58, s59
    s_add_u32 s53, s36, 1
    s_mov_b32 s52, s45
    s_cmp_eq_u32 s45, 0
    s_cselect_b32 s58, s53, s58
    s_cselect_b32 s59, s59, s53
    s_waitcnt vmcnt(4)
    s_barrier
    v_lshlrev_b32 v5, 2, v1
    v_add_u32 v5, s51, v5
    ds_read_b32 v4, v5
    s_xor_b32 s51, s51, 256
    s_waitcnt lgkmcnt(0)
    s_cmp_ge_u32 s42, 64
    s_cbranch_scc1 L_pvq_w_try1
    s_mov_b32 s48, s42
    s_and_b32 s36, s48, 3
    s_lshl_b32 s36, s36, 1
    s_add_u32 s36, s36, 32
    s_lshr_b32 s37, s48, 2
    s_add_u32 s37, s37, 1
    v_subrev_u32 v7, s36, v1
    v_cmp_gt_u32 vcc, 2, v7
    v_mov_b32 v6, s37
    s_nop 0
    v_cndmask_b32 v7, 0, v6, vcc
    v_cmp_lt_u32 vcc, v4, v7
    s_nop 1
    s_cmp_eq_u64 vcc, 0
    s_cbranch_scc0 L_pvq_w_try1
    s_mov_b32 s47, 1
    s_add_u32 s42, s42, 1
    s_cmp_eq_u32 s47, s47
    s_branch L_pvq_w_done
L_pvq_w_try1:
    s_cmp_ge_u32 s41, 64
    s_cbranch_scc1 L_pvq_w_try2
    s_mov_b32 s48, s41
    s_and_b32 s36, s48, 3
    s_lshl_b32 s36, s36, 1
    s_add_u32 s36, s36, 0
    s_lshr_b32 s37, s48, 2
    s_add_u32 s37, s37, 1
    v_subrev_u32 v7, s36, v1
    v_cmp_gt_u32 vcc, 2, v7
    v_mov_b32 v6, s37
    s_nop 0
    v_cndmask_b32 v7, 0, v6, vcc
    v_cmp_lt_u32 vcc, v4, v7
    s_nop 1
    s_cmp_eq_u64 vcc, 0
    s_cbranch_scc0 L_pvq_w_try2
    s_mov_b32 s47, 0
    s_add_u32 s41, s41, 1
    s_cmp_eq_u32 s47, s47
    s_branch L_pvq_w_done
L_pvq_w_try2:
    s_cmp_lg_u32 s47, s47
L_pvq_w_done:
    s_cbranch_scc0 L_pvq_cold
    s_xor_b32 s50, s50, 32768
    s_mov_b32 m0, s51
    s_nop 0
    buffer_load_dword v2, s[4:7], s63 offen sc1 lds
    s_lshl_b32 s36, s47, 21
    s_lshl_b32 s37, s48, 15
    s_add_u32 s36, s36, s37
    s_lshl_b32 s37, s30, 13
    s_add_u32 s36, s36, s37
    s_add_u32 s60, s36, 0x200000
    s_add_u32 s61, s37, s50
    s_mov_b32 m0, s61
    s_add_u32 s61, s61, 1024
    buffer_load_dwordx4 v0, s[4:7], s60 offen sc1 lds
    s_add_u32 s60, s60, 1024
    s_mov_b32 m0, s61
    s_add_u32 s61, s61, 1024
    buffer_load_dwordx4 v0, s[4:7], s60 offen sc1 lds
    s_add_u32 s60, s60, 1024
    s_mov_b32 m0, s61
    s_add_u32 s61, s61, 1024
    buffer_load_dwordx4 v0, s[4:7], s60 offen sc1 lds
    s_add_u32 s60, s60, 1024
    s_mov_b32 m0, s61
    s_add_u32 s61, s61, 1024
    buffer_load_dwordx4 v0, s[4:7], s60 offen sc1 lds
    s_add_u32 s60, s60, 1024
    s_mov_b32 m0, s61
    s_add_u32 s61, s61, 1024
    buffer_load_dwordx4 v0, s[4:7], s60 offen sc1 lds
    s_add_u32 s60, s60, 1024
    s_mov_b32 m0, s61
    s_add_u32 s61, s61, 1024
    buffer_load_dwordx4 v0, s[4:7], s60 offen sc1 lds
    s_add_u32 s60, s60, 1024
    s_mov_b32 m0, s61
    s_add_u32 s61, s61, 1024
    buffer_load_dwordx4 v0, s[4:7], s60 offen sc1 lds
    s_add_u32 s60, s60, 1024
    s_mov_b32 m0, s61
    s_add_u32 s61, s61, 1024
    buffer_load_dwordx4 v0, s[4:7], s60 offen sc1 lds
    s_add_u32 s60, s60, 1024
    s_mov_b32 s45, s47
    s_mov_b32 s46, s48
    s_waitcnt vmcnt(9)
    s_barrier
    s_cmp_eq_u32 s43, s52
    s_cbranch_scc1 L_pvq_wnopub2
    v_mov_b32 v5, s44
    v_mov_b32 v6, 0
    s_mov_b64 exec, 1
    s_cmp_lg_u32 s30, 0
    s_cbranch_scc1 L_pub_12_d
    s_lshl_b32 s36, s43, 7
    s_add_u32 s36, s36, s62
    buffer_store_dword v5, v6, s[4:7], s36 offen sc1
    s_branch L_pub_12_e
L_pub_12_d:
    buffer_store_dword v5, v6, s[4:7], s97 offen
L_pub_12_e:
    s_mov_b64 exec, -1
L_pvq_wnopub2:
    v_mov_b32 v5, s53
    v_mov_b32 v6, 0
    s_mov_b64 exec, 1
    s_cmp_lg_u32 s30, 0
    s_cbranch_scc1 L_pub_13_d
    s_lshl_b32 s36, s52, 7
    s_add_u32 s36, s36, s62
    buffer_store_dword v5, v6, s[4:7], s36 offen sc1
    s_branch L_pub_13_e
L_pub_13_d:
    buffer_store_dword v5, v6, s[4:7], s97 offen
L_pub_13_e:
    s_mov_b64 exec, -1
    s_mov_b32 s43, s52
    s_mov_b32 s44, s53
    s_waitcnt vmcnt(1)
    s_barrier
    v_add_u32 v8, s50, v0
    ds_read_b128 v[48:51], v8 offset:0
    ds_read_b128 v[52:55], v8 offset:16384
    ds_read_b128 v[56:59], v8 offset:1024
    ds_read_b128 v[60:63], v8 offset:17408
    v_lshlrev_b32 v5, 2, v1
    v_add_u32 v5, s51, v5
    ds_read_b32 v4, v5
    s_xor_b32 s51, s51, 256
    s_branch L_pvq_main
L_pvq_exit:
    s_waitcnt vmcnt(0)
    s_branch L_end
L_role_a:
    v_mbcnt_lo_u32_b32 v1, -1, 0
    v_mbcnt_hi_u32_b32 v1, -1, v1
    v_lshlrev_b32 v0, 4, v1
    s_mov_b32 s35, 65536
    s_lshl_b32 s36, s28, 5
    s_add_u32 s36, s36, s29
    s_lshl_b32 s36, s36, 2
    s_add_u32 s36, s36, s30
    s_lshl_b32 s36, s36, 5
    s_and_b32 s36, s36, 0x7fff
    s_add_u32 s97, s36, 0x8000
    s_lshr_b32 s71, s30, 1
    s_and_b32 s72, s30, 1
    s_mov_b32 s63, 0
    v_lshrrev_b32 v5, 5, v1
    v_lshlrev_b32 v2, 7, v5
    v_and_b32 v5, 31, v1
    v_mov_b32 v6, 768
    v_mov_b32 v7, 2304
    v_cmp_eq_u32 vcc, 1, v5
    s_nop 1
    v_cndmask_b32 v6, v6, v7, vcc
    v_mov_b32 v7, 256
    v_cmp_eq_u32 vcc, 2, v5
    s_nop 1
    v_cndmask_b32 v6, v6, v7, vcc
    v_add_u32 v2, v2, v6
    s_lshl_b32 s36, s31, 2
    v_add_u32 v2, s36, v2
    s_lshl_b32 s36, s31, 2
    s_add_u32 s62, s36, 1024
    v_cmp_gt_u32 s[68:69], 32, v1
    s_mov_b32 s70, 0x3e0293ee
    v_lshrrev_b32 v13, 4, v1
    v_lshlrev_b32 v13, 2, v13
    v_and_b32 v14, 15, v1
    s_mov_b32 s36, 0xf149f2ca
    v_mov_b32 v88, 0
    v_add_u32 v15, 0, v13
    v_cmp_le_u32 vcc, v15, v14
    v_mov_b32 v15, s36
    s_nop 0
    v_cndmask_b32 v15, v15, v88, vcc
    s_cmp_eq_u32 s72, 0
    s_cbranch_scc1 L_att_u0_0
    v_mov_b32 v80, 0
    v_mov_b32 v84, v15
    s_branch L_att_uj_0
L_att_u0_0:
    v_mov_b32 v80, v15
    v_mov_b32 v84, s36
L_att_uj_0:
    v_add_u32 v15, 1, v13
    v_cmp_le_u32 vcc, v15, v14
    v_mov_b32 v15, s36
    s_nop 0
    v_cndmask_b32 v15, v15, v88, vcc
    s_cmp_eq_u32 s72, 0
    s_cbranch_scc1 L_att_u0_1
    v_mov_b32 v81, 0
    v_mov_b32 v85, v15
    s_branch L_att_uj_1
L_att_u0_1:
    v_mov_b32 v81, v15
    v_mov_b32 v85, s36
L_att_uj_1:
    v_add_u32 v15, 2, v13
    v_cmp_le_u32 vcc, v15, v14
    v_mov_b32 v15, s36
    s_nop 0
    v_cndmask_b32 v15, v15, v88, vcc
    s_cmp_eq_u32 s72, 0
    s_cbranch_scc1 L_att_u0_2
    v_mov_b32 v82, 0
    v_mov_b32 v86, v15
    s_branch L_att_uj_2
L_att_u0_2:
    v_mov_b32 v82, v15
    v_mov_b32 v86, s36
L_att_uj_2:
    v_add_u32 v15, 3, v13
    v_cmp_le_u32 vcc, v15, v14
    v_mov_b32 v15, s36
    s_nop 0
    v_cndmask_b32 v15, v15, v88, vcc
    s_cmp_eq_u32 s72, 0
    s_cbranch_scc1 L_att_u0_3
    v_mov_b32 v83, 0
    v_mov_b32 v87, v15
    s_branch L_att_uj_3
L_att_u0_3:
    v_mov_b32 v83, v15
    v_mov_b32 v87, s36
L_att_uj_3:
    v_mov_b32 v168, 0x3f803f80
    v_mov_b32 v169, 0x3f803f80
    v_mov_b32 v170, 0x3f803f80
    v_mov_b32 v171, 0x3f803f80
    s_cmp_lg_u32 s30, 0
    s_cbranch_scc1 L_pw_ok_ida
    s_mov_b32 s36, 0
    v_mov_b32 v120, 32
L_pw_ida:
    buffer_load_dword v121, v120, s[24:27], 0 offen sc1
    s_waitcnt vmcnt(0)
    v_readfirstlane_b32 s37, v121
    s_nop 3
    s_cmp_ge_u32 s37, 256
    s_cbranch_scc1 L_pw_ok_ida
    s_sleep 4
    s_add_u32 s36, s36, 1
    s_cmp_lt_u32 s36, 65536
    s_cbranch_scc1 L_pw_ida
    s_mov_b32 s33, 1
L_pw_ok_ida:
    s_barrier
    s_mov_b32 s41, 0
    s_mov_b32 s73, 0
    s_mov_b32 s42, 0
    s_mov_b32 s74, 0
    s_mov_b32 s75, 0
    s_mov_b32 s52, 0
    s_mov_b32 s53, 0
    s_mov_b32 s51, 163328
    s_mov_b32 s96, 0
L_at_idle:
    s_add_u32 s36, s41, s42
    s_cmp_ge_u32 s36, 64
    s_cbranch_scc1 L_at_fin
    s_cmp_lg_u32 s30, 0
    s_cbranch_scc1 L_at_cwait
    s_mov_b32 s40, 0
L_at_spin:
    buffer_load_dword v14, v2, s[4:7], s63 offen sc1
    s_waitcnt vmcnt(0)
    v_readlane_b32 s76, v14, 0
    v_readlane_b32 s77, v14, 1
    v_readlane_b32 s78, v14, 2
    v_readlane_b32 s79, v14, 32
    v_readlane_b32 s80, v14, 33
    v_readlane_b32 s81, v14, 34
    s_nop 3
    s_cmp_ge_u32 s41, 32
    s_cbranch_scc1 L_at_p_r0
    s_lshl_b32 s54, s41, 1
    s_add_u32 s54, s54, 2
    s_mov_b32 s90, s76
    s_min_u32 s91, s77, s78
    s_cmp_eq_u32 s73, 0
    s_cselect_b32 s90, s91, s90
    s_cmp_ge_u32 s90, s54
    s_cbranch_scc1 L_at_got
L_at_p_r0:
    s_cmp_ge_u32 s42, 32
    s_cbranch_scc1 L_at_p_r1
    s_lshl_b32 s54, s42, 1
    s_add_u32 s54, s54, 2
    s_mov_b32 s90, s79
    s_min_u32 s91, s80, s81
    s_cmp_eq_u32 s74, 0
    s_cselect_b32 s90, s91, s90
    s_cmp_ge_u32 s90, s54
    s_cbranch_scc1 L_at_got
L_at_p_r1:
    s_add_u32 s40, s40, 1
    s_cmp_lt_u32 s40, s35
    s_cbranch_scc1 L_at_spin
    s_mov_b32 s33, 1
    s_branch L_at_got
L_at_after:
    s_cmp_lg_u32 s30, 0
    s_cbranch_scc1 L_at_cwait
    s_waitcnt vmcnt(4)
L_at_got:
    v_mov_b32 v4, v14
    v_mov_b32 v6, s33
    v_writelane_b32 v4, s33, 6
    v_lshlrev_b32 v5, 2, v1
    v_add_u32 v5, s51, v5
    ds_write_b32 v5, v4
    s_waitcnt lgkmcnt(0)
L_at_cwait:
    s_barrier
    v_lshlrev_b32 v5, 2, v1
    v_add_u32 v5, s51, v5
    ds_read_b32 v4, v5
    s_xor_b32 s51, s51, 256
    s_waitcnt lgkmcnt(0)
    v_readlane_b32 s76, v4, 0
    v_readlane_b32 s77, v4, 1
    v_readlane_b32 s78, v4, 2
    v_readlane_b32 s79, v4, 32
    v_readlane_b32 s80, v4, 33
    v_readlane_b32 s81, v4, 34
    s_nop 3
    v_readlane_b32 s33, v4, 6
    s_nop 3
    s_cmp_lg_u32 s33, 0
    s_cbranch_scc1 L_at_fin
    s_mov_b32 s93, 0
    s_cmp_ge_u32 s41, 32
    s_cbranch_scc1 L_at_r0
    s_cmp_eq_u32 s73, 0
    s_cbranch_scc1 L_at_r0
    s_lshl_b32 s54, s41, 1
    s_add_u32 s54, s54, 2
    s_mov_b32 s90, s76
    s_min_u32 s91, s77, s78
    s_cmp_lt_u32 s90, s54
    s_cbranch_scc1 L_at_r0
    s_lshl_b32 s56, s41, 1
    s_add_u32 s56, s56, s71
    s_lshl_b32 s36, s56, 17
    s_lshl_b32 s37, s31, 12
    s_add_u32 s36, s36, s37
    s_mul_i32 s37, s72, 2048
    s_add_u32 s36, s36, s37
    s_add_u32 s36, s36, 0x7000000
    s_mul_i32 s37, s30, 2048
    s_add_u32 s37, s37, 32768
    s_mov_b32 m0, s37
    s_add_u32 s37, s37, 1024
    buffer_load_dwordx4 v0, s[4:7], s36 offen sc1 lds
    s_add_u32 s36, s36, 1024
    s_mov_b32 m0, s37
    s_add_u32 s37, s37, 1024
    buffer_load_dwordx4 v0, s[4:7], s36 offen sc1 lds
    s_add_u32 s36, s36, 1024
    s_lshl_b32 s36, s56, 16
    s_lshl_b32 s37, s31, 11
    s_add_u32 s36, s36, s37
    s_mul_i32 s37, s72, 1024
    s_add_u32 s36, s36, s37
    s_add_u32 s36, s36, 0x8000000
    s_mul_i32 s37, s30, 1024
    s_add_u32 s37, s37, 40960
    s_mov_b32 m0, s37
    s_add_u32 s37, s37, 1024
    buffer_load_dwordx4 v0, s[4:7], s36 offen sc1 lds
    s_add_u32 s36, s36, 1024
    s_mov_b32 s45, 0
    s_mov_b32 s46, s41
    s_mov_b32 s50, 0
    s_add_u32 s41, s41, 1
    s_mov_b32 s73, 0
    s_cmp_ge_u32 s42, 32
    s_cbranch_scc1 L_at_o0_b1
    s_cmp_lg_u32 s74, 0
    s_cbranch_scc1 L_at_o0_b1
    s_lshl_b32 s54, s42, 1
    s_add_u32 s54, s54, 2
    s_mov_b32 s90, s79
    s_min_u32 s91, s80, s81
    s_cmp_lt_u32 s91, s54
    s_cbranch_scc1 L_at_o0_b1
    s_lshl_b32 s56, s42, 1
    s_add_u32 s56, s56, s71
    s_lshl_b32 s36, s56, 18
    s_lshl_b32 s37, s31, 13
    s_add_u32 s36, s36, s37
    s_mul_i32 s37, s72, 4096
    s_add_u32 s36, s36, s37
    s_add_u32 s36, s36, 0x2000000
    s_mul_i32 s37, s30, 4096
    s_add_u32 s37, s37, 65536
    s_mov_b32 m0, s37
    s_add_u32 s37, s37, 1024
    buffer_load_dwordx4 v0, s[4:7], s36 offen sc1 lds
    s_add_u32 s36, s36, 1024
    s_mov_b32 m0, s37
    s_add_u32 s37, s37, 1024
    buffer_load_dwordx4 v0, s[4:7], s36 offen sc1 lds
    s_add_u32 s36, s36, 1024
    s_mov_b32 m0, s37
    s_add_u32 s37, s37, 1024
    buffer_load_dwordx4 v0, s[4:7], s36 offen sc1 lds
    s_add_u32 s36, s36, 1024
    s_mov_b32 m0, s37
    s_add_u32 s37, s37, 1024
    buffer_load_dwordx4 v0, s[4:7], s36 offen sc1 lds
    s_add_u32 s36, s36, 1024
    s_lshl_b32 s36, s56, 18
    s_lshl_b32 s37, s31, 13
    s_add_u32 s36, s36, s37
    s_mul_i32 s37, s72, 4096
    s_add_u32 s36, s36, s37
    s_add_u32 s36, s36, 0x4000000
    s_mul_i32 s37, s30, 4096
    s_add_u32 s37, s37, 81920
    s_mov_b32 m0, s37
    s_add_u32 s37, s37, 1024
    buffer_load_dwordx4 v0, s[4:7], s36 offen sc1 lds
    s_add_u32 s36, s36, 1024
    s_mov_b32 m0, s37
    s_add_u32 s37, s37, 1024
    buffer_load_dwordx4 v0, s[4:7], s36 offen sc1 lds
    s_add_u32 s36, s36, 1024
    s_mov_b32 m0, s37
    s_add_u32 s37, s37, 1024
    buffer_load_dwordx4 v0, s[4:7], s36 offen sc1 lds
    s_add_u32 s36, s36, 1024
    s_mov_b32 m0, s37
    s_add_u32 s37, s37, 1024
    buffer_load_dwordx4 v0, s[4:7], s36 offen sc1 lds
    s_add_u32 s36, s36, 1024
    s_lshl_b32 s36, s56, 18
    s_lshl_b32 s37, s31, 13
    s_add_u32 s36, s36, s37
    s_mul_i32 s37, s72, 4096
    s_add_u32 s36, s36, s37
    s_add_u32 s36, s36, 0x6000000
    s_mul_i32 s37, s30, 4096
    s_add_u32 s37, s37, 110592
    s_mov_b32 m0, s37
    s_add_u32 s37, s37, 1024
    buffer_load_dwordx4 v0, s[4:7], s36 offen sc1 lds
    s_add_u32 s36, s36, 1024
    s_mov_b32 m0, s37
    s_add_u32 s37, s37, 1024
    buffer_load_dwordx4 v0, s[4:7], s36 offen sc1 lds
    s_add_u32 s36, s36, 1024
    s_mov_b32 m0, s37
    s_add_u32 s37, s37, 1024
    buffer_load_dwordx4 v0, s[4:7], s36 offen sc1 lds
    s_add_u32 s36, s36, 1024
    s_mov_b32 m0, s37
    s_add_u32 s37, s37, 1024
    buffer_load_dwordx4 v0, s[4:7], s36 offen sc1 lds
    s_add_u32 s36, s36, 1024
    s_mov_b32 s74, 1
    s_add_u32 s93, s93, 12
L_at_o0_b1:
    s_branch L_at_run
L_at_r0:
    s_cmp_ge_u32 s42, 32
    s_cbranch_scc1 L_at_r1
    s_cmp_eq_u32 s74, 0
    s_cbranch_scc1 L_at_r1
    s_lshl_b32 s54, s42, 1
    s_add_u32 s54, s54, 2
    s_mov_b32 s90, s79
    s_min_u32 s91, s80, s81
    s_cmp_lt_u32 s90, s54
    s_cbranch_scc1 L_at_r1
    s_lshl_b32 s56, s42, 1
    s_add_u32 s56, s56, s71
    s_lshl_b32 s36, s56, 17
    s_lshl_b32 s37, s31, 12
    s_add_u32 s36, s36, s37
    s_mul_i32 s37, s72, 2048
    s_add_u32 s36, s36, s37
    s_add_u32 s36, s36, 0x7800000
    s_mul_i32 s37, s30, 2048
    s_add_u32 s37, s37, 98304
    s_mov_b32 m0, s37
    s_add_u32 s37, s37, 1024
    buffer_load_dwordx4 v0, s[4:7], s36 offen sc1 lds
    s_add_u32 s36, s36, 1024
    s_mov_b32 m0, s37
    s_add_u32 s37, s37, 1024
    buffer_load_dwordx4 v0, s[4:7], s36 offen sc1 lds
    s_add_u32 s36, s36, 1024
    s_lshl_b32 s36, s56, 16
    s_lshl_b32 s37, s31, 11
    s_add_u32 s36, s36, s37
    s_mul_i32 s37, s72, 1024
    s_add_u32 s36, s36, s37
    s_add_u32 s36, s36, 0x8400000
    s_mul_i32 s37, s30, 1024
    s_add_u32 s37, s37, 106496
    s_mov_b32 m0, s37
    s_add_u32 s37, s37, 1024
    buffer_load_dwordx4 v0, s[4:7], s36 offen sc1 lds
    s_add_u32 s36, s36, 1024
    s_mov_b32 s45, 1
    s_mov_b32 s46, s42
    s_mov_b32 s50, 65536
    s_add_u32 s42, s42, 1
    s_mov_b32 s74, 0
    s_cmp_ge_u32 s41, 32
    s_cbranch_scc1 L_at_o1_b0
    s_cmp_lg_u32 s73, 0
    s_cbranch_scc1 L_at_o1_b0
    s_lshl_b32 s54, s41, 1
    s_add_u32 s54, s54, 2
    s_mov_b32 s90, s76
    s_min_u32 s91, s77, s78
    s_cmp_lt_u32 s91, s54
    s_cbranch_scc1 L_at_o1_b0
    s_lshl_b32 s56, s41, 1
    s_add_u32 s56, s56, s71
    s_lshl_b32 s36, s56, 18
    s_lshl_b32 s37, s31, 13
    s_add_u32 s36, s36, s37
    s_mul_i32 s37, s72, 4096
    s_add_u32 s36, s36, s37
    s_add_u32 s36, s36, 0x1000000
    s_mul_i32 s37, s30, 4096
    s_add_u32 s37, s37, 0
    s_mov_b32 m0, s37
    s_add_u32 s37, s37, 1024
    buffer_load_dwordx4 v0, s[4:7], s36 offen sc1 lds
    s_add_u32 s36, s36, 1024
    s_mov_b32 m0, s37
    s_add_u32 s37, s37, 1024
    buffer_load_dwordx4 v0, s[4:7], s36 offen sc1 lds
    s_add_u32 s36, s36, 1024
    s_mov_b32 m0, s37
    s_add_u32 s37, s37, 1024
    buffer_load_dwordx4 v0, s[4:7], s36 offen sc1 lds
    s_add_u32 s36, s36, 1024
    s_mov_b32 m0, s37
    s_add_u32 s37, s37, 1024
    buffer_load_dwordx4 v0, s[4:7], s36 offen sc1 lds
    s_add_u32 s36, s36, 1024
    s_lshl_b32 s36, s56, 18
    s_lshl_b32 s37, s31, 13
    s_add_u32 s36, s36, s37
    s_mul_i32 s37, s72, 4096
    s_add_u32 s36, s36, s37
    s_add_u32 s36, s36, 0x3000000
    s_mul_i32 s37, s30, 4096
    s_add_u32 s37, s37, 16384
    s_mov_b32 m0, s37
    s_add_u32 s37, s37, 1024
    buffer_load_dwordx4 v0, s[4:7], s36 offen sc1 lds
    s_add_u32 s36, s36, 1024
    s_mov_b32 m0, s37
    s_add_u32 s37, s37, 1024
    buffer_load_dwordx4 v0, s[4:7], s36 offen sc1 lds
    s_add_u32 s36, s36, 1024
    s_mov_b32 m0, s37
    s_add_u32 s37, s37, 1024
    buffer_load_dwordx4 v0, s[4:7], s36 offen sc1 lds
    s_add_u32 s36, s36, 1024
    s_mov_b32 m0, s37
    s_add_u32 s37, s37, 1024
    buffer_load_dwordx4 v0, s[4:7], s36 offen sc1 lds
    s_add_u32 s36, s36, 1024
    s_lshl_b32 s36, s56, 18
    s_lshl_b32 s37, s31, 13
    s_add_u32 s36, s36, s37
    s_mul_i32 s37, s72, 4096
    s_add_u32 s36, s36, s37
    s_add_u32 s36, s36, 0x5000000
    s_mul_i32 s37, s30, 4096
    s_add_u32 s37, s37, 45056
    s_mov_b32 m0, s37
    s_add_u32 s37, s37, 1024
    buffer_load_dwordx4 v0, s[4:7], s36 offen sc1 lds
    s_add_u32 s36, s36, 1024
    s_mov_b32 m0, s37
    s_add_u32 s37, s37, 1024
    buffer_load_dwordx4 v0, s[4:7], s36 offen sc1 lds
    s_add_u32 s36, s36, 1024
    s_mov_b32 m0, s37
    s_add_u32 s37, s37, 1024
    buffer_load_dwordx4 v0, s[4:7], s36 offen sc1 lds
    s_add_u32 s36, s36, 1024
    s_mov_b32 m0, s37
    s_add_u32 s37, s37, 1024
    buffer_load_dwordx4 v0, s[4:7], s36 offen sc1 lds
    s_add_u32 s36, s36, 1024
    s_mov_b32 s73, 1
    s_add_u32 s93, s93, 12
L_at_o1_b0:
    s_branch L_at_run
L_at_r1:
    s_cmp_ge_u32 s41, 32
    s_cbranch_scc1 L_at_n_b0
    s_cmp_lg_u32 s73, 0
    s_cbranch_scc1 L_at_n_b0
    s_lshl_b32 s54, s41, 1
    s_add_u32 s54, s54, 2
    s_mov_b32 s90, s76
    s_min_u32 s91, s77, s78
    s_cmp_lt_u32 s91, s54
    s_cbranch_scc1 L_at_n_b0
    s_lshl_b32 s56, s41, 1
    s_add_u32 s56, s56, s71
    s_lshl_b32 s36, s56, 18
    s_lshl_b32 s37, s31, 13
    s_add_u32 s36, s36, s37
    s_mul_i32 s37, s72, 4096
    s_add_u32 s36, s36, s37
    s_add_u32 s36, s36, 0x1000000
    s_mul_i32 s37, s30, 4096
    s_add_u32 s37, s37, 0
    s_mov_b32 m0, s37
    s_add_u32 s37, s37, 1024
    buffer_load_dwordx4 v0, s[4:7], s36 offen sc1 lds
    s_add_u32 s36, s36, 1024
    s_mov_b32 m0, s37
    s_add_u32 s37, s37, 1024
    buffer_load_dwordx4 v0, s[4:7], s36 offen sc1 lds
    s_add_u32 s36, s36, 1024
    s_mov_b32 m0, s37
    s_add_u32 s37, s37, 1024
    buffer_load_dwordx4 v0, s[4:7], s36 offen sc1 lds
    s_add_u32 s36, s36, 1024
    s_mov_b32 m0, s37
    s_add_u32 s37, s37, 1024
    buffer_load_dwordx4 v0, s[4:7], s36 offen sc1 lds
    s_add_u32 s36, s36, 1024
    s_lshl_b32 s36, s56, 18
    s_lshl_b32 s37, s31, 13
    s_add_u32 s36, s36, s37
    s_mul_i32 s37, s72, 4096
    s_add_u32 s36, s36, s37
    s_add_u32 s36, s36, 0x3000000
    s_mul_i32 s37, s30, 4096
    s_add_u32 s37, s37, 16384
    s_mov_b32 m0, s37
    s_add_u32 s37, s37, 1024
    buffer_load_dwordx4 v0, s[4:7], s36 offen sc1 lds
    s_add_u32 s36, s36, 1024
    s_mov_b32 m0, s37
    s_add_u32 s37, s37, 1024
    buffer_load_dwordx4 v0, s[4:7], s36 offen sc1 lds
    s_add_u32 s36, s36, 1024
    s_mov_b32 m0, s37
    s_add_u32 s37, s37, 1024
    buffer_load_dwordx4 v0, s[4:7], s36 offen sc1 lds
    s_add_u32 s36, s36, 1024
    s_mov_b32 m0, s37
    s_add_u32 s37, s37, 1024
    buffer_load_dwordx4 v0, s[4:7], s36 offen sc1 lds
    s_add_u32 s36, s36, 1024
    s_lshl_b32 s36, s56, 18
    s_lshl_b32 s37, s31, 13
    s_add_u32 s36, s36, s37
    s_mul_i32 s37, s72, 4096
    s_add_u32 s36, s36, s37
    s_add_u32 s36, s36, 0x5000000
    s_mul_i32 s37, s30, 4096
    s_add_u32 s37, s37, 45056
    s_mov_b32 m0, s37
    s_add_u32 s37, s37, 1024
    buffer_load_dwordx4 v0, s[4:7], s36 offen sc1 lds
    s_add_u32 s36, s36, 1024
    s_mov_b32 m0, s37
    s_add_u32 s37, s37, 1024
    buffer_load_dwordx4 v0, s[4:7], s36 offen sc1 lds
    s_add_u32 s36, s36, 1024
    s_mov_b32 m0, s37
    s_add_u32 s37, s37, 1024
    buffer_load_dwordx4 v0, s[4:7], s36 offen sc1 lds
    s_add_u32 s36, s36, 1024
    s_mov_b32 m0, s37
    s_add_u32 s37, s37, 1024
    buffer_load_dwordx4 v0, s[4:7], s36 offen sc1 lds
    s_add_u32 s36, s36, 1024
    s_mov_b32 s73, 1
    s_add_u32 s93, s93, 12
L_at_n_b0:
    s_cmp_ge_u32 s42, 32
    s_cbranch_scc1 L_at_n_b1
    s_cmp_lg_u32 s74, 0
    s_cbranch_scc1 L_at_n_b1
    s_lshl_b32 s54, s42, 1
    s_add_u32 s54, s54, 2
    s_mov_b32 s90, s79
    s_min_u32 s91, s80, s81
    s_cmp_lt_u32 s91, s54
    s_cbranch_scc1 L_at_n_b1
    s_lshl_b32 s56, s42, 1
    s_add_u32 s56, s56, s71
    s_lshl_b32 s36, s56, 18
    s_lshl_b32 s37, s31, 13
    s_add_u32 s36, s36, s37
    s_mul_i32 s37, s72, 4096
    s_add_u32 s36, s36, s37
    s_add_u32 s36, s36, 0x2000000
    s_mul_i32 s37, s30, 4096
    s_add_u32 s37, s37, 65536
    s_mov_b32 m0, s37
    s_add_u32 s37, s37, 1024
    buffer_load_dwordx4 v0, s[4:7], s36 offen sc1 lds
    s_add_u32 s36, s36, 1024
    s_mov_b32 m0, s37
    s_add_u32 s37, s37, 1024
    buffer_load_dwordx4 v0, s[4:7], s36 offen sc1 lds
    s_add_u32 s36, s36, 1024
    s_mov_b32 m0, s37
    s_add_u32 s37, s37, 1024
    buffer_load_dwordx4 v0, s[4:7], s36 offen sc1 lds
    s_add_u32 s36, s36, 1024
    s_mov_b32 m0, s37
    s_add_u32 s37, s37, 1024
    buffer_load_dwordx4 v0, s[4:7], s36 offen sc1 lds
    s_add_u32 s36, s36, 1024
    s_lshl_b32 s36, s56, 18
    s_lshl_b32 s37, s31, 13
    s_add_u32 s36, s36, s37
    s_mul_i32 s37, s72, 4096
    s_add_u32 s36, s36, s37
    s_add_u32 s36, s36, 0x4000000
    s_mul_i32 s37, s30, 4096
    s_add_u32 s37, s37, 81920
    s_mov_b32 m0, s37
    s_add_u32 s37, s37, 1024
    buffer_load_dwordx4 v0, s[4:7], s36 offen sc1 lds
    s_add_u32 s36, s36, 1024
    s_mov_b32 m0, s37
    s_add_u32 s37, s37, 1024
    buffer_load_dwordx4 v0, s[4:7], s36 offen sc1 lds
    s_add_u32 s36, s36, 1024
    s_mov_b32 m0, s37
    s_add_u32 s37, s37, 1024
    buffer_load_dwordx4 v0, s[4:7], s36 offen sc1 lds
    s_add_u32 s36, s36, 1024
    s_mov_b32 m0, s37
    s_add_u32 s37, s37, 1024
    buffer_load_dwordx4 v0, s[4:7], s36 offen sc1 lds
    s_add_u32 s36, s36, 1024
    s_lshl_b32 s36, s56, 18
    s_lshl_b32 s37, s31, 13
    s_add_u32 s36, s36, s37
    s_mul_i32 s37, s72, 4096
    s_add_u32 s36, s36, s37
    s_add_u32 s36, s36, 0x6000000
    s_mul_i32 s37, s30, 4096
    s_add_u32 s37, s37, 110592
    s_mov_b32 m0, s37
    s_add_u32 s37, s37, 1024
    buffer_load_dwordx4 v0, s[4:7], s36 offen sc1 lds
    s_add_u32 s36, s36, 1024
    s_mov_b32 m0, s37
    s_add_u32 s37, s37, 1024
    buffer_load_dwordx4 v0, s[4:7], s36 offen sc1 lds
    s_add_u32 s36, s36, 1024
    s_mov_b32 m0, s37
    s_add_u32 s37, s37, 1024
    buffer_load_dwordx4 v0, s[4:7], s36 offen sc1 lds
    s_add_u32 s36, s36, 1024
    s_mov_b32 m0, s37
    s_add_u32 s37, s37, 1024
    buffer_load_dwordx4 v0, s[4:7], s36 offen sc1 lds
    s_add_u32 s36, s36, 1024
    s_mov_b32 s74, 1
    s_add_u32 s93, s93, 12
L_at_n_b1:
    s_cmp_eq_u32 s75, 0
    s_cbranch_scc1 L_at_idle
    s_cmp_eq_u32 s93, 0
    s_cbranch_scc1 L_at_f_0
    s_cmp_eq_u32 s93, 12
    s_cbranch_scc1 L_at_f_12
    s_waitcnt vmcnt(24)
    s_branch L_at_f_e
L_at_f_12:
    s_waitcnt vmcnt(12)
    s_branch L_at_f_e
L_at_f_0:
    s_waitcnt vmcnt(0)
L_at_f_e:
    s_barrier
    s_cmp_eq_u32 s75, 0
    s_cbranch_scc1 L_at_f_np
    v_mov_b32 v5, s53
    v_mov_b32 v6, 0
    s_mov_b64 exec, 1
    s_cmp_lg_u32 s30, 0
    s_cbranch_scc1 L_pub_14_d
    s_lshl_b32 s36, s52, 7
    s_add_u32 s36, s36, s62
    buffer_store_dword v5, v6, s[4:7], s36 offen sc1
    s_branch L_pub_14_e
L_pub_14_d:
    buffer_store_dword v5, v6, s[4:7], s97 offen
L_pub_14_e:
    s_mov_b64 exec, -1
    s_mov_b32 s75, 0
L_at_f_np:
    s_branch L_at_idle
L_at_run:
    s_cmp_eq_u32 s93, 0
    s_cbranch_scc1 L_at_r_0
    s_cmp_eq_u32 s93, 12
    s_cbranch_scc1 L_at_r_12
    s_waitcnt vmcnt(24)
    s_branch L_at_r_e
L_at_r_12:
    s_waitcnt vmcnt(12)
    s_branch L_at_r_e
L_at_r_0:
    s_waitcnt vmcnt(0)
L_at_r_e:
    s_barrier
    s_cmp_eq_u32 s75, 0
    s_cbranch_scc1 L_at_r_np
    v_mov_b32 v5, s53
    v_mov_b32 v6, 0
    s_mov_b64 exec, 1
    s_cmp_lg_u32 s30, 0
    s_cbranch_scc1 L_pub_15_d
    s_lshl_b32 s36, s52, 7
    s_add_u32 s36, s36, s62
    buffer_store_dword v5, v6, s[4:7], s36 offen sc1
    s_branch L_pub_15_e
L_pub_15_d:
    buffer_store_dword v5, v6, s[4:7], s97 offen
L_pub_15_e:
    s_mov_b64 exec, -1
    s_mov_b32 s75, 0
L_at_r_np:
    s_lshl_b32 s36, s71, 13
    s_add_u32 s36, s36, s50
    v_add_u32 v9, s36, v0
    v_add_u32 v10, 16384, v9
    s_lshl_b32 s36, s71, 12
    s_add_u32 s36, s36, s50
    s_add_u32 s36, s36, 32768
    v_add_u32 v11, s36, v0
    s_lshl_b32 s36, s71, 11
    s_add_u32 s36, s36, s50
    s_add_u32 s36, s36, 40960
    v_lshrrev_b32 v12, 1, v0
    v_add_u32 v12, s36, v12
    s_lshl_b32 s36, s30, 12
    s_add_u32 s36, s36, s50
    s_add_u32 s36, s36, 45056
    v_add_u32 v13, s36, v0
    ds_read_b128 v[64:67], v13 offset:0
    ds_read_b128 v[96:99], v9 offset:0
    ds_read_b128 v[100:103], v9 offset:4096
    ds_read_b128 v[104:107], v11 offset:0
    ds_read_b128 v[68:71], v13 offset:1024
    ds_read_b128 v[108:111], v9 offset:1024
    ds_read_b128 v[112:115], v9 offset:5120
    ds_read_b128 v[116:119], v11 offset:1024
    ds_read_b128 v[72:75], v13 offset:2048
    ds_read_b128 v[120:123], v9 offset:2048
    ds_read_b128 v[124:127], v9 offset:6144
    ds_read_b128 v[128:131], v11 offset:2048
    ds_read_b128 v[76:79], v13 offset:3072
    ds_read_b128 v[132:135], v9 offset:3072
    ds_read_b128 v[136:139], v9 offset:7168
    ds_read_b128 v[140:143], v11 offset:3072
    s_waitcnt lgkmcnt(12)
    v_mfma_f32_16x16x32_bf16 v[148:151], v[96:99], v[64:67], 0
    v_mfma_f32_16x16x32_bf16 v[152:155], v[100:103], v[64:67], 0
    v_mfma_f32_16x16x32_bf16 v[144:147], v[104:107], v[64:67], 0
    s_waitcnt lgkmcnt(8)
    v_mfma_f32_16x16x32_bf16 v[148:151], v[108:111], v[68:71], v[148:151]
    v_mfma_f32_16x16x32_bf16 v[152:155], v[112:115], v[68:71], v[152:155]
    v_mfma_f32_16x16x32_bf16 v[144:147], v[116:119], v[68:71], v[144:147]
    s_waitcnt lgkmcnt(4)
    v_mfma_f32_16x16x32_bf16 v[148:151], v[120:123], v[72:75], v[148:151]
    v_mfma_f32_16x16x32_bf16 v[152:155], v[124:127], v[72:75], v[152:155]
    v_mfma_f32_16x16x32_bf16 v[144:147], v[128:131], v[72:75], v[144:147]
    s_waitcnt lgkmcnt(0)
    v_mfma_f32_16x16x32_bf16 v[148:151], v[132:135], v[76:79], v[148:151]
    v_mfma_f32_16x16x32_bf16 v[152:155], v[136:139], v[76:79], v[152:155]
    v_mfma_f32_16x16x32_bf16 v[144:147], v[140:143], v[76:79], v[144:147]
    ds_read_b128 v[96:99], v10 offset:0
    ds_read_b128 v[100:103], v10 offset:1024
    ds_read_b128 v[104:107], v10 offset:2048
    ds_read_b128 v[108:111], v10 offset:3072
    ds_read_b128 v[112:115], v10 offset:4096
    ds_read_b128 v[116:119], v10 offset:5120
    ds_read_b128 v[120:123], v10 offset:6144
    ds_read_b128 v[124:127], v10 offset:7168
    ds_read_b64 v[128:129], v12 offset:0
    ds_read_b64 v[130:131], v12 offset:512
    ds_read_b64 v[132:133], v12 offset:1024
    ds_read_b64 v[134:135], v12 offset:1536
    v_fma_f32 v148, v148, s70, v80
    v_fma_f32 v152, v152, s70, v84
    v_mul_f32 v144, s70, v144
    v_fma_f32 v149, v149, s70, v81
    v_fma_f32 v153, v153, s70, v85
    v_mul_f32 v145, s70, v145
    v_fma_f32 v150, v150, s70, v82
    v_fma_f32 v154, v154, s70, v86
    v_mul_f32 v146, s70, v146
    v_fma_f32 v151, v151, s70, v83
    v_fma_f32 v155, v155, s70, v87
    v_mul_f32 v147, s70, v147
    v_max3_f32 v156, v148, v149, v150
    v_max3_f32 v157, v151, v152, v153
    v_max3_f32 v156, v156, v154, v155
    v_max3_f32 v157, v157, v144, v145
    v_max3_f32 v156, v156, v146, v147
    v_max_f32 v156, v156, v157
    v_mov_b32 v157, v156
    s_nop 1
    v_permlane32_swap_b32 v156, v157
    v_max_f32 v156, v156, v157
    v_mov_b32 v157, v156
    s_nop 1
    v_permlane16_swap_b32 v156, v157
    v_max_f32 v156, v156, v157
    v_sub_f32 v144, v144, v156
    v_sub_f32 v145, v145, v156
    v_sub_f32 v146, v146, v156
    v_sub_f32 v147, v147, v156
    v_sub_f32 v148, v148, v156
    v_sub_f32 v149, v149, v156
    v_sub_f32 v150, v150, v156
    v_sub_f32 v151, v151, v156
    v_sub_f32 v152, v152, v156
    v_sub_f32 v153, v153, v156
    v_sub_f32 v154, v154, v156
    v_sub_f32 v155, v155, v156
    v_exp_f32 v144, v144
    v_exp_f32 v145, v145
    v_exp_f32 v146, v146
    v_exp_f32 v147, v147
    v_exp_f32 v148, v148
    v_exp_f32 v149, v149
    v_exp_f32 v150, v150
    v_exp_f32 v151, v151
    v_exp_f32 v152, v152
    v_exp_f32 v153, v153
    v_exp_f32 v154, v154
    v_exp_f32 v155, v155
    s_nop 0
    v_cvt_pk_bf16_f32 v160, v148, v149
    v_cvt_pk_bf16_f32 v161, v150, v151
    v_cvt_pk_bf16_f32 v162, v152, v153
    v_cvt_pk_bf16_f32 v163, v154, v155
    v_cvt_pk_bf16_f32 v156, v144, v145
    v_cvt_pk_bf16_f32 v157, v146, v147
    v_cndmask_b32 v164, 0, v156, s[68:69]
    v_cndmask_b32 v165, 0, v157, s[68:69]
    v_cndmask_b32 v166, v156, 0, s[68:69]
    v_cndmask_b32 v167, v157, 0, s[68:69]
    s_waitcnt lgkmcnt(0)
    s_cmp_lg_u32 s30, 0
    s_cbranch_scc1 L_at_nopoll
    buffer_load_dword v14, v2, s[4:7], s63 offen sc1
L_at_nopoll:
    v_mfma_f32_16x16x32_bf16 v[208:211], v[168:171], v[160:163], 0
    v_mfma_f32_16x16x32_bf16 v[176:179], v[96:99], v[160:163], 0
    v_mfma_f32_16x16x32_bf16 v[180:183], v[100:103], v[160:163], 0
    v_mfma_f32_16x16x32_bf16 v[184:187], v[104:107], v[160:163], 0
    v_mfma_f32_16x16x32_bf16 v[188:191], v[108:111], v[160:163], 0
    v_mfma_f32_16x16x32_bf16 v[192:195], v[112:115], v[160:163], 0
    v_mfma_f32_16x16x32_bf16 v[196:199], v[116:119], v[160:163], 0
    v_mfma_f32_16x16x32_bf16 v[200:203], v[120:123], v[160:163], 0
    v_mfma_f32_16x16x32_bf16 v[204:207], v[124:127], v[160:163], 0
    v_mfma_f32_16x16x16_bf16 v[208:211], v[168:169], v[164:165], v[208:211]
    v_mfma_f32_16x16x16_bf16 v[176:179], v[128:129], v[164:165], v[176:179]
    v_mfma_f32_16x16x16_bf16 v[180:183], v[128:129], v[166:167], v[180:183]
    v_mfma_f32_16x16x16_bf16 v[184:187], v[130:131], v[164:165], v[184:187]
    v_mfma_f32_16x16x16_bf16 v[188:191], v[130:131], v[166:167], v[188:191]
    v_mfma_f32_16x16x16_bf16 v[192:195], v[132:133], v[164:165], v[192:195]
    v_mfma_f32_16x16x16_bf16 v[196:199], v[132:133], v[166:167], v[196:199]
    v_mfma_f32_16x16x16_bf16 v[200:203], v[134:135], v[164:165], v[200:203]
    v_mfma_f32_16x16x16_bf16 v[204:207], v[134:135], v[166:167], v[204:207]
    v_rcp_f32 v156, v208
    s_lshl_b32 s36, s46, 1
    s_add_u32 s36, s36, s71
    s_lshl_b32 s36, s36, 18
    s_lshl_b32 s37, s45, 24
    s_add_u32 s36, s36, s37
    s_lshl_b32 s37, s72, 17
    s_add_u32 s36, s36, s37
    s_lshl_b32 s37, s31, 12
    s_add_u32 s36, s36, s37
    s_add_u32 s36, s36, 0xa800000
    v_pk_mul_f32 v[176:177], v[176:177], v[156:157] op_sel_hi:[1,0]
    v_pk_mul_f32 v[178:179], v[178:179], v[156:157] op_sel_hi:[1,0]
    v_pk_mul_f32 v[180:181], v[180:181], v[156:157] op_sel_hi:[1,0]
    v_pk_mul_f32 v[182:183], v[182:183], v[156:157] op_sel_hi:[1,0]
    v_cvt_pk_bf16_f32 v212, v176, v177
    v_cvt_pk_bf16_f32 v213, v178, v179
    v_cvt_pk_bf16_f32 v214, v180, v181
    v_cvt_pk_bf16_f32 v215, v182, v183
    buffer_store_dwordx4 v[212:215], v0, s[4:7], s36 offen offset:0 sc1
    v_pk_mul_f32 v[184:185], v[184:185], v[156:157] op_sel_hi:[1,0]
    v_pk_mul_f32 v[186:187], v[186:187], v[156:157] op_sel_hi:[1,0]
    v_pk_mul_f32 v[188:189], v[188:189], v[156:157] op_sel_hi:[1,0]
    v_pk_mul_f32 v[190:191], v[190:191], v[156:157] op_sel_hi:[1,0]
    v_cvt_pk_bf16_f32 v216, v184, v185
    v_cvt_pk_bf16_f32 v217, v186, v187
    v_cvt_pk_bf16_f32 v218, v188, v189
    v_cvt_pk_bf16_f32 v219, v190, v191
    buffer_store_dwordx4 v[216:219], v0, s[4:7], s36 offen offset:1024 sc1
    v_pk_mul_f32 v[192:193], v[192:193], v[156:157] op_sel_hi:[1,0]
    v_pk_mul_f32 v[194:195], v[194:195], v[156:157] op_sel_hi:[1,0]
    v_pk_mul_f32 v[196:197], v[196:197], v[156:157] op_sel_hi:[1,0]
    v_pk_mul_f32 v[198:199], v[198:199], v[156:157] op_sel_hi:[1,0]
    v_cvt_pk_bf16_f32 v220, v192, v193
    v_cvt_pk_bf16_f32 v221, v194, v195
    v_cvt_pk_bf16_f32 v222, v196, v197
    v_cvt_pk_bf16_f32 v223, v198, v199
    buffer_store_dwordx4 v[220:223], v0, s[4:7], s36 offen offset:2048 sc1
    v_pk_mul_f32 v[200:201], v[200:201], v[156:157] op_sel_hi:[1,0]
    v_pk_mul_f32 v[202:203], v[202:203], v[156:157] op_sel_hi:[1,0]
    v_pk_mul_f32 v[204:205], v[204:205], v[156:157] op_sel_hi:[1,0]
    v_pk_mul_f32 v[206:207], v[206:207], v[156:157] op_sel_hi:[1,0]
    v_cvt_pk_bf16_f32 v224, v200, v201
    v_cvt_pk_bf16_f32 v225, v202, v203
    v_cvt_pk_bf16_f32 v226, v204, v205
    v_cvt_pk_bf16_f32 v227, v206, v207
    buffer_store_dwordx4 v[224:227], v0, s[4:7], s36 offen offset:3072 sc1
    s_mov_b32 s52, s45
    s_lshl_b32 s36, s46, 1
    s_add_u32 s53, s36, 2
    s_mov_b32 s75, 1
    s_add_u32 s36, s41, s42
    s_cmp_ge_u32 s36, 64
    s_cbranch_scc0 L_at_after
L_at_fin:
    s_waitcnt vmcnt(0) lgkmcnt(0)
    s_barrier
    s_cmp_eq_u32 s75, 0
    s_cbranch_scc1 L_at_e_np
    v_mov_b32 v5, s53
    v_mov_b32 v6, 0
    s_mov_b64 exec, 1
    s_cmp_lg_u32 s30, 0
    s_cbranch_scc1 L_pub_16_d
    s_lshl_b32 s36, s52, 7
    s_add_u32 s36, s36, s62
    buffer_store_dword v5, v6, s[4:7], s36 offen sc1
    s_branch L_pub_16_e
L_pub_16_d:
    buffer_store_dword v5, v6, s[4:7], s97 offen
L_pub_16_e:
    s_mov_b64 exec, -1
    s_mov_b32 s75, 0
L_at_e_np:
    s_waitcnt vmcnt(0)
    s_branch L_end
L_role_o:
    v_mbcnt_lo_u32_b32 v1, -1, 0
    v_mbcnt_hi_u32_b32 v1, -1, v1
    v_lshlrev_b32 v0, 4, v1
    s_mov_b32 s35, 65536
    s_lshl_b32 s36, s28, 5
    s_add_u32 s36, s36, s29
    s_lshl_b32 s36, s36, 2
    s_add_u32 s36, s36, s30
    s_lshl_b32 s36, s36, 5
    s_and_b32 s36, s36, 0x7fff
    s_add_u32 s97, s36, 0x8000
    s_lshr_b32 s64, s31, 4
    s_bfe_u32 s65, s31, 0x20002
    s_lshl_b32 s67, s65, 3
    s_load_dwordx2 s[36:37], s[0:1], 40
    s_waitcnt lgkmcnt(0)
    s_mov_b32 s8, s36
    s_and_b32 s9, s37, 0xffff
    s_mov_b32 s10, 0x400000
    s_mov_b32 s11, 0x20000
    s_and_b32 s66, s31, 3
    s_mul_i32 s68, s65, 1048576
    s_lshl_b32 s36, s66, 8
    s_add_u32 s68, s68, s36
    s_cmp_lg_u32 s30, 0
    s_cbranch_scc1 L_pw_ok_hao
    s_mov_b32 s36, 0
    v_mov_b32 v120, 32
L_pw_hao:
    buffer_load_dword v121, v120, s[24:27], 0 offen sc1
    s_waitcnt vmcnt(0)
    v_readfirstlane_b32 s37, v121
    s_nop 3
    s_cmp_ge_u32 s37, 256
    s_cbranch_scc1 L_pw_ok_hao
    s_sleep 16
    s_add_u32 s36, s36, 1
    s_cmp_lt_u32 s36, 65536
    s_cbranch_scc1 L_pw_hao
    s_mov_b32 s33, 1
L_pw_ok_hao:
    s_cmp_lg_u32 s30, 0
    s_cbranch_scc1 L_pw_ok_hbo
    s_mov_b32 s36, 0
    v_mov_b32 v120, 256
L_pw_hbo:
    buffer_load_dword v121, v120, s[4:7], 0 offen sc1
    s_waitcnt vmcnt(0)
    v_readfirstlane_b32 s37, v121
    s_nop 3
    s_cmp_ge_u32 s37, 1
    s_cbranch_scc1 L_pw_ok_hbo
    s_sleep 16
    s_add_u32 s36, s36, 1
    s_cmp_lt_u32 s36, 65536
    s_cbranch_scc1 L_pw_hbo
L_pw_ok_hbo:
    s_barrier
    v_lshrrev_b32 v10, 4, v1
    s_mov_b32 s36, 1024
    v_mul_lo_u32 v8, v10, s36
    v_and_b32 v10, 15, v1
    v_lshl_add_u32 v8, v10, 4, v8
    v_lshrrev_b32 v10, 4, v1
    v_lshlrev_b32 v10, 3, v10
    v_bfe_u32 v11, v1, 2, 2
    v_add_u32 v10, v10, v11
    v_mul_u32_u24 v9, 256, v10
    v_and_b32 v10, 3, v1
    v_lshlrev_b32 v10, 4, v10
    s_lshl_b32 s36, s30, 6
    v_add_u32 v10, s36, v10
    v_add_u32 v9, v9, v10
    s_mul_i32 s37, s30, 65536
    s_add_u32 s37, s37, s68
    s_add_u32 s37, s37, 0
    s_mul_i32 s38, s30, 16384
    s_add_u32 s38, s38, 0
    s_mov_b32 m0, s38
    s_add_u32 s38, s38, 1024
    buffer_load_dwordx4 v8, s[8:11], s37 offen lds
    s_add_u32 s37, s37, 4096
    s_mov_b32 m0, s38
    s_add_u32 s38, s38, 1024
    buffer_load_dwordx4 v8, s[8:11], s37 offen lds
    s_add_u32 s37, s37, 4096
    s_mov_b32 m0, s38
    s_add_u32 s38, s38, 1024
    buffer_load_dwordx4 v8, s[8:11], s37 offen lds
    s_add_u32 s37, s37, 4096
    s_mov_b32 m0, s38
    s_add_u32 s38, s38, 1024
    buffer_load_dwordx4 v8, s[8:11], s37 offen lds
    s_add_u32 s37, s37, 4096
    s_mov_b32 m0, s38
    s_add_u32 s38, s38, 1024
    buffer_load_dwordx4 v8, s[8:11], s37 offen lds
    s_add_u32 s37, s37, 4096
    s_mov_b32 m0, s38
    s_add_u32 s38, s38, 1024
    buffer_load_dwordx4 v8, s[8:11], s37 offen lds
    s_add_u32 s37, s37, 4096
    s_mov_b32 m0, s38
    s_add_u32 s38, s38, 1024
    buffer_load_dwordx4 v8, s[8:11], s37 offen lds
    s_add_u32 s37, s37, 4096
    s_mov_b32 m0, s38
    s_add_u32 s38, s38, 1024
    buffer_load_dwordx4 v8, s[8:11], s37 offen lds
    s_add_u32 s37, s37, 4096
    s_mov_b32 m0, s38
    s_add_u32 s38, s38, 1024
    buffer_load_dwordx4 v8, s[8:11], s37 offen lds
    s_add_u32 s37, s37, 4096
    s_mov_b32 m0, s38
    s_add_u32 s38, s38, 1024
    buffer_load_dwordx4 v8, s[8:11], s37 offen lds
    s_add_u32 s37, s37, 4096
    s_mov_b32 m0, s38
    s_add_u32 s38, s38, 1024
    buffer_load_dwordx4 v8, s[8:11], s37 offen lds
    s_add_u32 s37, s37, 4096
    s_mov_b32 m0, s38
    s_add_u32 s38, s38, 1024
    buffer_load_dwordx4 v8, s[8:11], s37 offen lds
    s_add_u32 s37, s37, 4096
    s_mov_b32 m0, s38
    s_add_u32 s38, s38, 1024
    buffer_load_dwordx4 v8, s[8:11], s37 offen lds
    s_add_u32 s37, s37, 4096
    s_mov_b32 m0, s38
    s_add_u32 s38, s38, 1024
    buffer_load_dwordx4 v8, s[8:11], s37 offen lds
    s_add_u32 s37, s37, 4096
    s_mov_b32 m0, s38
    s_add_u32 s38, s38, 1024
    buffer_load_dwordx4 v8, s[8:11], s37 offen lds
    s_add_u32 s37, s37, 4096
    s_mov_b32 m0, s38
    s_add_u32 s38, s38, 1024
    buffer_load_dwordx4 v8, s[8:11], s37 offen lds
    s_add_u32 s37, s37, 4096
    s_mul_i32 s37, s30, 65536
    s_add_u32 s37, s37, s68
    s_add_u32 s37, s37, 262144
    s_mul_i32 s38, s30, 16384
    s_add_u32 s38, s38, 65536
    s_mov_b32 m0, s38
    s_add_u32 s38, s38, 1024
    buffer_load_dwordx4 v8, s[8:11], s37 offen lds
    s_add_u32 s37, s37, 4096
    s_mov_b32 m0, s38
    s_add_u32 s38, s38, 1024
    buffer_load_dwordx4 v8, s[8:11], s37 offen lds
    s_add_u32 s37, s37, 4096
    s_mov_b32 m0, s38
    s_add_u32 s38, s38, 1024
    buffer_load_dwordx4 v8, s[8:11], s37 offen lds
    s_add_u32 s37, s37, 4096
    s_mov_b32 m0, s38
    s_add_u32 s38, s38, 1024
    buffer_load_dwordx4 v8, s[8:11], s37 offen lds
    s_add_u32 s37, s37, 4096
    s_mov_b32 m0, s38
    s_add_u32 s38, s38, 1024
    buffer_load_dwordx4 v8, s[8:11], s37 offen lds
    s_add_u32 s37, s37, 4096
    s_mov_b32 m0, s38
    s_add_u32 s38, s38, 1024
    buffer_load_dwordx4 v8, s[8:11], s37 offen lds
    s_add_u32 s37, s37, 4096
    s_mov_b32 m0, s38
    s_add_u32 s38, s38, 1024
    buffer_load_dwordx4 v8, s[8:11], s37 offen lds
    s_add_u32 s37, s37, 4096
    s_mov_b32 m0, s38
    s_add_u32 s38, s38, 1024
    buffer_load_dwordx4 v8, s[8:11], s37 offen lds
    s_add_u32 s37, s37, 4096
    s_mov_b32 m0, s38
    s_add_u32 s38, s38, 1024
    buffer_load_dwordx4 v8, s[8:11], s37 offen lds
    s_add_u32 s37, s37, 4096
    s_mov_b32 m0, s38
    s_add_u32 s38, s38, 1024
    buffer_load_dwordx4 v8, s[8:11], s37 offen lds
    s_add_u32 s37, s37, 4096
    s_mov_b32 m0, s38
    s_add_u32 s38, s38, 1024
    buffer_load_dwordx4 v8, s[8:11], s37 offen lds
    s_add_u32 s37, s37, 4096
    s_mov_b32 m0, s38
    s_add_u32 s38, s38, 1024
    buffer_load_dwordx4 v8, s[8:11], s37 offen lds
    s_add_u32 s37, s37, 4096
    s_mov_b32 m0, s38
    s_add_u32 s38, s38, 1024
    buffer_load_dwordx4 v8, s[8:11], s37 offen lds
    s_add_u32 s37, s37, 4096
    s_mov_b32 m0, s38
    s_add_u32 s38, s38, 1024
    buffer_load_dwordx4 v8, s[8:11], s37 offen lds
    s_add_u32 s37, s37, 4096
    s_mov_b32 m0, s38
    s_add_u32 s38, s38, 1024
    buffer_load_dwordx4 v8, s[8:11], s37 offen lds
    s_add_u32 s37, s37, 4096
    s_mov_b32 m0, s38
    s_add_u32 s38, s38, 1024
    buffer_load_dwordx4 v8, s[8:11], s37 offen lds
    s_add_u32 s37, s37, 4096
    s_waitcnt vmcnt(16)
    s_barrier
    v_add_u32 v11, 0, v9
    ds_read_b64_tr_b16 a[0:1], v11 offset:0
    ds_read_b64_tr_b16 a[2:3], v11 offset:1024
    ds_read_b64_tr_b16 a[128:129], v11 offset:8
    ds_read_b64_tr_b16 a[130:131], v11 offset:1032
    ds_read_b64_tr_b16 a[4:5], v11 offset:8192
    ds_read_b64_tr_b16 a[6:7], v11 offset:9216
    ds_read_b64_tr_b16 a[132:133], v11 offset:8200
    ds_read_b64_tr_b16 a[134:135], v11 offset:9224
    ds_read_b64_tr_b16 a[8:9], v11 offset:16384
    ds_read_b64_tr_b16 a[10:11], v11 offset:17408
    ds_read_b64_tr_b16 a[136:137], v11 offset:16392
    ds_read_b64_tr_b16 a[138:139], v11 offset:17416
    ds_read_b64_tr_b16 a[12:13], v11 offset:24576
    ds_read_b64_tr_b16 a[14:15], v11 offset:25600
    s_waitcnt lgkmcnt(0)
    ds_read_b64_tr_b16 a[140:141], v11 offset:24584
    ds_read_b64_tr_b16 a[142:143], v11 offset:25608
    ds_read_b64_tr_b16 a[16:17], v11 offset:32768
    ds_read_b64_tr_b16 a[18:19], v11 offset:33792
    ds_read_b64_tr_b16 a[144:145], v11 offset:32776
    ds_read_b64_tr_b16 a[146:147], v11 offset:33800
    ds_read_b64_tr_b16 a[20:21], v11 offset:40960
    ds_read_b64_tr_b16 a[22:23], v11 offset:41984
    ds_read_b64_tr_b16 a[148:149], v11 offset:40968
    ds_read_b64_tr_b16 a[150:151], v11 offset:41992
    ds_read_b64_tr_b16 a[24:25], v11 offset:49152
    ds_read_b64_tr_b16 a[26:27], v11 offset:50176
    ds_read_b64_tr_b16 a[152:153], v11 offset:49160
    ds_read_b64_tr_b16 a[154:155], v11 offset:50184
    s_waitcnt lgkmcnt(0)
    ds_read_b64_tr_b16 a[28:29], v11 offset:57344
    ds_read_b64_tr_b16 a[30:31], v11 offset:58368
    ds_read_b64_tr_b16 a[156:157], v11 offset:57352
    ds_read_b64_tr_b16 a[158:159], v11 offset:58376
    s_waitcnt lgkmcnt(0)
    s_barrier
    s_mul_i32 s37, s30, 65536
    s_add_u32 s37, s37, s68
    s_add_u32 s37, s37, 524288
    s_mul_i32 s38, s30, 16384
    s_add_u32 s38, s38, 0
    s_mov_b32 m0, s38
    s_add_u32 s38, s38, 1024
    buffer_load_dwordx4 v8, s[8:11], s37 offen lds
    s_add_u32 s37, s37, 4096
    s_mov_b32 m0, s38
    s_add_u32 s38, s38, 1024
    buffer_load_dwordx4 v8, s[8:11], s37 offen lds
    s_add_u32 s37, s37, 4096
    s_mov_b32 m0, s38
    s_add_u32 s38, s38, 1024
    buffer_load_dwordx4 v8, s[8:11], s37 offen lds
    s_add_u32 s37, s37, 4096
    s_mov_b32 m0, s38
    s_add_u32 s38, s38, 1024
    buffer_load_dwordx4 v8, s[8:11], s37 offen lds
    s_add_u32 s37, s37, 4096
    s_mov_b32 m0, s38
    s_add_u32 s38, s38, 1024
    buffer_load_dwordx4 v8, s[8:11], s37 offen lds
    s_add_u32 s37, s37, 4096
    s_mov_b32 m0, s38
    s_add_u32 s38, s38, 1024
    buffer_load_dwordx4 v8, s[8:11], s37 offen lds
    s_add_u32 s37, s37, 4096
    s_mov_b32 m0, s38
    s_add_u32 s38, s38, 1024
    buffer_load_dwordx4 v8, s[8:11], s37 offen lds
    s_add_u32 s37, s37, 4096
    s_mov_b32 m0, s38
    s_add_u32 s38, s38, 1024
    buffer_load_dwordx4 v8, s[8:11], s37 offen lds
    s_add_u32 s37, s37, 4096
    s_mov_b32 m0, s38
    s_add_u32 s38, s38, 1024
    buffer_load_dwordx4 v8, s[8:11], s37 offen lds
    s_add_u32 s37, s37, 4096
    s_mov_b32 m0, s38
    s_add_u32 s38, s38, 1024
    buffer_load_dwordx4 v8, s[8:11], s37 offen lds
    s_add_u32 s37, s37, 4096
    s_mov_b32 m0, s38
    s_add_u32 s38, s38, 1024
    buffer_load_dwordx4 v8, s[8:11], s37 offen lds
    s_add_u32 s37, s37, 4096
    s_mov_b32 m0, s38
    s_add_u32 s38, s38, 1024
    buffer_load_dwordx4 v8, s[8:11], s37 offen lds
    s_add_u32 s37, s37, 4096
    s_mov_b32 m0, s38
    s_add_u32 s38, s38, 1024
    buffer_load_dwordx4 v8, s[8:11], s37 offen lds
    s_add_u32 s37, s37, 4096
    s_mov_b32 m0, s38
    s_add_u32 s38, s38, 1024
    buffer_load_dwordx4 v8, s[8:11], s37 offen lds
    s_add_u32 s37, s37, 4096
    s_mov_b32 m0, s38
    s_add_u32 s38, s38, 1024
    buffer_load_dwordx4 v8, s[8:11], s37 offen lds
    s_add_u32 s37, s37, 4096
    s_mov_b32 m0, s38
    s_add_u32 s38, s38, 1024
    buffer_load_dwordx4 v8, s[8:11], s37 offen lds
    s_add_u32 s37, s37, 4096
    s_waitcnt vmcnt(16)
    s_barrier
    v_add_u32 v11, 65536, v9
    ds_read_b64_tr_b16 a[32:33], v11 offset:0
    ds_read_b64_tr_b16 a[34:35], v11 offset:1024
    ds_read_b64_tr_b16 a[160:161], v11 offset:8
    ds_read_b64_tr_b16 a[162:163], v11 offset:1032
    ds_read_b64_tr_b16 a[36:37], v11 offset:8192
    ds_read_b64_tr_b16 a[38:39], v11 offset:9216
    ds_read_b64_tr_b16 a[164:165], v11 offset:8200
    ds_read_b64_tr_b16 a[166:167], v11 offset:9224
    ds_read_b64_tr_b16 a[40:41], v11 offset:16384
    ds_read_b64_tr_b16 a[42:43], v11 offset:17408
    ds_read_b64_tr_b16 a[168:169], v11 offset:16392
    ds_read_b64_tr_b16 a[170:171], v11 offset:17416
    ds_read_b64_tr_b16 a[44:45], v11 offset:24576
    ds_read_b64_tr_b16 a[46:47], v11 offset:25600
    s_waitcnt lgkmcnt(0)
    ds_read_b64_tr_b16 a[172:173], v11 offset:24584
    ds_read_b64_tr_b16 a[174:175], v11 offset:25608
    ds_read_b64_tr_b16 a[48:49], v11 offset:32768
    ds_read_b64_tr_b16 a[50:51], v11 offset:33792
    ds_read_b64_tr_b16 a[176:177], v11 offset:32776
    ds_read_b64_tr_b16 a[178:179], v11 offset:33800
    ds_read_b64_tr_b16 a[52:53], v11 offset:40960
    ds_read_b64_tr_b16 a[54:55], v11 offset:41984
    ds_read_b64_tr_b16 a[180:181], v11 offset:40968
    ds_read_b64_tr_b16 a[182:183], v11 offset:41992
    ds_read_b64_tr_b16 a[56:57], v11 offset:49152
    ds_read_b64_tr_b16 a[58:59], v11 offset:50176
    ds_read_b64_tr_b16 a[184:185], v11 offset:49160
    ds_read_b64_tr_b16 a[186:187], v11 offset:50184
    s_waitcnt lgkmcnt(0)
    ds_read_b64_tr_b16 a[60:61], v11 offset:57344
    ds_read_b64_tr_b16 a[62:63], v11 offset:58368
    ds_read_b64_tr_b16 a[188:189], v11 offset:57352
    ds_read_b64_tr_b16 a[190:191], v11 offset:58376
    s_waitcnt lgkmcnt(0)
    s_barrier
    s_mul_i32 s37, s30, 65536
    s_add_u32 s37, s37, s68
    s_add_u32 s37, s37, 786432
    s_mul_i32 s38, s30, 16384
    s_add_u32 s38, s38, 65536
    s_mov_b32 m0, s38
    s_add_u32 s38, s38, 1024
    buffer_load_dwordx4 v8, s[8:11], s37 offen lds
    s_add_u32 s37, s37, 4096
    s_mov_b32 m0, s38
    s_add_u32 s38, s38, 1024
    buffer_load_dwordx4 v8, s[8:11], s37 offen lds
    s_add_u32 s37, s37, 4096
    s_mov_b32 m0, s38
    s_add_u32 s38, s38, 1024
    buffer_load_dwordx4 v8, s[8:11], s37 offen lds
    s_add_u32 s37, s37, 4096
    s_mov_b32 m0, s38
    s_add_u32 s38, s38, 1024
    buffer_load_dwordx4 v8, s[8:11], s37 offen lds
    s_add_u32 s37, s37, 4096
    s_mov_b32 m0, s38
    s_add_u32 s38, s38, 1024
    buffer_load_dwordx4 v8, s[8:11], s37 offen lds
    s_add_u32 s37, s37, 4096
    s_mov_b32 m0, s38
    s_add_u32 s38, s38, 1024
    buffer_load_dwordx4 v8, s[8:11], s37 offen lds
    s_add_u32 s37, s37, 4096
    s_mov_b32 m0, s38
    s_add_u32 s38, s38, 1024
    buffer_load_dwordx4 v8, s[8:11], s37 offen lds
    s_add_u32 s37, s37, 4096
    s_mov_b32 m0, s38
    s_add_u32 s38, s38, 1024
    buffer_load_dwordx4 v8, s[8:11], s37 offen lds
    s_add_u32 s37, s37, 4096
    s_mov_b32 m0, s38
    s_add_u32 s38, s38, 1024
    buffer_load_dwordx4 v8, s[8:11], s37 offen lds
    s_add_u32 s37, s37, 4096
    s_mov_b32 m0, s38
    s_add_u32 s38, s38, 1024
    buffer_load_dwordx4 v8, s[8:11], s37 offen lds
    s_add_u32 s37, s37, 4096
    s_mov_b32 m0, s38
    s_add_u32 s38, s38, 1024
    buffer_load_dwordx4 v8, s[8:11], s37 offen lds
    s_add_u32 s37, s37, 4096
    s_mov_b32 m0, s38
    s_add_u32 s38, s38, 1024
    buffer_load_dwordx4 v8, s[8:11], s37 offen lds
    s_add_u32 s37, s37, 4096
    s_mov_b32 m0, s38
    s_add_u32 s38, s38, 1024
    buffer_load_dwordx4 v8, s[8:11], s37 offen lds
    s_add_u32 s37, s37, 4096
    s_mov_b32 m0, s38
    s_add_u32 s38, s38, 1024
    buffer_load_dwordx4 v8, s[8:11], s37 offen lds
    s_add_u32 s37, s37, 4096
    s_mov_b32 m0, s38
    s_add_u32 s38, s38, 1024
    buffer_load_dwordx4 v8, s[8:11], s37 offen lds
    s_add_u32 s37, s37, 4096
    s_mov_b32 m0, s38
    s_add_u32 s38, s38, 1024
    buffer_load_dwordx4 v8, s[8:11], s37 offen lds
    s_add_u32 s37, s37, 4096
    s_waitcnt vmcnt(16)
    s_barrier
    v_add_u32 v11, 0, v9
    ds_read_b64_tr_b16 a[64:65], v11 offset:0
    ds_read_b64_tr_b16 a[66:67], v11 offset:1024
    ds_read_b64_tr_b16 a[192:193], v11 offset:8
    ds_read_b64_tr_b16 a[194:195], v11 offset:1032
    ds_read_b64_tr_b16 a[68:69], v11 offset:8192
    ds_read_b64_tr_b16 a[70:71], v11 offset:9216
    ds_read_b64_tr_b16 a[196:197], v11 offset:8200
    ds_read_b64_tr_b16 a[198:199], v11 offset:9224
    ds_read_b64_tr_b16 a[72:73], v11 offset:16384
    ds_read_b64_tr_b16 a[74:75], v11 offset:17408
    ds_read_b64_tr_b16 a[200:201], v11 offset:16392
    ds_read_b64_tr_b16 a[202:203], v11 offset:17416
    ds_read_b64_tr_b16 a[76:77], v11 offset:24576
    ds_read_b64_tr_b16 a[78:79], v11 offset:25600
    s_waitcnt lgkmcnt(0)
    ds_read_b64_tr_b16 a[204:205], v11 offset:24584
    ds_read_b64_tr_b16 a[206:207], v11 offset:25608
    ds_read_b64_tr_b16 a[80:81], v11 offset:32768
    ds_read_b64_tr_b16 a[82:83], v11 offset:33792
    ds_read_b64_tr_b16 a[208:209], v11 offset:32776
    ds_read_b64_tr_b16 a[210:211], v11 offset:33800
    ds_read_b64_tr_b16 a[84:85], v11 offset:40960
    ds_read_b64_tr_b16 a[86:87], v11 offset:41984
    ds_read_b64_tr_b16 a[212:213], v11 offset:40968
    ds_read_b64_tr_b16 a[214:215], v11 offset:41992
    ds_read_b64_tr_b16 a[88:89], v11 offset:49152
    ds_read_b64_tr_b16 a[90:91], v11 offset:50176
    ds_read_b64_tr_b16 a[216:217], v11 offset:49160
    ds_read_b64_tr_b16 a[218:219], v11 offset:50184
    s_waitcnt lgkmcnt(0)
    ds_read_b64_tr_b16 a[92:93], v11 offset:57344
    ds_read_b64_tr_b16 a[94:95], v11 offset:58368
    ds_read_b64_tr_b16 a[220:221], v11 offset:57352
    ds_read_b64_tr_b16 a[222:223], v11 offset:58376
    s_waitcnt lgkmcnt(0)
    s_barrier
    s_waitcnt vmcnt(0)
    s_barrier
    v_add_u32 v11, 65536, v9
    ds_read_b64_tr_b16 a[96:97], v11 offset:0
    ds_read_b64_tr_b16 a[98:99], v11 offset:1024
    ds_read_b64_tr_b16 a[224:225], v11 offset:8
    ds_read_b64_tr_b16 a[226:227], v11 offset:1032
    ds_read_b64_tr_b16 a[100:101], v11 offset:8192
    ds_read_b64_tr_b16 a[102:103], v11 offset:9216
    ds_read_b64_tr_b16 a[228:229], v11 offset:8200
    ds_read_b64_tr_b16 a[230:231], v11 offset:9224
    ds_read_b64_tr_b16 a[104:105], v11 offset:16384
    ds_read_b64_tr_b16 a[106:107], v11 offset:17408
    ds_read_b64_tr_b16 a[232:233], v11 offset:16392
    ds_read_b64_tr_b16 a[234:235], v11 offset:17416
    ds_read_b64_tr_b16 a[108:109], v11 offset:24576
    ds_read_b64_tr_b16 a[110:111], v11 offset:25600
    s_waitcnt lgkmcnt(0)
    ds_read_b64_tr_b16 a[236:237], v11 offset:24584
    ds_read_b64_tr_b16 a[238:239], v11 offset:25608
    ds_read_b64_tr_b16 a[112:113], v11 offset:32768
    ds_read_b64_tr_b16 a[114:115], v11 offset:33792
    ds_read_b64_tr_b16 a[240:241], v11 offset:32776
    ds_read_b64_tr_b16 a[242:243], v11 offset:33800
    ds_read_b64_tr_b16 a[116:117], v11 offset:40960
    ds_read_b64_tr_b16 a[118:119], v11 offset:41984
    ds_read_b64_tr_b16 a[244:245], v11 offset:40968
    ds_read_b64_tr_b16 a[246:247], v11 offset:41992
    ds_read_b64_tr_b16 a[120:121], v11 offset:49152
    ds_read_b64_tr_b16 a[122:123], v11 offset:50176
    ds_read_b64_tr_b16 a[248:249], v11 offset:49160
    ds_read_b64_tr_b16 a[250:251], v11 offset:50184
    s_waitcnt lgkmcnt(0)
    ds_read_b64_tr_b16 a[124:125], v11 offset:57344
    ds_read_b64_tr_b16 a[126:127], v11 offset:58368
    ds_read_b64_tr_b16 a[252:253], v11 offset:57352
    ds_read_b64_tr_b16 a[254:255], v11 offset:58376
    s_waitcnt lgkmcnt(0)
    s_barrier
    v_and_b32 v5, 31, v1
    v_lshlrev_b32 v2, 2, v5
    v_lshrrev_b32 v5, 5, v1
    v_lshl_add_u32 v2, v5, 7, v2
    s_mov_b32 s63, 1024
    s_and_b32 s36, s31, 15
    s_lshl_b32 s36, s36, 2
    s_mul_i32 s37, s64, 1280
    s_add_u32 s36, s36, s37
    s_add_u32 s62, s36, 1280
    s_cmp_lg_u32 s30, 0
    s_cbranch_scc1 L_pw_ok_ido
    s_mov_b32 s36, 0
    v_mov_b32 v120, 32
L_pw_ido:
    buffer_load_dword v121, v120, s[24:27], 0 offen sc1
    s_waitcnt vmcnt(0)
    v_readfirstlane_b32 s37, v121
    s_nop 3
    s_cmp_ge_u32 s37, 256
    s_cbranch_scc1 L_pw_ok_ido
    s_sleep 4
    s_add_u32 s36, s36, 1
    s_cmp_lt_u32 s36, 65536
    s_cbranch_scc1 L_pw_ido
    s_mov_b32 s33, 1
L_pw_ok_ido:
    s_barrier
    s_mov_b32 s41, 0
    s_mov_b32 s58, 0
    s_mov_b32 s42, 0
    s_mov_b32 s59, 0
    s_mov_b32 s49, 0
    s_mov_b32 s50, 0
    s_mov_b32 s52, 0
    s_mov_b32 s53, 0
    s_mov_b32 s43, 0
    s_mov_b32 s44, 0
    s_mov_b32 s47, 0
    s_mov_b32 s48, 0
    s_mov_b32 s51, 163328
    v_cmp_lt_u32 s[88:89], 31, v1
    v_and_b32 v15, 31, v1
    v_subrev_u32 v15, s67, v15
    v_cmp_gt_u32 vcc, 8, v15
    s_nop 1
    v_cndmask_b32 v15, 0, 1, vcc
    s_mov_b32 s96, 0
L_o_cold:
    s_waitcnt vmcnt(0)
    s_barrier
    s_cmp_eq_u32 s43, s52
    s_cbranch_scc1 L_o_nopub2
    v_mov_b32 v5, s44
    v_mov_b32 v6, 0
    s_mov_b64 exec, 1
    s_cmp_lg_u32 s30, 0
    s_cbranch_scc1 L_pub_17_d
    s_lshl_b32 s36, s43, 7
    s_add_u32 s36, s36, s62
    buffer_store_dword v5, v6, s[4:7], s36 offen sc1
    s_branch L_pub_17_e
L_pub_17_d:
    buffer_store_dword v5, v6, s[4:7], s97 offen
L_pub_17_e:
    s_mov_b64 exec, -1
L_o_nopub2:
    v_mov_b32 v5, s53
    v_mov_b32 v6, 0
    s_mov_b64 exec, 1
    s_cmp_lg_u32 s30, 0
    s_cbranch_scc1 L_pub_18_d
    s_lshl_b32 s36, s52, 7
    s_add_u32 s36, s36, s62
    buffer_store_dword v5, v6, s[4:7], s36 offen sc1
    s_branch L_pub_18_e
L_pub_18_d:
    buffer_store_dword v5, v6, s[4:7], s97 offen
L_pub_18_e:
    s_mov_b64 exec, -1
    s_mov_b32 s43, s52
    s_mov_b32 s44, s53
    s_mov_b32 s40, 0
    s_add_u32 s36, s41, s42
    s_cmp_ge_u32 s36, 64
    s_cbranch_scc1 L_o_exit
    s_cmp_lg_u32 s30, 0
    s_cbranch_scc1 L_o_cwait
    s_waitcnt vmcnt(0)
    buffer_load_dword v12, v2, s[4:7], s63 offen sc1
    s_nop 15
    s_nop 15
    s_nop 15
    s_nop 15
    s_nop 15
    s_nop 15
L_o_w0spin:
    buffer_load_dword v13, v2, s[4:7], s63 offen sc1
    s_waitcnt vmcnt(1)
    v_mov_b32 v4, v12
    s_cmp_ge_u32 s41, 32
    s_cbranch_scc1 L_o_p_try1
    s_lshl_b32 s48, s41, 1
    s_add_u32 s48, s48, s64
    s_add_u32 s54, s48, 1
    s_add_u32 s36, s67, 0
    v_subrev_u32 v7, s36, v1
    v_cmp_gt_u32 vcc, 8, v7
    v_mov_b32 v6, s54
    s_nop 0
    v_cndmask_b32 v7, 0, v6, vcc
    v_cmp_lt_u32 vcc, v4, v7
    s_nop 1
    s_cmp_eq_u64 vcc, 0
    s_cbranch_scc1 L_o_p_done
L_o_p_try1:
    s_cmp_ge_u32 s42, 32
    s_cbranch_scc1 L_o_p_try2
    s_lshl_b32 s48, s42, 1
    s_add_u32 s48, s48, s64
    s_add_u32 s54, s48, 1
    s_add_u32 s36, s67, 32
    v_subrev_u32 v7, s36, v1
    v_cmp_gt_u32 vcc, 8, v7
    v_mov_b32 v6, s54
    s_nop 0
    v_cndmask_b32 v7, 0, v6, vcc
    v_cmp_lt_u32 vcc, v4, v7
    s_nop 1
    s_cmp_eq_u64 vcc, 0
    s_cbranch_scc1 L_o_p_done
L_o_p_try2:
    s_cmp_lg_u32 s47, s47
L_o_p_done:
    s_cbranch_scc1 L_o_w0got
    buffer_load_dword v12, v2, s[4:7], s63 offen sc1
    s_waitcnt vmcnt(1)
    v_mov_b32 v4, v13
    s_cmp_ge_u32 s41, 32
    s_cbranch_scc1 L_o_q_try1
    s_lshl_b32 s48, s41, 1
    s_add_u32 s48, s48, s64
    s_add_u32 s54, s48, 1
    s_add_u32 s36, s67, 0
    v_subrev_u32 v7, s36, v1
    v_cmp_gt_u32 vcc, 8, v7
    v_mov_b32 v6, s54
    s_nop 0
    v_cndmask_b32 v7, 0, v6, vcc
    v_cmp_lt_u32 vcc, v4, v7
    s_nop 1
    s_cmp_eq_u64 vcc, 0
    s_cbranch_scc1 L_o_q_done
L_o_q_try1:
    s_cmp_ge_u32 s42, 32
    s_cbranch_scc1 L_o_q_try2
    s_lshl_b32 s48, s42, 1
    s_add_u32 s48, s48, s64
    s_add_u32 s54, s48, 1
    s_add_u32 s36, s67, 32
    v_subrev_u32 v7, s36, v1
    v_cmp_gt_u32 vcc, 8, v7
    v_mov_b32 v6, s54
    s_nop 0
    v_cndmask_b32 v7, 0, v6, vcc
    v_cmp_lt_u32 vcc, v4, v7
    s_nop 1
    s_cmp_eq_u64 vcc, 0
    s_cbranch_scc1 L_o_q_done
L_o_q_try2:
    s_cmp_lg_u32 s47, s47
L_o_q_done:
    s_cbranch_scc1 L_o_w0got
    s_add_u32 s40, s40, 1
    s_cmp_lt_u32 s40, s35
    s_cbranch_scc1 L_o_w0spin
L_o_w0got:
    v_lshlrev_b32 v5, 2, v1
    v_add_u32 v5, s51, v5
    ds_write_b32 v5, v4
    s_waitcnt lgkmcnt(0)
L_o_cwait:
    s_barrier
    v_lshlrev_b32 v5, 2, v1
    v_add_u32 v5, s51, v5
    ds_read_b32 v4, v5
    s_xor_b32 s51, s51, 256
    s_waitcnt lgkmcnt(0)
    s_cmp_ge_u32 s41, 32
    s_cbranch_scc1 L_o_c_try1
    s_lshl_b32 s48, s41, 1
    s_add_u32 s48, s48, s64
    s_add_u32 s54, s48, 1
    s_add_u32 s36, s67, 0
    v_subrev_u32 v7, s36, v1
    v_cmp_gt_u32 vcc, 8, v7
    v_mov_b32 v6, s54
    s_nop 0
    v_cndmask_b32 v7, 0, v6, vcc
    v_cmp_lt_u32 vcc, v4, v7
    s_nop 1
    s_cmp_eq_u64 vcc, 0
    s_cbranch_scc0 L_o_c_try1
    s_mov_b32 s47, 0
    s_add_u32 s41, s41, 1
    s_cmp_eq_u32 s47, s47
    s_branch L_o_c_done
L_o_c_try1:
    s_cmp_ge_u32 s42, 32
    s_cbranch_scc1 L_o_c_try2
    s_lshl_b32 s48, s42, 1
    s_add_u32 s48, s48, s64
    s_add_u32 s54, s48, 1
    s_add_u32 s36, s67, 32
    v_subrev_u32 v7, s36, v1
    v_cmp_gt_u32 vcc, 8, v7
    v_mov_b32 v6, s54
    s_nop 0
    v_cndmask_b32 v7, 0, v6, vcc
    v_cmp_lt_u32 vcc, v4, v7
    s_nop 1
    s_cmp_eq_u64 vcc, 0
    s_cbranch_scc0 L_o_c_try2
    s_mov_b32 s47, 1
    s_add_u32 s42, s42, 1
    s_cmp_eq_u32 s47, s47
    s_branch L_o_c_done
L_o_c_try2:
    s_cmp_lg_u32 s47, s47
L_o_c_done:
    s_cbranch_scc1 L_o_got
    s_mov_b32 s33, 1
    s_branch L_o_exit
L_o_got:
    s_lshl_b32 s36, s47, 24
    s_lshl_b32 s37, s48, 18
    s_add_u32 s36, s36, s37
    s_add_u32 s36, s36, 0xa800000
    s_mul_i32 s37, s65, 32768
    s_add_u32 s36, s36, s37
    s_lshr_b32 s37, s30, 1
    s_mul_i32 s38, s37, 131072
    s_add_u32 s36, s36, s38
    s_mul_i32 s38, s37, 32768
    s_and_b32 s37, s30, 1
    s_mul_i32 s37, s37, 16384
    s_add_u32 s60, s36, s37
    s_add_u32 s37, s37, s38
    s_add_u32 s61, s37, s50
    s_mov_b32 m0, s61
    s_add_u32 s61, s61, 1024
    buffer_load_dwordx4 v0, s[4:7], s60 offen sc1 lds
    s_add_u32 s60, s60, 1024
    s_mov_b32 m0, s61
    s_add_u32 s61, s61, 1024
    buffer_load_dwordx4 v0, s[4:7], s60 offen sc1 lds
    s_add_u32 s60, s60, 1024
    s_mov_b32 m0, s61
    s_add_u32 s61, s61, 1024
    buffer_load_dwordx4 v0, s[4:7], s60 offen sc1 lds
    s_add_u32 s60, s60, 1024
    s_mov_b32 m0, s61
    s_add_u32 s61, s61, 1024
    buffer_load_dwordx4 v0, s[4:7], s60 offen sc1 lds
    s_add_u32 s60, s60, 1024
    s_mov_b32 m0, s61
    s_add_u32 s61, s61, 1024
    buffer_load_dwordx4 v0, s[4:7], s60 offen sc1 lds
    s_add_u32 s60, s60, 1024
    s_mov_b32 m0, s61
    s_add_u32 s61, s61, 1024
    buffer_load_dwordx4 v0, s[4:7], s60 offen sc1 lds
    s_add_u32 s60, s60, 1024
    s_mov_b32 m0, s61
    s_add_u32 s61, s61, 1024
    buffer_load_dwordx4 v0, s[4:7], s60 offen sc1 lds
    s_add_u32 s60, s60, 1024
    s_mov_b32 m0, s61
    s_add_u32 s61, s61, 1024
    buffer_load_dwordx4 v0, s[4:7], s60 offen sc1 lds
    s_add_u32 s60, s60, 1024
    s_mov_b32 m0, s61
    s_add_u32 s61, s61, 1024
    buffer_load_dwordx4 v0, s[4:7], s60 offen sc1 lds
    s_add_u32 s60, s60, 1024
    s_mov_b32 m0, s61
    s_add_u32 s61, s61, 1024
    buffer_load_dwordx4 v0, s[4:7], s60 offen sc1 lds
    s_add_u32 s60, s60, 1024
    s_mov_b32 m0, s61
    s_add_u32 s61, s61, 1024
    buffer_load_dwordx4 v0, s[4:7], s60 offen sc1 lds
    s_add_u32 s60, s60, 1024
    s_mov_b32 m0, s61
    s_add_u32 s61, s61, 1024
    buffer_load_dwordx4 v0, s[4:7], s60 offen sc1 lds
    s_add_u32 s60, s60, 1024
    s_mov_b32 m0, s61
    s_add_u32 s61, s61, 1024
    buffer_load_dwordx4 v0, s[4:7], s60 offen sc1 lds
    s_add_u32 s60, s60, 1024
    s_mov_b32 m0, s61
    s_add_u32 s61, s61, 1024
    buffer_load_dwordx4 v0, s[4:7], s60 offen sc1 lds
    s_add_u32 s60, s60, 1024
    s_mov_b32 m0, s61
    s_add_u32 s61, s61, 1024
    buffer_load_dwordx4 v0, s[4:7], s60 offen sc1 lds
    s_add_u32 s60, s60, 1024
    s_mov_b32 m0, s61
    s_add_u32 s61, s61, 1024
    buffer_load_dwordx4 v0, s[4:7], s60 offen sc1 lds
    s_add_u32 s60, s60, 1024
    s_mov_b32 m0, s51
    s_nop 0
    buffer_load_dword v2, s[4:7], s63 offen sc1 lds
    s_mov_b32 s45, s47
    s_mov_b32 s46, s48
    s_waitcnt vmcnt(0)
    s_barrier
    v_add_u32 v8, s50, v0
    ds_read_b128 v[32:35], v8 offset:0
    ds_read_b128 v[36:39], v8 offset:32768
    ds_read_b128 v[40:43], v8 offset:1024
    ds_read_b128 v[44:47], v8 offset:33792
    v_lshlrev_b32 v5, 2, v1
    v_add_u32 v5, s51, v5
    ds_read_b32 v4, v5
    s_xor_b32 s51, s51, 256
L_o_main:
    s_waitcnt lgkmcnt(3)
    v_mfma_f32_16x16x32_bf16 v[16:19], a[0:3], v[32:35], 0
    ds_read_b128 v[48:51], v8 offset:2048
    ds_read_b128 v[52:55], v8 offset:34816
    v_mfma_f32_16x16x32_bf16 v[20:23], a[128:131], v[32:35], 0
    s_lshl_b32 s86, s41, 1
    s_add_u32 s86, s86, s64
    v_mfma_f32_16x16x32_bf16 v[24:27], a[0:3], v[36:39], 0
    s_lshl_b32 s87, s42, 1
    s_add_u32 s87, s87, s64
    v_mfma_f32_16x16x32_bf16 v[28:31], a[128:131], v[36:39], 0
    s_waitcnt lgkmcnt(3)
    v_mfma_f32_16x16x32_bf16 v[16:19], a[4:7], v[40:43], v[16:19]
    ds_read_b128 v[32:35], v8 offset:3072
    v_mfma_f32_16x16x32_bf16 v[20:23], a[132:135], v[40:43], v[20:23]
    ds_read_b128 v[36:39], v8 offset:35840
    v_mfma_f32_16x16x32_bf16 v[24:27], a[4:7], v[44:47], v[24:27]
    v_mfma_f32_16x16x32_bf16 v[28:31], a[132:135], v[44:47], v[28:31]
    s_waitcnt lgkmcnt(2)
    v_mfma_f32_16x16x32_bf16 v[16:19], a[8:11], v[48:51], v[16:19]
    ds_read_b128 v[40:43], v8 offset:4096
    ds_read_b128 v[44:47], v8 offset:36864
    v_mfma_f32_16x16x32_bf16 v[20:23], a[136:139], v[48:51], v[20:23]
    v_mov_b32 v6, s86
    v_mov_b32 v7, s87
    v_mfma_f32_16x16x32_bf16 v[24:27], a[8:11], v[52:55], v[24:27]
    v_cndmask_b32 v6, v6, v7, s[88:89]
    v_add_u32 v6, 1, v6
    v_mfma_f32_16x16x32_bf16 v[28:31], a[136:139], v[52:55], v[28:31]
    v_mul_u32_u24 v7, v6, v15
    v_cmp_lt_u32 vcc, v4, v7
    s_waitcnt lgkmcnt(2)
    v_mfma_f32_16x16x32_bf16 v[16:19], a[12:15], v[32:35], v[16:19]
    ds_read_b128 v[48:51], v8 offset:5120
    v_mfma_f32_16x16x32_bf16 v[20:23], a[140:143], v[32:35], v[20:23]
    ds_read_b128 v[52:55], v8 offset:37888
    v_mfma_f32_16x16x32_bf16 v[24:27], a[12:15], v[36:39], v[24:27]
    v_mfma_f32_16x16x32_bf16 v[28:31], a[140:143], v[36:39], v[28:31]
    s_cmp_eq_u32 vcc_lo, 0
    s_cselect_b32 s54, 1, 0
    s_cmp_lt_u32 s41, 32
    s_cselect_b32 s54, s54, 0
    s_cmp_eq_u32 vcc_hi, 0
    s_cselect_b32 s55, 1, 0
    s_cmp_lt_u32 s42, 32
    s_cselect_b32 s55, s55, 0
    s_or_b32 s49, s54, s55
    s_cmp_eq_u32 s54, 1
    s_cselect_b32 s47, 0, 1
    s_cselect_b32 s48, s86, s87
    s_cselect_b32 s55, 0, s55
    s_add_u32 s41, s41, s54
    s_add_u32 s42, s42, s55
    s_cmp_eq_u32 s49, 0
    s_cbranch_scc1 L_o_nopf
    s_xor_b32 s57, s50, 65536
    s_lshl_b32 s36, s47, 24
    s_lshl_b32 s37, s48, 18
    s_add_u32 s36, s36, s37
    s_add_u32 s36, s36, 0xa800000
    s_mul_i32 s37, s65, 32768
    s_add_u32 s36, s36, s37
    s_lshr_b32 s37, s30, 1
    s_mul_i32 s38, s37, 131072
    s_add_u32 s36, s36, s38
    s_mul_i32 s38, s37, 32768
    s_and_b32 s37, s30, 1
    s_mul_i32 s37, s37, 16384
    s_add_u32 s60, s36, s37
    s_add_u32 s37, s37, s38
    s_add_u32 s61, s37, s57
    s_waitcnt lgkmcnt(2)
    v_mfma_f32_16x16x32_bf16 v[16:19], a[16:19], v[40:43], v[16:19]
    ds_read_b128 v[32:35], v8 offset:6144
    ds_read_b128 v[36:39], v8 offset:38912
    v_mfma_f32_16x16x32_bf16 v[20:23], a[144:147], v[40:43], v[20:23]
    s_mov_b32 m0, s61
    s_add_u32 s61, s61, 1024
    v_mfma_f32_16x16x32_bf16 v[24:27], a[16:19], v[44:47], v[24:27]
    buffer_load_dwordx4 v0, s[4:7], s60 offen sc1 lds
    s_add_u32 s60, s60, 1024
    v_mfma_f32_16x16x32_bf16 v[28:31], a[144:147], v[44:47], v[28:31]
    s_waitcnt lgkmcnt(2)
    v_mfma_f32_16x16x32_bf16 v[16:19], a[20:23], v[48:51], v[16:19]
    ds_read_b128 v[40:43], v8 offset:7168
    ds_read_b128 v[44:47], v8 offset:39936
    v_mfma_f32_16x16x32_bf16 v[20:23], a[148:151], v[48:51], v[20:23]
    s_mov_b32 m0, s61
    s_add_u32 s61, s61, 1024
    v_mfma_f32_16x16x32_bf16 v[24:27], a[20:23], v[52:55], v[24:27]
    buffer_load_dwordx4 v0, s[4:7], s60 offen sc1 lds
    s_add_u32 s60, s60, 1024
    v_mfma_f32_16x16x32_bf16 v[28:31], a[148:151], v[52:55], v[28:31]
    s_waitcnt lgkmcnt(2)
    v_mfma_f32_16x16x32_bf16 v[16:19], a[24:27], v[32:35], v[16:19]
    ds_read_b128 v[48:51], v8 offset:8192
    ds_read_b128 v[52:55], v8 offset:40960
    v_mfma_f32_16x16x32_bf16 v[20:23], a[152:155], v[32:35], v[20:23]
    s_mov_b32 m0, s61
    s_add_u32 s61, s61, 1024
    v_mfma_f32_16x16x32_bf16 v[24:27], a[24:27], v[36:39], v[24:27]
    buffer_load_dwordx4 v0, s[4:7], s60 offen sc1 lds
    s_add_u32 s60, s60, 1024
    v_mfma_f32_16x16x32_bf16 v[28:31], a[152:155], v[36:39], v[28:31]
    s_waitcnt lgkmcnt(2)
    v_mfma_f32_16x16x32_bf16 v[16:19], a[28:31], v[40:43], v[16:19]
    ds_read_b128 v[32:35], v8 offset:9216
    ds_read_b128 v[36:39], v8 offset:41984
    v_mfma_f32_16x16x32_bf16 v[20:23], a[156:159], v[40:43], v[20:23]
    s_mov_b32 m0, s61
    s_add_u32 s61, s61, 1024
    v_mfma_f32_16x16x32_bf16 v[24:27], a[28:31], v[44:47], v[24:27]
    buffer_load_dwordx4 v0, s[4:7], s60 offen sc1 lds
    s_add_u32 s60, s60, 1024
    v_mfma_f32_16x16x32_bf16 v[28:31], a[156:159], v[44:47], v[28:31]
    s_waitcnt lgkmcnt(2)
    v_mfma_f32_16x16x32_bf16 v[16:19], a[32:35], v[48:51], v[16:19]
    ds_read_b128 v[40:43], v8 offset:10240
    ds_read_b128 v[44:47], v8 offset:43008
    v_mfma_f32_16x16x32_bf16 v[20:23], a[160:163], v[48:51], v[20:23]
    s_mov_b32 m0, s61
    s_add_u32 s61, s61, 1024
    v_mfma_f32_16x16x32_bf16 v[24:27], a[32:35], v[52:55], v[24:27]
    buffer_load_dwordx4 v0, s[4:7], s60 offen sc1 lds
    s_add_u32 s60, s60, 1024
    v_mfma_f32_16x16x32_bf16 v[28:31], a[160:163], v[52:55], v[28:31]
    s_waitcnt lgkmcnt(2)
    v_mfma_f32_16x16x32_bf16 v[16:19], a[36:39], v[32:35], v[16:19]
    ds_read_b128 v[48:51], v8 offset:11264
    ds_read_b128 v[52:55], v8 offset:44032
    v_mfma_f32_16x16x32_bf16 v[20:23], a[164:167], v[32:35], v[20:23]
    s_mov_b32 m0, s61
    s_add_u32 s61, s61, 1024
    v_mfma_f32_16x16x32_bf16 v[24:27], a[36:39], v[36:39], v[24:27]
    buffer_load_dwordx4 v0, s[4:7], s60 offen sc1 lds
    s_add_u32 s60, s60, 1024
    v_mfma_f32_16x16x32_bf16 v[28:31], a[164:167], v[36:39], v[28:31]
    s_waitcnt lgkmcnt(2)
    v_mfma_f32_16x16x32_bf16 v[16:19], a[40:43], v[40:43], v[16:19]
    ds_read_b128 v[32:35], v8 offset:12288
    ds_read_b128 v[36:39], v8 offset:45056
    v_mfma_f32_16x16x32_bf16 v[20:23], a[168:171], v[40:43], v[20:23]
    s_mov_b32 m0, s61
    s_add_u32 s61, s61, 1024
    v_mfma_f32_16x16x32_bf16 v[24:27], a[40:43], v[44:47], v[24:27]
    buffer_load_dwordx4 v0, s[4:7], s60 offen sc1 lds
    s_add_u32 s60, s60, 1024
    v_mfma_f32_16x16x32_bf16 v[28:31], a[168:171], v[44:47], v[28:31]
    s_waitcnt lgkmcnt(2)
    v_mfma_f32_16x16x32_bf16 v[16:19], a[44:47], v[48:51], v[16:19]
    ds_read_b128 v[40:43], v8 offset:13312
    ds_read_b128 v[44:47], v8 offset:46080
    v_mfma_f32_16x16x32_bf16 v[20:23], a[172:175], v[48:51], v[20:23]
    s_mov_b32 m0, s61
    s_add_u32 s61, s61, 1024
    v_mfma_f32_16x16x32_bf16 v[24:27], a[44:47], v[52:55], v[24:27]
    buffer_load_dwordx4 v0, s[4:7], s60 offen sc1 lds
    s_add_u32 s60, s60, 1024
    v_mfma_f32_16x16x32_bf16 v[28:31], a[172:175], v[52:55], v[28:31]
    s_waitcnt lgkmcnt(2)
    v_mfma_f32_16x16x32_bf16 v[16:19], a[48:51], v[32:35], v[16:19]
    ds_read_b128 v[48:51], v8 offset:14336
    ds_read_b128 v[52:55], v8 offset:47104
    v_mfma_f32_16x16x32_bf16 v[20:23], a[176:179], v[32:35], v[20:23]
    s_mov_b32 m0, s61
    s_add_u32 s61, s61, 1024
    v_mfma_f32_16x16x32_bf16 v[24:27], a[48:51], v[36:39], v[24:27]
    buffer_load_dwordx4 v0, s[4:7], s60 offen sc1 lds
    s_add_u32 s60, s60, 1024
    v_mfma_f32_16x16x32_bf16 v[28:31], a[176:179], v[36:39], v[28:31]
    s_waitcnt lgkmcnt(2)
    v_mfma_f32_16x16x32_bf16 v[16:19], a[52:55], v[40:43], v[16:19]
    ds_read_b128 v[32:35], v8 offset:15360
    ds_read_b128 v[36:39], v8 offset:48128
    v_mfma_f32_16x16x32_bf16 v[20:23], a[180:183], v[40:43], v[20:23]
    s_mov_b32 m0, s61
    s_add_u32 s61, s61, 1024
    v_mfma_f32_16x16x32_bf16 v[24:27], a[52:55], v[44:47], v[24:27]
    buffer_load_dwordx4 v0, s[4:7], s60 offen sc1 lds
    s_add_u32 s60, s60, 1024
    v_mfma_f32_16x16x32_bf16 v[28:31], a[180:183], v[44:47], v[28:31]
    s_waitcnt lgkmcnt(2)
    v_mfma_f32_16x16x32_bf16 v[16:19], a[56:59], v[48:51], v[16:19]
    ds_read_b128 v[40:43], v8 offset:16384
    ds_read_b128 v[44:47], v8 offset:49152
    v_mfma_f32_16x16x32_bf16 v[20:23], a[184:187], v[48:51], v[20:23]
    s_mov_b32 m0, s61
    s_add_u32 s61, s61, 1024
    v_mfma_f32_16x16x32_bf16 v[24:27], a[56:59], v[52:55], v[24:27]
    buffer_load_dwordx4 v0, s[4:7], s60 offen sc1 lds
    s_add_u32 s60, s60, 1024
    v_mfma_f32_16x16x32_bf16 v[28:31], a[184:187], v[52:55], v[28:31]
    s_waitcnt lgkmcnt(2)
    v_mfma_f32_16x16x32_bf16 v[16:19], a[60:63], v[32:35], v[16:19]
    ds_read_b128 v[48:51], v8 offset:17408
    ds_read_b128 v[52:55], v8 offset:50176
    v_mfma_f32_16x16x32_bf16 v[20:23], a[188:191], v[32:35], v[20:23]
    s_mov_b32 m0, s61
    s_add_u32 s61, s61, 1024
    v_mfma_f32_16x16x32_bf16 v[24:27], a[60:63], v[36:39], v[24:27]
    buffer_load_dwordx4 v0, s[4:7], s60 offen sc1 lds
    s_add_u32 s60, s60, 1024
    v_mfma_f32_16x16x32_bf16 v[28:31], a[188:191], v[36:39], v[28:31]
    s_waitcnt lgkmcnt(2)
    v_mfma_f32_16x16x32_bf16 v[16:19], a[64:67], v[40:43], v[16:19]
    ds_read_b128 v[32:35], v8 offset:18432
    ds_read_b128 v[36:39], v8 offset:51200
    v_mfma_f32_16x16x32_bf16 v[20:23], a[192:195], v[40:43], v[20:23]
    s_mov_b32 m0, s61
    s_add_u32 s61, s61, 1024
    v_mfma_f32_16x16x32_bf16 v[24:27], a[64:67], v[44:47], v[24:27]
    buffer_load_dwordx4 v0, s[4:7], s60 offen sc1 lds
    s_add_u32 s60, s60, 1024
    v_mfma_f32_16x16x32_bf16 v[28:31], a[192:195], v[44:47], v[28:31]
    s_waitcnt lgkmcnt(2)
    v_mfma_f32_16x16x32_bf16 v[16:19], a[68:71], v[48:51], v[16:19]
    ds_read_b128 v[40:43], v8 offset:19456
    ds_read_b128 v[44:47], v8 offset:52224
    v_mfma_f32_16x16x32_bf16 v[20:23], a[196:199], v[48:51], v[20:23]
    s_mov_b32 m0, s61
    s_add_u32 s61, s61, 1024
    v_mfma_f32_16x16x32_bf16 v[24:27], a[68:71], v[52:55], v[24:27]
    buffer_load_dwordx4 v0, s[4:7], s60 offen sc1 lds
    s_add_u32 s60, s60, 1024
    v_mfma_f32_16x16x32_bf16 v[28:31], a[196:199], v[52:55], v[28:31]
    s_waitcnt lgkmcnt(2)
    v_mfma_f32_16x16x32_bf16 v[16:19], a[72:75], v[32:35], v[16:19]
    ds_read_b128 v[48:51], v8 offset:20480
    ds_read_b128 v[52:55], v8 offset:53248
    v_mfma_f32_16x16x32_bf16 v[20:23], a[200:203], v[32:35], v[20:23]
    s_mov_b32 m0, s61
    s_add_u32 s61, s61, 1024
    v_mfma_f32_16x16x32_bf16 v[24:27], a[72:75], v[36:39], v[24:27]
    buffer_load_dwordx4 v0, s[4:7], s60 offen sc1 lds
    s_add_u32 s60, s60, 1024
    v_mfma_f32_16x16x32_bf16 v[28:31], a[200:203], v[36:39], v[28:31]
    s_waitcnt lgkmcnt(2)
    v_mfma_f32_16x16x32_bf16 v[16:19], a[76:79], v[40:43], v[16:19]
    ds_read_b128 v[32:35], v8 offset:21504
    ds_read_b128 v[36:39], v8 offset:54272
    v_mfma_f32_16x16x32_bf16 v[20:23], a[204:207], v[40:43], v[20:23]
    s_mov_b32 m0, s61
    s_add_u32 s61, s61, 1024
    v_mfma_f32_16x16x32_bf16 v[24:27], a[76:79], v[44:47], v[24:27]
    buffer_load_dwordx4 v0, s[4:7], s60 offen sc1 lds
    s_add_u32 s60, s60, 1024
    v_mfma_f32_16x16x32_bf16 v[28:31], a[204:207], v[44:47], v[28:31]
    s_waitcnt lgkmcnt(2)
    v_mfma_f32_16x16x32_bf16 v[16:19], a[80:83], v[48:51], v[16:19]
    ds_read_b128 v[40:43], v8 offset:22528
    v_mfma_f32_16x16x32_bf16 v[20:23], a[208:211], v[48:51], v[20:23]
    ds_read_b128 v[44:47], v8 offset:55296
    v_mfma_f32_16x16x32_bf16 v[24:27], a[80:83], v[52:55], v[24:27]
    v_mfma_f32_16x16x32_bf16 v[28:31], a[208:211], v[52:55], v[28:31]
    s_waitcnt lgkmcnt(2)
    v_mfma_f32_16x16x32_bf16 v[16:19], a[84:87], v[32:35], v[16:19]
    ds_read_b128 v[48:51], v8 offset:23552
    v_mfma_f32_16x16x32_bf16 v[20:23], a[212:215], v[32:35], v[20:23]
    ds_read_b128 v[52:55], v8 offset:56320
    v_mfma_f32_16x16x32_bf16 v[24:27], a[84:87], v[36:39], v[24:27]
    v_mfma_f32_16x16x32_bf16 v[28:31], a[212:215], v[36:39], v[28:31]
    s_waitcnt lgkmcnt(2)
    v_mfma_f32_16x16x32_bf16 v[16:19], a[88:91], v[40:43], v[16:19]
    ds_read_b128 v[32:35], v8 offset:24576
    v_mfma_f32_16x16x32_bf16 v[20:23], a[216:219], v[40:43], v[20:23]
    ds_read_b128 v[36:39], v8 offset:57344
    v_mfma_f32_16x16x32_bf16 v[24:27], a[88:91], v[44:47], v[24:27]
    v_mfma_f32_16x16x32_bf16 v[28:31], a[216:219], v[44:47], v[28:31]
    s_waitcnt lgkmcnt(2)
    v_mfma_f32_16x16x32_bf16 v[16:19], a[92:95], v[48:51], v[16:19]
    ds_read_b128 v[40:43], v8 offset:25600
    ds_read_b128 v[44:47], v8 offset:58368
    v_mfma_f32_16x16x32_bf16 v[20:23], a[220:223], v[48:51], v[20:23]
    s_mov_b32 m0, s51
    s_nop 0
    v_mfma_f32_16x16x32_bf16 v[24:27], a[92:95], v[52:55], v[24:27]
    buffer_load_dword v2, s[4:7], s63 offen sc1 lds
    v_mfma_f32_16x16x32_bf16 v[28:31], a[220:223], v[52:55], v[28:31]
    s_waitcnt lgkmcnt(2)
    v_mfma_f32_16x16x32_bf16 v[16:19], a[96:99], v[32:35], v[16:19]
    ds_read_b128 v[48:51], v8 offset:26624
    v_mfma_f32_16x16x32_bf16 v[20:23], a[224:227], v[32:35], v[20:23]
    ds_read_b128 v[52:55], v8 offset:59392
    v_mfma_f32_16x16x32_bf16 v[24:27], a[96:99], v[36:39], v[24:27]
    v_mfma_f32_16x16x32_bf16 v[28:31], a[224:227], v[36:39], v[28:31]
    s_waitcnt vmcnt(17)
    s_barrier
    v_mov_b32 v5, s53
    v_mov_b32 v6, 0
    s_mov_b64 exec, 1
    s_cmp_lg_u32 s30, 0
    s_cbranch_scc1 L_pub_19_d
    s_lshl_b32 s36, s52, 7
    s_add_u32 s36, s36, s62
    buffer_store_dword v5, v6, s[4:7], s36 offen sc1
    s_branch L_pub_19_e
L_pub_19_d:
    buffer_store_dword v5, v6, s[4:7], s97 offen
L_pub_19_e:
    s_mov_b64 exec, -1
    s_waitcnt lgkmcnt(2)
    v_mfma_f32_16x16x32_bf16 v[16:19], a[100:103], v[40:43], v[16:19]
    ds_read_b128 v[32:35], v8 offset:27648
    v_mfma_f32_16x16x32_bf16 v[20:23], a[228:231], v[40:43], v[20:23]
    ds_read_b128 v[36:39], v8 offset:60416
    v_mfma_f32_16x16x32_bf16 v[24:27], a[100:103], v[44:47], v[24:27]
    v_mfma_f32_16x16x32_bf16 v[28:31], a[228:231], v[44:47], v[28:31]
    s_waitcnt lgkmcnt(2)
    v_mfma_f32_16x16x32_bf16 v[16:19], a[104:107], v[48:51], v[16:19]
    ds_read_b128 v[40:43], v8 offset:28672
    v_mfma_f32_16x16x32_bf16 v[20:23], a[232:235], v[48:51], v[20:23]
    ds_read_b128 v[44:47], v8 offset:61440
    v_mfma_f32_16x16x32_bf16 v[24:27], a[104:107], v[52:55], v[24:27]
    v_mfma_f32_16x16x32_bf16 v[28:31], a[232:235], v[52:55], v[28:31]
    s_waitcnt lgkmcnt(2)
    v_mfma_f32_16x16x32_bf16 v[16:19], a[108:111], v[32:35], v[16:19]
    ds_read_b128 v[48:51], v8 offset:29696
    v_mfma_f32_16x16x32_bf16 v[20:23], a[236:239], v[32:35], v[20:23]
    ds_read_b128 v[52:55], v8 offset:62464
    v_mfma_f32_16x16x32_bf16 v[24:27], a[108:111], v[36:39], v[24:27]
    v_mfma_f32_16x16x32_bf16 v[28:31], a[236:239], v[36:39], v[28:31]
    s_waitcnt lgkmcnt(2)
    v_mfma_f32_16x16x32_bf16 v[16:19], a[112:115], v[40:43], v[16:19]
    ds_read_b128 v[32:35], v8 offset:30720
    v_mfma_f32_16x16x32_bf16 v[20:23], a[240:243], v[40:43], v[20:23]
    ds_read_b128 v[36:39], v8 offset:63488
    v_mfma_f32_16x16x32_bf16 v[24:27], a[112:115], v[44:47], v[24:27]
    v_mfma_f32_16x16x32_bf16 v[28:31], a[240:243], v[44:47], v[28:31]
    s_waitcnt lgkmcnt(2)
    v_mfma_f32_16x16x32_bf16 v[16:19], a[116:119], v[48:51], v[16:19]
    ds_read_b128 v[40:43], v8 offset:31744
    v_mfma_f32_16x16x32_bf16 v[20:23], a[244:247], v[48:51], v[20:23]
    ds_read_b128 v[44:47], v8 offset:64512
    v_mfma_f32_16x16x32_bf16 v[24:27], a[116:119], v[52:55], v[24:27]
    v_mfma_f32_16x16x32_bf16 v[28:31], a[244:247], v[52:55], v[28:31]
    s_waitcnt lgkmcnt(2)
    v_mfma_f32_16x16x32_bf16 v[16:19], a[120:123], v[32:35], v[16:19]
    s_lshl_b32 s90, s45, 24
    s_lshl_b32 s91, s46, 2
    s_add_u32 s91, s91, s65
    v_mfma_f32_16x16x32_bf16 v[20:23], a[248:251], v[32:35], v[20:23]
    s_lshl_b32 s91, s91, 15
    s_add_u32 s90, s90, s91
    s_lshl_b32 s91, s66, 2
    v_mfma_f32_16x16x32_bf16 v[24:27], a[120:123], v[36:39], v[24:27]
    s_add_u32 s91, s91, s30
    s_lshl_b32 s91, s91, 10
    s_add_u32 s90, s90, s91
    v_mfma_f32_16x16x32_bf16 v[28:31], a[248:251], v[36:39], v[28:31]
    s_add_u32 s90, s90, 0xc800000
    s_add_u32 s91, s90, 16384
    s_waitcnt lgkmcnt(0)
    v_mfma_f32_16x16x32_bf16 v[16:19], a[124:127], v[40:43], v[16:19]
    v_mfma_f32_16x16x32_bf16 v[20:23], a[252:255], v[40:43], v[20:23]
    v_mfma_f32_16x16x32_bf16 v[24:27], a[124:127], v[44:47], v[24:27]
    v_mfma_f32_16x16x32_bf16 v[28:31], a[252:255], v[44:47], v[28:31]
    s_waitcnt vmcnt(1)
    s_barrier
    s_xor_b32 s50, s50, 65536
    v_add_u32 v8, s50, v0
    ds_read_b128 v[32:35], v8 offset:0
    ds_read_b128 v[36:39], v8 offset:32768
    ds_read_b128 v[40:43], v8 offset:1024
    ds_read_b128 v[44:47], v8 offset:33792
    v_lshlrev_b32 v5, 2, v1
    v_add_u32 v5, s51, v5
    ds_read_b32 v4, v5
    s_xor_b32 s51, s51, 256
    v_cvt_pk_bf16_f32 v56, v16, v17
    v_cvt_pk_bf16_f32 v57, v18, v19
    v_cvt_pk_bf16_f32 v58, v20, v21
    v_cvt_pk_bf16_f32 v59, v22, v23
    buffer_store_dwordx4 v[56:59], v0, s[4:7], s90 offen sc1
    v_cvt_pk_bf16_f32 v60, v24, v25
    v_cvt_pk_bf16_f32 v61, v26, v27
    v_cvt_pk_bf16_f32 v62, v28, v29
    v_cvt_pk_bf16_f32 v63, v30, v31
    buffer_store_dwordx4 v[60:63], v0, s[4:7], s91 offen sc1
    s_mov_b32 s43, s52
    s_mov_b32 s44, s53
    s_cmp_eq_u32 s45, 0
    s_cselect_b32 s36, s58, s59
    s_add_u32 s53, s36, 1
    s_mov_b32 s52, s45
    s_cmp_eq_u32 s45, 0
    s_cselect_b32 s58, s53, s58
    s_cselect_b32 s59, s59, s53
    s_mov_b32 s45, s47
    s_mov_b32 s46, s48
    s_branch L_o_main
L_o_nopf:
    s_waitcnt lgkmcnt(2)
    v_mfma_f32_16x16x32_bf16 v[16:19], a[16:19], v[40:43], v[16:19]
    ds_read_b128 v[32:35], v8 offset:6144
    v_mfma_f32_16x16x32_bf16 v[20:23], a[144:147], v[40:43], v[20:23]
    ds_read_b128 v[36:39], v8 offset:38912
    v_mfma_f32_16x16x32_bf16 v[24:27], a[16:19], v[44:47], v[24:27]
    v_mfma_f32_16x16x32_bf16 v[28:31], a[144:147], v[44:47], v[28:31]
    s_waitcnt lgkmcnt(2)
    v_mfma_f32_16x16x32_bf16 v[16:19], a[20:23], v[48:51], v[16:19]
    ds_read_b128 v[40:43], v8 offset:7168
    v_mfma_f32_16x16x32_bf16 v[20:23], a[148:151], v[48:51], v[20:23]
    ds_read_b128 v[44:47], v8 offset:39936
    v_mfma_f32_16x16x32_bf16 v[24:27], a[20:23], v[52:55], v[24:27]
    v_mfma_f32_16x16x32_bf16 v[28:31], a[148:151], v[52:55], v[28:31]
    s_waitcnt lgkmcnt(2)
    v_mfma_f32_16x16x32_bf16 v[16:19], a[24:27], v[32:35], v[16:19]
    ds_read_b128 v[48:51], v8 offset:8192
    v_mfma_f32_16x16x32_bf16 v[20:23], a[152:155], v[32:35], v[20:23]
    ds_read_b128 v[52:55], v8 offset:40960
    v_mfma_f32_16x16x32_bf16 v[24:27], a[24:27], v[36:39], v[24:27]
    v_mfma_f32_16x16x32_bf16 v[28:31], a[152:155], v[36:39], v[28:31]
    s_waitcnt lgkmcnt(2)
    v_mfma_f32_16x16x32_bf16 v[16:19], a[28:31], v[40:43], v[16:19]
    ds_read_b128 v[32:35], v8 offset:9216
    v_mfma_f32_16x16x32_bf16 v[20:23], a[156:159], v[40:43], v[20:23]
    ds_read_b128 v[36:39], v8 offset:41984
    v_mfma_f32_16x16x32_bf16 v[24:27], a[28:31], v[44:47], v[24:27]
    v_mfma_f32_16x16x32_bf16 v[28:31], a[156:159], v[44:47], v[28:31]
    s_waitcnt lgkmcnt(2)
    v_mfma_f32_16x16x32_bf16 v[16:19], a[32:35], v[48:51], v[16:19]
    ds_read_b128 v[40:43], v8 offset:10240
    v_mfma_f32_16x16x32_bf16 v[20:23], a[160:163], v[48:51], v[20:23]
    ds_read_b128 v[44:47], v8 offset:43008
    v_mfma_f32_16x16x32_bf16 v[24:27], a[32:35], v[52:55], v[24:27]
    v_mfma_f32_16x16x32_bf16 v[28:31], a[160:163], v[52:55], v[28:31]
    s_waitcnt lgkmcnt(2)
    v_mfma_f32_16x16x32_bf16 v[16:19], a[36:39], v[32:35], v[16:19]
    ds_read_b128 v[48:51], v8 offset:11264
    v_mfma_f32_16x16x32_bf16 v[20:23], a[164:167], v[32:35], v[20:23]
    ds_read_b128 v[52:55], v8 offset:44032
    v_mfma_f32_16x16x32_bf16 v[24:27], a[36:39], v[36:39], v[24:27]
    v_mfma_f32_16x16x32_bf16 v[28:31], a[164:167], v[36:39], v[28:31]
    s_waitcnt lgkmcnt(2)
    v_mfma_f32_16x16x32_bf16 v[16:19], a[40:43], v[40:43], v[16:19]
    ds_read_b128 v[32:35], v8 offset:12288
    v_mfma_f32_16x16x32_bf16 v[20:23], a[168:171], v[40:43], v[20:23]
    ds_read_b128 v[36:39], v8 offset:45056
    v_mfma_f32_16x16x32_bf16 v[24:27], a[40:43], v[44:47], v[24:27]
    v_mfma_f32_16x16x32_bf16 v[28:31], a[168:171], v[44:47], v[28:31]
    s_waitcnt lgkmcnt(2)
    v_mfma_f32_16x16x32_bf16 v[16:19], a[44:47], v[48:51], v[16:19]
    ds_read_b128 v[40:43], v8 offset:13312
    v_mfma_f32_16x16x32_bf16 v[20:23], a[172:175], v[48:51], v[20:23]
    ds_read_b128 v[44:47], v8 offset:46080
    v_mfma_f32_16x16x32_bf16 v[24:27], a[44:47], v[52:55], v[24:27]
    v_mfma_f32_16x16x32_bf16 v[28:31], a[172:175], v[52:55], v[28:31]
    s_waitcnt lgkmcnt(2)
    v_mfma_f32_16x16x32_bf16 v[16:19], a[48:51], v[32:35], v[16:19]
    ds_read_b128 v[48:51], v8 offset:14336
    v_mfma_f32_16x16x32_bf16 v[20:23], a[176:179], v[32:35], v[20:23]
    ds_read_b128 v[52:55], v8 offset:47104
    v_mfma_f32_16x16x32_bf16 v[24:27], a[48:51], v[36:39], v[24:27]
    v_mfma_f32_16x16x32_bf16 v[28:31], a[176:179], v[36:39], v[28:31]
    s_waitcnt lgkmcnt(2)
    v_mfma_f32_16x16x32_bf16 v[16:19], a[52:55], v[40:43], v[16:19]
    ds_read_b128 v[32:35], v8 offset:15360
    v_mfma_f32_16x16x32_bf16 v[20:23], a[180:183], v[40:43], v[20:23]
    ds_read_b128 v[36:39], v8 offset:48128
    v_mfma_f32_16x16x32_bf16 v[24:27], a[52:55], v[44:47], v[24:27]
    v_mfma_f32_16x16x32_bf16 v[28:31], a[180:183], v[44:47], v[28:31]
    s_waitcnt lgkmcnt(2)
    v_mfma_f32_16x16x32_bf16 v[16:19], a[56:59], v[48:51], v[16:19]
    ds_read_b128 v[40:43], v8 offset:16384
    v_mfma_f32_16x16x32_bf16 v[20:23], a[184:187], v[48:51], v[20:23]
    ds_read_b128 v[44:47], v8 offset:49152
    v_mfma_f32_16x16x32_bf16 v[24:27], a[56:59], v[52:55], v[24:27]
    v_mfma_f32_16x16x32_bf16 v[28:31], a[184:187], v[52:55], v[28:31]
    s_waitcnt lgkmcnt(2)
    v_mfma_f32_16x16x32_bf16 v[16:19], a[60:63], v[32:35], v[16:19]
    ds_read_b128 v[48:51], v8 offset:17408
    v_mfma_f32_16x16x32_bf16 v[20:23], a[188:191], v[32:35], v[20:23]
    ds_read_b128 v[52:55], v8 offset:50176
    v_mfma_f32_16x16x32_bf16 v[24:27], a[60:63], v[36:39], v[24:27]
    v_mfma_f32_16x16x32_bf16 v[28:31], a[188:191], v[36:39], v[28:31]
    s_waitcnt lgkmcnt(2)
    v_mfma_f32_16x16x32_bf16 v[16:19], a[64:67], v[40:43], v[16:19]
    ds_read_b128 v[32:35], v8 offset:18432
    v_mfma_f32_16x16x32_bf16 v[20:23], a[192:195], v[40:43], v[20:23]
    ds_read_b128 v[36:39], v8 offset:51200
    v_mfma_f32_16x16x32_bf16 v[24:27], a[64:67], v[44:47], v[24:27]
    v_mfma_f32_16x16x32_bf16 v[28:31], a[192:195], v[44:47], v[28:31]
    s_waitcnt lgkmcnt(2)
    v_mfma_f32_16x16x32_bf16 v[16:19], a[68:71], v[48:51], v[16:19]
    ds_read_b128 v[40:43], v8 offset:19456
    v_mfma_f32_16x16x32_bf16 v[20:23], a[196:199], v[48:51], v[20:23]
    ds_read_b128 v[44:47], v8 offset:52224
    v_mfma_f32_16x16x32_bf16 v[24:27], a[68:71], v[52:55], v[24:27]
    v_mfma_f32_16x16x32_bf16 v[28:31], a[196:199], v[52:55], v[28:31]
    s_waitcnt lgkmcnt(2)
    v_mfma_f32_16x16x32_bf16 v[16:19], a[72:75], v[32:35], v[16:19]
    ds_read_b128 v[48:51], v8 offset:20480
    v_mfma_f32_16x16x32_bf16 v[20:23], a[200:203], v[32:35], v[20:23]
    ds_read_b128 v[52:55], v8 offset:53248
    v_mfma_f32_16x16x32_bf16 v[24:27], a[72:75], v[36:39], v[24:27]
    v_mfma_f32_16x16x32_bf16 v[28:31], a[200:203], v[36:39], v[28:31]
    s_waitcnt lgkmcnt(2)
    v_mfma_f32_16x16x32_bf16 v[16:19], a[76:79], v[40:43], v[16:19]
    ds_read_b128 v[32:35], v8 offset:21504
    v_mfma_f32_16x16x32_bf16 v[20:23], a[204:207], v[40:43], v[20:23]
    ds_read_b128 v[36:39], v8 offset:54272
    v_mfma_f32_16x16x32_bf16 v[24:27], a[76:79], v[44:47], v[24:27]
    v_mfma_f32_16x16x32_bf16 v[28:31], a[204:207], v[44:47], v[28:31]
    s_waitcnt lgkmcnt(2)
    v_mfma_f32_16x16x32_bf16 v[16:19], a[80:83], v[48:51], v[16:19]
    ds_read_b128 v[40:43], v8 offset:22528
    v_mfma_f32_16x16x32_bf16 v[20:23], a[208:211], v[48:51], v[20:23]
    ds_read_b128 v[44:47], v8 offset:55296
    v_mfma_f32_16x16x32_bf16 v[24:27], a[80:83], v[52:55], v[24:27]
    v_mfma_f32_16x16x32_bf16 v[28:31], a[208:211], v[52:55], v[28:31]
    s_waitcnt lgkmcnt(2)
    v_mfma_f32_16x16x32_bf16 v[16:19], a[84:87], v[32:35], v[16:19]
    ds_read_b128 v[48:51], v8 offset:23552
    v_mfma_f32_16x16x32_bf16 v[20:23], a[212:215], v[32:35], v[20:23]
    ds_read_b128 v[52:55], v8 offset:56320
    v_mfma_f32_16x16x32_bf16 v[24:27], a[84:87], v[36:39], v[24:27]
    v_mfma_f32_16x16x32_bf16 v[28:31], a[212:215], v[36:39], v[28:31]
    s_waitcnt lgkmcnt(2)
    v_mfma_f32_16x16x32_bf16 v[16:19], a[88:91], v[40:43], v[16:19]
    ds_read_b128 v[32:35], v8 offset:24576
    v_mfma_f32_16x16x32_bf16 v[20:23], a[216:219], v[40:43], v[20:23]
    ds_read_b128 v[36:39], v8 offset:57344
    v_mfma_f32_16x16x32_bf16 v[24:27], a[88:91], v[44:47], v[24:27]
    v_mfma_f32_16x16x32_bf16 v[28:31], a[216:219], v[44:47], v[28:31]
    s_waitcnt lgkmcnt(2)
    v_mfma_f32_16x16x32_bf16 v[16:19], a[92:95], v[48:51], v[16:19]
    ds_read_b128 v[40:43], v8 offset:25600
    ds_read_b128 v[44:47], v8 offset:58368
    v_mfma_f32_16x16x32_bf16 v[20:23], a[220:223], v[48:51], v[20:23]
    s_mov_b32 m0, s51
    s_nop 0
    v_mfma_f32_16x16x32_bf16 v[24:27], a[92:95], v[52:55], v[24:27]
    buffer_load_dword v2, s[4:7], s63 offen sc1 lds
    v_mfma_f32_16x16x32_bf16 v[28:31], a[220:223], v[52:55], v[28:31]
    s_waitcnt lgkmcnt(2)
    v_mfma_f32_16x16x32_bf16 v[16:19], a[96:99], v[32:35], v[16:19]
    ds_read_b128 v[48:51], v8 offset:26624
    v_mfma_f32_16x16x32_bf16 v[20:23], a[224:227], v[32:35], v[20:23]
    ds_read_b128 v[52:55], v8 offset:59392
    v_mfma_f32_16x16x32_bf16 v[24:27], a[96:99], v[36:39], v[24:27]
    v_mfma_f32_16x16x32_bf16 v[28:31], a[224:227], v[36:39], v[28:31]
    s_waitcnt vmcnt(1)
    s_barrier
    v_mov_b32 v5, s53
    v_mov_b32 v6, 0
    s_mov_b64 exec, 1
    s_cmp_lg_u32 s30, 0
    s_cbranch_scc1 L_pub_20_d
    s_lshl_b32 s36, s52, 7
    s_add_u32 s36, s36, s62
    buffer_store_dword v5, v6, s[4:7], s36 offen sc1
    s_branch L_pub_20_e
L_pub_20_d:
    buffer_store_dword v5, v6, s[4:7], s97 offen
L_pub_20_e:
    s_mov_b64 exec, -1
    s_waitcnt lgkmcnt(2)
    v_mfma_f32_16x16x32_bf16 v[16:19], a[100:103], v[40:43], v[16:19]
    ds_read_b128 v[32:35], v8 offset:27648
    v_mfma_f32_16x16x32_bf16 v[20:23], a[228:231], v[40:43], v[20:23]
    ds_read_b128 v[36:39], v8 offset:60416
    v_mfma_f32_16x16x32_bf16 v[24:27], a[100:103], v[44:47], v[24:27]
    v_mfma_f32_16x16x32_bf16 v[28:31], a[228:231], v[44:47], v[28:31]
    s_waitcnt lgkmcnt(2)
    v_mfma_f32_16x16x32_bf16 v[16:19], a[104:107], v[48:51], v[16:19]
    ds_read_b128 v[40:43], v8 offset:28672
    v_mfma_f32_16x16x32_bf16 v[20:23], a[232:235], v[48:51], v[20:23]
    ds_read_b128 v[44:47], v8 offset:61440
    v_mfma_f32_16x16x32_bf16 v[24:27], a[104:107], v[52:55], v[24:27]
    v_mfma_f32_16x16x32_bf16 v[28:31], a[232:235], v[52:55], v[28:31]
    s_waitcnt lgkmcnt(2)
    v_mfma_f32_16x16x32_bf16 v[16:19], a[108:111], v[32:35], v[16:19]
    ds_read_b128 v[48:51], v8 offset:29696
    v_mfma_f32_16x16x32_bf16 v[20:23], a[236:239], v[32:35], v[20:23]
    ds_read_b128 v[52:55], v8 offset:62464
    v_mfma_f32_16x16x32_bf16 v[24:27], a[108:111], v[36:39], v[24:27]
    v_mfma_f32_16x16x32_bf16 v[28:31], a[236:239], v[36:39], v[28:31]
    s_waitcnt lgkmcnt(2)
    v_mfma_f32_16x16x32_bf16 v[16:19], a[112:115], v[40:43], v[16:19]
    ds_read_b128 v[32:35], v8 offset:30720
    v_mfma_f32_16x16x32_bf16 v[20:23], a[240:243], v[40:43], v[20:23]
    ds_read_b128 v[36:39], v8 offset:63488
    v_mfma_f32_16x16x32_bf16 v[24:27], a[112:115], v[44:47], v[24:27]
    v_mfma_f32_16x16x32_bf16 v[28:31], a[240:243], v[44:47], v[28:31]
    s_waitcnt lgkmcnt(2)
    v_mfma_f32_16x16x32_bf16 v[16:19], a[116:119], v[48:51], v[16:19]
    ds_read_b128 v[40:43], v8 offset:31744
    v_mfma_f32_16x16x32_bf16 v[20:23], a[244:247], v[48:51], v[20:23]
    ds_read_b128 v[44:47], v8 offset:64512
    v_mfma_f32_16x16x32_bf16 v[24:27], a[116:119], v[52:55], v[24:27]
    v_mfma_f32_16x16x32_bf16 v[28:31], a[244:247], v[52:55], v[28:31]
    s_waitcnt lgkmcnt(2)
    v_mfma_f32_16x16x32_bf16 v[16:19], a[120:123], v[32:35], v[16:19]
    s_lshl_b32 s90, s45, 24
    s_lshl_b32 s91, s46, 2
    s_add_u32 s91, s91, s65
    v_mfma_f32_16x16x32_bf16 v[20:23], a[248:251], v[32:35], v[20:23]
    s_lshl_b32 s91, s91, 15
    s_add_u32 s90, s90, s91
    s_lshl_b32 s91, s66, 2
    v_mfma_f32_16x16x32_bf16 v[24:27], a[120:123], v[36:39], v[24:27]
    s_add_u32 s91, s91, s30
    s_lshl_b32 s91, s91, 10
    s_add_u32 s90, s90, s91
    v_mfma_f32_16x16x32_bf16 v[28:31], a[248:251], v[36:39], v[28:31]
    s_add_u32 s90, s90, 0xc800000
    s_add_u32 s91, s90, 16384
    s_waitcnt lgkmcnt(0)
    v_mfma_f32_16x16x32_bf16 v[16:19], a[124:127], v[40:43], v[16:19]
    v_mfma_f32_16x16x32_bf16 v[20:23], a[252:255], v[40:43], v[20:23]
    v_mfma_f32_16x16x32_bf16 v[24:27], a[124:127], v[44:47], v[24:27]
    v_mfma_f32_16x16x32_bf16 v[28:31], a[252:255], v[44:47], v[28:31]
    s_nop 7
    v_cvt_pk_bf16_f32 v56, v16, v17
    v_cvt_pk_bf16_f32 v57, v18, v19
    v_cvt_pk_bf16_f32 v58, v20, v21
    v_cvt_pk_bf16_f32 v59, v22, v23
    buffer_store_dwordx4 v[56:59], v0, s[4:7], s90 offen sc1
    v_cvt_pk_bf16_f32 v60, v24, v25
    v_cvt_pk_bf16_f32 v61, v26, v27
    v_cvt_pk_bf16_f32 v62, v28, v29
    v_cvt_pk_bf16_f32 v63, v30, v31
    buffer_store_dwordx4 v[60:63], v0, s[4:7], s91 offen sc1
    s_mov_b32 s43, s52
    s_mov_b32 s44, s53
    s_cmp_eq_u32 s45, 0
    s_cselect_b32 s36, s58, s59
    s_add_u32 s53, s36, 1
    s_mov_b32 s52, s45
    s_cmp_eq_u32 s45, 0
    s_cselect_b32 s58, s53, s58
    s_cselect_b32 s59, s59, s53
    s_waitcnt vmcnt(3)
    s_barrier
    v_lshlrev_b32 v5, 2, v1
    v_add_u32 v5, s51, v5
    ds_read_b32 v4, v5
    s_xor_b32 s51, s51, 256
    s_waitcnt lgkmcnt(0)
    s_cmp_ge_u32 s41, 32
    s_cbranch_scc1 L_o_w_try1
    s_lshl_b32 s48, s41, 1
    s_add_u32 s48, s48, s64
    s_add_u32 s54, s48, 1
    s_add_u32 s36, s67, 0
    v_subrev_u32 v7, s36, v1
    v_cmp_gt_u32 vcc, 8, v7
    v_mov_b32 v6, s54
    s_nop 0
    v_cndmask_b32 v7, 0, v6, vcc
    v_cmp_lt_u32 vcc, v4, v7
    s_nop 1
    s_cmp_eq_u64 vcc, 0
    s_cbranch_scc0 L_o_w_try1
    s_mov_b32 s47, 0
    s_add_u32 s41, s41, 1
    s_cmp_eq_u32 s47, s47
    s_branch L_o_w_done
L_o_w_try1:
    s_cmp_ge_u32 s42, 32
    s_cbranch_scc1 L_o_w_try2
    s_lshl_b32 s48, s42, 1
    s_add_u32 s48, s48, s64
    s_add_u32 s54, s48, 1
    s_add_u32 s36, s67, 32
    v_subrev_u32 v7, s36, v1
    v_cmp_gt_u32 vcc, 8, v7
    v_mov_b32 v6, s54
    s_nop 0
    v_cndmask_b32 v7, 0, v6, vcc
    v_cmp_lt_u32 vcc, v4, v7
    s_nop 1
    s_cmp_eq_u64 vcc, 0
    s_cbranch_scc0 L_o_w_try2
    s_mov_b32 s47, 1
    s_add_u32 s42, s42, 1
    s_cmp_eq_u32 s47, s47
    s_branch L_o_w_done
L_o_w_try2:
    s_cmp_lg_u32 s47, s47
L_o_w_done:
    s_cbranch_scc0 L_o_cold
    s_xor_b32 s50, s50, 65536
    s_mov_b32 m0, s51
    s_nop 0
    buffer_load_dword v2, s[4:7], s63 offen sc1 lds
    s_lshl_b32 s36, s47, 24
    s_lshl_b32 s37, s48, 18
    s_add_u32 s36, s36, s37
    s_add_u32 s36, s36, 0xa800000
    s_mul_i32 s37, s65, 32768
    s_add_u32 s36, s36, s37
    s_lshr_b32 s37, s30, 1
    s_mul_i32 s38, s37, 131072
    s_add_u32 s36, s36, s38
    s_mul_i32 s38, s37, 32768
    s_and_b32 s37, s30, 1
    s_mul_i32 s37, s37, 16384
    s_add_u32 s60, s36, s37
    s_add_u32 s37, s37, s38
    s_add_u32 s61, s37, s50
    s_mov_b32 m0, s61
    s_add_u32 s61, s61, 1024
    buffer_load_dwordx4 v0, s[4:7], s60 offen sc1 lds
    s_add_u32 s60, s60, 1024
    s_mov_b32 m0, s61
    s_add_u32 s61, s61, 1024
    buffer_load_dwordx4 v0, s[4:7], s60 offen sc1 lds
    s_add_u32 s60, s60, 1024
    s_mov_b32 m0, s61
    s_add_u32 s61, s61, 1024
    buffer_load_dwordx4 v0, s[4:7], s60 offen sc1 lds
    s_add_u32 s60, s60, 1024
    s_mov_b32 m0, s61
    s_add_u32 s61, s61, 1024
    buffer_load_dwordx4 v0, s[4:7], s60 offen sc1 lds
    s_add_u32 s60, s60, 1024
    s_mov_b32 m0, s61
    s_add_u32 s61, s61, 1024
    buffer_load_dwordx4 v0, s[4:7], s60 offen sc1 lds
    s_add_u32 s60, s60, 1024
    s_mov_b32 m0, s61
    s_add_u32 s61, s61, 1024
    buffer_load_dwordx4 v0, s[4:7], s60 offen sc1 lds
    s_add_u32 s60, s60, 1024
    s_mov_b32 m0, s61
    s_add_u32 s61, s61, 1024
    buffer_load_dwordx4 v0, s[4:7], s60 offen sc1 lds
    s_add_u32 s60, s60, 1024
    s_mov_b32 m0, s61
    s_add_u32 s61, s61, 1024
    buffer_load_dwordx4 v0, s[4:7], s60 offen sc1 lds
    s_add_u32 s60, s60, 1024
    s_mov_b32 m0, s61
    s_add_u32 s61, s61, 1024
    buffer_load_dwordx4 v0, s[4:7], s60 offen sc1 lds
    s_add_u32 s60, s60, 1024
    s_mov_b32 m0, s61
    s_add_u32 s61, s61, 1024
    buffer_load_dwordx4 v0, s[4:7], s60 offen sc1 lds
    s_add_u32 s60, s60, 1024
    s_mov_b32 m0, s61
    s_add_u32 s61, s61, 1024
    buffer_load_dwordx4 v0, s[4:7], s60 offen sc1 lds
    s_add_u32 s60, s60, 1024
    s_mov_b32 m0, s61
    s_add_u32 s61, s61, 1024
    buffer_load_dwordx4 v0, s[4:7], s60 offen sc1 lds
    s_add_u32 s60, s60, 1024
    s_mov_b32 m0, s61
    s_add_u32 s61, s61, 1024
    buffer_load_dwordx4 v0, s[4:7], s60 offen sc1 lds
    s_add_u32 s60, s60, 1024
    s_mov_b32 m0, s61
    s_add_u32 s61, s61, 1024
    buffer_load_dwordx4 v0, s[4:7], s60 offen sc1 lds
    s_add_u32 s60, s60, 1024
    s_mov_b32 m0, s61
    s_add_u32 s61, s61, 1024
    buffer_load_dwordx4 v0, s[4:7], s60 offen sc1 lds
    s_add_u32 s60, s60, 1024
    s_mov_b32 m0, s61
    s_add_u32 s61, s61, 1024
    buffer_load_dwordx4 v0, s[4:7], s60 offen sc1 lds
    s_add_u32 s60, s60, 1024
    s_mov_b32 s45, s47
    s_mov_b32 s46, s48
    s_waitcnt vmcnt(17)
    s_barrier
    s_cmp_eq_u32 s43, s52
    s_cbranch_scc1 L_o_wnopub2
    v_mov_b32 v5, s44
    v_mov_b32 v6, 0
    s_mov_b64 exec, 1
    s_cmp_lg_u32 s30, 0
    s_cbranch_scc1 L_pub_21_d
    s_lshl_b32 s36, s43, 7
    s_add_u32 s36, s36, s62
    buffer_store_dword v5, v6, s[4:7], s36 offen sc1
    s_branch L_pub_21_e
L_pub_21_d:
    buffer_store_dword v5, v6, s[4:7], s97 offen
L_pub_21_e:
    s_mov_b64 exec, -1
L_o_wnopub2:
    v_mov_b32 v5, s53
    v_mov_b32 v6, 0
    s_mov_b64 exec, 1
    s_cmp_lg_u32 s30, 0
    s_cbranch_scc1 L_pub_22_d
    s_lshl_b32 s36, s52, 7
    s_add_u32 s36, s36, s62
    buffer_store_dword v5, v6, s[4:7], s36 offen sc1
    s_branch L_pub_22_e
L_pub_22_d:
    buffer_store_dword v5, v6, s[4:7], s97 offen
L_pub_22_e:
    s_mov_b64 exec, -1
    s_mov_b32 s43, s52
    s_mov_b32 s44, s53
    s_waitcnt vmcnt(1)
    s_barrier
    v_add_u32 v8, s50, v0
    ds_read_b128 v[32:35], v8 offset:0
    ds_read_b128 v[36:39], v8 offset:32768
    ds_read_b128 v[40:43], v8 offset:1024
    ds_read_b128 v[44:47], v8 offset:33792
    v_lshlrev_b32 v5, 2, v1
    v_add_u32 v5, s51, v5
    ds_read_b32 v4, v5
    s_xor_b32 s51, s51, 256
    s_branch L_o_main
L_o_exit:
    s_waitcnt vmcnt(0)
    s_branch L_end
L_role_f1:
    v_mbcnt_lo_u32_b32 v1, -1, 0
    v_mbcnt_hi_u32_b32 v1, -1, v1
    v_lshlrev_b32 v0, 4, v1
    s_mov_b32 s35, 65536
    s_lshl_b32 s36, s28, 5
    s_add_u32 s36, s36, s29
    s_lshl_b32 s36, s36, 2
    s_add_u32 s36, s36, s30
    s_lshl_b32 s36, s36, 5
    s_and_b32 s36, s36, 0x7fff
    s_add_u32 s97, s36, 0x8000
    s_load_dwordx2 s[36:37], s[0:1], 64
    s_waitcnt lgkmcnt(0)
    s_mov_b32 s8, s36
    s_and_b32 s9, s37, 0xffff
    s_mov_b32 s10, 0x1c0000
    s_mov_b32 s11, 0x20000
    s_load_dwordx2 s[36:37], s[0:1], 72
    s_waitcnt lgkmcnt(0)
    s_mov_b32 s12, s36
    s_and_b32 s13, s37, 0xffff
    s_mov_b32 s14, 0x1c0000
    s_mov_b32 s15, 0x20000
    s_lshl_b32 s64, s31, 7
    s_cmp_lg_u32 s30, 0
    s_cbranch_scc1 L_pw_ok_haf1
    s_mov_b32 s36, 0
    v_mov_b32 v120, 32
L_pw_haf1:
    buffer_load_dword v121, v120, s[24:27], 0 offen sc1
    s_waitcnt vmcnt(0)
    v_readfirstlane_b32 s37, v121
    s_nop 3
    s_cmp_ge_u32 s37, 256
    s_cbranch_scc1 L_pw_ok_haf1
    s_sleep 16
    s_add_u32 s36, s36, 1
    s_cmp_lt_u32 s36, 65536
    s_cbranch_scc1 L_pw_haf1
    s_mov_b32 s33, 1
L_pw_ok_haf1:
    s_cmp_lg_u32 s30, 0
    s_cbranch_scc1 L_pw_ok_hbf1
    s_mov_b32 s36, 0
    v_mov_b32 v120, 256
L_pw_hbf1:
    buffer_load_dword v121, v120, s[4:7], 0 offen sc1
    s_waitcnt vmcnt(0)
    v_readfirstlane_b32 s37, v121
    s_nop 3
    s_cmp_ge_u32 s37, 1
    s_cbranch_scc1 L_pw_ok_hbf1
    s_sleep 16
    s_add_u32 s36, s36, 1
    s_cmp_lt_u32 s36, 65536
    s_cbranch_scc1 L_pw_hbf1
L_pw_ok_hbf1:
    s_barrier
    v_lshrrev_b32 v10, 3, v1
    s_mov_b32 s36, 3584
    v_mul_lo_u32 v8, v10, s36
    v_and_b32 v10, 7, v1
    v_lshl_add_u32 v8, v10, 4, v8
    v_lshrrev_b32 v10, 4, v1
    v_lshlrev_b32 v10, 3, v10
    v_bfe_u32 v11, v1, 2, 2
    v_add_u32 v10, v10, v11
    v_mul_u32_u24 v9, 128, v10
    v_and_b32 v10, 3, v1
    v_lshlrev_b32 v10, 4, v10
    s_lshr_b32 s36, s30, 1
    s_lshl_b32 s36, s36, 6
    v_add_u32 v10, s36, v10
    v_add_u32 v9, v9, v10
    s_mul_i32 s37, s30, 458752
    s_add_u32 s37, s37, s64
    s_add_u32 s37, s37, 0
    s_mul_i32 s38, s30, 16384
    s_add_u32 s38, s38, 0
    s_mov_b32 m0, s38
    s_add_u32 s38, s38, 1024
    buffer_load_dwordx4 v8, s[8:11], s37 offen lds
    s_add_u32 s37, s37, 28672
    s_mov_b32 m0, s38
    s_add_u32 s38, s38, 1024
    buffer_load_dwordx4 v8, s[8:11], s37 offen lds
    s_add_u32 s37, s37, 28672
    s_mov_b32 m0, s38
    s_add_u32 s38, s38, 1024
    buffer_load_dwordx4 v8, s[8:11], s37 offen lds
    s_add_u32 s37, s37, 28672
    s_mov_b32 m0, s38
    s_add_u32 s38, s38, 1024
    buffer_load_dwordx4 v8, s[8:11], s37 offen lds
    s_add_u32 s37, s37, 28672
    s_mov_b32 m0, s38
    s_add_u32 s38, s38, 1024
    buffer_load_dwordx4 v8, s[8:11], s37 offen lds
    s_add_u32 s37, s37, 28672
    s_mov_b32 m0, s38
    s_add_u32 s38, s38, 1024
    buffer_load_dwordx4 v8, s[8:11], s37 offen lds
    s_add_u32 s37, s37, 28672
    s_mov_b32 m0, s38
    s_add_u32 s38, s38, 1024
    buffer_load_dwordx4 v8, s[8:11], s37 offen lds
    s_add_u32 s37, s37, 28672
    s_mov_b32 m0, s38
    s_add_u32 s38, s38, 1024
    buffer_load_dwordx4 v8, s[8:11], s37 offen lds
    s_add_u32 s37, s37, 28672
    s_mov_b32 m0, s38
    s_add_u32 s38, s38, 1024
    buffer_load_dwordx4 v8, s[8:11], s37 offen lds
    s_add_u32 s37, s37, 28672
    s_mov_b32 m0, s38
    s_add_u32 s38, s38, 1024
    buffer_load_dwordx4 v8, s[8:11], s37 offen lds
    s_add_u32 s37, s37, 28672
    s_mov_b32 m0, s38
    s_add_u32 s38, s38, 1024
    buffer_load_dwordx4 v8, s[8:11], s37 offen lds
    s_add_u32 s37, s37, 28672
    s_mov_b32 m0, s38
    s_add_u32 s38, s38, 1024
    buffer_load_dwordx4 v8, s[8:11], s37 offen lds
    s_add_u32 s37, s37, 28672
    s_mov_b32 m0, s38
    s_add_u32 s38, s38, 1024
    buffer_load_dwordx4 v8, s[8:11], s37 offen lds
    s_add_u32 s37, s37, 28672
    s_mov_b32 m0, s38
    s_add_u32 s38, s38, 1024
    buffer_load_dwordx4 v8, s[8:11], s37 offen lds
    s_add_u32 s37, s37, 28672
    s_mov_b32 m0, s38
    s_add_u32 s38, s38, 1024
    buffer_load_dwordx4 v8, s[8:11], s37 offen lds
    s_add_u32 s37, s37, 28672
    s_mov_b32 m0, s38
    s_add_u32 s38, s38, 1024
    buffer_load_dwordx4 v8, s[8:11], s37 offen lds
    s_add_u32 s37, s37, 28672
    s_waitcnt vmcnt(0)
    s_barrier
    v_add_u32 v11, 0, v9
    ds_read_b64_tr_b16 a[0:1], v11 offset:0
    ds_read_b64_tr_b16 a[2:3], v11 offset:512
    ds_read_b64_tr_b16 a[64:65], v11 offset:8
    ds_read_b64_tr_b16 a[66:67], v11 offset:520
    ds_read_b64_tr_b16 a[4:5], v11 offset:4096
    ds_read_b64_tr_b16 a[6:7], v11 offset:4608
    ds_read_b64_tr_b16 a[68:69], v11 offset:4104
    ds_read_b64_tr_b16 a[70:71], v11 offset:4616
    ds_read_b64_tr_b16 a[8:9], v11 offset:8192
    ds_read_b64_tr_b16 a[10:11], v11 offset:8704
    ds_read_b64_tr_b16 a[72:73], v11 offset:8200
    ds_read_b64_tr_b16 a[74:75], v11 offset:8712
    ds_read_b64_tr_b16 a[12:13], v11 offset:12288
    ds_read_b64_tr_b16 a[14:15], v11 offset:12800
    s_waitcnt lgkmcnt(0)
    ds_read_b64_tr_b16 a[76:77], v11 offset:12296
    ds_read_b64_tr_b16 a[78:79], v11 offset:12808
    ds_read_b64_tr_b16 a[16:17], v11 offset:16384
    ds_read_b64_tr_b16 a[18:19], v11 offset:16896
    ds_read_b64_tr_b16 a[80:81], v11 offset:16392
    ds_read_b64_tr_b16 a[82:83], v11 offset:16904
    ds_read_b64_tr_b16 a[20:21], v11 offset:20480
    ds_read_b64_tr_b16 a[22:23], v11 offset:20992
    ds_read_b64_tr_b16 a[84:85], v11 offset:20488
    ds_read_b64_tr_b16 a[86:87], v11 offset:21000
    ds_read_b64_tr_b16 a[24:25], v11 offset:24576
    ds_read_b64_tr_b16 a[26:27], v11 offset:25088
    ds_read_b64_tr_b16 a[88:89], v11 offset:24584
    ds_read_b64_tr_b16 a[90:91], v11 offset:25096
    s_waitcnt lgkmcnt(0)
    ds_read_b64_tr_b16 a[28:29], v11 offset:28672
    ds_read_b64_tr_b16 a[30:31], v11 offset:29184
    ds_read_b64_tr_b16 a[92:93], v11 offset:28680
    ds_read_b64_tr_b16 a[94:95], v11 offset:29192
    ds_read_b64_tr_b16 a[32:33], v11 offset:32768
    ds_read_b64_tr_b16 a[34:35], v11 offset:33280
    ds_read_b64_tr_b16 a[96:97], v11 offset:32776
    ds_read_b64_tr_b16 a[98:99], v11 offset:33288
    ds_read_b64_tr_b16 a[36:37], v11 offset:36864
    ds_read_b64_tr_b16 a[38:39], v11 offset:37376
    ds_read_b64_tr_b16 a[100:101], v11 offset:36872
    ds_read_b64_tr_b16 a[102:103], v11 offset:37384
    ds_read_b64_tr_b16 a[40:41], v11 offset:40960
    ds_read_b64_tr_b16 a[42:43], v11 offset:41472
    s_waitcnt lgkmcnt(0)
    ds_read_b64_tr_b16 a[104:105], v11 offset:40968
    ds_read_b64_tr_b16 a[106:107], v11 offset:41480
    ds_read_b64_tr_b16 a[44:45], v11 offset:45056
    ds_read_b64_tr_b16 a[46:47], v11 offset:45568
    ds_read_b64_tr_b16 a[108:109], v11 offset:45064
    ds_read_b64_tr_b16 a[110:111], v11 offset:45576
    ds_read_b64_tr_b16 a[48:49], v11 offset:49152
    ds_read_b64_tr_b16 a[50:51], v11 offset:49664
    ds_read_b64_tr_b16 a[112:113], v11 offset:49160
    ds_read_b64_tr_b16 a[114:115], v11 offset:49672
    ds_read_b64_tr_b16 a[52:53], v11 offset:53248
    ds_read_b64_tr_b16 a[54:55], v11 offset:53760
    ds_read_b64_tr_b16 a[116:117], v11 offset:53256
    ds_read_b64_tr_b16 a[118:119], v11 offset:53768
    s_waitcnt lgkmcnt(0)
    ds_read_b64_tr_b16 a[56:57], v11 offset:57344
    ds_read_b64_tr_b16 a[58:59], v11 offset:57856
    ds_read_b64_tr_b16 a[120:121], v11 offset:57352
    ds_read_b64_tr_b16 a[122:123], v11 offset:57864
    ds_read_b64_tr_b16 a[60:61], v11 offset:61440
    ds_read_b64_tr_b16 a[62:63], v11 offset:61952
    ds_read_b64_tr_b16 a[124:125], v11 offset:61448
    ds_read_b64_tr_b16 a[126:127], v11 offset:61960
    s_waitcnt lgkmcnt(0)
    s_barrier
    v_lshrrev_b32 v10, 3, v1
    s_mov_b32 s36, 3584
    v_mul_lo_u32 v8, v10, s36
    v_and_b32 v10, 7, v1
    v_lshl_add_u32 v8, v10, 4, v8
    v_lshrrev_b32 v10, 4, v1
    v_lshlrev_b32 v10, 3, v10
    v_bfe_u32 v11, v1, 2, 2
    v_add_u32 v10, v10, v11
    v_mul_u32_u24 v9, 128, v10
    v_and_b32 v10, 3, v1
    v_lshlrev_b32 v10, 4, v10
    s_lshr_b32 s36, s30, 1
    s_lshl_b32 s36, s36, 6
    v_add_u32 v10, s36, v10
    v_add_u32 v9, v9, v10
    s_mul_i32 s37, s30, 458752
    s_add_u32 s37, s37, s64
    s_add_u32 s37, s37, 0
    s_mul_i32 s38, s30, 16384
    s_add_u32 s38, s38, 0
    s_mov_b32 m0, s38
    s_add_u32 s38, s38, 1024
    buffer_load_dwordx4 v8, s[12:15], s37 offen lds
    s_add_u32 s37, s37, 28672
    s_mov_b32 m0, s38
    s_add_u32 s38, s38, 1024
    buffer_load_dwordx4 v8, s[12:15], s37 offen lds
    s_add_u32 s37, s37, 28672
    s_mov_b32 m0, s38
    s_add_u32 s38, s38, 1024
    buffer_load_dwordx4 v8, s[12:15], s37 offen lds
    s_add_u32 s37, s37, 28672
    s_mov_b32 m0, s38
    s_add_u32 s38, s38, 1024
    buffer_load_dwordx4 v8, s[12:15], s37 offen lds
    s_add_u32 s37, s37, 28672
    s_mov_b32 m0, s38
    s_add_u32 s38, s38, 1024
    buffer_load_dwordx4 v8, s[12:15], s37 offen lds
    s_add_u32 s37, s37, 28672
    s_mov_b32 m0, s38
    s_add_u32 s38, s38, 1024
    buffer_load_dwordx4 v8, s[12:15], s37 offen lds
    s_add_u32 s37, s37, 28672
    s_mov_b32 m0, s38
    s_add_u32 s38, s38, 1024
    buffer_load_dwordx4 v8, s[12:15], s37 offen lds
    s_add_u32 s37, s37, 28672
    s_mov_b32 m0, s38
    s_add_u32 s38, s38, 1024
    buffer_load_dwordx4 v8, s[12:15], s37 offen lds
    s_add_u32 s37, s37, 28672
    s_mov_b32 m0, s38
    s_add_u32 s38, s38, 1024
    buffer_load_dwordx4 v8, s[12:15], s37 offen lds
    s_add_u32 s37, s37, 28672
    s_mov_b32 m0, s38
    s_add_u32 s38, s38, 1024
    buffer_load_dwordx4 v8, s[12:15], s37 offen lds
    s_add_u32 s37, s37, 28672
    s_mov_b32 m0, s38
    s_add_u32 s38, s38, 1024
    buffer_load_dwordx4 v8, s[12:15], s37 offen lds
    s_add_u32 s37, s37, 28672
    s_mov_b32 m0, s38
    s_add_u32 s38, s38, 1024
    buffer_load_dwordx4 v8, s[12:15], s37 offen lds
    s_add_u32 s37, s37, 28672
    s_mov_b32 m0, s38
    s_add_u32 s38, s38, 1024
    buffer_load_dwordx4 v8, s[12:15], s37 offen lds
    s_add_u32 s37, s37, 28672
    s_mov_b32 m0, s38
    s_add_u32 s38, s38, 1024
    buffer_load_dwordx4 v8, s[12:15], s37 offen lds
    s_add_u32 s37, s37, 28672
    s_mov_b32 m0, s38
    s_add_u32 s38, s38, 1024
    buffer_load_dwordx4 v8, s[12:15], s37 offen lds
    s_add_u32 s37, s37, 28672
    s_mov_b32 m0, s38
    s_add_u32 s38, s38, 1024
    buffer_load_dwordx4 v8, s[12:15], s37 offen lds
    s_add_u32 s37, s37, 28672
    s_waitcnt vmcnt(0)
    s_barrier
    v_add_u32 v11, 0, v9
    ds_read_b64_tr_b16 a[128:129], v11 offset:0
    ds_read_b64_tr_b16 a[130:131], v11 offset:512
    ds_read_b64_tr_b16 a[192:193], v11 offset:8
    ds_read_b64_tr_b16 a[194:195], v11 offset:520
    ds_read_b64_tr_b16 a[132:133], v11 offset:4096
    ds_read_b64_tr_b16 a[134:135], v11 offset:4608
    ds_read_b64_tr_b16 a[196:197], v11 offset:4104
    ds_read_b64_tr_b16 a[198:199], v11 offset:4616
    ds_read_b64_tr_b16 a[136:137], v11 offset:8192
    ds_read_b64_tr_b16 a[138:139], v11 offset:8704
    ds_read_b64_tr_b16 a[200:201], v11 offset:8200
    ds_read_b64_tr_b16 a[202:203], v11 offset:8712
    ds_read_b64_tr_b16 a[140:141], v11 offset:12288
    ds_read_b64_tr_b16 a[142:143], v11 offset:12800
    s_waitcnt lgkmcnt(0)
    ds_read_b64_tr_b16 a[204:205], v11 offset:12296
    ds_read_b64_tr_b16 a[206:207], v11 offset:12808
    ds_read_b64_tr_b16 a[144:145], v11 offset:16384
    ds_read_b64_tr_b16 a[146:147], v11 offset:16896
    ds_read_b64_tr_b16 a[208:209], v11 offset:16392
    ds_read_b64_tr_b16 a[210:211], v11 offset:16904
    ds_read_b64_tr_b16 a[148:149], v11 offset:20480
    ds_read_b64_tr_b16 a[150:151], v11 offset:20992
    ds_read_b64_tr_b16 a[212:213], v11 offset:20488
    ds_read_b64_tr_b16 a[214:215], v11 offset:21000
    ds_read_b64_tr_b16 a[152:153], v11 offset:24576
    ds_read_b64_tr_b16 a[154:155], v11 offset:25088
    ds_read_b64_tr_b16 a[216:217], v11 offset:24584
    ds_read_b64_tr_b16 a[218:219], v11 offset:25096
    s_waitcnt lgkmcnt(0)
    ds_read_b64_tr_b16 a[156:157], v11 offset:28672
    ds_read_b64_tr_b16 a[158:159], v11 offset:29184
    ds_read_b64_tr_b16 a[220:221], v11 offset:28680
    ds_read_b64_tr_b16 a[222:223], v11 offset:29192
    ds_read_b64_tr_b16 a[160:161], v11 offset:32768
    ds_read_b64_tr_b16 a[162:163], v11 offset:33280
    ds_read_b64_tr_b16 a[224:225], v11 offset:32776
    ds_read_b64_tr_b16 a[226:227], v11 offset:33288
    ds_read_b64_tr_b16 a[164:165], v11 offset:36864
    ds_read_b64_tr_b16 a[166:167], v11 offset:37376
    ds_read_b64_tr_b16 a[228:229], v11 offset:36872
    ds_read_b64_tr_b16 a[230:231], v11 offset:37384
    ds_read_b64_tr_b16 a[168:169], v11 offset:40960
    ds_read_b64_tr_b16 a[170:171], v11 offset:41472
    s_waitcnt lgkmcnt(0)
    ds_read_b64_tr_b16 a[232:233], v11 offset:40968
    ds_read_b64_tr_b16 a[234:235], v11 offset:41480
    ds_read_b64_tr_b16 a[172:173], v11 offset:45056
    ds_read_b64_tr_b16 a[174:175], v11 offset:45568
    ds_read_b64_tr_b16 a[236:237], v11 offset:45064
    ds_read_b64_tr_b16 a[238:239], v11 offset:45576
    ds_read_b64_tr_b16 a[176:177], v11 offset:49152
    ds_read_b64_tr_b16 a[178:179], v11 offset:49664
    ds_read_b64_tr_b16 a[240:241], v11 offset:49160
    ds_read_b64_tr_b16 a[242:243], v11 offset:49672
    ds_read_b64_tr_b16 a[180:181], v11 offset:53248
    ds_read_b64_tr_b16 a[182:183], v11 offset:53760
    ds_read_b64_tr_b16 a[244:245], v11 offset:53256
    ds_read_b64_tr_b16 a[246:247], v11 offset:53768
    s_waitcnt lgkmcnt(0)
    ds_read_b64_tr_b16 a[184:185], v11 offset:57344
    ds_read_b64_tr_b16 a[186:187], v11 offset:57856
    ds_read_b64_tr_b16 a[248:249], v11 offset:57352
    ds_read_b64_tr_b16 a[250:251], v11 offset:57864
    ds_read_b64_tr_b16 a[188:189], v11 offset:61440
    ds_read_b64_tr_b16 a[190:191], v11 offset:61952
    ds_read_b64_tr_b16 a[252:253], v11 offset:61448
    ds_read_b64_tr_b16 a[254:255], v11 offset:61960
    s_waitcnt lgkmcnt(0)
    s_barrier
    v_and_b32 v5, 31, v1
    v_lshlrev_b32 v2, 2, v5
    v_lshrrev_b32 v5, 5, v1
    v_lshl_add_u32 v2, v5, 7, v2
    s_mov_b32 s63, 1536
    s_lshl_b32 s36, s31, 2
    s_add_u32 s62, s36, 1792
    s_cmp_lg_u32 s30, 0
    s_cbranch_scc1 L_pw_ok_idf1
    s_mov_b32 s36, 0
    v_mov_b32 v120, 32
L_pw_idf1:
    buffer_load_dword v121, v120, s[24:27], 0 offen sc1
    s_waitcnt vmcnt(0)
    v_readfirstlane_b32 s37, v121
    s_nop 3
    s_cmp_ge_u32 s37, 256
    s_cbranch_scc1 L_pw_ok_idf1
    s_sleep 4
    s_add_u32 s36, s36, 1
    s_cmp_lt_u32 s36, 65536
    s_cbranch_scc1 L_pw_idf1
    s_mov_b32 s33, 1
L_pw_ok_idf1:
    s_barrier
    s_mov_b32 s41, 0
    s_mov_b32 s58, 0
    s_mov_b32 s42, 0
    s_mov_b32 s59, 0
    s_mov_b32 s49, 0
    s_mov_b32 s50, 0
    s_mov_b32 s52, 0
    s_mov_b32 s53, 0
    s_mov_b32 s43, 0
    s_mov_b32 s44, 0
    s_mov_b32 s47, 0
    s_mov_b32 s48, 0
    s_mov_b32 s51, 163328
    v_cmp_lt_u32 s[88:89], 31, v1
    v_and_b32 v14, 31, v1
    s_mov_b32 s96, 0
L_f1_cold:
    s_waitcnt vmcnt(0)
    s_barrier
    s_cmp_eq_u32 s43, s52
    s_cbranch_scc1 L_f1_nopub2
    v_mov_b32 v5, s44
    v_mov_b32 v6, 0
    s_mov_b64 exec, 1
    s_cmp_lg_u32 s30, 0
    s_cbranch_scc1 L_pub_23_d
    s_lshl_b32 s36, s43, 7
    s_add_u32 s36, s36, s62
    buffer_store_dword v5, v6, s[4:7], s36 offen sc1
    s_branch L_pub_23_e
L_pub_23_d:
    buffer_store_dword v5, v6, s[4:7], s97 offen
L_pub_23_e:
    s_mov_b64 exec, -1
L_f1_nopub2:
    v_mov_b32 v5, s53
    v_mov_b32 v6, 0
    s_mov_b64 exec, 1
    s_cmp_lg_u32 s30, 0
    s_cbranch_scc1 L_pub_24_d
    s_lshl_b32 s36, s52, 7
    s_add_u32 s36, s36, s62
    buffer_store_dword v5, v6, s[4:7], s36 offen sc1
    s_branch L_pub_24_e
L_pub_24_d:
    buffer_store_dword v5, v6, s[4:7], s97 offen
L_pub_24_e:
    s_mov_b64 exec, -1
    s_mov_b32 s43, s52
    s_mov_b32 s44, s53
    s_mov_b32 s40, 0
    s_add_u32 s36, s41, s42
    s_cmp_ge_u32 s36, 128
    s_cbranch_scc1 L_f1_exit
    s_cmp_lg_u32 s30, 0
    s_cbranch_scc1 L_f1_cwait
    s_waitcnt vmcnt(0)
    buffer_load_dword v12, v2, s[4:7], s63 offen sc1
    s_nop 15
    s_nop 15
    s_nop 15
    s_nop 15
    s_nop 15
    s_nop 15
L_f1_w0spin:
    buffer_load_dword v13, v2, s[4:7], s63 offen sc1
    s_waitcnt vmcnt(1)
    v_mov_b32 v4, v12
    s_cmp_ge_u32 s41, 64
    s_cbranch_scc1 L_f1_p_try1
    s_mov_b32 s48, s41
    s_and_b32 s36, s48, 3
    s_lshl_b32 s36, s36, 1
    s_add_u32 s36, s36, 0
    s_lshr_b32 s37, s48, 2
    s_add_u32 s37, s37, 1
    v_subrev_u32 v7, s36, v1
    v_cmp_gt_u32 vcc, 2, v7
    v_mov_b32 v6, s37
    s_nop 0
    v_cndmask_b32 v7, 0, v6, vcc
    v_cmp_lt_u32 vcc, v4, v7
    s_nop 1
    s_cmp_eq_u64 vcc, 0
    s_cbranch_scc1 L_f1_p_done
L_f1_p_try1:
    s_cmp_ge_u32 s42, 64
    s_cbranch_scc1 L_f1_p_try2
    s_mov_b32 s48, s42
    s_and_b32 s36, s48, 3
    s_lshl_b32 s36, s36, 1
    s_add_u32 s36, s36, 32
    s_lshr_b32 s37, s48, 2
    s_add_u32 s37, s37, 1
    v_subrev_u32 v7, s36, v1
    v_cmp_gt_u32 vcc, 2, v7
    v_mov_b32 v6, s37
    s_nop 0
    v_cndmask_b32 v7, 0, v6, vcc
    v_cmp_lt_u32 vcc, v4, v7
    s_nop 1
    s_cmp_eq_u64 vcc, 0
    s_cbranch_scc1 L_f1_p_done
L_f1_p_try2:
    s_cmp_lg_u32 s47, s47
L_f1_p_done:
    s_cbranch_scc1 L_f1_w0got
    buffer_load_dword v12, v2, s[4:7], s63 offen sc1
    s_waitcnt vmcnt(1)
    v_mov_b32 v4, v13
    s_cmp_ge_u32 s41, 64
    s_cbranch_scc1 L_f1_q_try1
    s_mov_b32 s48, s41
    s_and_b32 s36, s48, 3
    s_lshl_b32 s36, s36, 1
    s_add_u32 s36, s36, 0
    s_lshr_b32 s37, s48, 2
    s_add_u32 s37, s37, 1
    v_subrev_u32 v7, s36, v1
    v_cmp_gt_u32 vcc, 2, v7
    v_mov_b32 v6, s37
    s_nop 0
    v_cndmask_b32 v7, 0, v6, vcc
    v_cmp_lt_u32 vcc, v4, v7
    s_nop 1
    s_cmp_eq_u64 vcc, 0
    s_cbranch_scc1 L_f1_q_done
L_f1_q_try1:
    s_cmp_ge_u32 s42, 64
    s_cbranch_scc1 L_f1_q_try2
    s_mov_b32 s48, s42
    s_and_b32 s36, s48, 3
    s_lshl_b32 s36, s36, 1
    s_add_u32 s36, s36, 32
    s_lshr_b32 s37, s48, 2
    s_add_u32 s37, s37, 1
    v_subrev_u32 v7, s36, v1
    v_cmp_gt_u32 vcc, 2, v7
    v_mov_b32 v6, s37
    s_nop 0
    v_cndmask_b32 v7, 0, v6, vcc
    v_cmp_lt_u32 vcc, v4, v7
    s_nop 1
    s_cmp_eq_u64 vcc, 0
    s_cbranch_scc1 L_f1_q_done
L_f1_q_try2:
    s_cmp_lg_u32 s47, s47
L_f1_q_done:
    s_cbranch_scc1 L_f1_w0got
    s_add_u32 s40, s40, 1
    s_cmp_lt_u32 s40, s35
    s_cbranch_scc1 L_f1_w0spin
L_f1_w0got:
    v_lshlrev_b32 v5, 2, v1
    v_add_u32 v5, s51, v5
    ds_write_b32 v5, v4
    s_waitcnt lgkmcnt(0)
L_f1_cwait:
    s_barrier
    v_lshlrev_b32 v5, 2, v1
    v_add_u32 v5, s51, v5
    ds_read_b32 v4, v5
    s_xor_b32 s51, s51, 256
    s_waitcnt lgkmcnt(0)
    s_cmp_ge_u32 s41, 64
    s_cbranch_scc1 L_f1_c_try1
    s_mov_b32 s48, s41
    s_and_b32 s36, s48, 3
    s_lshl_b32 s36, s36, 1
    s_add_u32 s36, s36, 0
    s_lshr_b32 s37, s48, 2
    s_add_u32 s37, s37, 1
    v_subrev_u32 v7, s36, v1
    v_cmp_gt_u32 vcc, 2, v7
    v_mov_b32 v6, s37
    s_nop 0
    v_cndmask_b32 v7, 0, v6, vcc
    v_cmp_lt_u32 vcc, v4, v7
    s_nop 1
    s_cmp_eq_u64 vcc, 0
    s_cbranch_scc0 L_f1_c_try1
    s_mov_b32 s47, 0
    s_add_u32 s41, s41, 1
    s_cmp_eq_u32 s47, s47
    s_branch L_f1_c_done
L_f1_c_try1:
    s_cmp_ge_u32 s42, 64
    s_cbranch_scc1 L_f1_c_try2
    s_mov_b32 s48, s42
    s_and_b32 s36, s48, 3
    s_lshl_b32 s36, s36, 1
    s_add_u32 s36, s36, 32
    s_lshr_b32 s37, s48, 2
    s_add_u32 s37, s37, 1
    v_subrev_u32 v7, s36, v1
    v_cmp_gt_u32 vcc, 2, v7
    v_mov_b32 v6, s37
    s_nop 0
    v_cndmask_b32 v7, 0, v6, vcc
    v_cmp_lt_u32 vcc, v4, v7
    s_nop 1
    s_cmp_eq_u64 vcc, 0
    s_cbranch_scc0 L_f1_c_try2
    s_mov_b32 s47, 1
    s_add_u32 s42, s42, 1
    s_cmp_eq_u32 s47, s47
    s_branch L_f1_c_done
L_f1_c_try2:
    s_cmp_lg_u32 s47, s47
L_f1_c_done:
    s_cbranch_scc1 L_f1_got
    s_mov_b32 s33, 1
    s_branch L_f1_exit
L_f1_got:
    s_lshl_b32 s36, s47, 21
    s_lshl_b32 s37, s48, 15
    s_add_u32 s36, s36, s37
    s_lshl_b32 s37, s30, 13
    s_add_u32 s36, s36, s37
    s_add_u32 s60, s36, 0x600000
    s_add_u32 s61, s37, s50
    s_mov_b32 m0, s61
    s_add_u32 s61, s61, 1024
    buffer_load_dwordx4 v0, s[4:7], s60 offen sc1 lds
    s_add_u32 s60, s60, 1024
    s_mov_b32 m0, s61
    s_add_u32 s61, s61, 1024
    buffer_load_dwordx4 v0, s[4:7], s60 offen sc1 lds
    s_add_u32 s60, s60, 1024
    s_mov_b32 m0, s61
    s_add_u32 s61, s61, 1024
    buffer_load_dwordx4 v0, s[4:7], s60 offen sc1 lds
    s_add_u32 s60, s60, 1024
    s_mov_b32 m0, s61
    s_add_u32 s61, s61, 1024
    buffer_load_dwordx4 v0, s[4:7], s60 offen sc1 lds
    s_add_u32 s60, s60, 1024
    s_mov_b32 m0, s61
    s_add_u32 s61, s61, 1024
    buffer_load_dwordx4 v0, s[4:7], s60 offen sc1 lds
    s_add_u32 s60, s60, 1024
    s_mov_b32 m0, s61
    s_add_u32 s61, s61, 1024
    buffer_load_dwordx4 v0, s[4:7], s60 offen sc1 lds
    s_add_u32 s60, s60, 1024
    s_mov_b32 m0, s61
    s_add_u32 s61, s61, 1024
    buffer_load_dwordx4 v0, s[4:7], s60 offen sc1 lds
    s_add_u32 s60, s60, 1024
    s_mov_b32 m0, s61
    s_add_u32 s61, s61, 1024
    buffer_load_dwordx4 v0, s[4:7], s60 offen sc1 lds
    s_add_u32 s60, s60, 1024
    s_mov_b32 m0, s51
    s_nop 0
    buffer_load_dword v2, s[4:7], s63 offen sc1 lds
    s_mov_b32 s45, s47
    s_mov_b32 s46, s48
    s_waitcnt vmcnt(0)
    s_barrier
    s_and_b32 s36, s30, 1
    s_lshl_b32 s36, s36, 14
    s_add_u32 s36, s36, s50
    v_add_u32 v8, s36, v0
    ds_read_b128 v[32:35], v8 offset:0
    ds_read_b128 v[36:39], v8 offset:1024
    v_lshlrev_b32 v5, 2, v1
    v_add_u32 v5, s51, v5
    ds_read_b32 v4, v5
    s_xor_b32 s51, s51, 256
L_f1_main:
    s_waitcnt lgkmcnt(2)
    v_mfma_f32_16x16x32_bf16 v[16:19], a[0:3], v[32:35], 0
    ds_read_b128 v[40:43], v8 offset:2048
    v_mfma_f32_16x16x32_bf16 v[20:23], a[64:67], v[32:35], 0
    s_mov_b32 s86, s41
    v_mfma_f32_16x16x32_bf16 v[24:27], a[128:131], v[32:35], 0
    s_mov_b32 s87, s42
    v_mfma_f32_16x16x32_bf16 v[28:31], a[192:195], v[32:35], 0
    s_waitcnt lgkmcnt(2)
    v_mfma_f32_16x16x32_bf16 v[16:19], a[4:7], v[36:39], v[16:19]
    ds_read_b128 v[32:35], v8 offset:3072
    v_mfma_f32_16x16x32_bf16 v[20:23], a[68:71], v[36:39], v[20:23]
    v_mfma_f32_16x16x32_bf16 v[24:27], a[132:135], v[36:39], v[24:27]
    v_mfma_f32_16x16x32_bf16 v[28:31], a[196:199], v[36:39], v[28:31]
    s_waitcnt lgkmcnt(1)
    v_mfma_f32_16x16x32_bf16 v[16:19], a[8:11], v[40:43], v[16:19]
    ds_read_b128 v[36:39], v8 offset:4096
    v_mov_b32 v6, s86
    v_mov_b32 v7, s87
    v_cndmask_b32 v6, v6, v7, s[88:89]
    v_mfma_f32_16x16x32_bf16 v[20:23], a[72:75], v[40:43], v[20:23]
    v_and_b32 v7, 3, v6
    v_lshlrev_b32 v7, 1, v7
    v_sub_u32 v7, v14, v7
    v_lshrrev_b32 v6, 2, v6
    v_mfma_f32_16x16x32_bf16 v[24:27], a[136:139], v[40:43], v[24:27]
    v_add_u32 v6, 1, v6
    v_cmp_gt_u32 vcc, 2, v7
    s_nop 1
    v_cndmask_b32 v7, 0, v6, vcc
    v_mfma_f32_16x16x32_bf16 v[28:31], a[200:203], v[40:43], v[28:31]
    v_cmp_lt_u32 vcc, v4, v7
    s_waitcnt lgkmcnt(1)
    v_mfma_f32_16x16x32_bf16 v[16:19], a[12:15], v[32:35], v[16:19]
    ds_read_b128 v[40:43], v8 offset:5120
    v_mfma_f32_16x16x32_bf16 v[20:23], a[76:79], v[32:35], v[20:23]
    v_mfma_f32_16x16x32_bf16 v[24:27], a[140:143], v[32:35], v[24:27]
    v_mfma_f32_16x16x32_bf16 v[28:31], a[204:207], v[32:35], v[28:31]
    s_cmp_eq_u32 vcc_lo, 0
    s_cselect_b32 s54, 1, 0
    s_cmp_lt_u32 s41, 64
    s_cselect_b32 s54, s54, 0
    s_cmp_eq_u32 vcc_hi, 0
    s_cselect_b32 s55, 1, 0
    s_cmp_lt_u32 s42, 64
    s_cselect_b32 s55, s55, 0
    s_or_b32 s49, s54, s55
    s_cmp_eq_u32 s54, 1
    s_cselect_b32 s47, 0, 1
    s_cselect_b32 s48, s86, s87
    s_cselect_b32 s55, 0, s55
    s_add_u32 s41, s41, s54
    s_add_u32 s42, s42, s55
    s_cmp_eq_u32 s49, 0
    s_cbranch_scc1 L_f1_nopf
    s_xor_b32 s57, s50, 32768
    s_lshl_b32 s36, s47, 21
    s_lshl_b32 s37, s48, 15
    s_add_u32 s36, s36, s37
    s_lshl_b32 s37, s30, 13
    s_add_u32 s36, s36, s37
    s_add_u32 s60, s36, 0x600000
    s_add_u32 s61, s37, s57
    s_waitcnt lgkmcnt(1)
    v_mfma_f32_16x16x32_bf16 v[16:19], a[16:19], v[36:39], v[16:19]
    ds_read_b128 v[32:35], v8 offset:6144
    s_mov_b32 m0, s61
    v_mfma_f32_16x16x32_bf16 v[20:23], a[80:83], v[36:39], v[20:23]
    s_add_u32 s61, s61, 1024
    buffer_load_dwordx4 v0, s[4:7], s60 offen sc1 lds
    v_mfma_f32_16x16x32_bf16 v[24:27], a[144:147], v[36:39], v[24:27]
    s_add_u32 s60, s60, 1024
    v_mfma_f32_16x16x32_bf16 v[28:31], a[208:211], v[36:39], v[28:31]
    s_waitcnt lgkmcnt(1)
    v_mfma_f32_16x16x32_bf16 v[16:19], a[20:23], v[40:43], v[16:19]
    ds_read_b128 v[36:39], v8 offset:7168
    s_mov_b32 m0, s61
    v_mfma_f32_16x16x32_bf16 v[20:23], a[84:87], v[40:43], v[20:23]
    s_add_u32 s61, s61, 1024
    buffer_load_dwordx4 v0, s[4:7], s60 offen sc1 lds
    v_mfma_f32_16x16x32_bf16 v[24:27], a[148:151], v[40:43], v[24:27]
    s_add_u32 s60, s60, 1024
    v_mfma_f32_16x16x32_bf16 v[28:31], a[212:215], v[40:43], v[28:31]
    s_waitcnt lgkmcnt(1)
    v_mfma_f32_16x16x32_bf16 v[16:19], a[24:27], v[32:35], v[16:19]
    ds_read_b128 v[40:43], v8 offset:8192
    s_mov_b32 m0, s61
    v_mfma_f32_16x16x32_bf16 v[20:23], a[88:91], v[32:35], v[20:23]
    s_add_u32 s61, s61, 1024
    buffer_load_dwordx4 v0, s[4:7], s60 offen sc1 lds
    v_mfma_f32_16x16x32_bf16 v[24:27], a[152:155], v[32:35], v[24:27]
    s_add_u32 s60, s60, 1024
    v_mfma_f32_16x16x32_bf16 v[28:31], a[216:219], v[32:35], v[28:31]
    s_waitcnt lgkmcnt(1)
    v_mfma_f32_16x16x32_bf16 v[16:19], a[28:31], v[36:39], v[16:19]
    ds_read_b128 v[32:35], v8 offset:9216
    s_mov_b32 m0, s61
    v_mfma_f32_16x16x32_bf16 v[20:23], a[92:95], v[36:39], v[20:23]
    s_add_u32 s61, s61, 1024
    buffer_load_dwordx4 v0, s[4:7], s60 offen sc1 lds
    v_mfma_f32_16x16x32_bf16 v[24:27], a[156:159], v[36:39], v[24:27]
    s_add_u32 s60, s60, 1024
    v_mfma_f32_16x16x32_bf16 v[28:31], a[220:223], v[36:39], v[28:31]
    s_waitcnt lgkmcnt(1)
    v_mfma_f32_16x16x32_bf16 v[16:19], a[32:35], v[40:43], v[16:19]
    ds_read_b128 v[36:39], v8 offset:10240
    s_mov_b32 m0, s61
    v_mfma_f32_16x16x32_bf16 v[20:23], a[96:99], v[40:43], v[20:23]
    s_add_u32 s61, s61, 1024
    buffer_load_dwordx4 v0, s[4:7], s60 offen sc1 lds
    v_mfma_f32_16x16x32_bf16 v[24:27], a[160:163], v[40:43], v[24:27]
    s_add_u32 s60, s60, 1024
    v_mfma_f32_16x16x32_bf16 v[28:31], a[224:227], v[40:43], v[28:31]
    s_waitcnt lgkmcnt(1)
    v_mfma_f32_16x16x32_bf16 v[16:19], a[36:39], v[32:35], v[16:19]
    ds_read_b128 v[40:43], v8 offset:11264
    s_mov_b32 m0, s61
    v_mfma_f32_16x16x32_bf16 v[20:23], a[100:103], v[32:35], v[20:23]
    s_add_u32 s61, s61, 1024
    buffer_load_dwordx4 v0, s[4:7], s60 offen sc1 lds
    v_mfma_f32_16x16x32_bf16 v[24:27], a[164:167], v[32:35], v[24:27]
    s_add_u32 s60, s60, 1024
    v_mfma_f32_16x16x32_bf16 v[28:31], a[228:231], v[32:35], v[28:31]
    s_waitcnt lgkmcnt(1)
    v_mfma_f32_16x16x32_bf16 v[16:19], a[40:43], v[36:39], v[16:19]
    ds_read_b128 v[32:35], v8 offset:12288
    s_mov_b32 m0, s61
    v_mfma_f32_16x16x32_bf16 v[20:23], a[104:107], v[36:39], v[20:23]
    s_add_u32 s61, s61, 1024
    buffer_load_dwordx4 v0, s[4:7], s60 offen sc1 lds
    v_mfma_f32_16x16x32_bf16 v[24:27], a[168:171], v[36:39], v[24:27]
    s_add_u32 s60, s60, 1024
    v_mfma_f32_16x16x32_bf16 v[28:31], a[232:235], v[36:39], v[28:31]
    s_waitcnt lgkmcnt(1)
    v_mfma_f32_16x16x32_bf16 v[16:19], a[44:47], v[40:43], v[16:19]
    ds_read_b128 v[36:39], v8 offset:13312
    s_mov_b32 m0, s61
    v_mfma_f32_16x16x32_bf16 v[20:23], a[108:111], v[40:43], v[20:23]
    s_add_u32 s61, s61, 1024
    buffer_load_dwordx4 v0, s[4:7], s60 offen sc1 lds
    v_mfma_f32_16x16x32_bf16 v[24:27], a[172:175], v[40:43], v[24:27]
    s_add_u32 s60, s60, 1024
    s_mov_b32 m0, s51
    v_mfma_f32_16x16x32_bf16 v[28:31], a[236:239], v[40:43], v[28:31]
    s_nop 0
    buffer_load_dword v2, s[4:7], s63 offen sc1 lds
    s_waitcnt lgkmcnt(1)
    v_mfma_f32_16x16x32_bf16 v[16:19], a[48:51], v[32:35], v[16:19]
    ds_read_b128 v[40:43], v8 offset:14336
    v_mfma_f32_16x16x32_bf16 v[20:23], a[112:115], v[32:35], v[20:23]
    v_mfma_f32_16x16x32_bf16 v[24:27], a[176:179], v[32:35], v[24:27]
    v_mfma_f32_16x16x32_bf16 v[28:31], a[240:243], v[32:35], v[28:31]
    s_waitcnt vmcnt(20)
    s_barrier
    v_mov_b32 v5, s44
    v_mov_b32 v6, 0
    s_mov_b64 exec, 1
    s_cmp_lg_u32 s30, 0
    s_cbranch_scc1 L_pub_25_d
    s_lshl_b32 s36, s43, 7
    s_add_u32 s36, s36, s62
    buffer_store_dword v5, v6, s[4:7], s36 offen sc1
    s_branch L_pub_25_e
L_pub_25_d:
    buffer_store_dword v5, v6, s[4:7], s97 offen
L_pub_25_e:
    s_mov_b64 exec, -1
    s_waitcnt lgkmcnt(1)
    v_mfma_f32_16x16x32_bf16 v[16:19], a[52:55], v[36:39], v[16:19]
    ds_read_b128 v[32:35], v8 offset:15360
    v_mfma_f32_16x16x32_bf16 v[20:23], a[116:119], v[36:39], v[20:23]
    v_mfma_f32_16x16x32_bf16 v[24:27], a[180:183], v[36:39], v[24:27]
    v_mfma_f32_16x16x32_bf16 v[28:31], a[244:247], v[36:39], v[28:31]
    s_waitcnt lgkmcnt(1)
    v_mfma_f32_16x16x32_bf16 v[16:19], a[56:59], v[40:43], v[16:19]
    s_lshl_b32 s90, s45, 23
    s_mul_i32 s91, s46, 114688
    s_add_u32 s90, s90, s91
    v_mfma_f32_16x16x32_bf16 v[20:23], a[120:123], v[40:43], v[20:23]
    s_and_b32 s91, s30, 1
    s_mul_i32 s91, s91, 57344
    s_add_u32 s90, s90, s91
    v_mfma_f32_16x16x32_bf16 v[24:27], a[184:187], v[40:43], v[24:27]
    s_lshl_b32 s91, s31, 1
    s_lshr_b32 s92, s30, 1
    s_add_u32 s91, s91, s92
    v_mfma_f32_16x16x32_bf16 v[28:31], a[248:251], v[40:43], v[28:31]
    s_lshl_b32 s91, s91, 10
    s_add_u32 s90, s90, s91
    s_add_u32 s90, s90, 0x8800000
    s_waitcnt lgkmcnt(0)
    v_mfma_f32_16x16x32_bf16 v[16:19], a[60:63], v[32:35], v[16:19]
    v_mfma_f32_16x16x32_bf16 v[20:23], a[124:127], v[32:35], v[20:23]
    v_mfma_f32_16x16x32_bf16 v[24:27], a[188:191], v[32:35], v[24:27]
    v_mfma_f32_16x16x32_bf16 v[28:31], a[252:255], v[32:35], v[28:31]
    s_waitcnt vmcnt(1)
    s_barrier
    s_xor_b32 s50, s50, 32768
    s_and_b32 s36, s30, 1
    s_lshl_b32 s36, s36, 14
    s_add_u32 s36, s36, s50
    v_add_u32 v8, s36, v0
    ds_read_b128 v[32:35], v8 offset:0
    ds_read_b128 v[36:39], v8 offset:1024
    v_lshlrev_b32 v5, 2, v1
    v_add_u32 v5, s51, v5
    ds_read_b32 v4, v5
    s_xor_b32 s51, s51, 256
    v_pk_mul_f32 v[16:17], v[16:17], v[24:25]
    v_pk_mul_f32 v[18:19], v[18:19], v[26:27]
    v_pk_mul_f32 v[20:21], v[20:21], v[28:29]
    v_pk_mul_f32 v[22:23], v[22:23], v[30:31]
    v_cvt_pk_bf16_f32 v56, v16, v17
    v_cvt_pk_bf16_f32 v57, v18, v19
    v_cvt_pk_bf16_f32 v58, v20, v21
    v_cvt_pk_bf16_f32 v59, v22, v23
    buffer_store_dwordx4 v[56:59], v0, s[4:7], s90 offen sc1
    s_mov_b32 s43, s52
    s_mov_b32 s44, s53
    s_cmp_eq_u32 s45, 0
    s_cselect_b32 s36, s58, s59
    s_add_u32 s53, s36, 1
    s_mov_b32 s52, s45
    s_cmp_eq_u32 s45, 0
    s_cselect_b32 s58, s53, s58
    s_cselect_b32 s59, s59, s53
    s_mov_b32 s45, s47
    s_mov_b32 s46, s48
    s_branch L_f1_main
L_f1_nopf:
    s_waitcnt lgkmcnt(1)
    v_mfma_f32_16x16x32_bf16 v[16:19], a[16:19], v[36:39], v[16:19]
    ds_read_b128 v[32:35], v8 offset:6144
    v_mfma_f32_16x16x32_bf16 v[20:23], a[80:83], v[36:39], v[20:23]
    v_mfma_f32_16x16x32_bf16 v[24:27], a[144:147], v[36:39], v[24:27]
    v_mfma_f32_16x16x32_bf16 v[28:31], a[208:211], v[36:39], v[28:31]
    s_waitcnt lgkmcnt(1)
    v_mfma_f32_16x16x32_bf16 v[16:19], a[20:23], v[40:43], v[16:19]
    ds_read_b128 v[36:39], v8 offset:7168
    v_mfma_f32_16x16x32_bf16 v[20:23], a[84:87], v[40:43], v[20:23]
    v_mfma_f32_16x16x32_bf16 v[24:27], a[148:151], v[40:43], v[24:27]
    v_mfma_f32_16x16x32_bf16 v[28:31], a[212:215], v[40:43], v[28:31]
    s_waitcnt lgkmcnt(1)
    v_mfma_f32_16x16x32_bf16 v[16:19], a[24:27], v[32:35], v[16:19]
    ds_read_b128 v[40:43], v8 offset:8192
    v_mfma_f32_16x16x32_bf16 v[20:23], a[88:91], v[32:35], v[20:23]
    v_mfma_f32_16x16x32_bf16 v[24:27], a[152:155], v[32:35], v[24:27]
    v_mfma_f32_16x16x32_bf16 v[28:31], a[216:219], v[32:35], v[28:31]
    s_waitcnt lgkmcnt(1)
    v_mfma_f32_16x16x32_bf16 v[16:19], a[28:31], v[36:39], v[16:19]
    ds_read_b128 v[32:35], v8 offset:9216
    v_mfma_f32_16x16x32_bf16 v[20:23], a[92:95], v[36:39], v[20:23]
    v_mfma_f32_16x16x32_bf16 v[24:27], a[156:159], v[36:39], v[24:27]
    v_mfma_f32_16x16x32_bf16 v[28:31], a[220:223], v[36:39], v[28:31]
    s_waitcnt lgkmcnt(1)
    v_mfma_f32_16x16x32_bf16 v[16:19], a[32:35], v[40:43], v[16:19]
    ds_read_b128 v[36:39], v8 offset:10240
    v_mfma_f32_16x16x32_bf16 v[20:23], a[96:99], v[40:43], v[20:23]
    v_mfma_f32_16x16x32_bf16 v[24:27], a[160:163], v[40:43], v[24:27]
    v_mfma_f32_16x16x32_bf16 v[28:31], a[224:227], v[40:43], v[28:31]
    s_waitcnt lgkmcnt(1)
    v_mfma_f32_16x16x32_bf16 v[16:19], a[36:39], v[32:35], v[16:19]
    ds_read_b128 v[40:43], v8 offset:11264
    v_mfma_f32_16x16x32_bf16 v[20:23], a[100:103], v[32:35], v[20:23]
    v_mfma_f32_16x16x32_bf16 v[24:27], a[164:167], v[32:35], v[24:27]
    v_mfma_f32_16x16x32_bf16 v[28:31], a[228:231], v[32:35], v[28:31]
    s_waitcnt lgkmcnt(1)
    v_mfma_f32_16x16x32_bf16 v[16:19], a[40:43], v[36:39], v[16:19]
    ds_read_b128 v[32:35], v8 offset:12288
    v_mfma_f32_16x16x32_bf16 v[20:23], a[104:107], v[36:39], v[20:23]
    v_mfma_f32_16x16x32_bf16 v[24:27], a[168:171], v[36:39], v[24:27]
    v_mfma_f32_16x16x32_bf16 v[28:31], a[232:235], v[36:39], v[28:31]
    s_waitcnt lgkmcnt(1)
    v_mfma_f32_16x16x32_bf16 v[16:19], a[44:47], v[40:43], v[16:19]
    ds_read_b128 v[36:39], v8 offset:13312
    v_mfma_f32_16x16x32_bf16 v[20:23], a[108:111], v[40:43], v[20:23]
    s_mov_b32 m0, s51
    v_mfma_f32_16x16x32_bf16 v[24:27], a[172:175], v[40:43], v[24:27]
    s_nop 0
    v_mfma_f32_16x16x32_bf16 v[28:31], a[236:239], v[40:43], v[28:31]
    buffer_load_dword v2, s[4:7], s63 offen sc1 lds
    s_waitcnt lgkmcnt(1)
    v_mfma_f32_16x16x32_bf16 v[16:19], a[48:51], v[32:35], v[16:19]
    ds_read_b128 v[40:43], v8 offset:14336
    v_mfma_f32_16x16x32_bf16 v[20:23], a[112:115], v[32:35], v[20:23]
    v_mfma_f32_16x16x32_bf16 v[24:27], a[176:179], v[32:35], v[24:27]
    v_mfma_f32_16x16x32_bf16 v[28:31], a[240:243], v[32:35], v[28:31]
    s_waitcnt vmcnt(12)
    s_barrier
    v_mov_b32 v5, s44
    v_mov_b32 v6, 0
    s_mov_b64 exec, 1
    s_cmp_lg_u32 s30, 0
    s_cbranch_scc1 L_pub_26_d
    s_lshl_b32 s36, s43, 7
    s_add_u32 s36, s36, s62
    buffer_store_dword v5, v6, s[4:7], s36 offen sc1
    s_branch L_pub_26_e
L_pub_26_d:
    buffer_store_dword v5, v6, s[4:7], s97 offen
L_pub_26_e:
    s_mov_b64 exec, -1
    s_waitcnt lgkmcnt(1)
    v_mfma_f32_16x16x32_bf16 v[16:19], a[52:55], v[36:39], v[16:19]
    ds_read_b128 v[32:35], v8 offset:15360
    v_mfma_f32_16x16x32_bf16 v[20:23], a[116:119], v[36:39], v[20:23]
    v_mfma_f32_16x16x32_bf16 v[24:27], a[180:183], v[36:39], v[24:27]
    v_mfma_f32_16x16x32_bf16 v[28:31], a[244:247], v[36:39], v[28:31]
    s_waitcnt lgkmcnt(1)
    v_mfma_f32_16x16x32_bf16 v[16:19], a[56:59], v[40:43], v[16:19]
    s_lshl_b32 s90, s45, 23
    s_mul_i32 s91, s46, 114688
    s_add_u32 s90, s90, s91
    v_mfma_f32_16x16x32_bf16 v[20:23], a[120:123], v[40:43], v[20:23]
    s_and_b32 s91, s30, 1
    s_mul_i32 s91, s91, 57344
    s_add_u32 s90, s90, s91
    v_mfma_f32_16x16x32_bf16 v[24:27], a[184:187], v[40:43], v[24:27]
    s_lshl_b32 s91, s31, 1
    s_lshr_b32 s92, s30, 1
    s_add_u32 s91, s91, s92
    v_mfma_f32_16x16x32_bf16 v[28:31], a[248:251], v[40:43], v[28:31]
    s_lshl_b32 s91, s91, 10
    s_add_u32 s90, s90, s91
    s_add_u32 s90, s90, 0x8800000
    s_waitcnt lgkmcnt(0)
    v_mfma_f32_16x16x32_bf16 v[16:19], a[60:63], v[32:35], v[16:19]
    v_mfma_f32_16x16x32_bf16 v[20:23], a[124:127], v[32:35], v[20:23]
    v_mfma_f32_16x16x32_bf16 v[24:27], a[188:191], v[32:35], v[24:27]
    v_mfma_f32_16x16x32_bf16 v[28:31], a[252:255], v[32:35], v[28:31]
    s_nop 7
    v_pk_mul_f32 v[16:17], v[16:17], v[24:25]
    v_pk_mul_f32 v[18:19], v[18:19], v[26:27]
    v_pk_mul_f32 v[20:21], v[20:21], v[28:29]
    v_pk_mul_f32 v[22:23], v[22:23], v[30:31]
    v_cvt_pk_bf16_f32 v56, v16, v17
    v_cvt_pk_bf16_f32 v57, v18, v19
    v_cvt_pk_bf16_f32 v58, v20, v21
    v_cvt_pk_bf16_f32 v59, v22, v23
    buffer_store_dwordx4 v[56:59], v0, s[4:7], s90 offen sc1
    s_mov_b32 s43, s52
    s_mov_b32 s44, s53
    s_cmp_eq_u32 s45, 0
    s_cselect_b32 s36, s58, s59
    s_add_u32 s53, s36, 1
    s_mov_b32 s52, s45
    s_cmp_eq_u32 s45, 0
    s_cselect_b32 s58, s53, s58
    s_cselect_b32 s59, s59, s53
    s_waitcnt vmcnt(2)
    s_barrier
    v_lshlrev_b32 v5, 2, v1
    v_add_u32 v5, s51, v5
    ds_read_b32 v4, v5
    s_xor_b32 s51, s51, 256
    s_waitcnt lgkmcnt(0)
    s_cmp_ge_u32 s41, 64
    s_cbranch_scc1 L_f1_w_try1
    s_mov_b32 s48, s41
    s_and_b32 s36, s48, 3
    s_lshl_b32 s36, s36, 1
    s_add_u32 s36, s36, 0
    s_lshr_b32 s37, s48, 2
    s_add_u32 s37, s37, 1
    v_subrev_u32 v7, s36, v1
    v_cmp_gt_u32 vcc, 2, v7
    v_mov_b32 v6, s37
    s_nop 0
    v_cndmask_b32 v7, 0, v6, vcc
    v_cmp_lt_u32 vcc, v4, v7
    s_nop 1
    s_cmp_eq_u64 vcc, 0
    s_cbranch_scc0 L_f1_w_try1
    s_mov_b32 s47, 0
    s_add_u32 s41, s41, 1
    s_cmp_eq_u32 s47, s47
    s_branch L_f1_w_done
L_f1_w_try1:
    s_cmp_ge_u32 s42, 64
    s_cbranch_scc1 L_f1_w_try2
    s_mov_b32 s48, s42
    s_and_b32 s36, s48, 3
    s_lshl_b32 s36, s36, 1
    s_add_u32 s36, s36, 32
    s_lshr_b32 s37, s48, 2
    s_add_u32 s37, s37, 1
    v_subrev_u32 v7, s36, v1
    v_cmp_gt_u32 vcc, 2, v7
    v_mov_b32 v6, s37
    s_nop 0
    v_cndmask_b32 v7, 0, v6, vcc
    v_cmp_lt_u32 vcc, v4, v7
    s_nop 1
    s_cmp_eq_u64 vcc, 0
    s_cbranch_scc0 L_f1_w_try2
    s_mov_b32 s47, 1
    s_add_u32 s42, s42, 1
    s_cmp_eq_u32 s47, s47
    s_branch L_f1_w_done
L_f1_w_try2:
    s_cmp_lg_u32 s47, s47
L_f1_w_done:
    s_cbranch_scc0 L_f1_cold
    s_xor_b32 s50, s50, 32768
    s_mov_b32 m0, s51
    s_nop 0
    buffer_load_dword v2, s[4:7], s63 offen sc1 lds
    s_lshl_b32 s36, s47, 21
    s_lshl_b32 s37, s48, 15
    s_add_u32 s36, s36, s37
    s_lshl_b32 s37, s30, 13
    s_add_u32 s36, s36, s37
    s_add_u32 s60, s36, 0x600000
    s_add_u32 s61, s37, s50
    s_mov_b32 m0, s61
    s_add_u32 s61, s61, 1024
    buffer_load_dwordx4 v0, s[4:7], s60 offen sc1 lds
    s_add_u32 s60, s60, 1024
    s_mov_b32 m0, s61
    s_add_u32 s61, s61, 1024
    buffer_load_dwordx4 v0, s[4:7], s60 offen sc1 lds
    s_add_u32 s60, s60, 1024
    s_mov_b32 m0, s61
    s_add_u32 s61, s61, 1024
    buffer_load_dwordx4 v0, s[4:7], s60 offen sc1 lds
    s_add_u32 s60, s60, 1024
    s_mov_b32 m0, s61
    s_add_u32 s61, s61, 1024
    buffer_load_dwordx4 v0, s[4:7], s60 offen sc1 lds
    s_add_u32 s60, s60, 1024
    s_mov_b32 m0, s61
    s_add_u32 s61, s61, 1024
    buffer_load_dwordx4 v0, s[4:7], s60 offen sc1 lds
    s_add_u32 s60, s60, 1024
    s_mov_b32 m0, s61
    s_add_u32 s61, s61, 1024
    buffer_load_dwordx4 v0, s[4:7], s60 offen sc1 lds
    s_add_u32 s60, s60, 1024
    s_mov_b32 m0, s61
    s_add_u32 s61, s61, 1024
    buffer_load_dwordx4 v0, s[4:7], s60 offen sc1 lds
    s_add_u32 s60, s60, 1024
    s_mov_b32 m0, s61
    s_add_u32 s61, s61, 1024
    buffer_load_dwordx4 v0, s[4:7], s60 offen sc1 lds
    s_add_u32 s60, s60, 1024
    s_mov_b32 s45, s47
    s_mov_b32 s46, s48
    s_waitcnt vmcnt(9)
    s_barrier
    s_cmp_eq_u32 s43, s52
    s_cbranch_scc1 L_f1_wnopub2
    v_mov_b32 v5, s44
    v_mov_b32 v6, 0
    s_mov_b64 exec, 1
    s_cmp_lg_u32 s30, 0
    s_cbranch_scc1 L_pub_27_d
    s_lshl_b32 s36, s43, 7
    s_add_u32 s36, s36, s62
    buffer_store_dword v5, v6, s[4:7], s36 offen sc1
    s_branch L_pub_27_e
L_pub_27_d:
    buffer_store_dword v5, v6, s[4:7], s97 offen
L_pub_27_e:
    s_mov_b64 exec, -1
L_f1_wnopub2:
    v_mov_b32 v5, s53
    v_mov_b32 v6, 0
    s_mov_b64 exec, 1
    s_cmp_lg_u32 s30, 0
    s_cbranch_scc1 L_pub_28_d
    s_lshl_b32 s36, s52, 7
    s_add_u32 s36, s36, s62
    buffer_store_dword v5, v6, s[4:7], s36 offen sc1
    s_branch L_pub_28_e
L_pub_28_d:
    buffer_store_dword v5, v6, s[4:7], s97 offen
L_pub_28_e:
    s_mov_b64 exec, -1
    s_mov_b32 s43, s52
    s_mov_b32 s44, s53
    s_waitcnt vmcnt(1)
    s_barrier
    s_and_b32 s36, s30, 1
    s_lshl_b32 s36, s36, 14
    s_add_u32 s36, s36, s50
    v_add_u32 v8, s36, v0
    ds_read_b128 v[32:35], v8 offset:0
    ds_read_b128 v[36:39], v8 offset:1024
    v_lshlrev_b32 v5, 2, v1
    v_add_u32 v5, s51, v5
    ds_read_b32 v4, v5
    s_xor_b32 s51, s51, 256
    s_branch L_f1_main
L_f1_exit:
    s_waitcnt vmcnt(0)
    s_branch L_end
L_role_f2:
    v_mbcnt_lo_u32_b32 v1, -1, 0
    v_mbcnt_hi_u32_b32 v1, -1, v1
    v_lshlrev_b32 v0, 4, v1
    s_mov_b32 s35, 65536
    s_lshl_b32 s36, s28, 5
    s_add_u32 s36, s36, s29
    s_lshl_b32 s36, s36, 2
    s_add_u32 s36, s36, s30
    s_lshl_b32 s36, s36, 5
    s_and_b32 s36, s36, 0x7fff
    s_add_u32 s97, s36, 0x8000
    s_lshr_b32 s64, s31, 3
    s_bfe_u32 s65, s31, 0x10002
    s_mul_i32 s67, s65, 14
    s_load_dwordx2 s[36:37], s[0:1], 80
    s_waitcnt lgkmcnt(0)
    s_mov_b32 s8, s36
    s_and_b32 s9, s37, 0xffff
    s_mov_b32 s10, 0x1c0000
    s_mov_b32 s11, 0x20000
    s_and_b32 s66, s31, 3
    s_mul_i32 s68, s65, 917504
    s_lshl_b32 s36, s66, 8
    s_add_u32 s68, s68, s36
    s_cmp_lg_u32 s30, 0
    s_cbranch_scc1 L_pw_ok_haf2
    s_mov_b32 s36, 0
    v_mov_b32 v120, 32
L_pw_haf2:
    buffer_load_dword v121, v120, s[24:27], 0 offen sc1
    s_waitcnt vmcnt(0)
    v_readfirstlane_b32 s37, v121
    s_nop 3
    s_cmp_ge_u32 s37, 256
    s_cbranch_scc1 L_pw_ok_haf2
    s_sleep 16
    s_add_u32 s36, s36, 1
    s_cmp_lt_u32 s36, 65536
    s_cbranch_scc1 L_pw_haf2
    s_mov_b32 s33, 1
L_pw_ok_haf2:
    s_cmp_lg_u32 s30, 0
    s_cbranch_scc1 L_pw_ok_hbf2
    s_mov_b32 s36, 0
    v_mov_b32 v120, 768
L_pw_hbf2:
    buffer_load_dword v121, v120, s[4:7], 0 offen sc1
    s_waitcnt vmcnt(0)
    v_readfirstlane_b32 s37, v121
    s_nop 3
    s_cmp_ge_u32 s37, 1
    s_cbranch_scc1 L_pw_ok_hbf2
    s_sleep 16
    s_add_u32 s36, s36, 1
    s_cmp_lt_u32 s36, 65536
    s_cbranch_scc1 L_pw_hbf2
L_pw_ok_hbf2:
    s_barrier
    v_lshrrev_b32 v10, 4, v1
    s_mov_b32 s36, 1024
    v_mul_lo_u32 v8, v10, s36
    v_and_b32 v10, 15, v1
    v_lshl_add_u32 v8, v10, 4, v8
    v_lshrrev_b32 v10, 4, v1
    v_lshlrev_b32 v10, 3, v10
    v_bfe_u32 v11, v1, 2, 2
    v_add_u32 v10, v10, v11
    v_mul_u32_u24 v9, 256, v10
    v_and_b32 v10, 3, v1
    v_lshlrev_b32 v10, 4, v10
    s_lshl_b32 s36, s30, 6
    v_add_u32 v10, s36, v10
    v_add_u32 v9, v9, v10
    s_mul_i32 s37, s30, 65536
    s_add_u32 s37, s37, s68
    s_add_u32 s37, s37, 0
    s_mul_i32 s38, s30, 16384
    s_add_u32 s38, s38, 0
    s_mov_b32 m0, s38
    s_add_u32 s38, s38, 1024
    buffer_load_dwordx4 v8, s[8:11], s37 offen lds
    s_add_u32 s37, s37, 4096
    s_mov_b32 m0, s38
    s_add_u32 s38, s38, 1024
    buffer_load_dwordx4 v8, s[8:11], s37 offen lds
    s_add_u32 s37, s37, 4096
    s_mov_b32 m0, s38
    s_add_u32 s38, s38, 1024
    buffer_load_dwordx4 v8, s[8:11], s37 offen lds
    s_add_u32 s37, s37, 4096
    s_mov_b32 m0, s38
    s_add_u32 s38, s38, 1024
    buffer_load_dwordx4 v8, s[8:11], s37 offen lds
    s_add_u32 s37, s37, 4096
    s_mov_b32 m0, s38
    s_add_u32 s38, s38, 1024
    buffer_load_dwordx4 v8, s[8:11], s37 offen lds
    s_add_u32 s37, s37, 4096
    s_mov_b32 m0, s38
    s_add_u32 s38, s38, 1024
    buffer_load_dwordx4 v8, s[8:11], s37 offen lds
    s_add_u32 s37, s37, 4096
    s_mov_b32 m0, s38
    s_add_u32 s38, s38, 1024
    buffer_load_dwordx4 v8, s[8:11], s37 offen lds
    s_add_u32 s37, s37, 4096
    s_mov_b32 m0, s38
    s_add_u32 s38, s38, 1024
    buffer_load_dwordx4 v8, s[8:11], s37 offen lds
    s_add_u32 s37, s37, 4096
    s_mov_b32 m0, s38
    s_add_u32 s38, s38, 1024
    buffer_load_dwordx4 v8, s[8:11], s37 offen lds
    s_add_u32 s37, s37, 4096
    s_mov_b32 m0, s38
    s_add_u32 s38, s38, 1024
    buffer_load_dwordx4 v8, s[8:11], s37 offen lds
    s_add_u32 s37, s37, 4096
    s_mov_b32 m0, s38
    s_add_u32 s38, s38, 1024
    buffer_load_dwordx4 v8, s[8:11], s37 offen lds
    s_add_u32 s37, s37, 4096
    s_mov_b32 m0, s38
    s_add_u32 s38, s38, 1024
    buffer_load_dwordx4 v8, s[8:11], s37 offen lds
    s_add_u32 s37, s37, 4096
    s_mov_b32 m0, s38
    s_add_u32 s38, s38, 1024
    buffer_load_dwordx4 v8, s[8:11], s37 offen lds
    s_add_u32 s37, s37, 4096
    s_mov_b32 m0, s38
    s_add_u32 s38, s38, 1024
    buffer_load_dwordx4 v8, s[8:11], s37 offen lds
    s_add_u32 s37, s37, 4096
    s_mov_b32 m0, s38
    s_add_u32 s38, s38, 1024
    buffer_load_dwordx4 v8, s[8:11], s37 offen lds
    s_add_u32 s37, s37, 4096
    s_mov_b32 m0, s38
    s_add_u32 s38, s38, 1024
    buffer_load_dwordx4 v8, s[8:11], s37 offen lds
    s_add_u32 s37, s37, 4096
    s_mul_i32 s37, s30, 65536
    s_add_u32 s37, s37, s68
    s_add_u32 s37, s37, 262144
    s_mul_i32 s38, s30, 16384
    s_add_u32 s38, s38, 65536
    s_mov_b32 m0, s38
    s_add_u32 s38, s38, 1024
    buffer_load_dwordx4 v8, s[8:11], s37 offen lds
    s_add_u32 s37, s37, 4096
    s_mov_b32 m0, s38
    s_add_u32 s38, s38, 1024
    buffer_load_dwordx4 v8, s[8:11], s37 offen lds
    s_add_u32 s37, s37, 4096
    s_mov_b32 m0, s38
    s_add_u32 s38, s38, 1024
    buffer_load_dwordx4 v8, s[8:11], s37 offen lds
    s_add_u32 s37, s37, 4096
    s_mov_b32 m0, s38
    s_add_u32 s38, s38, 1024
    buffer_load_dwordx4 v8, s[8:11], s37 offen lds
    s_add_u32 s37, s37, 4096
    s_mov_b32 m0, s38
    s_add_u32 s38, s38, 1024
    buffer_load_dwordx4 v8, s[8:11], s37 offen lds
    s_add_u32 s37, s37, 4096
    s_mov_b32 m0, s38
    s_add_u32 s38, s38, 1024
    buffer_load_dwordx4 v8, s[8:11], s37 offen lds
    s_add_u32 s37, s37, 4096
    s_mov_b32 m0, s38
    s_add_u32 s38, s38, 1024
    buffer_load_dwordx4 v8, s[8:11], s37 offen lds
    s_add_u32 s37, s37, 4096
    s_mov_b32 m0, s38
    s_add_u32 s38, s38, 1024
    buffer_load_dwordx4 v8, s[8:11], s37 offen lds
    s_add_u32 s37, s37, 4096
    s_mov_b32 m0, s38
    s_add_u32 s38, s38, 1024
    buffer_load_dwordx4 v8, s[8:11], s37 offen lds
    s_add_u32 s37, s37, 4096
    s_mov_b32 m0, s38
    s_add_u32 s38, s38, 1024
    buffer_load_dwordx4 v8, s[8:11], s37 offen lds
    s_add_u32 s37, s37, 4096
    s_mov_b32 m0, s38
    s_add_u32 s38, s38, 1024
    buffer_load_dwordx4 v8, s[8:11], s37 offen lds
    s_add_u32 s37, s37, 4096
    s_mov_b32 m0, s38
    s_add_u32 s38, s38, 1024
    buffer_load_dwordx4 v8, s[8:11], s37 offen lds
    s_add_u32 s37, s37, 4096
    s_mov_b32 m0, s38
    s_add_u32 s38, s38, 1024
    buffer_load_dwordx4 v8, s[8:11], s37 offen lds
    s_add_u32 s37, s37, 4096
    s_mov_b32 m0, s38
    s_add_u32 s38, s38, 1024
    buffer_load_dwordx4 v8, s[8:11], s37 offen lds
    s_add_u32 s37, s37, 4096
    s_mov_b32 m0, s38
    s_add_u32 s38, s38, 1024
    buffer_load_dwordx4 v8, s[8:11], s37 offen lds
    s_add_u32 s37, s37, 4096
    s_mov_b32 m0, s38
    s_add_u32 s38, s38, 1024
    buffer_load_dwordx4 v8, s[8:11], s37 offen lds
    s_add_u32 s37, s37, 4096
    s_waitcnt vmcnt(16)
    s_barrier
    v_add_u32 v11, 0, v9
    ds_read_b64_tr_b16 a[0:1], v11 offset:0
    ds_read_b64_tr_b16 a[2:3], v11 offset:1024
    ds_read_b64_tr_b16 a[112:113], v11 offset:8
    ds_read_b64_tr_b16 a[114:115], v11 offset:1032
    ds_read_b64_tr_b16 a[4:5], v11 offset:8192
    ds_read_b64_tr_b16 a[6:7], v11 offset:9216
    ds_read_b64_tr_b16 a[116:117], v11 offset:8200
    ds_read_b64_tr_b16 a[118:119], v11 offset:9224
    ds_read_b64_tr_b16 a[8:9], v11 offset:16384
    ds_read_b64_tr_b16 a[10:11], v11 offset:17408
    ds_read_b64_tr_b16 a[120:121], v11 offset:16392
    ds_read_b64_tr_b16 a[122:123], v11 offset:17416
    ds_read_b64_tr_b16 a[12:13], v11 offset:24576
    ds_read_b64_tr_b16 a[14:15], v11 offset:25600
    s_waitcnt lgkmcnt(0)
    ds_read_b64_tr_b16 a[124:125], v11 offset:24584
    ds_read_b64_tr_b16 a[126:127], v11 offset:25608
    ds_read_b64_tr_b16 a[16:17], v11 offset:32768
    ds_read_b64_tr_b16 a[18:19], v11 offset:33792
    ds_read_b64_tr_b16 a[128:129], v11 offset:32776
    ds_read_b64_tr_b16 a[130:131], v11 offset:33800
    ds_read_b64_tr_b16 a[20:21], v11 offset:40960
    ds_read_b64_tr_b16 a[22:23], v11 offset:41984
    ds_read_b64_tr_b16 a[132:133], v11 offset:40968
    ds_read_b64_tr_b16 a[134:135], v11 offset:41992
    ds_read_b64_tr_b16 a[24:25], v11 offset:49152
    ds_read_b64_tr_b16 a[26:27], v11 offset:50176
    ds_read_b64_tr_b16 a[136:137], v11 offset:49160
    ds_read_b64_tr_b16 a[138:139], v11 offset:50184
    s_waitcnt lgkmcnt(0)
    ds_read_b64_tr_b16 a[28:29], v11 offset:57344
    ds_read_b64_tr_b16 a[30:31], v11 offset:58368
    ds_read_b64_tr_b16 a[140:141], v11 offset:57352
    ds_read_b64_tr_b16 a[142:143], v11 offset:58376
    s_waitcnt lgkmcnt(0)
    s_barrier
    s_mul_i32 s37, s30, 65536
    s_add_u32 s37, s37, s68
    s_add_u32 s37, s37, 524288
    s_mul_i32 s38, s30, 16384
    s_add_u32 s38, s38, 0
    s_mov_b32 m0, s38
    s_add_u32 s38, s38, 1024
    buffer_load_dwordx4 v8, s[8:11], s37 offen lds
    s_add_u32 s37, s37, 4096
    s_mov_b32 m0, s38
    s_add_u32 s38, s38, 1024
    buffer_load_dwordx4 v8, s[8:11], s37 offen lds
    s_add_u32 s37, s37, 4096
    s_mov_b32 m0, s38
    s_add_u32 s38, s38, 1024
    buffer_load_dwordx4 v8, s[8:11], s37 offen lds
    s_add_u32 s37, s37, 4096
    s_mov_b32 m0, s38
    s_add_u32 s38, s38, 1024
    buffer_load_dwordx4 v8, s[8:11], s37 offen lds
    s_add_u32 s37, s37, 4096
    s_mov_b32 m0, s38
    s_add_u32 s38, s38, 1024
    buffer_load_dwordx4 v8, s[8:11], s37 offen lds
    s_add_u32 s37, s37, 4096
    s_mov_b32 m0, s38
    s_add_u32 s38, s38, 1024
    buffer_load_dwordx4 v8, s[8:11], s37 offen lds
    s_add_u32 s37, s37, 4096
    s_mov_b32 m0, s38
    s_add_u32 s38, s38, 1024
    buffer_load_dwordx4 v8, s[8:11], s37 offen lds
    s_add_u32 s37, s37, 4096
    s_mov_b32 m0, s38
    s_add_u32 s38, s38, 1024
    buffer_load_dwordx4 v8, s[8:11], s37 offen lds
    s_add_u32 s37, s37, 4096
    s_mov_b32 m0, s38
    s_add_u32 s38, s38, 1024
    buffer_load_dwordx4 v8, s[8:11], s37 offen lds
    s_add_u32 s37, s37, 4096
    s_mov_b32 m0, s38
    s_add_u32 s38, s38, 1024
    buffer_load_dwordx4 v8, s[8:11], s37 offen lds
    s_add_u32 s37, s37, 4096
    s_mov_b32 m0, s38
    s_add_u32 s38, s38, 1024
    buffer_load_dwordx4 v8, s[8:11], s37 offen lds
    s_add_u32 s37, s37, 4096
    s_mov_b32 m0, s38
    s_add_u32 s38, s38, 1024
    buffer_load_dwordx4 v8, s[8:11], s37 offen lds
    s_add_u32 s37, s37, 4096
    s_mov_b32 m0, s38
    s_add_u32 s38, s38, 1024
    buffer_load_dwordx4 v8, s[8:11], s37 offen lds
    s_add_u32 s37, s37, 4096
    s_mov_b32 m0, s38
    s_add_u32 s38, s38, 1024
    buffer_load_dwordx4 v8, s[8:11], s37 offen lds
    s_add_u32 s37, s37, 4096
    s_mov_b32 m0, s38
    s_add_u32 s38, s38, 1024
    buffer_load_dwordx4 v8, s[8:11], s37 offen lds
    s_add_u32 s37, s37, 4096
    s_mov_b32 m0, s38
    s_add_u32 s38, s38, 1024
    buffer_load_dwordx4 v8, s[8:11], s37 offen lds
    s_add_u32 s37, s37, 4096
    s_waitcnt vmcnt(16)
    s_barrier
    v_add_u32 v11, 65536, v9
    ds_read_b64_tr_b16 a[32:33], v11 offset:0
    ds_read_b64_tr_b16 a[34:35], v11 offset:1024
    ds_read_b64_tr_b16 a[144:145], v11 offset:8
    ds_read_b64_tr_b16 a[146:147], v11 offset:1032
    ds_read_b64_tr_b16 a[36:37], v11 offset:8192
    ds_read_b64_tr_b16 a[38:39], v11 offset:9216
    ds_read_b64_tr_b16 a[148:149], v11 offset:8200
    ds_read_b64_tr_b16 a[150:151], v11 offset:9224
    ds_read_b64_tr_b16 a[40:41], v11 offset:16384
    ds_read_b64_tr_b16 a[42:43], v11 offset:17408
    ds_read_b64_tr_b16 a[152:153], v11 offset:16392
    ds_read_b64_tr_b16 a[154:155], v11 offset:17416
    ds_read_b64_tr_b16 a[44:45], v11 offset:24576
    ds_read_b64_tr_b16 a[46:47], v11 offset:25600
    s_waitcnt lgkmcnt(0)
    ds_read_b64_tr_b16 a[156:157], v11 offset:24584
    ds_read_b64_tr_b16 a[158:159], v11 offset:25608
    ds_read_b64_tr_b16 a[48:49], v11 offset:32768
    ds_read_b64_tr_b16 a[50:51], v11 offset:33792
    ds_read_b64_tr_b16 a[160:161], v11 offset:32776
    ds_read_b64_tr_b16 a[162:163], v11 offset:33800
    ds_read_b64_tr_b16 a[52:53], v11 offset:40960
    ds_read_b64_tr_b16 a[54:55], v11 offset:41984
    ds_read_b64_tr_b16 a[164:165], v11 offset:40968
    ds_read_b64_tr_b16 a[166:167], v11 offset:41992
    ds_read_b64_tr_b16 a[56:57], v11 offset:49152
    ds_read_b64_tr_b16 a[58:59], v11 offset:50176
    ds_read_b64_tr_b16 a[168:169], v11 offset:49160
    ds_read_b64_tr_b16 a[170:171], v11 offset:50184
    s_waitcnt lgkmcnt(0)
    ds_read_b64_tr_b16 a[60:61], v11 offset:57344
    ds_read_b64_tr_b16 a[62:63], v11 offset:58368
    ds_read_b64_tr_b16 a[172:173], v11 offset:57352
    ds_read_b64_tr_b16 a[174:175], v11 offset:58376
    s_waitcnt lgkmcnt(0)
    s_barrier
    s_mul_i32 s37, s30, 32768
    s_add_u32 s37, s37, s68
    s_add_u32 s37, s37, 786432
    s_mul_i32 s38, s30, 8192
    s_add_u32 s38, s38, 65536
    s_mov_b32 m0, s38
    s_add_u32 s38, s38, 1024
    buffer_load_dwordx4 v8, s[8:11], s37 offen lds
    s_add_u32 s37, s37, 4096
    s_mov_b32 m0, s38
    s_add_u32 s38, s38, 1024
    buffer_load_dwordx4 v8, s[8:11], s37 offen lds
    s_add_u32 s37, s37, 4096
    s_mov_b32 m0, s38
    s_add_u32 s38, s38, 1024
    buffer_load_dwordx4 v8, s[8:11], s37 offen lds
    s_add_u32 s37, s37, 4096
    s_mov_b32 m0, s38
    s_add_u32 s38, s38, 1024
    buffer_load_dwordx4 v8, s[8:11], s37 offen lds
    s_add_u32 s37, s37, 4096
    s_mov_b32 m0, s38
    s_add_u32 s38, s38, 1024
    buffer_load_dwordx4 v8, s[8:11], s37 offen lds
    s_add_u32 s37, s37, 4096
    s_mov_b32 m0, s38
    s_add_u32 s38, s38, 1024
    buffer_load_dwordx4 v8, s[8:11], s37 offen lds
    s_add_u32 s37, s37, 4096
    s_mov_b32 m0, s38
    s_add_u32 s38, s38, 1024
    buffer_load_dwordx4 v8, s[8:11], s37 offen lds
    s_add_u32 s37, s37, 4096
    s_mov_b32 m0, s38
    s_add_u32 s38, s38, 1024
    buffer_load_dwordx4 v8, s[8:11], s37 offen lds
    s_add_u32 s37, s37, 4096
    s_waitcnt vmcnt(8)
    s_barrier
    v_add_u32 v11, 0, v9
    ds_read_b64_tr_b16 a[64:65], v11 offset:0
    ds_read_b64_tr_b16 a[66:67], v11 offset:1024
    ds_read_b64_tr_b16 a[176:177], v11 offset:8
    ds_read_b64_tr_b16 a[178:179], v11 offset:1032
    ds_read_b64_tr_b16 a[68:69], v11 offset:8192
    ds_read_b64_tr_b16 a[70:71], v11 offset:9216
    ds_read_b64_tr_b16 a[180:181], v11 offset:8200
    ds_read_b64_tr_b16 a[182:183], v11 offset:9224
    ds_read_b64_tr_b16 a[72:73], v11 offset:16384
    ds_read_b64_tr_b16 a[74:75], v11 offset:17408
    ds_read_b64_tr_b16 a[184:185], v11 offset:16392
    ds_read_b64_tr_b16 a[186:187], v11 offset:17416
    ds_read_b64_tr_b16 a[76:77], v11 offset:24576
    ds_read_b64_tr_b16 a[78:79], v11 offset:25600
    s_waitcnt lgkmcnt(0)
    ds_read_b64_tr_b16 a[188:189], v11 offset:24584
    ds_read_b64_tr_b16 a[190:191], v11 offset:25608
    ds_read_b64_tr_b16 a[80:81], v11 offset:32768
    ds_read_b64_tr_b16 a[82:83], v11 offset:33792
    ds_read_b64_tr_b16 a[192:193], v11 offset:32776
    ds_read_b64_tr_b16 a[194:195], v11 offset:33800
    ds_read_b64_tr_b16 a[84:85], v11 offset:40960
    ds_read_b64_tr_b16 a[86:87], v11 offset:41984
    ds_read_b64_tr_b16 a[196:197], v11 offset:40968
    ds_read_b64_tr_b16 a[198:199], v11 offset:41992
    ds_read_b64_tr_b16 a[88:89], v11 offset:49152
    ds_read_b64_tr_b16 a[90:91], v11 offset:50176
    ds_read_b64_tr_b16 a[200:201], v11 offset:49160
    ds_read_b64_tr_b16 a[202:203], v11 offset:50184
    s_waitcnt lgkmcnt(0)
    ds_read_b64_tr_b16 a[92:93], v11 offset:57344
    ds_read_b64_tr_b16 a[94:95], v11 offset:58368
    ds_read_b64_tr_b16 a[204:205], v11 offset:57352
    ds_read_b64_tr_b16 a[206:207], v11 offset:58376
    s_waitcnt lgkmcnt(0)
    s_barrier
    s_waitcnt vmcnt(0)
    s_barrier
    v_add_u32 v11, 65536, v9
    ds_read_b64_tr_b16 a[96:97], v11 offset:0
    ds_read_b64_tr_b16 a[98:99], v11 offset:1024
    ds_read_b64_tr_b16 a[208:209], v11 offset:8
    ds_read_b64_tr_b16 a[210:211], v11 offset:1032
    ds_read_b64_tr_b16 a[100:101], v11 offset:8192
    ds_read_b64_tr_b16 a[102:103], v11 offset:9216
    ds_read_b64_tr_b16 a[212:213], v11 offset:8200
    ds_read_b64_tr_b16 a[214:215], v11 offset:9224
    ds_read_b64_tr_b16 a[104:105], v11 offset:16384
    ds_read_b64_tr_b16 a[106:107], v11 offset:17408
    ds_read_b64_tr_b16 a[216:217], v11 offset:16392
    ds_read_b64_tr_b16 a[218:219], v11 offset:17416
    ds_read_b64_tr_b16 a[108:109], v11 offset:24576
    ds_read_b64_tr_b16 a[110:111], v11 offset:25600
    s_waitcnt lgkmcnt(0)
    ds_read_b64_tr_b16 a[220:221], v11 offset:24584
    ds_read_b64_tr_b16 a[222:223], v11 offset:25608
    s_waitcnt lgkmcnt(0)
    s_barrier
    v_and_b32 v5, 31, v1
    v_lshlrev_b32 v2, 2, v5
    v_lshrrev_b32 v5, 5, v1
    v_lshl_add_u32 v2, v5, 7, v2
    s_mov_b32 s63, 1792
    s_and_b32 s36, s31, 7
    s_lshl_b32 s36, s36, 2
    s_mul_i32 s37, s64, 768
    s_add_u32 s36, s36, s37
    s_add_u32 s62, s36, 2048
    s_cmp_lg_u32 s30, 0
    s_cbranch_scc1 L_pw_ok_idf2
    s_mov_b32 s36, 0
    v_mov_b32 v120, 32
L_pw_idf2:
    buffer_load_dword v121, v120, s[24:27], 0 offen sc1
    s_waitcnt vmcnt(0)
    v_readfirstlane_b32 s37, v121
    s_nop 3
    s_cmp_ge_u32 s37, 256
    s_cbranch_scc1 L_pw_ok_idf2
    s_sleep 4
    s_add_u32 s36, s36, 1
    s_cmp_lt_u32 s36, 65536
    s_cbranch_scc1 L_pw_idf2
    s_mov_b32 s33, 1
L_pw_ok_idf2:
    s_barrier
    s_mov_b32 s41, 0
    s_mov_b32 s58, 0
    s_mov_b32 s42, 0
    s_mov_b32 s59, 0
    s_mov_b32 s49, 0
    s_mov_b32 s50, 0
    s_mov_b32 s52, 0
    s_mov_b32 s53, 0
    s_mov_b32 s43, 0
    s_mov_b32 s44, 0
    s_mov_b32 s47, 0
    s_mov_b32 s48, 0
    s_mov_b32 s51, 163328
    v_cmp_lt_u32 s[88:89], 31, v1
    v_and_b32 v15, 31, v1
    v_subrev_u32 v15, s67, v15
    v_cmp_gt_u32 vcc, 14, v15
    s_nop 1
    v_cndmask_b32 v15, 0, 1, vcc
    s_mov_b32 s96, 0
L_f2_cold:
    s_waitcnt vmcnt(0)
    s_barrier
    s_cmp_eq_u32 s43, s52
    s_cbranch_scc1 L_f2_nopub2
    v_mov_b32 v5, s44
    v_mov_b32 v6, 0
    s_mov_b64 exec, 1
    s_cmp_lg_u32 s30, 0
    s_cbranch_scc1 L_pub_29_d
    s_lshl_b32 s36, s43, 7
    s_add_u32 s36, s36, s62
    buffer_store_dword v5, v6, s[4:7], s36 offen sc1
    s_branch L_pub_29_e
L_pub_29_d:
    buffer_store_dword v5, v6, s[4:7], s97 offen
L_pub_29_e:
    s_mov_b64 exec, -1
L_f2_nopub2:
    v_mov_b32 v5, s53
    v_mov_b32 v6, 0
    s_mov_b64 exec, 1
    s_cmp_lg_u32 s30, 0
    s_cbranch_scc1 L_pub_30_d
    s_lshl_b32 s36, s52, 7
    s_add_u32 s36, s36, s62
    buffer_store_dword v5, v6, s[4:7], s36 offen sc1
    s_branch L_pub_30_e
L_pub_30_d:
    buffer_store_dword v5, v6, s[4:7], s97 offen
L_pub_30_e:
    s_mov_b64 exec, -1
    s_mov_b32 s43, s52
    s_mov_b32 s44, s53
    s_mov_b32 s40, 0
    s_add_u32 s36, s41, s42
    s_cmp_ge_u32 s36, 64
    s_cbranch_scc1 L_f2_exit
    s_cmp_lg_u32 s30, 0
    s_cbranch_scc1 L_f2_cwait
    s_waitcnt vmcnt(0)
    buffer_load_dword v12, v2, s[4:7], s63 offen sc1
    s_nop 15
    s_nop 15
    s_nop 15
    s_nop 15
    s_nop 15
    s_nop 15
L_f2_w0spin:
    buffer_load_dword v13, v2, s[4:7], s63 offen sc1
    s_waitcnt vmcnt(1)
    v_mov_b32 v4, v12
    s_cmp_ge_u32 s41, 32
    s_cbranch_scc1 L_f2_p_try1
    s_lshl_b32 s48, s41, 1
    s_add_u32 s48, s48, s64
    s_add_u32 s54, s48, 1
    s_add_u32 s36, s67, 0
    v_subrev_u32 v7, s36, v1
    v_cmp_gt_u32 vcc, 14, v7
    v_mov_b32 v6, s54
    s_nop 0
    v_cndmask_b32 v7, 0, v6, vcc
    v_cmp_lt_u32 vcc, v4, v7
    s_nop 1
    s_cmp_eq_u64 vcc, 0
    s_cbranch_scc1 L_f2_p_done
L_f2_p_try1:
    s_cmp_ge_u32 s42, 32
    s_cbranch_scc1 L_f2_p_try2
    s_lshl_b32 s48, s42, 1
    s_add_u32 s48, s48, s64
    s_add_u32 s54, s48, 1
    s_add_u32 s36, s67, 32
    v_subrev_u32 v7, s36, v1
    v_cmp_gt_u32 vcc, 14, v7
    v_mov_b32 v6, s54
    s_nop 0
    v_cndmask_b32 v7, 0, v6, vcc
    v_cmp_lt_u32 vcc, v4, v7
    s_nop 1
    s_cmp_eq_u64 vcc, 0
    s_cbranch_scc1 L_f2_p_done
L_f2_p_try2:
    s_cmp_lg_u32 s47, s47
L_f2_p_done:
    s_cbranch_scc1 L_f2_w0got
    buffer_load_dword v12, v2, s[4:7], s63 offen sc1
    s_waitcnt vmcnt(1)
    v_mov_b32 v4, v13
    s_cmp_ge_u32 s41, 32
    s_cbranch_scc1 L_f2_q_try1
    s_lshl_b32 s48, s41, 1
    s_add_u32 s48, s48, s64
    s_add_u32 s54, s48, 1
    s_add_u32 s36, s67, 0
    v_subrev_u32 v7, s36, v1
    v_cmp_gt_u32 vcc, 14, v7
    v_mov_b32 v6, s54
    s_nop 0
    v_cndmask_b32 v7, 0, v6, vcc
    v_cmp_lt_u32 vcc, v4, v7
    s_nop 1
    s_cmp_eq_u64 vcc, 0
    s_cbranch_scc1 L_f2_q_done
L_f2_q_try1:
    s_cmp_ge_u32 s42, 32
    s_cbranch_scc1 L_f2_q_try2
    s_lshl_b32 s48, s42, 1
    s_add_u32 s48, s48, s64
    s_add_u32 s54, s48, 1
    s_add_u32 s36, s67, 32
    v_subrev_u32 v7, s36, v1
    v_cmp_gt_u32 vcc, 14, v7
    v_mov_b32 v6, s54
    s_nop 0
    v_cndmask_b32 v7, 0, v6, vcc
    v_cmp_lt_u32 vcc, v4, v7
    s_nop 1
    s_cmp_eq_u64 vcc, 0
    s_cbranch_scc1 L_f2_q_done
L_f2_q_try2:
    s_cmp_lg_u32 s47, s47
L_f2_q_done:
    s_cbranch_scc1 L_f2_w0got
    s_add_u32 s40, s40, 1
    s_cmp_lt_u32 s40, s35
    s_cbranch_scc1 L_f2_w0spin
L_f2_w0got:
    v_lshlrev_b32 v5, 2, v1
    v_add_u32 v5, s51, v5
    ds_write_b32 v5, v4
    s_waitcnt lgkmcnt(0)
L_f2_cwait:
    s_barrier
    v_lshlrev_b32 v5, 2, v1
    v_add_u32 v5, s51, v5
    ds_read_b32 v4, v5
    s_xor_b32 s51, s51, 256
    s_waitcnt lgkmcnt(0)
    s_cmp_ge_u32 s41, 32
    s_cbranch_scc1 L_f2_c_try1
    s_lshl_b32 s48, s41, 1
    s_add_u32 s48, s48, s64
    s_add_u32 s54, s48, 1
    s_add_u32 s36, s67, 0
    v_subrev_u32 v7, s36, v1
    v_cmp_gt_u32 vcc, 14, v7
    v_mov_b32 v6, s54
    s_nop 0
    v_cndmask_b32 v7, 0, v6, vcc
    v_cmp_lt_u32 vcc, v4, v7
    s_nop 1
    s_cmp_eq_u64 vcc, 0
    s_cbranch_scc0 L_f2_c_try1
    s_mov_b32 s47, 0
    s_add_u32 s41, s41, 1
    s_cmp_eq_u32 s47, s47
    s_branch L_f2_c_done
L_f2_c_try1:
    s_cmp_ge_u32 s42, 32
    s_cbranch_scc1 L_f2_c_try2
    s_lshl_b32 s48, s42, 1
    s_add_u32 s48, s48, s64
    s_add_u32 s54, s48, 1
    s_add_u32 s36, s67, 32
    v_subrev_u32 v7, s36, v1
    v_cmp_gt_u32 vcc, 14, v7
    v_mov_b32 v6, s54
    s_nop 0
    v_cndmask_b32 v7, 0, v6, vcc
    v_cmp_lt_u32 vcc, v4, v7
    s_nop 1
    s_cmp_eq_u64 vcc, 0
    s_cbranch_scc0 L_f2_c_try2
    s_mov_b32 s47, 1
    s_add_u32 s42, s42, 1
    s_cmp_eq_u32 s47, s47
    s_branch L_f2_c_done
L_f2_c_try2:
    s_cmp_lg_u32 s47, s47
L_f2_c_done:
    s_cbranch_scc1 L_f2_got
    s_mov_b32 s33, 1
    s_branch L_f2_exit
L_f2_got:
    s_lshl_b32 s36, s47, 23
    s_mul_i32 s37, s48, 114688
    s_add_u32 s36, s36, s37
    s_add_u32 s36, s36, 0x8800000
    s_mul_i32 s37, s65, 28672
    s_add_u32 s36, s36, s37
    s_lshr_b32 s37, s30, 1
    s_mul_i32 s38, s37, 57344
    s_add_u32 s36, s36, s38
    s_mul_i32 s38, s37, 28672
    s_and_b32 s37, s30, 1
    s_mul_i32 s37, s37, 14336
    s_add_u32 s60, s36, s37
    s_add_u32 s37, s37, s38
    s_add_u32 s61, s37, s50
    s_mov_b32 m0, s61
    s_add_u32 s61, s61, 1024
    buffer_load_dwordx4 v0, s[4:7], s60 offen sc1 lds
    s_add_u32 s60, s60, 1024
    s_mov_b32 m0, s61
    s_add_u32 s61, s61, 1024
    buffer_load_dwordx4 v0, s[4:7], s60 offen sc1 lds
    s_add_u32 s60, s60, 1024
    s_mov_b32 m0, s61
    s_add_u32 s61, s61, 1024
    buffer_load_dwordx4 v0, s[4:7], s60 offen sc1 lds
    s_add_u32 s60, s60, 1024
    s_mov_b32 m0, s61
    s_add_u32 s61, s61, 1024
    buffer_load_dwordx4 v0, s[4:7], s60 offen sc1 lds
    s_add_u32 s60, s60, 1024
    s_mov_b32 m0, s61
    s_add_u32 s61, s61, 1024
    buffer_load_dwordx4 v0, s[4:7], s60 offen sc1 lds
    s_add_u32 s60, s60, 1024
    s_mov_b32 m0, s61
    s_add_u32 s61, s61, 1024
    buffer_load_dwordx4 v0, s[4:7], s60 offen sc1 lds
    s_add_u32 s60, s60, 1024
    s_mov_b32 m0, s61
    s_add_u32 s61, s61, 1024
    buffer_load_dwordx4 v0, s[4:7], s60 offen sc1 lds
    s_add_u32 s60, s60, 1024
    s_mov_b32 m0, s61
    s_add_u32 s61, s61, 1024
    buffer_load_dwordx4 v0, s[4:7], s60 offen sc1 lds
    s_add_u32 s60, s60, 1024
    s_mov_b32 m0, s61
    s_add_u32 s61, s61, 1024
    buffer_load_dwordx4 v0, s[4:7], s60 offen sc1 lds
    s_add_u32 s60, s60, 1024
    s_mov_b32 m0, s61
    s_add_u32 s61, s61, 1024
    buffer_load_dwordx4 v0, s[4:7], s60 offen sc1 lds
    s_add_u32 s60, s60, 1024
    s_mov_b32 m0, s61
    s_add_u32 s61, s61, 1024
    buffer_load_dwordx4 v0, s[4:7], s60 offen sc1 lds
    s_add_u32 s60, s60, 1024
    s_mov_b32 m0, s61
    s_add_u32 s61, s61, 1024
    buffer_load_dwordx4 v0, s[4:7], s60 offen sc1 lds
    s_add_u32 s60, s60, 1024
    s_mov_b32 m0, s61
    s_add_u32 s61, s61, 1024
    buffer_load_dwordx4 v0, s[4:7], s60 offen sc1 lds
    s_add_u32 s60, s60, 1024
    s_mov_b32 m0, s61
    s_add_u32 s61, s61, 1024
    buffer_load_dwordx4 v0, s[4:7], s60 offen sc1 lds
    s_add_u32 s60, s60, 1024
    s_mov_b32 m0, s51
    s_nop 0
    buffer_load_dword v2, s[4:7], s63 offen sc1 lds
    s_mov_b32 s45, s47
    s_mov_b32 s46, s48
    s_waitcnt vmcnt(0)
    s_barrier
    v_add_u32 v8, s50, v0
    ds_read_b128 v[32:35], v8 offset:0
    ds_read_b128 v[36:39], v8 offset:28672
    ds_read_b128 v[40:43], v8 offset:1024
    ds_read_b128 v[44:47], v8 offset:29696
    v_lshlrev_b32 v5, 2, v1
    v_add_u32 v5, s51, v5
    ds_read_b32 v4, v5
    s_xor_b32 s51, s51, 256
L_f2_main:
    s_waitcnt lgkmcnt(3)
    v_mfma_f32_16x16x32_bf16 v[16:19], a[0:3], v[32:35], 0
    ds_read_b128 v[48:51], v8 offset:2048
    ds_read_b128 v[52:55], v8 offset:30720
    v_mfma_f32_16x16x32_bf16 v[20:23], a[112:115], v[32:35], 0
    s_lshl_b32 s86, s41, 1
    s_add_u32 s86, s86, s64
    v_mfma_f32_16x16x32_bf16 v[24:27], a[0:3], v[36:39], 0
    s_lshl_b32 s87, s42, 1
    s_add_u32 s87, s87, s64
    v_mfma_f32_16x16x32_bf16 v[28:31], a[112:115], v[36:39], 0
    s_waitcnt lgkmcnt(3)
    v_mfma_f32_16x16x32_bf16 v[16:19], a[4:7], v[40:43], v[16:19]
    ds_read_b128 v[32:35], v8 offset:3072
    v_mfma_f32_16x16x32_bf16 v[20:23], a[116:119], v[40:43], v[20:23]
    ds_read_b128 v[36:39], v8 offset:31744
    v_mfma_f32_16x16x32_bf16 v[24:27], a[4:7], v[44:47], v[24:27]
    v_mfma_f32_16x16x32_bf16 v[28:31], a[116:119], v[44:47], v[28:31]
    s_waitcnt lgkmcnt(2)
    v_mfma_f32_16x16x32_bf16 v[16:19], a[8:11], v[48:51], v[16:19]
    ds_read_b128 v[40:43], v8 offset:4096
    ds_read_b128 v[44:47], v8 offset:32768
    v_mfma_f32_16x16x32_bf16 v[20:23], a[120:123], v[48:51], v[20:23]
    v_mov_b32 v6, s86
    v_mov_b32 v7, s87
    v_mfma_f32_16x16x32_bf16 v[24:27], a[8:11], v[52:55], v[24:27]
    v_cndmask_b32 v6, v6, v7, s[88:89]
    v_add_u32 v6, 1, v6
    v_mfma_f32_16x16x32_bf16 v[28:31], a[120:123], v[52:55], v[28:31]
    v_mul_u32_u24 v7, v6, v15
    v_cmp_lt_u32 vcc, v4, v7
    s_waitcnt lgkmcnt(2)
    v_mfma_f32_16x16x32_bf16 v[16:19], a[12:15], v[32:35], v[16:19]
    ds_read_b128 v[48:51], v8 offset:5120
    v_mfma_f32_16x16x32_bf16 v[20:23], a[124:127], v[32:35], v[20:23]
    ds_read_b128 v[52:55], v8 offset:33792
    v_mfma_f32_16x16x32_bf16 v[24:27], a[12:15], v[36:39], v[24:27]
    v_mfma_f32_16x16x32_bf16 v[28:31], a[124:127], v[36:39], v[28:31]
    s_cmp_eq_u32 vcc_lo, 0
    s_cselect_b32 s54, 1, 0
    s_cmp_lt_u32 s41, 32
    s_cselect_b32 s54, s54, 0
    s_cmp_eq_u32 vcc_hi, 0
    s_cselect_b32 s55, 1, 0
    s_cmp_lt_u32 s42, 32
    s_cselect_b32 s55, s55, 0
    s_or_b32 s49, s54, s55
    s_cmp_eq_u32 s54, 1
    s_cselect_b32 s47, 0, 1
    s_cselect_b32 s48, s86, s87
    s_cselect_b32 s55, 0, s55
    s_add_u32 s41, s41, s54
    s_add_u32 s42, s42, s55
    s_cmp_eq_u32 s49, 0
    s_cbranch_scc1 L_f2_nopf
    s_xor_b32 s57, s50, 65536
    s_lshl_b32 s36, s47, 23
    s_mul_i32 s37, s48, 114688
    s_add_u32 s36, s36, s37
    s_add_u32 s36, s36, 0x8800000
    s_mul_i32 s37, s65, 28672
    s_add_u32 s36, s36, s37
    s_lshr_b32 s37, s30, 1
    s_mul_i32 s38, s37, 57344
    s_add_u32 s36, s36, s38
    s_mul_i32 s38, s37, 28672
    s_and_b32 s37, s30, 1
    s_mul_i32 s37, s37, 14336
    s_add_u32 s60, s36, s37
    s_add_u32 s37, s37, s38
    s_add_u32 s61, s37, s57
    s_waitcnt lgkmcnt(2)
    v_mfma_f32_16x16x32_bf16 v[16:19], a[16:19], v[40:43], v[16:19]
    ds_read_b128 v[32:35], v8 offset:6144
    ds_read_b128 v[36:39], v8 offset:34816
    v_mfma_f32_16x16x32_bf16 v[20:23], a[128:131], v[40:43], v[20:23]
    s_mov_b32 m0, s61
    s_add_u32 s61, s61, 1024
    v_mfma_f32_16x16x32_bf16 v[24:27], a[16:19], v[44:47], v[24:27]
    buffer_load_dwordx4 v0, s[4:7], s60 offen sc1 lds
    s_add_u32 s60, s60, 1024
    v_mfma_f32_16x16x32_bf16 v[28:31], a[128:131], v[44:47], v[28:31]
    s_waitcnt lgkmcnt(2)
    v_mfma_f32_16x16x32_bf16 v[16:19], a[20:23], v[48:51], v[16:19]
    ds_read_b128 v[40:43], v8 offset:7168
    ds_read_b128 v[44:47], v8 offset:35840
    v_mfma_f32_16x16x32_bf16 v[20:23], a[132:135], v[48:51], v[20:23]
    s_mov_b32 m0, s61
    s_add_u32 s61, s61, 1024
    v_mfma_f32_16x16x32_bf16 v[24:27], a[20:23], v[52:55], v[24:27]
    buffer_load_dwordx4 v0, s[4:7], s60 offen sc1 lds
    s_add_u32 s60, s60, 1024
    v_mfma_f32_16x16x32_bf16 v[28:31], a[132:135], v[52:55], v[28:31]
    s_waitcnt lgkmcnt(2)
    v_mfma_f32_16x16x32_bf16 v[16:19], a[24:27], v[32:35], v[16:19]
    ds_read_b128 v[48:51], v8 offset:8192
    ds_read_b128 v[52:55], v8 offset:36864
    v_mfma_f32_16x16x32_bf16 v[20:23], a[136:139], v[32:35], v[20:23]
    s_mov_b32 m0, s61
    s_add_u32 s61, s61, 1024
    v_mfma_f32_16x16x32_bf16 v[24:27], a[24:27], v[36:39], v[24:27]
    buffer_load_dwordx4 v0, s[4:7], s60 offen sc1 lds
    s_add_u32 s60, s60, 1024
    v_mfma_f32_16x16x32_bf16 v[28:31], a[136:139], v[36:39], v[28:31]
    s_waitcnt lgkmcnt(2)
    v_mfma_f32_16x16x32_bf16 v[16:19], a[28:31], v[40:43], v[16:19]
    ds_read_b128 v[32:35], v8 offset:9216
    ds_read_b128 v[36:39], v8 offset:37888
    v_mfma_f32_16x16x32_bf16 v[20:23], a[140:143], v[40:43], v[20:23]
    s_mov_b32 m0, s61
    s_add_u32 s61, s61, 1024
    v_mfma_f32_16x16x32_bf16 v[24:27], a[28:31], v[44:47], v[24:27]
    buffer_load_dwordx4 v0, s[4:7], s60 offen sc1 lds
    s_add_u32 s60, s60, 1024
    v_mfma_f32_16x16x32_bf16 v[28:31], a[140:143], v[44:47], v[28:31]
    s_waitcnt lgkmcnt(2)
    v_mfma_f32_16x16x32_bf16 v[16:19], a[32:35], v[48:51], v[16:19]
    ds_read_b128 v[40:43], v8 offset:10240
    ds_read_b128 v[44:47], v8 offset:38912
    v_mfma_f32_16x16x32_bf16 v[20:23], a[144:147], v[48:51], v[20:23]
    s_mov_b32 m0, s61
    s_add_u32 s61, s61, 1024
    v_mfma_f32_16x16x32_bf16 v[24:27], a[32:35], v[52:55], v[24:27]
    buffer_load_dwordx4 v0, s[4:7], s60 offen sc1 lds
    s_add_u32 s60, s60, 1024
    v_mfma_f32_16x16x32_bf16 v[28:31], a[144:147], v[52:55], v[28:31]
    s_waitcnt lgkmcnt(2)
    v_mfma_f32_16x16x32_bf16 v[16:19], a[36:39], v[32:35], v[16:19]
    ds_read_b128 v[48:51], v8 offset:11264
    ds_read_b128 v[52:55], v8 offset:39936
    v_mfma_f32_16x16x32_bf16 v[20:23], a[148:151], v[32:35], v[20:23]
    s_mov_b32 m0, s61
    s_add_u32 s61, s61, 1024
    v_mfma_f32_16x16x32_bf16 v[24:27], a[36:39], v[36:39], v[24:27]
    buffer_load_dwordx4 v0, s[4:7], s60 offen sc1 lds
    s_add_u32 s60, s60, 1024
    v_mfma_f32_16x16x32_bf16 v[28:31], a[148:151], v[36:39], v[28:31]
    s_waitcnt lgkmcnt(2)
    v_mfma_f32_16x16x32_bf16 v[16:19], a[40:43], v[40:43], v[16:19]
    ds_read_b128 v[32:35], v8 offset:12288
    ds_read_b128 v[36:39], v8 offset:40960
    v_mfma_f32_16x16x32_bf16 v[20:23], a[152:155], v[40:43], v[20:23]
    s_mov_b32 m0, s61
    s_add_u32 s61, s61, 1024
    v_mfma_f32_16x16x32_bf16 v[24:27], a[40:43], v[44:47], v[24:27]
    buffer_load_dwordx4 v0, s[4:7], s60 offen sc1 lds
    s_add_u32 s60, s60, 1024
    v_mfma_f32_16x16x32_bf16 v[28:31], a[152:155], v[44:47], v[28:31]
    s_waitcnt lgkmcnt(2)
    v_mfma_f32_16x16x32_bf16 v[16:19], a[44:47], v[48:51], v[16:19]
    ds_read_b128 v[40:43], v8 offset:13312
    ds_read_b128 v[44:47], v8 offset:41984
    v_mfma_f32_16x16x32_bf16 v[20:23], a[156:159], v[48:51], v[20:23]
    s_mov_b32 m0, s61
    s_add_u32 s61, s61, 1024
    v_mfma_f32_16x16x32_bf16 v[24:27], a[44:47], v[52:55], v[24:27]
    buffer_load_dwordx4 v0, s[4:7], s60 offen sc1 lds
    s_add_u32 s60, s60, 1024
    v_mfma_f32_16x16x32_bf16 v[28:31], a[156:159], v[52:55], v[28:31]
    s_waitcnt lgkmcnt(2)
    v_mfma_f32_16x16x32_bf16 v[16:19], a[48:51], v[32:35], v[16:19]
    ds_read_b128 v[48:51], v8 offset:14336
    ds_read_b128 v[52:55], v8 offset:43008
    v_mfma_f32_16x16x32_bf16 v[20:23], a[160:163], v[32:35], v[20:23]
    s_mov_b32 m0, s61
    s_add_u32 s61, s61, 1024
    v_mfma_f32_16x16x32_bf16 v[24:27], a[48:51], v[36:39], v[24:27]
    buffer_load_dwordx4 v0, s[4:7], s60 offen sc1 lds
    s_add_u32 s60, s60, 1024
    v_mfma_f32_16x16x32_bf16 v[28:31], a[160:163], v[36:39], v[28:31]
    s_waitcnt lgkmcnt(2)
    v_mfma_f32_16x16x32_bf16 v[16:19], a[52:55], v[40:43], v[16:19]
    ds_read_b128 v[32:35], v8 offset:15360
    ds_read_b128 v[36:39], v8 offset:44032
    v_mfma_f32_16x16x32_bf16 v[20:23], a[164:167], v[40:43], v[20:23]
    s_mov_b32 m0, s61
    s_add_u32 s61, s61, 1024
    v_mfma_f32_16x16x32_bf16 v[24:27], a[52:55], v[44:47], v[24:27]
    buffer_load_dwordx4 v0, s[4:7], s60 offen sc1 lds
    s_add_u32 s60, s60, 1024
    v_mfma_f32_16x16x32_bf16 v[28:31], a[164:167], v[44:47], v[28:31]
    s_waitcnt lgkmcnt(2)
    v_mfma_f32_16x16x32_bf16 v[16:19], a[56:59], v[48:51], v[16:19]
    ds_read_b128 v[40:43], v8 offset:16384
    ds_read_b128 v[44:47], v8 offset:45056
    v_mfma_f32_16x16x32_bf16 v[20:23], a[168:171], v[48:51], v[20:23]
    s_mov_b32 m0, s61
    s_add_u32 s61, s61, 1024
    v_mfma_f32_16x16x32_bf16 v[24:27], a[56:59], v[52:55], v[24:27]
    buffer_load_dwordx4 v0, s[4:7], s60 offen sc1 lds
    s_add_u32 s60, s60, 1024
    v_mfma_f32_16x16x32_bf16 v[28:31], a[168:171], v[52:55], v[28:31]
    s_waitcnt lgkmcnt(2)
    v_mfma_f32_16x16x32_bf16 v[16:19], a[60:63], v[32:35], v[16:19]
    ds_read_b128 v[48:51], v8 offset:17408
    ds_read_b128 v[52:55], v8 offset:46080
    v_mfma_f32_16x16x32_bf16 v[20:23], a[172:175], v[32:35], v[20:23]
    s_mov_b32 m0, s61
    s_add_u32 s61, s61, 1024
    v_mfma_f32_16x16x32_bf16 v[24:27], a[60:63], v[36:39], v[24:27]
    buffer_load_dwordx4 v0, s[4:7], s60 offen sc1 lds
    s_add_u32 s60, s60, 1024
    v_mfma_f32_16x16x32_bf16 v[28:31], a[172:175], v[36:39], v[28:31]
    s_waitcnt lgkmcnt(2)
    v_mfma_f32_16x16x32_bf16 v[16:19], a[64:67], v[40:43], v[16:19]
    ds_read_b128 v[32:35], v8 offset:18432
    ds_read_b128 v[36:39], v8 offset:47104
    v_mfma_f32_16x16x32_bf16 v[20:23], a[176:179], v[40:43], v[20:23]
    s_mov_b32 m0, s61
    s_add_u32 s61, s61, 1024
    v_mfma_f32_16x16x32_bf16 v[24:27], a[64:67], v[44:47], v[24:27]
    buffer_load_dwordx4 v0, s[4:7], s60 offen sc1 lds
    s_add_u32 s60, s60, 1024
    v_mfma_f32_16x16x32_bf16 v[28:31], a[176:179], v[44:47], v[28:31]
    s_waitcnt lgkmcnt(2)
    v_mfma_f32_16x16x32_bf16 v[16:19], a[68:71], v[48:51], v[16:19]
    ds_read_b128 v[40:43], v8 offset:19456
    ds_read_b128 v[44:47], v8 offset:48128
    v_mfma_f32_16x16x32_bf16 v[20:23], a[180:183], v[48:51], v[20:23]
    s_mov_b32 m0, s61
    s_add_u32 s61, s61, 1024
    v_mfma_f32_16x16x32_bf16 v[24:27], a[68:71], v[52:55], v[24:27]
    buffer_load_dwordx4 v0, s[4:7], s60 offen sc1 lds
    s_add_u32 s60, s60, 1024
    v_mfma_f32_16x16x32_bf16 v[28:31], a[180:183], v[52:55], v[28:31]
    s_waitcnt lgkmcnt(2)
    v_mfma_f32_16x16x32_bf16 v[16:19], a[72:75], v[32:35], v[16:19]
    ds_read_b128 v[48:51], v8 offset:20480
    v_mfma_f32_16x16x32_bf16 v[20:23], a[184:187], v[32:35], v[20:23]
    ds_read_b128 v[52:55], v8 offset:49152
    v_mfma_f32_16x16x32_bf16 v[24:27], a[72:75], v[36:39], v[24:27]
    v_mfma_f32_16x16x32_bf16 v[28:31], a[184:187], v[36:39], v[28:31]
    s_waitcnt lgkmcnt(2)
    v_mfma_f32_16x16x32_bf16 v[16:19], a[76:79], v[40:43], v[16:19]
    ds_read_b128 v[32:35], v8 offset:21504
    v_mfma_f32_16x16x32_bf16 v[20:23], a[188:191], v[40:43], v[20:23]
    ds_read_b128 v[36:39], v8 offset:50176
    v_mfma_f32_16x16x32_bf16 v[24:27], a[76:79], v[44:47], v[24:27]
    v_mfma_f32_16x16x32_bf16 v[28:31], a[188:191], v[44:47], v[28:31]
    s_waitcnt lgkmcnt(2)
    v_mfma_f32_16x16x32_bf16 v[16:19], a[80:83], v[48:51], v[16:19]
    ds_read_b128 v[40:43], v8 offset:22528
    ds_read_b128 v[44:47], v8 offset:51200
    v_mfma_f32_16x16x32_bf16 v[20:23], a[192:195], v[48:51], v[20:23]
    s_mov_b32 m0, s51
    s_nop 0
    v_mfma_f32_16x16x32_bf16 v[24:27], a[80:83], v[52:55], v[24:27]
    buffer_load_dword v2, s[4:7], s63 offen sc1 lds
    v_mfma_f32_16x16x32_bf16 v[28:31], a[192:195], v[52:55], v[28:31]
    s_waitcnt lgkmcnt(2)
    v_mfma_f32_16x16x32_bf16 v[16:19], a[84:87], v[32:35], v[16:19]
    ds_read_b128 v[48:51], v8 offset:23552
    v_mfma_f32_16x16x32_bf16 v[20:23], a[196:199], v[32:35], v[20:23]
    ds_read_b128 v[52:55], v8 offset:52224
    v_mfma_f32_16x16x32_bf16 v[24:27], a[84:87], v[36:39], v[24:27]
    v_mfma_f32_16x16x32_bf16 v[28:31], a[196:199], v[36:39], v[28:31]
    s_waitcnt vmcnt(15)
    s_barrier
    v_mov_b32 v5, s53
    v_mov_b32 v6, 0
    s_mov_b64 exec, 1
    s_cmp_lg_u32 s30, 0
    s_cbranch_scc1 L_pub_31_d
    s_lshl_b32 s36, s52, 7
    s_add_u32 s36, s36, s62
    buffer_store_dword v5, v6, s[4:7], s36 offen sc1
    s_branch L_pub_31_e
L_pub_31_d:
    buffer_store_dword v5, v6, s[4:7], s97 offen
L_pub_31_e:
    s_mov_b64 exec, -1
    s_waitcnt lgkmcnt(2)
    v_mfma_f32_16x16x32_bf16 v[16:19], a[88:91], v[40:43], v[16:19]
    ds_read_b128 v[32:35], v8 offset:24576
    v_mfma_f32_16x16x32_bf16 v[20:23], a[200:203], v[40:43], v[20:23]
    ds_read_b128 v[36:39], v8 offset:53248
    v_mfma_f32_16x16x32_bf16 v[24:27], a[88:91], v[44:47], v[24:27]
    v_mfma_f32_16x16x32_bf16 v[28:31], a[200:203], v[44:47], v[28:31]
    s_waitcnt lgkmcnt(2)
    v_mfma_f32_16x16x32_bf16 v[16:19], a[92:95], v[48:51], v[16:19]
    ds_read_b128 v[40:43], v8 offset:25600
    v_mfma_f32_16x16x32_bf16 v[20:23], a[204:207], v[48:51], v[20:23]
    ds_read_b128 v[44:47], v8 offset:54272
    v_mfma_f32_16x16x32_bf16 v[24:27], a[92:95], v[52:55], v[24:27]
    v_mfma_f32_16x16x32_bf16 v[28:31], a[204:207], v[52:55], v[28:31]
    s_waitcnt lgkmcnt(2)
    v_mfma_f32_16x16x32_bf16 v[16:19], a[96:99], v[32:35], v[16:19]
    ds_read_b128 v[48:51], v8 offset:26624
    v_mfma_f32_16x16x32_bf16 v[20:23], a[208:211], v[32:35], v[20:23]
    ds_read_b128 v[52:55], v8 offset:55296
    v_mfma_f32_16x16x32_bf16 v[24:27], a[96:99], v[36:39], v[24:27]
    v_mfma_f32_16x16x32_bf16 v[28:31], a[208:211], v[36:39], v[28:31]
    s_waitcnt lgkmcnt(2)
    v_mfma_f32_16x16x32_bf16 v[16:19], a[100:103], v[40:43], v[16:19]
    ds_read_b128 v[32:35], v8 offset:27648
    v_mfma_f32_16x16x32_bf16 v[20:23], a[212:215], v[40:43], v[20:23]
    ds_read_b128 v[36:39], v8 offset:56320
    v_mfma_f32_16x16x32_bf16 v[24:27], a[100:103], v[44:47], v[24:27]
    v_mfma_f32_16x16x32_bf16 v[28:31], a[212:215], v[44:47], v[28:31]
    s_waitcnt lgkmcnt(2)
    v_mfma_f32_16x16x32_bf16 v[16:19], a[104:107], v[48:51], v[16:19]
    s_lshl_b32 s90, s45, 23
    s_lshl_b32 s91, s46, 1
    s_add_u32 s91, s91, s65
    v_mfma_f32_16x16x32_bf16 v[20:23], a[216:219], v[48:51], v[20:23]
    s_lshl_b32 s91, s91, 15
    s_add_u32 s90, s90, s91
    s_lshl_b32 s91, s66, 2
    v_mfma_f32_16x16x32_bf16 v[24:27], a[104:107], v[52:55], v[24:27]
    s_add_u32 s91, s91, s30
    s_lshl_b32 s91, s91, 10
    s_add_u32 s90, s90, s91
    v_mfma_f32_16x16x32_bf16 v[28:31], a[216:219], v[52:55], v[28:31]
    s_add_u32 s90, s90, 0x9800000
    s_add_u32 s91, s90, 16384
    s_waitcnt lgkmcnt(0)
    v_mfma_f32_16x16x32_bf16 v[16:19], a[108:111], v[32:35], v[16:19]
    v_mfma_f32_16x16x32_bf16 v[20:23], a[220:223], v[32:35], v[20:23]
    v_mfma_f32_16x16x32_bf16 v[24:27], a[108:111], v[36:39], v[24:27]
    v_mfma_f32_16x16x32_bf16 v[28:31], a[220:223], v[36:39], v[28:31]
    s_waitcnt vmcnt(1)
    s_barrier
    s_xor_b32 s50, s50, 65536
    v_add_u32 v8, s50, v0
    ds_read_b128 v[32:35], v8 offset:0
    ds_read_b128 v[36:39], v8 offset:28672
    ds_read_b128 v[40:43], v8 offset:1024
    ds_read_b128 v[44:47], v8 offset:29696
    v_lshlrev_b32 v5, 2, v1
    v_add_u32 v5, s51, v5
    ds_read_b32 v4, v5
    s_xor_b32 s51, s51, 256
    v_cvt_pk_bf16_f32 v56, v16, v17
    v_cvt_pk_bf16_f32 v57, v18, v19
    v_cvt_pk_bf16_f32 v58, v20, v21
    v_cvt_pk_bf16_f32 v59, v22, v23
    buffer_store_dwordx4 v[56:59], v0, s[4:7], s90 offen sc1
    v_cvt_pk_bf16_f32 v60, v24, v25
    v_cvt_pk_bf16_f32 v61, v26, v27
    v_cvt_pk_bf16_f32 v62, v28, v29
    v_cvt_pk_bf16_f32 v63, v30, v31
    buffer_store_dwordx4 v[60:63], v0, s[4:7], s91 offen sc1
    s_mov_b32 s43, s52
    s_mov_b32 s44, s53
    s_cmp_eq_u32 s45, 0
    s_cselect_b32 s36, s58, s59
    s_add_u32 s53, s36, 1
    s_mov_b32 s52, s45
    s_cmp_eq_u32 s45, 0
    s_cselect_b32 s58, s53, s58
    s_cselect_b32 s59, s59, s53
    s_mov_b32 s45, s47
    s_mov_b32 s46, s48
    s_branch L_f2_main
L_f2_nopf:
    s_waitcnt lgkmcnt(2)
    v_mfma_f32_16x16x32_bf16 v[16:19], a[16:19], v[40:43], v[16:19]
    ds_read_b128 v[32:35], v8 offset:6144
    v_mfma_f32_16x16x32_bf16 v[20:23], a[128:131], v[40:43], v[20:23]
    ds_read_b128 v[36:39], v8 offset:34816
    v_mfma_f32_16x16x32_bf16 v[24:27], a[16:19], v[44:47], v[24:27]
    v_mfma_f32_16x16x32_bf16 v[28:31], a[128:131], v[44:47], v[28:31]
    s_waitcnt lgkmcnt(2)
    v_mfma_f32_16x16x32_bf16 v[16:19], a[20:23], v[48:51], v[16:19]
    ds_read_b128 v[40:43], v8 offset:7168
    v_mfma_f32_16x16x32_bf16 v[20:23], a[132:135], v[48:51], v[20:23]
    ds_read_b128 v[44:47], v8 offset:35840
    v_mfma_f32_16x16x32_bf16 v[24:27], a[20:23], v[52:55], v[24:27]
    v_mfma_f32_16x16x32_bf16 v[28:31], a[132:135], v[52:55], v[28:31]
    s_waitcnt lgkmcnt(2)
    v_mfma_f32_16x16x32_bf16 v[16:19], a[24:27], v[32:35], v[16:19]
    ds_read_b128 v[48:51], v8 offset:8192
    v_mfma_f32_16x16x32_bf16 v[20:23], a[136:139], v[32:35], v[20:23]
    ds_read_b128 v[52:55], v8 offset:36864
    v_mfma_f32_16x16x32_bf16 v[24:27], a[24:27], v[36:39], v[24:27]
    v_mfma_f32_16x16x32_bf16 v[28:31], a[136:139], v[36:39], v[28:31]
    s_waitcnt lgkmcnt(2)
    v_mfma_f32_16x16x32_bf16 v[16:19], a[28:31], v[40:43], v[16:19]
    ds_read_b128 v[32:35], v8 offset:9216
    v_mfma_f32_16x16x32_bf16 v[20:23], a[140:143], v[40:43], v[20:23]
    ds_read_b128 v[36:39], v8 offset:37888
    v_mfma_f32_16x16x32_bf16 v[24:27], a[28:31], v[44:47], v[24:27]
    v_mfma_f32_16x16x32_bf16 v[28:31], a[140:143], v[44:47], v[28:31]
    s_waitcnt lgkmcnt(2)
    v_mfma_f32_16x16x32_bf16 v[16:19], a[32:35], v[48:51], v[16:19]
    ds_read_b128 v[40:43], v8 offset:10240
    v_mfma_f32_16x16x32_bf16 v[20:23], a[144:147], v[48:51], v[20:23]
    ds_read_b128 v[44:47], v8 offset:38912
    v_mfma_f32_16x16x32_bf16 v[24:27], a[32:35], v[52:55], v[24:27]
    v_mfma_f32_16x16x32_bf16 v[28:31], a[144:147], v[52:55], v[28:31]
    s_waitcnt lgkmcnt(2)
    v_mfma_f32_16x16x32_bf16 v[16:19], a[36:39], v[32:35], v[16:19]
    ds_read_b128 v[48:51], v8 offset:11264
    v_mfma_f32_16x16x32_bf16 v[20:23], a[148:151], v[32:35], v[20:23]
    ds_read_b128 v[52:55], v8 offset:39936
    v_mfma_f32_16x16x32_bf16 v[24:27], a[36:39], v[36:39], v[24:27]
    v_mfma_f32_16x16x32_bf16 v[28:31], a[148:151], v[36:39], v[28:31]
    s_waitcnt lgkmcnt(2)
    v_mfma_f32_16x16x32_bf16 v[16:19], a[40:43], v[40:43], v[16:19]
    ds_read_b128 v[32:35], v8 offset:12288
    v_mfma_f32_16x16x32_bf16 v[20:23], a[152:155], v[40:43], v[20:23]
    ds_read_b128 v[36:39], v8 offset:40960
    v_mfma_f32_16x16x32_bf16 v[24:27], a[40:43], v[44:47], v[24:27]
    v_mfma_f32_16x16x32_bf16 v[28:31], a[152:155], v[44:47], v[28:31]
    s_waitcnt lgkmcnt(2)
    v_mfma_f32_16x16x32_bf16 v[16:19], a[44:47], v[48:51], v[16:19]
    ds_read_b128 v[40:43], v8 offset:13312
    v_mfma_f32_16x16x32_bf16 v[20:23], a[156:159], v[48:51], v[20:23]
    ds_read_b128 v[44:47], v8 offset:41984
    v_mfma_f32_16x16x32_bf16 v[24:27], a[44:47], v[52:55], v[24:27]
    v_mfma_f32_16x16x32_bf16 v[28:31], a[156:159], v[52:55], v[28:31]
    s_waitcnt lgkmcnt(2)
    v_mfma_f32_16x16x32_bf16 v[16:19], a[48:51], v[32:35], v[16:19]
    ds_read_b128 v[48:51], v8 offset:14336
    v_mfma_f32_16x16x32_bf16 v[20:23], a[160:163], v[32:35], v[20:23]
    ds_read_b128 v[52:55], v8 offset:43008
    v_mfma_f32_16x16x32_bf16 v[24:27], a[48:51], v[36:39], v[24:27]
    v_mfma_f32_16x16x32_bf16 v[28:31], a[160:163], v[36:39], v[28:31]
    s_waitcnt lgkmcnt(2)
    v_mfma_f32_16x16x32_bf16 v[16:19], a[52:55], v[40:43], v[16:19]
    ds_read_b128 v[32:35], v8 offset:15360
    v_mfma_f32_16x16x32_bf16 v[20:23], a[164:167], v[40:43], v[20:23]
    ds_read_b128 v[36:39], v8 offset:44032
    v_mfma_f32_16x16x32_bf16 v[24:27], a[52:55], v[44:47], v[24:27]
    v_mfma_f32_16x16x32_bf16 v[28:31], a[164:167], v[44:47], v[28:31]
    s_waitcnt lgkmcnt(2)
    v_mfma_f32_16x16x32_bf16 v[16:19], a[56:59], v[48:51], v[16:19]
    ds_read_b128 v[40:43], v8 offset:16384
    v_mfma_f32_16x16x32_bf16 v[20:23], a[168:171], v[48:51], v[20:23]
    ds_read_b128 v[44:47], v8 offset:45056
    v_mfma_f32_16x16x32_bf16 v[24:27], a[56:59], v[52:55], v[24:27]
    v_mfma_f32_16x16x32_bf16 v[28:31], a[168:171], v[52:55], v[28:31]
    s_waitcnt lgkmcnt(2)
    v_mfma_f32_16x16x32_bf16 v[16:19], a[60:63], v[32:35], v[16:19]
    ds_read_b128 v[48:51], v8 offset:17408
    v_mfma_f32_16x16x32_bf16 v[20:23], a[172:175], v[32:35], v[20:23]
    ds_read_b128 v[52:55], v8 offset:46080
    v_mfma_f32_16x16x32_bf16 v[24:27], a[60:63], v[36:39], v[24:27]
    v_mfma_f32_16x16x32_bf16 v[28:31], a[172:175], v[36:39], v[28:31]
    s_waitcnt lgkmcnt(2)
    v_mfma_f32_16x16x32_bf16 v[16:19], a[64:67], v[40:43], v[16:19]
    ds_read_b128 v[32:35], v8 offset:18432
    v_mfma_f32_16x16x32_bf16 v[20:23], a[176:179], v[40:43], v[20:23]
    ds_read_b128 v[36:39], v8 offset:47104
    v_mfma_f32_16x16x32_bf16 v[24:27], a[64:67], v[44:47], v[24:27]
    v_mfma_f32_16x16x32_bf16 v[28:31], a[176:179], v[44:47], v[28:31]
    s_waitcnt lgkmcnt(2)
    v_mfma_f32_16x16x32_bf16 v[16:19], a[68:71], v[48:51], v[16:19]
    ds_read_b128 v[40:43], v8 offset:19456
    v_mfma_f32_16x16x32_bf16 v[20:23], a[180:183], v[48:51], v[20:23]
    ds_read_b128 v[44:47], v8 offset:48128
    v_mfma_f32_16x16x32_bf16 v[24:27], a[68:71], v[52:55], v[24:27]
    v_mfma_f32_16x16x32_bf16 v[28:31], a[180:183], v[52:55], v[28:31]
    s_waitcnt lgkmcnt(2)
    v_mfma_f32_16x16x32_bf16 v[16:19], a[72:75], v[32:35], v[16:19]
    ds_read_b128 v[48:51], v8 offset:20480
    v_mfma_f32_16x16x32_bf16 v[20:23], a[184:187], v[32:35], v[20:23]
    ds_read_b128 v[52:55], v8 offset:49152
    v_mfma_f32_16x16x32_bf16 v[24:27], a[72:75], v[36:39], v[24:27]
    v_mfma_f32_16x16x32_bf16 v[28:31], a[184:187], v[36:39], v[28:31]
    s_waitcnt lgkmcnt(2)
    v_mfma_f32_16x16x32_bf16 v[16:19], a[76:79], v[40:43], v[16:19]
    ds_read_b128 v[32:35], v8 offset:21504
    v_mfma_f32_16x16x32_bf16 v[20:23], a[188:191], v[40:43], v[20:23]
    ds_read_b128 v[36:39], v8 offset:50176
    v_mfma_f32_16x16x32_bf16 v[24:27], a[76:79], v[44:47], v[24:27]
    v_mfma_f32_16x16x32_bf16 v[28:31], a[188:191], v[44:47], v[28:31]
    s_waitcnt lgkmcnt(2)
    v_mfma_f32_16x16x32_bf16 v[16:19], a[80:83], v[48:51], v[16:19]
    ds_read_b128 v[40:43], v8 offset:22528
    ds_read_b128 v[44:47], v8 offset:51200
    v_mfma_f32_16x16x32_bf16 v[20:23], a[192:195], v[48:51], v[20:23]
    s_mov_b32 m0, s51
    s_nop 0
    v_mfma_f32_16x16x32_bf16 v[24:27], a[80:83], v[52:55], v[24:27]
    buffer_load_dword v2, s[4:7], s63 offen sc1 lds
    v_mfma_f32_16x16x32_bf16 v[28:31], a[192:195], v[52:55], v[28:31]
    s_waitcnt lgkmcnt(2)
    v_mfma_f32_16x16x32_bf16 v[16:19], a[84:87], v[32:35], v[16:19]
    ds_read_b128 v[48:51], v8 offset:23552
    v_mfma_f32_16x16x32_bf16 v[20:23], a[196:199], v[32:35], v[20:23]
    ds_read_b128 v[52:55], v8 offset:52224
    v_mfma_f32_16x16x32_bf16 v[24:27], a[84:87], v[36:39], v[24:27]
    v_mfma_f32_16x16x32_bf16 v[28:31], a[196:199], v[36:39], v[28:31]
    s_waitcnt vmcnt(1)
    s_barrier
    v_mov_b32 v5, s53
    v_mov_b32 v6, 0
    s_mov_b64 exec, 1
    s_cmp_lg_u32 s30, 0
    s_cbranch_scc1 L_pub_32_d
    s_lshl_b32 s36, s52, 7
    s_add_u32 s36, s36, s62
    buffer_store_dword v5, v6, s[4:7], s36 offen sc1
    s_branch L_pub_32_e
L_pub_32_d:
    buffer_store_dword v5, v6, s[4:7], s97 offen
L_pub_32_e:
    s_mov_b64 exec, -1
    s_waitcnt lgkmcnt(2)
    v_mfma_f32_16x16x32_bf16 v[16:19], a[88:91], v[40:43], v[16:19]
    ds_read_b128 v[32:35], v8 offset:24576
    v_mfma_f32_16x16x32_bf16 v[20:23], a[200:203], v[40:43], v[20:23]
    ds_read_b128 v[36:39], v8 offset:53248
    v_mfma_f32_16x16x32_bf16 v[24:27], a[88:91], v[44:47], v[24:27]
    v_mfma_f32_16x16x32_bf16 v[28:31], a[200:203], v[44:47], v[28:31]
    s_waitcnt lgkmcnt(2)
    v_mfma_f32_16x16x32_bf16 v[16:19], a[92:95], v[48:51], v[16:19]
    ds_read_b128 v[40:43], v8 offset:25600
    v_mfma_f32_16x16x32_bf16 v[20:23], a[204:207], v[48:51], v[20:23]
    ds_read_b128 v[44:47], v8 offset:54272
    v_mfma_f32_16x16x32_bf16 v[24:27], a[92:95], v[52:55], v[24:27]
    v_mfma_f32_16x16x32_bf16 v[28:31], a[204:207], v[52:55], v[28:31]
    s_waitcnt lgkmcnt(2)
    v_mfma_f32_16x16x32_bf16 v[16:19], a[96:99], v[32:35], v[16:19]
    ds_read_b128 v[48:51], v8 offset:26624
    v_mfma_f32_16x16x32_bf16 v[20:23], a[208:211], v[32:35], v[20:23]
    ds_read_b128 v[52:55], v8 offset:55296
    v_mfma_f32_16x16x32_bf16 v[24:27], a[96:99], v[36:39], v[24:27]
    v_mfma_f32_16x16x32_bf16 v[28:31], a[208:211], v[36:39], v[28:31]
    s_waitcnt lgkmcnt(2)
    v_mfma_f32_16x16x32_bf16 v[16:19], a[100:103], v[40:43], v[16:19]
    ds_read_b128 v[32:35], v8 offset:27648
    v_mfma_f32_16x16x32_bf16 v[20:23], a[212:215], v[40:43], v[20:23]
    ds_read_b128 v[36:39], v8 offset:56320
    v_mfma_f32_16x16x32_bf16 v[24:27], a[100:103], v[44:47], v[24:27]
    v_mfma_f32_16x16x32_bf16 v[28:31], a[212:215], v[44:47], v[28:31]
    s_waitcnt lgkmcnt(2)
    v_mfma_f32_16x16x32_bf16 v[16:19], a[104:107], v[48:51], v[16:19]
    s_lshl_b32 s90, s45, 23
    s_lshl_b32 s91, s46, 1
    s_add_u32 s91, s91, s65
    v_mfma_f32_16x16x32_bf16 v[20:23], a[216:219], v[48:51], v[20:23]
    s_lshl_b32 s91, s91, 15
    s_add_u32 s90, s90, s91
    s_lshl_b32 s91, s66, 2
    v_mfma_f32_16x16x32_bf16 v[24:27], a[104:107], v[52:55], v[24:27]
    s_add_u32 s91, s91, s30
    s_lshl_b32 s91, s91, 10
    s_add_u32 s90, s90, s91
    v_mfma_f32_16x16x32_bf16 v[28:31], a[216:219], v[52:55], v[28:31]
    s_add_u32 s90, s90, 0x9800000
    s_add_u32 s91, s90, 16384
    s_waitcnt lgkmcnt(0)
    v_mfma_f32_16x16x32_bf16 v[16:19], a[108:111], v[32:35], v[16:19]
    v_mfma_f32_16x16x32_bf16 v[20:23], a[220:223], v[32:35], v[20:23]
    v_mfma_f32_16x16x32_bf16 v[24:27], a[108:111], v[36:39], v[24:27]
    v_mfma_f32_16x16x32_bf16 v[28:31], a[220:223], v[36:39], v[28:31]
    s_nop 7
    v_cvt_pk_bf16_f32 v56, v16, v17
    v_cvt_pk_bf16_f32 v57, v18, v19
    v_cvt_pk_bf16_f32 v58, v20, v21
    v_cvt_pk_bf16_f32 v59, v22, v23
    buffer_store_dwordx4 v[56:59], v0, s[4:7], s90 offen sc1
    v_cvt_pk_bf16_f32 v60, v24, v25
    v_cvt_pk_bf16_f32 v61, v26, v27
    v_cvt_pk_bf16_f32 v62, v28, v29
    v_cvt_pk_bf16_f32 v63, v30, v31
    buffer_store_dwordx4 v[60:63], v0, s[4:7], s91 offen sc1
    s_mov_b32 s43, s52
    s_mov_b32 s44, s53
    s_cmp_eq_u32 s45, 0
    s_cselect_b32 s36, s58, s59
    s_add_u32 s53, s36, 1
    s_mov_b32 s52, s45
    s_cmp_eq_u32 s45, 0
    s_cselect_b32 s58, s53, s58
    s_cselect_b32 s59, s59, s53
    s_waitcnt vmcnt(3)
    s_barrier
    v_lshlrev_b32 v5, 2, v1
    v_add_u32 v5, s51, v5
    ds_read_b32 v4, v5
    s_xor_b32 s51, s51, 256
    s_waitcnt lgkmcnt(0)
    s_cmp_ge_u32 s41, 32
    s_cbranch_scc1 L_f2_w_try1
    s_lshl_b32 s48, s41, 1
    s_add_u32 s48, s48, s64
    s_add_u32 s54, s48, 1
    s_add_u32 s36, s67, 0
    v_subrev_u32 v7, s36, v1
    v_cmp_gt_u32 vcc, 14, v7
    v_mov_b32 v6, s54
    s_nop 0
    v_cndmask_b32 v7, 0, v6, vcc
    v_cmp_lt_u32 vcc, v4, v7
    s_nop 1
    s_cmp_eq_u64 vcc, 0
    s_cbranch_scc0 L_f2_w_try1
    s_mov_b32 s47, 0
    s_add_u32 s41, s41, 1
    s_cmp_eq_u32 s47, s47
    s_branch L_f2_w_done
L_f2_w_try1:
    s_cmp_ge_u32 s42, 32
    s_cbranch_scc1 L_f2_w_try2
    s_lshl_b32 s48, s42, 1
    s_add_u32 s48, s48, s64
    s_add_u32 s54, s48, 1
    s_add_u32 s36, s67, 32
    v_subrev_u32 v7, s36, v1
    v_cmp_gt_u32 vcc, 14, v7
    v_mov_b32 v6, s54
    s_nop 0
    v_cndmask_b32 v7, 0, v6, vcc
    v_cmp_lt_u32 vcc, v4, v7
    s_nop 1
    s_cmp_eq_u64 vcc, 0
    s_cbranch_scc0 L_f2_w_try2
    s_mov_b32 s47, 1
    s_add_u32 s42, s42, 1
    s_cmp_eq_u32 s47, s47
    s_branch L_f2_w_done
L_f2_w_try2:
    s_cmp_lg_u32 s47, s47
L_f2_w_done:
    s_cbranch_scc0 L_f2_cold
    s_xor_b32 s50, s50, 65536
    s_mov_b32 m0, s51
    s_nop 0
    buffer_load_dword v2, s[4:7], s63 offen sc1 lds
    s_lshl_b32 s36, s47, 23
    s_mul_i32 s37, s48, 114688
    s_add_u32 s36, s36, s37
    s_add_u32 s36, s36, 0x8800000
    s_mul_i32 s37, s65, 28672
    s_add_u32 s36, s36, s37
    s_lshr_b32 s37, s30, 1
    s_mul_i32 s38, s37, 57344
    s_add_u32 s36, s36, s38
    s_mul_i32 s38, s37, 28672
    s_and_b32 s37, s30, 1
    s_mul_i32 s37, s37, 14336
    s_add_u32 s60, s36, s37
    s_add_u32 s37, s37, s38
    s_add_u32 s61, s37, s50
    s_mov_b32 m0, s61
    s_add_u32 s61, s61, 1024
    buffer_load_dwordx4 v0, s[4:7], s60 offen sc1 lds
    s_add_u32 s60, s60, 1024
    s_mov_b32 m0, s61
    s_add_u32 s61, s61, 1024
    buffer_load_dwordx4 v0, s[4:7], s60 offen sc1 lds
    s_add_u32 s60, s60, 1024
    s_mov_b32 m0, s61
    s_add_u32 s61, s61, 1024
    buffer_load_dwordx4 v0, s[4:7], s60 offen sc1 lds
    s_add_u32 s60, s60, 1024
    s_mov_b32 m0, s61
    s_add_u32 s61, s61, 1024
    buffer_load_dwordx4 v0, s[4:7], s60 offen sc1 lds
    s_add_u32 s60, s60, 1024
    s_mov_b32 m0, s61
    s_add_u32 s61, s61, 1024
    buffer_load_dwordx4 v0, s[4:7], s60 offen sc1 lds
    s_add_u32 s60, s60, 1024
    s_mov_b32 m0, s61
    s_add_u32 s61, s61, 1024
    buffer_load_dwordx4 v0, s[4:7], s60 offen sc1 lds
    s_add_u32 s60, s60, 1024
    s_mov_b32 m0, s61
    s_add_u32 s61, s61, 1024
    buffer_load_dwordx4 v0, s[4:7], s60 offen sc1 lds
    s_add_u32 s60, s60, 1024
    s_mov_b32 m0, s61
    s_add_u32 s61, s61, 1024
    buffer_load_dwordx4 v0, s[4:7], s60 offen sc1 lds
    s_add_u32 s60, s60, 1024
    s_mov_b32 m0, s61
    s_add_u32 s61, s61, 1024
    buffer_load_dwordx4 v0, s[4:7], s60 offen sc1 lds
    s_add_u32 s60, s60, 1024
    s_mov_b32 m0, s61
    s_add_u32 s61, s61, 1024
    buffer_load_dwordx4 v0, s[4:7], s60 offen sc1 lds
    s_add_u32 s60, s60, 1024
    s_mov_b32 m0, s61
    s_add_u32 s61, s61, 1024
    buffer_load_dwordx4 v0, s[4:7], s60 offen sc1 lds
    s_add_u32 s60, s60, 1024
    s_mov_b32 m0, s61
    s_add_u32 s61, s61, 1024
    buffer_load_dwordx4 v0, s[4:7], s60 offen sc1 lds
    s_add_u32 s60, s60, 1024
    s_mov_b32 m0, s61
    s_add_u32 s61, s61, 1024
    buffer_load_dwordx4 v0, s[4:7], s60 offen sc1 lds
    s_add_u32 s60, s60, 1024
    s_mov_b32 m0, s61
    s_add_u32 s61, s61, 1024
    buffer_load_dwordx4 v0, s[4:7], s60 offen sc1 lds
    s_add_u32 s60, s60, 1024
    s_mov_b32 s45, s47
    s_mov_b32 s46, s48
    s_waitcnt vmcnt(15)
    s_barrier
    s_cmp_eq_u32 s43, s52
    s_cbranch_scc1 L_f2_wnopub2
    v_mov_b32 v5, s44
    v_mov_b32 v6, 0
    s_mov_b64 exec, 1
    s_cmp_lg_u32 s30, 0
    s_cbranch_scc1 L_pub_33_d
    s_lshl_b32 s36, s43, 7
    s_add_u32 s36, s36, s62
    buffer_store_dword v5, v6, s[4:7], s36 offen sc1
    s_branch L_pub_33_e
L_pub_33_d:
    buffer_store_dword v5, v6, s[4:7], s97 offen
L_pub_33_e:
    s_mov_b64 exec, -1
L_f2_wnopub2:
    v_mov_b32 v5, s53
    v_mov_b32 v6, 0
    s_mov_b64 exec, 1
    s_cmp_lg_u32 s30, 0
    s_cbranch_scc1 L_pub_34_d
    s_lshl_b32 s36, s52, 7
    s_add_u32 s36, s36, s62
    buffer_store_dword v5, v6, s[4:7], s36 offen sc1
    s_branch L_pub_34_e
L_pub_34_d:
    buffer_store_dword v5, v6, s[4:7], s97 offen
L_pub_34_e:
    s_mov_b64 exec, -1
    s_mov_b32 s43, s52
    s_mov_b32 s44, s53
    s_waitcnt vmcnt(1)
    s_barrier
    v_add_u32 v8, s50, v0
    ds_read_b128 v[32:35], v8 offset:0
    ds_read_b128 v[36:39], v8 offset:28672
    ds_read_b128 v[40:43], v8 offset:1024
    ds_read_b128 v[44:47], v8 offset:29696
    v_lshlrev_b32 v5, 2, v1
    v_add_u32 v5, s51, v5
    ds_read_b32 v4, v5
    s_xor_b32 s51, s51, 256
    s_branch L_f2_main
L_f2_exit:
    s_waitcnt vmcnt(0)
    s_branch L_end
L_chain:
    s_load_dwordx4 s[36:39], s[0:1], 16
    s_load_dwordx4 s[40:43], s[0:1], 32
    s_waitcnt lgkmcnt(0)
    s_mov_b32 s8, s36
    s_and_b32 s9, s37, 0xffff
    s_mov_b32 s10, 0x400000
    s_mov_b32 s11, 0x20000
    s_mov_b32 s12, s38
    s_and_b32 s13, s39, 0xffff
    s_mov_b32 s14, 0x400000
    s_mov_b32 s15, 0x20000
    s_mov_b32 s16, s40
    s_and_b32 s17, s41, 0xffff
    s_mov_b32 s18, 0x400000
    s_mov_b32 s19, 0x20000
    s_mov_b32 s20, s42
    s_and_b32 s21, s43, 0xffff
    s_mov_b32 s22, 0x400000
    s_mov_b32 s23, 0x20000
    v_mbcnt_lo_u32_b32 v1, -1, 0
    v_mbcnt_hi_u32_b32 v1, -1, v1
    v_mov_b32 v31, v1
    v_lshlrev_b32 v0, 4, v31
    v_lshrrev_b32 v24, 4, v31
    v_lshlrev_b32 v20, 13, v24
    v_and_b32 v25, 15, v31
    v_lshlrev_b32 v25, 4, v25
    v_add_u32 v20, v20, v25
    v_lshrrev_b32 v24, 5, v31
    v_lshlrev_b32 v25, 4, v24
    v_bfe_u32 v24, v31, 4, 1
    v_lshl_add_u32 v25, v24, 2, v25
    v_bfe_u32 v24, v31, 2, 1
    v_add_u32 v25, v25, v24
    v_bfe_u32 v24, v31, 3, 1
    v_lshl_add_u32 v25, v24, 3, v25
    v_lshlrev_b32 v25, 8, v25
    v_and_b32 v24, 3, v31
    s_lshl_b32 s36, s30, 6
    v_lshl_add_u32 v21, v24, 3, v25
    v_add_u32 v21, s36, v21
    v_lshl_add_u32 v22, v24, 4, v25
    v_add_u32 v22, s36, v22
    v_lshrrev_b32 v24, 5, v31
    v_lshlrev_b32 v25, 3, v24
    v_bfe_u32 v24, v31, 4, 1
    v_lshl_add_u32 v25, v24, 2, v25
    v_bfe_u32 v24, v31, 2, 1
    v_add_u32 v25, v25, v24
    v_lshlrev_b32 v25, 10, v25
    v_bfe_u32 v24, v31, 3, 1
    v_lshl_add_u32 v25, v24, 6, v25
    v_and_b32 v24, 3, v31
    v_lshl_add_u32 v25, v24, 3, v25
    s_lshl_b32 s36, s30, 8
    v_add_u32 v23, s36, v25
    s_lshl_b32 s36, s30, 14
    v_add_u32 v8, s36, v0
    v_add_u32 v9, 0x10000, v8
    s_cmp_eq_u32 s32, 0
    s_cbranch_scc1 L_chain_nohold
    s_waitcnt vmcnt(0)
    s_barrier
    s_cmp_lg_u32 s30, 0
    s_cbranch_scc1 L_sd_chain1
    v_mov_b32 v13, 1
    v_mov_b32 v14, 32
    s_mov_b64 exec, 1
    buffer_atomic_add v13, v14, s[24:27], 0 offen
    s_mov_b64 exec, -1
L_sd_chain1:
    s_cmp_lg_u32 s30, 0
    s_cbranch_scc1 L_pw_ok_hachain1
    s_mov_b32 s36, 0
    v_mov_b32 v120, 32
L_pw_hachain1:
    buffer_load_dword v121, v120, s[24:27], 0 offen sc1
    s_waitcnt vmcnt(0)
    v_readfirstlane_b32 s37, v121
    s_nop 3
    s_cmp_ge_u32 s37, 256
    s_cbranch_scc1 L_pw_ok_hachain1
    s_sleep 16
    s_add_u32 s36, s36, 1
    s_cmp_lt_u32 s36, 65536
    s_cbranch_scc1 L_pw_hachain1
    s_mov_b32 s33, 1
L_pw_ok_hachain1:
    s_cmp_lg_u32 s30, 0
    s_cbranch_scc1 L_pw_ok_hbchain1
    s_mov_b32 s36, 0
    v_mov_b32 v120, 768
L_pw_hbchain1:
    buffer_load_dword v121, v120, s[4:7], 0 offen sc1
    s_waitcnt vmcnt(0)
    v_readfirstlane_b32 s37, v121
    s_nop 3
    s_cmp_ge_u32 s37, 1
    s_cbranch_scc1 L_pw_ok_hbchain1
    s_sleep 16
    s_add_u32 s36, s36, 1
    s_cmp_lt_u32 s36, 65536
    s_cbranch_scc1 L_pw_hbchain1
L_pw_ok_hbchain1:
    s_barrier
    s_lshl_b32 s36, s31, 8
    s_lshl_b32 s37, s30, 19
    s_add_u32 s36, s36, s37
    s_add_u32 s36, s36, 0x0
    s_lshl_b32 s38, s30, 14
    s_add_u32 s38, s38, 0
    s_mov_b32 m0, s38
    s_add_u32 s38, s38, 1024
    buffer_load_dwordx4 v20, s[16:19], s36 offen lds
    s_add_u32 s36, s36, 32768
    s_mov_b32 m0, s38
    s_add_u32 s38, s38, 1024
    buffer_load_dwordx4 v20, s[16:19], s36 offen lds
    s_add_u32 s36, s36, 32768
    s_mov_b32 m0, s38
    s_add_u32 s38, s38, 1024
    buffer_load_dwordx4 v20, s[16:19], s36 offen lds
    s_add_u32 s36, s36, 32768
    s_mov_b32 m0, s38
    s_add_u32 s38, s38, 1024
    buffer_load_dwordx4 v20, s[16:19], s36 offen lds
    s_add_u32 s36, s36, 32768
    s_mov_b32 m0, s38
    s_add_u32 s38, s38, 1024
    buffer_load_dwordx4 v20, s[16:19], s36 offen lds
    s_add_u32 s36, s36, 32768
    s_mov_b32 m0, s38
    s_add_u32 s38, s38, 1024
    buffer_load_dwordx4 v20, s[16:19], s36 offen lds
    s_add_u32 s36, s36, 32768
    s_mov_b32 m0, s38
    s_add_u32 s38, s38, 1024
    buffer_load_dwordx4 v20, s[16:19], s36 offen lds
    s_add_u32 s36, s36, 32768
    s_mov_b32 m0, s38
    s_add_u32 s38, s38, 1024
    buffer_load_dwordx4 v20, s[16:19], s36 offen lds
    s_add_u32 s36, s36, 32768
    s_mov_b32 m0, s38
    s_add_u32 s38, s38, 1024
    buffer_load_dwordx4 v20, s[16:19], s36 offen lds
    s_add_u32 s36, s36, 32768
    s_mov_b32 m0, s38
    s_add_u32 s38, s38, 1024
    buffer_load_dwordx4 v20, s[16:19], s36 offen lds
    s_add_u32 s36, s36, 32768
    s_mov_b32 m0, s38
    s_add_u32 s38, s38, 1024
    buffer_load_dwordx4 v20, s[16:19], s36 offen lds
    s_add_u32 s36, s36, 32768
    s_mov_b32 m0, s38
    s_add_u32 s38, s38, 1024
    buffer_load_dwordx4 v20, s[16:19], s36 offen lds
    s_add_u32 s36, s36, 32768
    s_mov_b32 m0, s38
    s_add_u32 s38, s38, 1024
    buffer_load_dwordx4 v20, s[16:19], s36 offen lds
    s_add_u32 s36, s36, 32768
    s_mov_b32 m0, s38
    s_add_u32 s38, s38, 1024
    buffer_load_dwordx4 v20, s[16:19], s36 offen lds
    s_add_u32 s36, s36, 32768
    s_mov_b32 m0, s38
    s_add_u32 s38, s38, 1024
    buffer_load_dwordx4 v20, s[16:19], s36 offen lds
    s_add_u32 s36, s36, 32768
    s_mov_b32 m0, s38
    s_add_u32 s38, s38, 1024
    buffer_load_dwordx4 v20, s[16:19], s36 offen lds
    s_add_u32 s36, s36, 32768
    s_lshl_b32 s36, s31, 8
    s_lshl_b32 s37, s30, 19
    s_add_u32 s36, s36, s37
    s_add_u32 s36, s36, 0x200000
    s_lshl_b32 s38, s30, 14
    s_add_u32 s38, s38, 65536
    s_mov_b32 m0, s38
    s_add_u32 s38, s38, 1024
    buffer_load_dwordx4 v20, s[16:19], s36 offen lds
    s_add_u32 s36, s36, 32768
    s_mov_b32 m0, s38
    s_add_u32 s38, s38, 1024
    buffer_load_dwordx4 v20, s[16:19], s36 offen lds
    s_add_u32 s36, s36, 32768
    s_mov_b32 m0, s38
    s_add_u32 s38, s38, 1024
    buffer_load_dwordx4 v20, s[16:19], s36 offen lds
    s_add_u32 s36, s36, 32768
    s_mov_b32 m0, s38
    s_add_u32 s38, s38, 1024
    buffer_load_dwordx4 v20, s[16:19], s36 offen lds
    s_add_u32 s36, s36, 32768
    s_mov_b32 m0, s38
    s_add_u32 s38, s38, 1024
    buffer_load_dwordx4 v20, s[16:19], s36 offen lds
    s_add_u32 s36, s36, 32768
    s_mov_b32 m0, s38
    s_add_u32 s38, s38, 1024
    buffer_load_dwordx4 v20, s[16:19], s36 offen lds
    s_add_u32 s36, s36, 32768
    s_mov_b32 m0, s38
    s_add_u32 s38, s38, 1024
    buffer_load_dwordx4 v20, s[16:19], s36 offen lds
    s_add_u32 s36, s36, 32768
    s_mov_b32 m0, s38
    s_add_u32 s38, s38, 1024
    buffer_load_dwordx4 v20, s[16:19], s36 offen lds
    s_add_u32 s36, s36, 32768
    s_mov_b32 m0, s38
    s_add_u32 s38, s38, 1024
    buffer_load_dwordx4 v20, s[16:19], s36 offen lds
    s_add_u32 s36, s36, 32768
    s_mov_b32 m0, s38
    s_add_u32 s38, s38, 1024
    buffer_load_dwordx4 v20, s[16:19], s36 offen lds
    s_add_u32 s36, s36, 32768
    s_mov_b32 m0, s38
    s_add_u32 s38, s38, 1024
    buffer_load_dwordx4 v20, s[16:19], s36 offen lds
    s_add_u32 s36, s36, 32768
    s_mov_b32 m0, s38
    s_add_u32 s38, s38, 1024
    buffer_load_dwordx4 v20, s[16:19], s36 offen lds
    s_add_u32 s36, s36, 32768
    s_mov_b32 m0, s38
    s_add_u32 s38, s38, 1024
    buffer_load_dwordx4 v20, s[16:19], s36 offen lds
    s_add_u32 s36, s36, 32768
    s_mov_b32 m0, s38
    s_add_u32 s38, s38, 1024
    buffer_load_dwordx4 v20, s[16:19], s36 offen lds
    s_add_u32 s36, s36, 32768
    s_mov_b32 m0, s38
    s_add_u32 s38, s38, 1024
    buffer_load_dwordx4 v20, s[16:19], s36 offen lds
    s_add_u32 s36, s36, 32768
    s_mov_b32 m0, s38
    s_add_u32 s38, s38, 1024
    buffer_load_dwordx4 v20, s[16:19], s36 offen lds
    s_add_u32 s36, s36, 32768
    s_branch L_chain_held
L_chain_nohold:
    s_lshl_b32 s36, s31, 8
    s_lshl_b32 s37, s30, 19
    s_add_u32 s36, s36, s37
    s_add_u32 s36, s36, 0x0
    s_lshl_b32 s38, s30, 14
    s_add_u32 s38, s38, 0
    s_mov_b32 m0, s38
    s_add_u32 s38, s38, 1024
    buffer_load_dwordx4 v20, s[16:19], s36 offen lds
    s_add_u32 s36, s36, 32768
    s_mov_b32 m0, s38
    s_add_u32 s38, s38, 1024
    buffer_load_dwordx4 v20, s[16:19], s36 offen lds
    s_add_u32 s36, s36, 32768
    s_mov_b32 m0, s38
    s_add_u32 s38, s38, 1024
    buffer_load_dwordx4 v20, s[16:19], s36 offen lds
    s_add_u32 s36, s36, 32768
    s_mov_b32 m0, s38
    s_add_u32 s38, s38, 1024
    buffer_load_dwordx4 v20, s[16:19], s36 offen lds
    s_add_u32 s36, s36, 32768
    s_mov_b32 m0, s38
    s_add_u32 s38, s38, 1024
    buffer_load_dwordx4 v20, s[16:19], s36 offen lds
    s_add_u32 s36, s36, 32768
    s_mov_b32 m0, s38
    s_add_u32 s38, s38, 1024
    buffer_load_dwordx4 v20, s[16:19], s36 offen lds
    s_add_u32 s36, s36, 32768
    s_mov_b32 m0, s38
    s_add_u32 s38, s38, 1024
    buffer_load_dwordx4 v20, s[16:19], s36 offen lds
    s_add_u32 s36, s36, 32768
    s_mov_b32 m0, s38
    s_add_u32 s38, s38, 1024
    buffer_load_dwordx4 v20, s[16:19], s36 offen lds
    s_add_u32 s36, s36, 32768
    s_mov_b32 m0, s38
    s_add_u32 s38, s38, 1024
    buffer_load_dwordx4 v20, s[16:19], s36 offen lds
    s_add_u32 s36, s36, 32768
    s_mov_b32 m0, s38
    s_add_u32 s38, s38, 1024
    buffer_load_dwordx4 v20, s[16:19], s36 offen lds
    s_add_u32 s36, s36, 32768
    s_mov_b32 m0, s38
    s_add_u32 s38, s38, 1024
    buffer_load_dwordx4 v20, s[16:19], s36 offen lds
    s_add_u32 s36, s36, 32768
    s_mov_b32 m0, s38
    s_add_u32 s38, s38, 1024
    buffer_load_dwordx4 v20, s[16:19], s36 offen lds
    s_add_u32 s36, s36, 32768
    s_mov_b32 m0, s38
    s_add_u32 s38, s38, 1024
    buffer_load_dwordx4 v20, s[16:19], s36 offen lds
    s_add_u32 s36, s36, 32768
    s_mov_b32 m0, s38
    s_add_u32 s38, s38, 1024
    buffer_load_dwordx4 v20, s[16:19], s36 offen lds
    s_add_u32 s36, s36, 32768
    s_mov_b32 m0, s38
    s_add_u32 s38, s38, 1024
    buffer_load_dwordx4 v20, s[16:19], s36 offen lds
    s_add_u32 s36, s36, 32768
    s_mov_b32 m0, s38
    s_add_u32 s38, s38, 1024
    buffer_load_dwordx4 v20, s[16:19], s36 offen lds
    s_add_u32 s36, s36, 32768
    s_lshl_b32 s36, s31, 8
    s_lshl_b32 s37, s30, 19
    s_add_u32 s36, s36, s37
    s_add_u32 s36, s36, 0x200000
    s_lshl_b32 s38, s30, 14
    s_add_u32 s38, s38, 65536
    s_mov_b32 m0, s38
    s_add_u32 s38, s38, 1024
    buffer_load_dwordx4 v20, s[16:19], s36 offen lds
    s_add_u32 s36, s36, 32768
    s_mov_b32 m0, s38
    s_add_u32 s38, s38, 1024
    buffer_load_dwordx4 v20, s[16:19], s36 offen lds
    s_add_u32 s36, s36, 32768
    s_mov_b32 m0, s38
    s_add_u32 s38, s38, 1024
    buffer_load_dwordx4 v20, s[16:19], s36 offen lds
    s_add_u32 s36, s36, 32768
    s_mov_b32 m0, s38
    s_add_u32 s38, s38, 1024
    buffer_load_dwordx4 v20, s[16:19], s36 offen lds
    s_add_u32 s36, s36, 32768
    s_mov_b32 m0, s38
    s_add_u32 s38, s38, 1024
    buffer_load_dwordx4 v20, s[16:19], s36 offen lds
    s_add_u32 s36, s36, 32768
    s_mov_b32 m0, s38
    s_add_u32 s38, s38, 1024
    buffer_load_dwordx4 v20, s[16:19], s36 offen lds
    s_add_u32 s36, s36, 32768
    s_mov_b32 m0, s38
    s_add_u32 s38, s38, 1024
    buffer_load_dwordx4 v20, s[16:19], s36 offen lds
    s_add_u32 s36, s36, 32768
    s_mov_b32 m0, s38
    s_add_u32 s38, s38, 1024
    buffer_load_dwordx4 v20, s[16:19], s36 offen lds
    s_add_u32 s36, s36, 32768
    s_mov_b32 m0, s38
    s_add_u32 s38, s38, 1024
    buffer_load_dwordx4 v20, s[16:19], s36 offen lds
    s_add_u32 s36, s36, 32768
    s_mov_b32 m0, s38
    s_add_u32 s38, s38, 1024
    buffer_load_dwordx4 v20, s[16:19], s36 offen lds
    s_add_u32 s36, s36, 32768
    s_mov_b32 m0, s38
    s_add_u32 s38, s38, 1024
    buffer_load_dwordx4 v20, s[16:19], s36 offen lds
    s_add_u32 s36, s36, 32768
    s_mov_b32 m0, s38
    s_add_u32 s38, s38, 1024
    buffer_load_dwordx4 v20, s[16:19], s36 offen lds
    s_add_u32 s36, s36, 32768
    s_mov_b32 m0, s38
    s_add_u32 s38, s38, 1024
    buffer_load_dwordx4 v20, s[16:19], s36 offen lds
    s_add_u32 s36, s36, 32768
    s_mov_b32 m0, s38
    s_add_u32 s38, s38, 1024
    buffer_load_dwordx4 v20, s[16:19], s36 offen lds
    s_add_u32 s36, s36, 32768
    s_mov_b32 m0, s38
    s_add_u32 s38, s38, 1024
    buffer_load_dwordx4 v20, s[16:19], s36 offen lds
    s_add_u32 s36, s36, 32768
    s_mov_b32 m0, s38
    s_add_u32 s38, s38, 1024
    buffer_load_dwordx4 v20, s[16:19], s36 offen lds
    s_add_u32 s36, s36, 32768
    s_waitcnt vmcnt(32)
    s_barrier
    s_cmp_lg_u32 s30, 0
    s_cbranch_scc1 L_sd_chain
    v_mov_b32 v13, 1
    v_mov_b32 v14, 32
    s_mov_b64 exec, 1
    buffer_atomic_add v13, v14, s[24:27], 0 offen
    s_mov_b64 exec, -1
L_sd_chain:
L_chain_held:
    s_and_b32 s39, s30, 1
    s_lshl_b32 s39, s39, 15
    s_xor_b32 s41, s39, 32768
    s_waitcnt vmcnt(16)
    s_barrier
    s_add_u32 s36, s39, 0
    v_add_u32 v27, s36, v22
    s_add_u32 s36, s41, 0
    v_add_u32 v28, s36, v22
    s_cmp_ge_u32 s30, 2
    s_cbranch_scc1 L_ini_b0
    ds_read_b64_tr_b16 v[128:129], v27 offset:0
    ds_read_b64_tr_b16 v[130:131], v27 offset:512
    ds_read_b64_tr_b16 v[132:133], v27 offset:8192
    ds_read_b64_tr_b16 v[134:135], v27 offset:8704
    ds_read_b64_tr_b16 v[136:137], v27 offset:16384
    ds_read_b64_tr_b16 v[138:139], v27 offset:16896
    ds_read_b64_tr_b16 v[140:141], v27 offset:24576
    ds_read_b64_tr_b16 v[142:143], v27 offset:25088
    ds_read_b64_tr_b16 v[144:145], v28 offset:0
    ds_read_b64_tr_b16 v[146:147], v28 offset:512
    ds_read_b64_tr_b16 v[148:149], v28 offset:8192
    ds_read_b64_tr_b16 v[150:151], v28 offset:8704
    ds_read_b64_tr_b16 v[152:153], v28 offset:16384
    ds_read_b64_tr_b16 v[154:155], v28 offset:16896
    ds_read_b64_tr_b16 v[156:157], v28 offset:24576
    ds_read_b64_tr_b16 v[158:159], v28 offset:25088
    s_waitcnt lgkmcnt(0)
    ds_read_b64_tr_b16 v[192:193], v27 offset:8
    ds_read_b64_tr_b16 v[194:195], v27 offset:520
    ds_read_b64_tr_b16 v[196:197], v27 offset:8200
    ds_read_b64_tr_b16 v[198:199], v27 offset:8712
    ds_read_b64_tr_b16 v[200:201], v27 offset:16392
    ds_read_b64_tr_b16 v[202:203], v27 offset:16904
    ds_read_b64_tr_b16 v[204:205], v27 offset:24584
    ds_read_b64_tr_b16 v[206:207], v27 offset:25096
    ds_read_b64_tr_b16 v[208:209], v28 offset:8
    ds_read_b64_tr_b16 v[210:211], v28 offset:520
    ds_read_b64_tr_b16 v[212:213], v28 offset:8200
    ds_read_b64_tr_b16 v[214:215], v28 offset:8712
    ds_read_b64_tr_b16 v[216:217], v28 offset:16392
    ds_read_b64_tr_b16 v[218:219], v28 offset:16904
    ds_read_b64_tr_b16 v[220:221], v28 offset:24584
    ds_read_b64_tr_b16 v[222:223], v28 offset:25096
    s_waitcnt lgkmcnt(0)
    s_branch L_ini_j0
L_ini_b0:
    ds_read_b64_tr_b16 v[160:161], v27 offset:0
    ds_read_b64_tr_b16 v[162:163], v27 offset:512
    ds_read_b64_tr_b16 v[164:165], v27 offset:8192
    ds_read_b64_tr_b16 v[166:167], v27 offset:8704
    ds_read_b64_tr_b16 v[168:169], v27 offset:16384
    ds_read_b64_tr_b16 v[170:171], v27 offset:16896
    ds_read_b64_tr_b16 v[172:173], v27 offset:24576
    ds_read_b64_tr_b16 v[174:175], v27 offset:25088
    ds_read_b64_tr_b16 v[176:177], v28 offset:0
    ds_read_b64_tr_b16 v[178:179], v28 offset:512
    ds_read_b64_tr_b16 v[180:181], v28 offset:8192
    ds_read_b64_tr_b16 v[182:183], v28 offset:8704
    ds_read_b64_tr_b16 v[184:185], v28 offset:16384
    ds_read_b64_tr_b16 v[186:187], v28 offset:16896
    ds_read_b64_tr_b16 v[188:189], v28 offset:24576
    ds_read_b64_tr_b16 v[190:191], v28 offset:25088
    s_waitcnt lgkmcnt(0)
    ds_read_b64_tr_b16 v[224:225], v27 offset:8
    ds_read_b64_tr_b16 v[226:227], v27 offset:520
    ds_read_b64_tr_b16 v[228:229], v27 offset:8200
    ds_read_b64_tr_b16 v[230:231], v27 offset:8712
    ds_read_b64_tr_b16 v[232:233], v27 offset:16392
    ds_read_b64_tr_b16 v[234:235], v27 offset:16904
    ds_read_b64_tr_b16 v[236:237], v27 offset:24584
    ds_read_b64_tr_b16 v[238:239], v27 offset:25096
    ds_read_b64_tr_b16 v[240:241], v28 offset:8
    ds_read_b64_tr_b16 v[242:243], v28 offset:520
    ds_read_b64_tr_b16 v[244:245], v28 offset:8200
    ds_read_b64_tr_b16 v[246:247], v28 offset:8712
    ds_read_b64_tr_b16 v[248:249], v28 offset:16392
    ds_read_b64_tr_b16 v[250:251], v28 offset:16904
    ds_read_b64_tr_b16 v[252:253], v28 offset:24584
    ds_read_b64_tr_b16 v[254:255], v28 offset:25096
    s_waitcnt lgkmcnt(0)
L_ini_j0:
    s_barrier
    s_lshl_b32 s36, s31, 8
    s_lshl_b32 s37, s30, 19
    s_add_u32 s36, s36, s37
    s_add_u32 s36, s36, 0x0
    s_lshl_b32 s38, s30, 14
    s_add_u32 s38, s38, 0
    s_mov_b32 m0, s38
    s_add_u32 s38, s38, 1024
    buffer_load_dwordx4 v20, s[8:11], s36 offen lds
    s_add_u32 s36, s36, 32768
    s_mov_b32 m0, s38
    s_add_u32 s38, s38, 1024
    buffer_load_dwordx4 v20, s[8:11], s36 offen lds
    s_add_u32 s36, s36, 32768
    s_mov_b32 m0, s38
    s_add_u32 s38, s38, 1024
    buffer_load_dwordx4 v20, s[8:11], s36 offen lds
    s_add_u32 s36, s36, 32768
    s_mov_b32 m0, s38
    s_add_u32 s38, s38, 1024
    buffer_load_dwordx4 v20, s[8:11], s36 offen lds
    s_add_u32 s36, s36, 32768
    s_mov_b32 m0, s38
    s_add_u32 s38, s38, 1024
    buffer_load_dwordx4 v20, s[8:11], s36 offen lds
    s_add_u32 s36, s36, 32768
    s_mov_b32 m0, s38
    s_add_u32 s38, s38, 1024
    buffer_load_dwordx4 v20, s[8:11], s36 offen lds
    s_add_u32 s36, s36, 32768
    s_mov_b32 m0, s38
    s_add_u32 s38, s38, 1024
    buffer_load_dwordx4 v20, s[8:11], s36 offen lds
    s_add_u32 s36, s36, 32768
    s_mov_b32 m0, s38
    s_add_u32 s38, s38, 1024
    buffer_load_dwordx4 v20, s[8:11], s36 offen lds
    s_add_u32 s36, s36, 32768
    s_mov_b32 m0, s38
    s_add_u32 s38, s38, 1024
    buffer_load_dwordx4 v20, s[8:11], s36 offen lds
    s_add_u32 s36, s36, 32768
    s_mov_b32 m0, s38
    s_add_u32 s38, s38, 1024
    buffer_load_dwordx4 v20, s[8:11], s36 offen lds
    s_add_u32 s36, s36, 32768
    s_mov_b32 m0, s38
    s_add_u32 s38, s38, 1024
    buffer_load_dwordx4 v20, s[8:11], s36 offen lds
    s_add_u32 s36, s36, 32768
    s_mov_b32 m0, s38
    s_add_u32 s38, s38, 1024
    buffer_load_dwordx4 v20, s[8:11], s36 offen lds
    s_add_u32 s36, s36, 32768
    s_mov_b32 m0, s38
    s_add_u32 s38, s38, 1024
    buffer_load_dwordx4 v20, s[8:11], s36 offen lds
    s_add_u32 s36, s36, 32768
    s_mov_b32 m0, s38
    s_add_u32 s38, s38, 1024
    buffer_load_dwordx4 v20, s[8:11], s36 offen lds
    s_add_u32 s36, s36, 32768
    s_mov_b32 m0, s38
    s_add_u32 s38, s38, 1024
    buffer_load_dwordx4 v20, s[8:11], s36 offen lds
    s_add_u32 s36, s36, 32768
    s_mov_b32 m0, s38
    s_add_u32 s38, s38, 1024
    buffer_load_dwordx4 v20, s[8:11], s36 offen lds
    s_add_u32 s36, s36, 32768
    s_waitcnt vmcnt(16)
    s_barrier
    s_add_u32 s36, s39, 65536
    v_add_u32 v27, s36, v22
    s_add_u32 s36, s41, 65536
    v_add_u32 v28, s36, v22
    s_cmp_ge_u32 s30, 2
    s_cbranch_scc1 L_ini_b1
    ds_read_b64_tr_b16 v[160:161], v27 offset:0
    ds_read_b64_tr_b16 v[162:163], v27 offset:512
    ds_read_b64_tr_b16 v[164:165], v27 offset:8192
    ds_read_b64_tr_b16 v[166:167], v27 offset:8704
    ds_read_b64_tr_b16 v[168:169], v27 offset:16384
    ds_read_b64_tr_b16 v[170:171], v27 offset:16896
    ds_read_b64_tr_b16 v[172:173], v27 offset:24576
    ds_read_b64_tr_b16 v[174:175], v27 offset:25088
    ds_read_b64_tr_b16 v[176:177], v28 offset:0
    ds_read_b64_tr_b16 v[178:179], v28 offset:512
    ds_read_b64_tr_b16 v[180:181], v28 offset:8192
    ds_read_b64_tr_b16 v[182:183], v28 offset:8704
    ds_read_b64_tr_b16 v[184:185], v28 offset:16384
    ds_read_b64_tr_b16 v[186:187], v28 offset:16896
    ds_read_b64_tr_b16 v[188:189], v28 offset:24576
    ds_read_b64_tr_b16 v[190:191], v28 offset:25088
    s_waitcnt lgkmcnt(0)
    ds_read_b64_tr_b16 v[224:225], v27 offset:8
    ds_read_b64_tr_b16 v[226:227], v27 offset:520
    ds_read_b64_tr_b16 v[228:229], v27 offset:8200
    ds_read_b64_tr_b16 v[230:231], v27 offset:8712
    ds_read_b64_tr_b16 v[232:233], v27 offset:16392
    ds_read_b64_tr_b16 v[234:235], v27 offset:16904
    ds_read_b64_tr_b16 v[236:237], v27 offset:24584
    ds_read_b64_tr_b16 v[238:239], v27 offset:25096
    ds_read_b64_tr_b16 v[240:241], v28 offset:8
    ds_read_b64_tr_b16 v[242:243], v28 offset:520
    ds_read_b64_tr_b16 v[244:245], v28 offset:8200
    ds_read_b64_tr_b16 v[246:247], v28 offset:8712
    ds_read_b64_tr_b16 v[248:249], v28 offset:16392
    ds_read_b64_tr_b16 v[250:251], v28 offset:16904
    ds_read_b64_tr_b16 v[252:253], v28 offset:24584
    ds_read_b64_tr_b16 v[254:255], v28 offset:25096
    s_waitcnt lgkmcnt(0)
    s_branch L_ini_j1
L_ini_b1:
    ds_read_b64_tr_b16 v[128:129], v27 offset:0
    ds_read_b64_tr_b16 v[130:131], v27 offset:512
    ds_read_b64_tr_b16 v[132:133], v27 offset:8192
    ds_read_b64_tr_b16 v[134:135], v27 offset:8704
    ds_read_b64_tr_b16 v[136:137], v27 offset:16384
    ds_read_b64_tr_b16 v[138:139], v27 offset:16896
    ds_read_b64_tr_b16 v[140:141], v27 offset:24576
    ds_read_b64_tr_b16 v[142:143], v27 offset:25088
    ds_read_b64_tr_b16 v[144:145], v28 offset:0
    ds_read_b64_tr_b16 v[146:147], v28 offset:512
    ds_read_b64_tr_b16 v[148:149], v28 offset:8192
    ds_read_b64_tr_b16 v[150:151], v28 offset:8704
    ds_read_b64_tr_b16 v[152:153], v28 offset:16384
    ds_read_b64_tr_b16 v[154:155], v28 offset:16896
    ds_read_b64_tr_b16 v[156:157], v28 offset:24576
    ds_read_b64_tr_b16 v[158:159], v28 offset:25088
    s_waitcnt lgkmcnt(0)
    ds_read_b64_tr_b16 v[192:193], v27 offset:8
    ds_read_b64_tr_b16 v[194:195], v27 offset:520
    ds_read_b64_tr_b16 v[196:197], v27 offset:8200
    ds_read_b64_tr_b16 v[198:199], v27 offset:8712
    ds_read_b64_tr_b16 v[200:201], v27 offset:16392
    ds_read_b64_tr_b16 v[202:203], v27 offset:16904
    ds_read_b64_tr_b16 v[204:205], v27 offset:24584
    ds_read_b64_tr_b16 v[206:207], v27 offset:25096
    ds_read_b64_tr_b16 v[208:209], v28 offset:8
    ds_read_b64_tr_b16 v[210:211], v28 offset:520
    ds_read_b64_tr_b16 v[212:213], v28 offset:8200
    ds_read_b64_tr_b16 v[214:215], v28 offset:8712
    ds_read_b64_tr_b16 v[216:217], v28 offset:16392
    ds_read_b64_tr_b16 v[218:219], v28 offset:16904
    ds_read_b64_tr_b16 v[220:221], v28 offset:24584
    ds_read_b64_tr_b16 v[222:223], v28 offset:25096
    s_waitcnt lgkmcnt(0)
L_ini_j1:
    s_barrier
    s_lshl_b32 s36, s31, 8
    s_lshl_b32 s37, s30, 19
    s_add_u32 s36, s36, s37
    s_add_u32 s36, s36, 0x200000
    s_lshl_b32 s38, s30, 14
    s_add_u32 s38, s38, 65536
    s_mov_b32 m0, s38
    s_add_u32 s38, s38, 1024
    buffer_load_dwordx4 v20, s[8:11], s36 offen lds
    s_add_u32 s36, s36, 32768
    s_mov_b32 m0, s38
    s_add_u32 s38, s38, 1024
    buffer_load_dwordx4 v20, s[8:11], s36 offen lds
    s_add_u32 s36, s36, 32768
    s_mov_b32 m0, s38
    s_add_u32 s38, s38, 1024
    buffer_load_dwordx4 v20, s[8:11], s36 offen lds
    s_add_u32 s36, s36, 32768
    s_mov_b32 m0, s38
    s_add_u32 s38, s38, 1024
    buffer_load_dwordx4 v20, s[8:11], s36 offen lds
    s_add_u32 s36, s36, 32768
    s_mov_b32 m0, s38
    s_add_u32 s38, s38, 1024
    buffer_load_dwordx4 v20, s[8:11], s36 offen lds
    s_add_u32 s36, s36, 32768
    s_mov_b32 m0, s38
    s_add_u32 s38, s38, 1024
    buffer_load_dwordx4 v20, s[8:11], s36 offen lds
    s_add_u32 s36, s36, 32768
    s_mov_b32 m0, s38
    s_add_u32 s38, s38, 1024
    buffer_load_dwordx4 v20, s[8:11], s36 offen lds
    s_add_u32 s36, s36, 32768
    s_mov_b32 m0, s38
    s_add_u32 s38, s38, 1024
    buffer_load_dwordx4 v20, s[8:11], s36 offen lds
    s_add_u32 s36, s36, 32768
    s_mov_b32 m0, s38
    s_add_u32 s38, s38, 1024
    buffer_load_dwordx4 v20, s[8:11], s36 offen lds
    s_add_u32 s36, s36, 32768
    s_mov_b32 m0, s38
    s_add_u32 s38, s38, 1024
    buffer_load_dwordx4 v20, s[8:11], s36 offen lds
    s_add_u32 s36, s36, 32768
    s_mov_b32 m0, s38
    s_add_u32 s38, s38, 1024
    buffer_load_dwordx4 v20, s[8:11], s36 offen lds
    s_add_u32 s36, s36, 32768
    s_mov_b32 m0, s38
    s_add_u32 s38, s38, 1024
    buffer_load_dwordx4 v20, s[8:11], s36 offen lds
    s_add_u32 s36, s36, 32768
    s_mov_b32 m0, s38
    s_add_u32 s38, s38, 1024
    buffer_load_dwordx4 v20, s[8:11], s36 offen lds
    s_add_u32 s36, s36, 32768
    s_mov_b32 m0, s38
    s_add_u32 s38, s38, 1024
    buffer_load_dwordx4 v20, s[8:11], s36 offen lds
    s_add_u32 s36, s36, 32768
    s_mov_b32 m0, s38
    s_add_u32 s38, s38, 1024
    buffer_load_dwordx4 v20, s[8:11], s36 offen lds
    s_add_u32 s36, s36, 32768
    s_mov_b32 m0, s38
    s_add_u32 s38, s38, 1024
    buffer_load_dwordx4 v20, s[8:11], s36 offen lds
    s_add_u32 s36, s36, 32768
    s_waitcnt vmcnt(16)
    s_barrier
    s_add_u32 s36, s39, 0
    v_add_u32 v27, s36, v21
    s_add_u32 s36, s41, 0
    v_add_u32 v28, s36, v21
    s_cmp_ge_u32 s30, 2
    s_cbranch_scc1 L_ini_b2
    ds_read_b64_tr_b16 a[0:1], v27 offset:0
    ds_read_b64_tr_b16 a[2:3], v27 offset:512
    ds_read_b64_tr_b16 a[4:5], v27 offset:8192
    ds_read_b64_tr_b16 a[6:7], v27 offset:8704
    ds_read_b64_tr_b16 a[8:9], v27 offset:16384
    ds_read_b64_tr_b16 a[10:11], v27 offset:16896
    ds_read_b64_tr_b16 a[12:13], v27 offset:24576
    ds_read_b64_tr_b16 a[14:15], v27 offset:25088
    ds_read_b64_tr_b16 a[16:17], v28 offset:0
    ds_read_b64_tr_b16 a[18:19], v28 offset:512
    ds_read_b64_tr_b16 a[20:21], v28 offset:8192
    ds_read_b64_tr_b16 a[22:23], v28 offset:8704
    ds_read_b64_tr_b16 a[24:25], v28 offset:16384
    ds_read_b64_tr_b16 a[26:27], v28 offset:16896
    ds_read_b64_tr_b16 a[28:29], v28 offset:24576
    ds_read_b64_tr_b16 a[30:31], v28 offset:25088
    s_waitcnt lgkmcnt(0)
    ds_read_b64_tr_b16 a[64:65], v27 offset:32
    ds_read_b64_tr_b16 a[66:67], v27 offset:544
    ds_read_b64_tr_b16 a[68:69], v27 offset:8224
    ds_read_b64_tr_b16 a[70:71], v27 offset:8736
    ds_read_b64_tr_b16 a[72:73], v27 offset:16416
    ds_read_b64_tr_b16 a[74:75], v27 offset:16928
    ds_read_b64_tr_b16 a[76:77], v27 offset:24608
    ds_read_b64_tr_b16 a[78:79], v27 offset:25120
    ds_read_b64_tr_b16 a[80:81], v28 offset:32
    ds_read_b64_tr_b16 a[82:83], v28 offset:544
    ds_read_b64_tr_b16 a[84:85], v28 offset:8224
    ds_read_b64_tr_b16 a[86:87], v28 offset:8736
    ds_read_b64_tr_b16 a[88:89], v28 offset:16416
    ds_read_b64_tr_b16 a[90:91], v28 offset:16928
    ds_read_b64_tr_b16 a[92:93], v28 offset:24608
    ds_read_b64_tr_b16 a[94:95], v28 offset:25120
    s_waitcnt lgkmcnt(0)
    s_branch L_ini_j2
L_ini_b2:
    ds_read_b64_tr_b16 a[32:33], v27 offset:0
    ds_read_b64_tr_b16 a[34:35], v27 offset:512
    ds_read_b64_tr_b16 a[36:37], v27 offset:8192
    ds_read_b64_tr_b16 a[38:39], v27 offset:8704
    ds_read_b64_tr_b16 a[40:41], v27 offset:16384
    ds_read_b64_tr_b16 a[42:43], v27 offset:16896
    ds_read_b64_tr_b16 a[44:45], v27 offset:24576
    ds_read_b64_tr_b16 a[46:47], v27 offset:25088
    ds_read_b64_tr_b16 a[48:49], v28 offset:0
    ds_read_b64_tr_b16 a[50:51], v28 offset:512
    ds_read_b64_tr_b16 a[52:53], v28 offset:8192
    ds_read_b64_tr_b16 a[54:55], v28 offset:8704
    ds_read_b64_tr_b16 a[56:57], v28 offset:16384
    ds_read_b64_tr_b16 a[58:59], v28 offset:16896
    ds_read_b64_tr_b16 a[60:61], v28 offset:24576
    ds_read_b64_tr_b16 a[62:63], v28 offset:25088
    s_waitcnt lgkmcnt(0)
    ds_read_b64_tr_b16 a[96:97], v27 offset:32
    ds_read_b64_tr_b16 a[98:99], v27 offset:544
    ds_read_b64_tr_b16 a[100:101], v27 offset:8224
    ds_read_b64_tr_b16 a[102:103], v27 offset:8736
    ds_read_b64_tr_b16 a[104:105], v27 offset:16416
    ds_read_b64_tr_b16 a[106:107], v27 offset:16928
    ds_read_b64_tr_b16 a[108:109], v27 offset:24608
    ds_read_b64_tr_b16 a[110:111], v27 offset:25120
    ds_read_b64_tr_b16 a[112:113], v28 offset:32
    ds_read_b64_tr_b16 a[114:115], v28 offset:544
    ds_read_b64_tr_b16 a[116:117], v28 offset:8224
    ds_read_b64_tr_b16 a[118:119], v28 offset:8736
    ds_read_b64_tr_b16 a[120:121], v28 offset:16416
    ds_read_b64_tr_b16 a[122:123], v28 offset:16928
    ds_read_b64_tr_b16 a[124:125], v28 offset:24608
    ds_read_b64_tr_b16 a[126:127], v28 offset:25120
    s_waitcnt lgkmcnt(0)
L_ini_j2:
    s_barrier
    s_lshl_b32 s36, s31, 17
    s_lshl_b32 s37, s30, 14
    s_add_u32 s36, s36, s37
    s_add_u32 s36, s36, 0
    s_lshl_b32 s38, s30, 14
    s_add_u32 s38, s38, 0
    s_mov_b32 m0, s38
    s_add_u32 s38, s38, 1024
    buffer_load_dwordx4 v0, s[20:23], s36 offen lds
    s_add_u32 s36, s36, 1024
    s_mov_b32 m0, s38
    s_add_u32 s38, s38, 1024
    buffer_load_dwordx4 v0, s[20:23], s36 offen lds
    s_add_u32 s36, s36, 1024
    s_mov_b32 m0, s38
    s_add_u32 s38, s38, 1024
    buffer_load_dwordx4 v0, s[20:23], s36 offen lds
    s_add_u32 s36, s36, 1024
    s_mov_b32 m0, s38
    s_add_u32 s38, s38, 1024
    buffer_load_dwordx4 v0, s[20:23], s36 offen lds
    s_add_u32 s36, s36, 1024
    s_mov_b32 m0, s38
    s_add_u32 s38, s38, 1024
    buffer_load_dwordx4 v0, s[20:23], s36 offen lds
    s_add_u32 s36, s36, 1024
    s_mov_b32 m0, s38
    s_add_u32 s38, s38, 1024
    buffer_load_dwordx4 v0, s[20:23], s36 offen lds
    s_add_u32 s36, s36, 1024
    s_mov_b32 m0, s38
    s_add_u32 s38, s38, 1024
    buffer_load_dwordx4 v0, s[20:23], s36 offen lds
    s_add_u32 s36, s36, 1024
    s_mov_b32 m0, s38
    s_add_u32 s38, s38, 1024
    buffer_load_dwordx4 v0, s[20:23], s36 offen lds
    s_add_u32 s36, s36, 1024
    s_mov_b32 m0, s38
    s_add_u32 s38, s38, 1024
    buffer_load_dwordx4 v0, s[20:23], s36 offen lds
    s_add_u32 s36, s36, 1024
    s_mov_b32 m0, s38
    s_add_u32 s38, s38, 1024
    buffer_load_dwordx4 v0, s[20:23], s36 offen lds
    s_add_u32 s36, s36, 1024
    s_mov_b32 m0, s38
    s_add_u32 s38, s38, 1024
    buffer_load_dwordx4 v0, s[20:23], s36 offen lds
    s_add_u32 s36, s36, 1024
    s_mov_b32 m0, s38
    s_add_u32 s38, s38, 1024
    buffer_load_dwordx4 v0, s[20:23], s36 offen lds
    s_add_u32 s36, s36, 1024
    s_mov_b32 m0, s38
    s_add_u32 s38, s38, 1024
    buffer_load_dwordx4 v0, s[20:23], s36 offen lds
    s_add_u32 s36, s36, 1024
    s_mov_b32 m0, s38
    s_add_u32 s38, s38, 1024
    buffer_load_dwordx4 v0, s[20:23], s36 offen lds
    s_add_u32 s36, s36, 1024
    s_mov_b32 m0, s38
    s_add_u32 s38, s38, 1024
    buffer_load_dwordx4 v0, s[20:23], s36 offen lds
    s_add_u32 s36, s36, 1024
    s_mov_b32 m0, s38
    s_add_u32 s38, s38, 1024
    buffer_load_dwordx4 v0, s[20:23], s36 offen lds
    s_add_u32 s36, s36, 1024
    s_waitcnt vmcnt(16)
    s_barrier
    s_add_u32 s36, s39, 65536
    v_add_u32 v27, s36, v21
    s_add_u32 s36, s41, 65536
    v_add_u32 v28, s36, v21
    s_cmp_ge_u32 s30, 2
    s_cbranch_scc1 L_ini_b3
    ds_read_b64_tr_b16 a[32:33], v27 offset:0
    ds_read_b64_tr_b16 a[34:35], v27 offset:512
    ds_read_b64_tr_b16 a[36:37], v27 offset:8192
    ds_read_b64_tr_b16 a[38:39], v27 offset:8704
    ds_read_b64_tr_b16 a[40:41], v27 offset:16384
    ds_read_b64_tr_b16 a[42:43], v27 offset:16896
    ds_read_b64_tr_b16 a[44:45], v27 offset:24576
    ds_read_b64_tr_b16 a[46:47], v27 offset:25088
    ds_read_b64_tr_b16 a[48:49], v28 offset:0
    ds_read_b64_tr_b16 a[50:51], v28 offset:512
    ds_read_b64_tr_b16 a[52:53], v28 offset:8192
    ds_read_b64_tr_b16 a[54:55], v28 offset:8704
    ds_read_b64_tr_b16 a[56:57], v28 offset:16384
    ds_read_b64_tr_b16 a[58:59], v28 offset:16896
    ds_read_b64_tr_b16 a[60:61], v28 offset:24576
    ds_read_b64_tr_b16 a[62:63], v28 offset:25088
    s_waitcnt lgkmcnt(0)
    ds_read_b64_tr_b16 a[96:97], v27 offset:32
    ds_read_b64_tr_b16 a[98:99], v27 offset:544
    ds_read_b64_tr_b16 a[100:101], v27 offset:8224
    ds_read_b64_tr_b16 a[102:103], v27 offset:8736
    ds_read_b64_tr_b16 a[104:105], v27 offset:16416
    ds_read_b64_tr_b16 a[106:107], v27 offset:16928
    ds_read_b64_tr_b16 a[108:109], v27 offset:24608
    ds_read_b64_tr_b16 a[110:111], v27 offset:25120
    ds_read_b64_tr_b16 a[112:113], v28 offset:32
    ds_read_b64_tr_b16 a[114:115], v28 offset:544
    ds_read_b64_tr_b16 a[116:117], v28 offset:8224
    ds_read_b64_tr_b16 a[118:119], v28 offset:8736
    ds_read_b64_tr_b16 a[120:121], v28 offset:16416
    ds_read_b64_tr_b16 a[122:123], v28 offset:16928
    ds_read_b64_tr_b16 a[124:125], v28 offset:24608
    ds_read_b64_tr_b16 a[126:127], v28 offset:25120
    s_waitcnt lgkmcnt(0)
    s_branch L_ini_j3
L_ini_b3:
    ds_read_b64_tr_b16 a[0:1], v27 offset:0
    ds_read_b64_tr_b16 a[2:3], v27 offset:512
    ds_read_b64_tr_b16 a[4:5], v27 offset:8192
    ds_read_b64_tr_b16 a[6:7], v27 offset:8704
    ds_read_b64_tr_b16 a[8:9], v27 offset:16384
    ds_read_b64_tr_b16 a[10:11], v27 offset:16896
    ds_read_b64_tr_b16 a[12:13], v27 offset:24576
    ds_read_b64_tr_b16 a[14:15], v27 offset:25088
    ds_read_b64_tr_b16 a[16:17], v28 offset:0
    ds_read_b64_tr_b16 a[18:19], v28 offset:512
    ds_read_b64_tr_b16 a[20:21], v28 offset:8192
    ds_read_b64_tr_b16 a[22:23], v28 offset:8704
    ds_read_b64_tr_b16 a[24:25], v28 offset:16384
    ds_read_b64_tr_b16 a[26:27], v28 offset:16896
    ds_read_b64_tr_b16 a[28:29], v28 offset:24576
    ds_read_b64_tr_b16 a[30:31], v28 offset:25088
    s_waitcnt lgkmcnt(0)
    ds_read_b64_tr_b16 a[64:65], v27 offset:32
    ds_read_b64_tr_b16 a[66:67], v27 offset:544
    ds_read_b64_tr_b16 a[68:69], v27 offset:8224
    ds_read_b64_tr_b16 a[70:71], v27 offset:8736
    ds_read_b64_tr_b16 a[72:73], v27 offset:16416
    ds_read_b64_tr_b16 a[74:75], v27 offset:16928
    ds_read_b64_tr_b16 a[76:77], v27 offset:24608
    ds_read_b64_tr_b16 a[78:79], v27 offset:25120
    ds_read_b64_tr_b16 a[80:81], v28 offset:32
    ds_read_b64_tr_b16 a[82:83], v28 offset:544
    ds_read_b64_tr_b16 a[84:85], v28 offset:8224
    ds_read_b64_tr_b16 a[86:87], v28 offset:8736
    ds_read_b64_tr_b16 a[88:89], v28 offset:16416
    ds_read_b64_tr_b16 a[90:91], v28 offset:16928
    ds_read_b64_tr_b16 a[92:93], v28 offset:24608
    ds_read_b64_tr_b16 a[94:95], v28 offset:25120
    s_waitcnt lgkmcnt(0)
L_ini_j3:
    s_barrier
    s_lshl_b32 s36, s31, 17
    s_lshl_b32 s37, s30, 14
    s_add_u32 s36, s36, s37
    s_add_u32 s36, s36, 65536
    s_lshl_b32 s38, s30, 14
    s_add_u32 s38, s38, 65536
    s_mov_b32 m0, s38
    s_add_u32 s38, s38, 1024
    buffer_load_dwordx4 v0, s[20:23], s36 offen lds
    s_add_u32 s36, s36, 1024
    s_mov_b32 m0, s38
    s_add_u32 s38, s38, 1024
    buffer_load_dwordx4 v0, s[20:23], s36 offen lds
    s_add_u32 s36, s36, 1024
    s_mov_b32 m0, s38
    s_add_u32 s38, s38, 1024
    buffer_load_dwordx4 v0, s[20:23], s36 offen lds
    s_add_u32 s36, s36, 1024
    s_mov_b32 m0, s38
    s_add_u32 s38, s38, 1024
    buffer_load_dwordx4 v0, s[20:23], s36 offen lds
    s_add_u32 s36, s36, 1024
    s_mov_b32 m0, s38
    s_add_u32 s38, s38, 1024
    buffer_load_dwordx4 v0, s[20:23], s36 offen lds
    s_add_u32 s36, s36, 1024
    s_mov_b32 m0, s38
    s_add_u32 s38, s38, 1024
    buffer_load_dwordx4 v0, s[20:23], s36 offen lds
    s_add_u32 s36, s36, 1024
    s_mov_b32 m0, s38
    s_add_u32 s38, s38, 1024
    buffer_load_dwordx4 v0, s[20:23], s36 offen lds
    s_add_u32 s36, s36, 1024
    s_mov_b32 m0, s38
    s_add_u32 s38, s38, 1024
    buffer_load_dwordx4 v0, s[20:23], s36 offen lds
    s_add_u32 s36, s36, 1024
    s_mov_b32 m0, s38
    s_add_u32 s38, s38, 1024
    buffer_load_dwordx4 v0, s[20:23], s36 offen lds
    s_add_u32 s36, s36, 1024
    s_mov_b32 m0, s38
    s_add_u32 s38, s38, 1024
    buffer_load_dwordx4 v0, s[20:23], s36 offen lds
    s_add_u32 s36, s36, 1024
    s_mov_b32 m0, s38
    s_add_u32 s38, s38, 1024
    buffer_load_dwordx4 v0, s[20:23], s36 offen lds
    s_add_u32 s36, s36, 1024
    s_mov_b32 m0, s38
    s_add_u32 s38, s38, 1024
    buffer_load_dwordx4 v0, s[20:23], s36 offen lds
    s_add_u32 s36, s36, 1024
    s_mov_b32 m0, s38
    s_add_u32 s38, s38, 1024
    buffer_load_dwordx4 v0, s[20:23], s36 offen lds
    s_add_u32 s36, s36, 1024
    s_mov_b32 m0, s38
    s_add_u32 s38, s38, 1024
    buffer_load_dwordx4 v0, s[20:23], s36 offen lds
    s_add_u32 s36, s36, 1024
    s_mov_b32 m0, s38
    s_add_u32 s38, s38, 1024
    buffer_load_dwordx4 v0, s[20:23], s36 offen lds
    s_add_u32 s36, s36, 1024
    s_mov_b32 m0, s38
    s_add_u32 s38, s38, 1024
    buffer_load_dwordx4 v0, s[20:23], s36 offen lds
    s_add_u32 s36, s36, 1024
    s_waitcnt vmcnt(16)
    s_barrier
    v_add_u32 v26, 0, v23
    ds_read_b64_tr_b16 a[192:193], v26 offset:0
    ds_read_b64_tr_b16 a[194:195], v26 offset:2048
    ds_read_b64_tr_b16 a[196:197], v26 offset:16384
    ds_read_b64_tr_b16 a[198:199], v26 offset:18432
    ds_read_b64_tr_b16 a[224:225], v26 offset:32
    ds_read_b64_tr_b16 a[226:227], v26 offset:2080
    ds_read_b64_tr_b16 a[228:229], v26 offset:16416
    ds_read_b64_tr_b16 a[230:231], v26 offset:18464
    ds_read_b64_tr_b16 v[32:33], v26 offset:128
    ds_read_b64_tr_b16 v[34:35], v26 offset:2176
    ds_read_b64_tr_b16 v[36:37], v26 offset:16512
    ds_read_b64_tr_b16 v[38:39], v26 offset:18560
    ds_read_b64_tr_b16 v[64:65], v26 offset:160
    ds_read_b64_tr_b16 v[66:67], v26 offset:2208
    ds_read_b64_tr_b16 v[68:69], v26 offset:16544
    ds_read_b64_tr_b16 v[70:71], v26 offset:18592
    s_waitcnt lgkmcnt(0)
    ds_read_b64_tr_b16 a[200:201], v26 offset:32768
    ds_read_b64_tr_b16 a[202:203], v26 offset:34816
    ds_read_b64_tr_b16 a[204:205], v26 offset:49152
    ds_read_b64_tr_b16 a[206:207], v26 offset:51200
    ds_read_b64_tr_b16 a[232:233], v26 offset:32800
    ds_read_b64_tr_b16 a[234:235], v26 offset:34848
    ds_read_b64_tr_b16 a[236:237], v26 offset:49184
    ds_read_b64_tr_b16 a[238:239], v26 offset:51232
    ds_read_b64_tr_b16 v[40:41], v26 offset:32896
    ds_read_b64_tr_b16 v[42:43], v26 offset:34944
    ds_read_b64_tr_b16 v[44:45], v26 offset:49280
    ds_read_b64_tr_b16 v[46:47], v26 offset:51328
    ds_read_b64_tr_b16 v[72:73], v26 offset:32928
    ds_read_b64_tr_b16 v[74:75], v26 offset:34976
    ds_read_b64_tr_b16 v[76:77], v26 offset:49312
    ds_read_b64_tr_b16 v[78:79], v26 offset:51360
    s_waitcnt lgkmcnt(0)
    s_barrier
    s_lshl_b32 s36, s31, 8
    s_lshl_b32 s37, s30, 19
    s_add_u32 s36, s36, s37
    s_add_u32 s36, s36, 0x0
    s_lshl_b32 s38, s30, 14
    s_add_u32 s38, s38, 0
    s_mov_b32 m0, s38
    s_add_u32 s38, s38, 1024
    buffer_load_dwordx4 v20, s[12:15], s36 offen lds
    s_add_u32 s36, s36, 32768
    s_mov_b32 m0, s38
    s_add_u32 s38, s38, 1024
    buffer_load_dwordx4 v20, s[12:15], s36 offen lds
    s_add_u32 s36, s36, 32768
    s_mov_b32 m0, s38
    s_add_u32 s38, s38, 1024
    buffer_load_dwordx4 v20, s[12:15], s36 offen lds
    s_add_u32 s36, s36, 32768
    s_mov_b32 m0, s38
    s_add_u32 s38, s38, 1024
    buffer_load_dwordx4 v20, s[12:15], s36 offen lds
    s_add_u32 s36, s36, 32768
    s_mov_b32 m0, s38
    s_add_u32 s38, s38, 1024
    buffer_load_dwordx4 v20, s[12:15], s36 offen lds
    s_add_u32 s36, s36, 32768
    s_mov_b32 m0, s38
    s_add_u32 s38, s38, 1024
    buffer_load_dwordx4 v20, s[12:15], s36 offen lds
    s_add_u32 s36, s36, 32768
    s_mov_b32 m0, s38
    s_add_u32 s38, s38, 1024
    buffer_load_dwordx4 v20, s[12:15], s36 offen lds
    s_add_u32 s36, s36, 32768
    s_mov_b32 m0, s38
    s_add_u32 s38, s38, 1024
    buffer_load_dwordx4 v20, s[12:15], s36 offen lds
    s_add_u32 s36, s36, 32768
    s_mov_b32 m0, s38
    s_add_u32 s38, s38, 1024
    buffer_load_dwordx4 v20, s[12:15], s36 offen lds
    s_add_u32 s36, s36, 32768
    s_mov_b32 m0, s38
    s_add_u32 s38, s38, 1024
    buffer_load_dwordx4 v20, s[12:15], s36 offen lds
    s_add_u32 s36, s36, 32768
    s_mov_b32 m0, s38
    s_add_u32 s38, s38, 1024
    buffer_load_dwordx4 v20, s[12:15], s36 offen lds
    s_add_u32 s36, s36, 32768
    s_mov_b32 m0, s38
    s_add_u32 s38, s38, 1024
    buffer_load_dwordx4 v20, s[12:15], s36 offen lds
    s_add_u32 s36, s36, 32768
    s_mov_b32 m0, s38
    s_add_u32 s38, s38, 1024
    buffer_load_dwordx4 v20, s[12:15], s36 offen lds
    s_add_u32 s36, s36, 32768
    s_mov_b32 m0, s38
    s_add_u32 s38, s38, 1024
    buffer_load_dwordx4 v20, s[12:15], s36 offen lds
    s_add_u32 s36, s36, 32768
    s_mov_b32 m0, s38
    s_add_u32 s38, s38, 1024
    buffer_load_dwordx4 v20, s[12:15], s36 offen lds
    s_add_u32 s36, s36, 32768
    s_mov_b32 m0, s38
    s_add_u32 s38, s38, 1024
    buffer_load_dwordx4 v20, s[12:15], s36 offen lds
    s_add_u32 s36, s36, 32768
    s_waitcnt vmcnt(16)
    s_barrier
    v_add_u32 v26, 65536, v23
    ds_read_b64_tr_b16 a[208:209], v26 offset:0
    ds_read_b64_tr_b16 a[210:211], v26 offset:2048
    ds_read_b64_tr_b16 a[212:213], v26 offset:16384
    ds_read_b64_tr_b16 a[214:215], v26 offset:18432
    ds_read_b64_tr_b16 a[240:241], v26 offset:32
    ds_read_b64_tr_b16 a[242:243], v26 offset:2080
    ds_read_b64_tr_b16 a[244:245], v26 offset:16416
    ds_read_b64_tr_b16 a[246:247], v26 offset:18464
    ds_read_b64_tr_b16 v[48:49], v26 offset:128
    ds_read_b64_tr_b16 v[50:51], v26 offset:2176
    ds_read_b64_tr_b16 v[52:53], v26 offset:16512
    ds_read_b64_tr_b16 v[54:55], v26 offset:18560
    ds_read_b64_tr_b16 v[80:81], v26 offset:160
    ds_read_b64_tr_b16 v[82:83], v26 offset:2208
    ds_read_b64_tr_b16 v[84:85], v26 offset:16544
    ds_read_b64_tr_b16 v[86:87], v26 offset:18592
    s_waitcnt lgkmcnt(0)
    ds_read_b64_tr_b16 a[216:217], v26 offset:32768
    ds_read_b64_tr_b16 a[218:219], v26 offset:34816
    ds_read_b64_tr_b16 a[220:221], v26 offset:49152
    ds_read_b64_tr_b16 a[222:223], v26 offset:51200
    ds_read_b64_tr_b16 a[248:249], v26 offset:32800
    ds_read_b64_tr_b16 a[250:251], v26 offset:34848
    ds_read_b64_tr_b16 a[252:253], v26 offset:49184
    ds_read_b64_tr_b16 a[254:255], v26 offset:51232
    ds_read_b64_tr_b16 v[56:57], v26 offset:32896
    ds_read_b64_tr_b16 v[58:59], v26 offset:34944
    ds_read_b64_tr_b16 v[60:61], v26 offset:49280
    ds_read_b64_tr_b16 v[62:63], v26 offset:51328
    ds_read_b64_tr_b16 v[88:89], v26 offset:32928
    ds_read_b64_tr_b16 v[90:91], v26 offset:34976
    ds_read_b64_tr_b16 v[92:93], v26 offset:49312
    ds_read_b64_tr_b16 v[94:95], v26 offset:51360
    s_waitcnt lgkmcnt(0)
    s_barrier
    s_lshl_b32 s36, s31, 8
    s_lshl_b32 s37, s30, 19
    s_add_u32 s36, s36, s37
    s_add_u32 s36, s36, 0x200000
    s_lshl_b32 s38, s30, 14
    s_add_u32 s38, s38, 65536
    s_mov_b32 m0, s38
    s_add_u32 s38, s38, 1024
    buffer_load_dwordx4 v20, s[12:15], s36 offen lds
    s_add_u32 s36, s36, 32768
    s_mov_b32 m0, s38
    s_add_u32 s38, s38, 1024
    buffer_load_dwordx4 v20, s[12:15], s36 offen lds
    s_add_u32 s36, s36, 32768
    s_mov_b32 m0, s38
    s_add_u32 s38, s38, 1024
    buffer_load_dwordx4 v20, s[12:15], s36 offen lds
    s_add_u32 s36, s36, 32768
    s_mov_b32 m0, s38
    s_add_u32 s38, s38, 1024
    buffer_load_dwordx4 v20, s[12:15], s36 offen lds
    s_add_u32 s36, s36, 32768
    s_mov_b32 m0, s38
    s_add_u32 s38, s38, 1024
    buffer_load_dwordx4 v20, s[12:15], s36 offen lds
    s_add_u32 s36, s36, 32768
    s_mov_b32 m0, s38
    s_add_u32 s38, s38, 1024
    buffer_load_dwordx4 v20, s[12:15], s36 offen lds
    s_add_u32 s36, s36, 32768
    s_mov_b32 m0, s38
    s_add_u32 s38, s38, 1024
    buffer_load_dwordx4 v20, s[12:15], s36 offen lds
    s_add_u32 s36, s36, 32768
    s_mov_b32 m0, s38
    s_add_u32 s38, s38, 1024
    buffer_load_dwordx4 v20, s[12:15], s36 offen lds
    s_add_u32 s36, s36, 32768
    s_mov_b32 m0, s38
    s_add_u32 s38, s38, 1024
    buffer_load_dwordx4 v20, s[12:15], s36 offen lds
    s_add_u32 s36, s36, 32768
    s_mov_b32 m0, s38
    s_add_u32 s38, s38, 1024
    buffer_load_dwordx4 v20, s[12:15], s36 offen lds
    s_add_u32 s36, s36, 32768
    s_mov_b32 m0, s38
    s_add_u32 s38, s38, 1024
    buffer_load_dwordx4 v20, s[12:15], s36 offen lds
    s_add_u32 s36, s36, 32768
    s_mov_b32 m0, s38
    s_add_u32 s38, s38, 1024
    buffer_load_dwordx4 v20, s[12:15], s36 offen lds
    s_add_u32 s36, s36, 32768
    s_mov_b32 m0, s38
    s_add_u32 s38, s38, 1024
    buffer_load_dwordx4 v20, s[12:15], s36 offen lds
    s_add_u32 s36, s36, 32768
    s_mov_b32 m0, s38
    s_add_u32 s38, s38, 1024
    buffer_load_dwordx4 v20, s[12:15], s36 offen lds
    s_add_u32 s36, s36, 32768
    s_mov_b32 m0, s38
    s_add_u32 s38, s38, 1024
    buffer_load_dwordx4 v20, s[12:15], s36 offen lds
    s_add_u32 s36, s36, 32768
    s_mov_b32 m0, s38
    s_add_u32 s38, s38, 1024
    buffer_load_dwordx4 v20, s[12:15], s36 offen lds
    s_add_u32 s36, s36, 32768
    s_cmp_lg_u32 s30, 0
    s_cbranch_scc1 L_wid_ok_chain
    s_mov_b32 s36, 0
L_wid_chain:
    s_load_dword s37, s[24:25], 32 glc
    s_waitcnt lgkmcnt(0)
    s_cmp_ge_u32 s37, 256
    s_cbranch_scc1 L_wid_ok_chain
    s_sleep 32
    s_add_u32 s36, s36, 1
    s_cmp_lt_u32 s36, 65536
    s_cbranch_scc1 L_wid_chain
    s_mov_b32 s33, 1
L_wid_ok_chain:
    s_barrier
    s_lshl_b32 s36, s32, 19
    s_lshl_b32 s37, s31, 13
    s_add_u32 s36, s36, s37
    s_lshl_b32 s37, s30, 11
    s_add_u32 s36, s36, s37
    s_add_u32 s36, s36, 0x100000
    s_add_u32 s37, s36, 0x40000
    buffer_load_dwordx4 v[16:19], v0, s[4:7], s36 offen offset:0 sc1
    buffer_load_dwordx4 v[16:19], v0, s[4:7], s36 offen offset:1024 sc1
    buffer_load_dwordx4 v[16:19], v0, s[4:7], s37 offen offset:0 sc1
    buffer_load_dwordx4 v[16:19], v0, s[4:7], s37 offen offset:1024 sc1
    v_lshlrev_b32 v29, 19, v31
    s_lshl_b32 s36, s32, 24
    s_add_u32 s36, s36, 0x1000000
    s_mov_b64 exec, 0xffffffff
    buffer_load_dword v30, v29, s[4:7], s36 offen
    s_lshl_b32 s36, s32, 24
    s_add_u32 s36, s36, 0x3000000
    s_mov_b64 exec, 0xffffffff
    buffer_load_dword v30, v29, s[4:7], s36 offen
    s_lshl_b32 s36, s32, 23
    s_add_u32 s36, s36, 0x7000000
    s_mov_b64 exec, 0xffff
    buffer_load_dword v30, v29, s[4:7], s36 offen
    s_lshl_b32 s36, s32, 22
    s_add_u32 s36, s36, 0x8000000
    s_mov_b64 exec, 0xff
    buffer_load_dword v30, v29, s[4:7], s36 offen
    s_mov_b64 exec, -1
    s_lshl_b32 s36, s32, 15
    s_lshl_b32 s37, s30, 13
    s_add_u32 s36, s36, s37
    s_add_u32 s36, s36, 0x10000
    s_add_u32 s37, s36, 4096
    buffer_load_dwordx4 v[16:19], v0, s[4:7], s36 offen offset:0 sc1
    buffer_load_dwordx4 v[16:19], v0, s[4:7], s36 offen offset:1024 sc1
    buffer_load_dwordx4 v[16:19], v0, s[4:7], s36 offen offset:2048 sc1
    buffer_load_dwordx4 v[16:19], v0, s[4:7], s36 offen offset:3072 sc1
    buffer_load_dwordx4 v[16:19], v0, s[4:7], s37 offen offset:0 sc1
    buffer_load_dwordx4 v[16:19], v0, s[4:7], s37 offen offset:1024 sc1
    buffer_load_dwordx4 v[16:19], v0, s[4:7], s37 offen offset:2048 sc1
    buffer_load_dwordx4 v[16:19], v0, s[4:7], s37 offen offset:3072 sc1
    s_waitcnt vmcnt(32)
    s_barrier
    s_add_u32 s36, s39, 0
    v_add_u32 v27, s36, v21
    s_add_u32 s36, s41, 0
    v_add_u32 v28, s36, v21
    s_cmp_ge_u32 s30, 2
    s_cbranch_scc1 L_ini_b6
    ds_read_b64_tr_b16 a[128:129], v27 offset:0
    ds_read_b64_tr_b16 a[130:131], v27 offset:512
    ds_read_b64_tr_b16 a[132:133], v27 offset:8192
    ds_read_b64_tr_b16 a[134:135], v27 offset:8704
    ds_read_b64_tr_b16 a[136:137], v27 offset:16384
    ds_read_b64_tr_b16 a[138:139], v27 offset:16896
    ds_read_b64_tr_b16 a[140:141], v27 offset:24576
    ds_read_b64_tr_b16 a[142:143], v27 offset:25088
    ds_read_b64_tr_b16 a[144:145], v28 offset:0
    ds_read_b64_tr_b16 a[146:147], v28 offset:512
    ds_read_b64_tr_b16 a[148:149], v28 offset:8192
    ds_read_b64_tr_b16 a[150:151], v28 offset:8704
    ds_read_b64_tr_b16 a[152:153], v28 offset:16384
    ds_read_b64_tr_b16 a[154:155], v28 offset:16896
    ds_read_b64_tr_b16 a[156:157], v28 offset:24576
    ds_read_b64_tr_b16 a[158:159], v28 offset:25088
    s_waitcnt lgkmcnt(0)
    ds_read_b64_tr_b16 v[96:97], v27 offset:32
    ds_read_b64_tr_b16 v[98:99], v27 offset:544
    ds_read_b64_tr_b16 v[100:101], v27 offset:8224
    ds_read_b64_tr_b16 v[102:103], v27 offset:8736
    ds_read_b64_tr_b16 v[104:105], v27 offset:16416
    ds_read_b64_tr_b16 v[106:107], v27 offset:16928
    ds_read_b64_tr_b16 v[108:109], v27 offset:24608
    ds_read_b64_tr_b16 v[110:111], v27 offset:25120
    ds_read_b64_tr_b16 v[112:113], v28 offset:32
    ds_read_b64_tr_b16 v[114:115], v28 offset:544
    ds_read_b64_tr_b16 v[116:117], v28 offset:8224
    ds_read_b64_tr_b16 v[118:119], v28 offset:8736
    ds_read_b64_tr_b16 v[120:121], v28 offset:16416
    ds_read_b64_tr_b16 v[122:123], v28 offset:16928
    ds_read_b64_tr_b16 v[124:125], v28 offset:24608
    ds_read_b64_tr_b16 v[126:127], v28 offset:25120
    s_waitcnt lgkmcnt(0)
    s_branch L_ini_j6
L_ini_b6:
    ds_read_b64_tr_b16 a[160:161], v27 offset:0
    ds_read_b64_tr_b16 a[162:163], v27 offset:512
    ds_read_b64_tr_b16 a[164:165], v27 offset:8192
    ds_read_b64_tr_b16 a[166:167], v27 offset:8704
    ds_read_b64_tr_b16 a[168:169], v27 offset:16384
    ds_read_b64_tr_b16 a[170:171], v27 offset:16896
    ds_read_b64_tr_b16 a[172:173], v27 offset:24576
    ds_read_b64_tr_b16 a[174:175], v27 offset:25088
    ds_read_b64_tr_b16 a[176:177], v28 offset:0
    ds_read_b64_tr_b16 a[178:179], v28 offset:512
    ds_read_b64_tr_b16 a[180:181], v28 offset:8192
    ds_read_b64_tr_b16 a[182:183], v28 offset:8704
    ds_read_b64_tr_b16 a[184:185], v28 offset:16384
    ds_read_b64_tr_b16 a[186:187], v28 offset:16896
    ds_read_b64_tr_b16 a[188:189], v28 offset:24576
    ds_read_b64_tr_b16 a[190:191], v28 offset:25088
    s_waitcnt lgkmcnt(0)
    ds_read_b64_tr_b16 v[96:97], v27 offset:32
    ds_read_b64_tr_b16 v[98:99], v27 offset:544
    ds_read_b64_tr_b16 v[100:101], v27 offset:8224
    ds_read_b64_tr_b16 v[102:103], v27 offset:8736
    ds_read_b64_tr_b16 v[104:105], v27 offset:16416
    ds_read_b64_tr_b16 v[106:107], v27 offset:16928
    ds_read_b64_tr_b16 v[108:109], v27 offset:24608
    ds_read_b64_tr_b16 v[110:111], v27 offset:25120
    ds_read_b64_tr_b16 v[112:113], v28 offset:32
    ds_read_b64_tr_b16 v[114:115], v28 offset:544
    ds_read_b64_tr_b16 v[116:117], v28 offset:8224
    ds_read_b64_tr_b16 v[118:119], v28 offset:8736
    ds_read_b64_tr_b16 v[120:121], v28 offset:16416
    ds_read_b64_tr_b16 v[122:123], v28 offset:16928
    ds_read_b64_tr_b16 v[124:125], v28 offset:24608
    ds_read_b64_tr_b16 v[126:127], v28 offset:25120
    s_waitcnt lgkmcnt(0)
L_ini_j6:
    s_barrier
    s_lshr_b32 s36, s30, 1
    s_xor_b32 s36, s36, 0
    s_lshl_b32 s36, s36, 13
    v_add_u32 v26, s36, v8
    ds_write_b128 v26, v[96:99] offset:0
    ds_write_b128 v26, v[100:103] offset:1024
    ds_write_b128 v26, v[104:107] offset:2048
    ds_write_b128 v26, v[108:111] offset:3072
    ds_write_b128 v26, v[112:115] offset:4096
    ds_write_b128 v26, v[116:119] offset:5120
    ds_write_b128 v26, v[120:123] offset:6144
    ds_write_b128 v26, v[124:127] offset:7168
    s_waitcnt lgkmcnt(0)
    s_waitcnt vmcnt(16)
    s_barrier
    s_add_u32 s36, s39, 65536
    v_add_u32 v27, s36, v21
    s_add_u32 s36, s41, 65536
    v_add_u32 v28, s36, v21
    s_cmp_ge_u32 s30, 2
    s_cbranch_scc1 L_ini_b7
    ds_read_b64_tr_b16 a[160:161], v27 offset:0
    ds_read_b64_tr_b16 a[162:163], v27 offset:512
    ds_read_b64_tr_b16 a[164:165], v27 offset:8192
    ds_read_b64_tr_b16 a[166:167], v27 offset:8704
    ds_read_b64_tr_b16 a[168:169], v27 offset:16384
    ds_read_b64_tr_b16 a[170:171], v27 offset:16896
    ds_read_b64_tr_b16 a[172:173], v27 offset:24576
    ds_read_b64_tr_b16 a[174:175], v27 offset:25088
    ds_read_b64_tr_b16 a[176:177], v28 offset:0
    ds_read_b64_tr_b16 a[178:179], v28 offset:512
    ds_read_b64_tr_b16 a[180:181], v28 offset:8192
    ds_read_b64_tr_b16 a[182:183], v28 offset:8704
    ds_read_b64_tr_b16 a[184:185], v28 offset:16384
    ds_read_b64_tr_b16 a[186:187], v28 offset:16896
    ds_read_b64_tr_b16 a[188:189], v28 offset:24576
    ds_read_b64_tr_b16 a[190:191], v28 offset:25088
    s_waitcnt lgkmcnt(0)
    ds_read_b64_tr_b16 v[96:97], v27 offset:32
    ds_read_b64_tr_b16 v[98:99], v27 offset:544
    ds_read_b64_tr_b16 v[100:101], v27 offset:8224
    ds_read_b64_tr_b16 v[102:103], v27 offset:8736
    ds_read_b64_tr_b16 v[104:105], v27 offset:16416
    ds_read_b64_tr_b16 v[106:107], v27 offset:16928
    ds_read_b64_tr_b16 v[108:109], v27 offset:24608
    ds_read_b64_tr_b16 v[110:111], v27 offset:25120
    ds_read_b64_tr_b16 v[112:113], v28 offset:32
    ds_read_b64_tr_b16 v[114:115], v28 offset:544
    ds_read_b64_tr_b16 v[116:117], v28 offset:8224
    ds_read_b64_tr_b16 v[118:119], v28 offset:8736
    ds_read_b64_tr_b16 v[120:121], v28 offset:16416
    ds_read_b64_tr_b16 v[122:123], v28 offset:16928
    ds_read_b64_tr_b16 v[124:125], v28 offset:24608
    ds_read_b64_tr_b16 v[126:127], v28 offset:25120
    s_waitcnt lgkmcnt(0)
    s_branch L_ini_j7
L_ini_b7:
    ds_read_b64_tr_b16 a[128:129], v27 offset:0
    ds_read_b64_tr_b16 a[130:131], v27 offset:512
    ds_read_b64_tr_b16 a[132:133], v27 offset:8192
    ds_read_b64_tr_b16 a[134:135], v27 offset:8704
    ds_read_b64_tr_b16 a[136:137], v27 offset:16384
    ds_read_b64_tr_b16 a[138:139], v27 offset:16896
    ds_read_b64_tr_b16 a[140:141], v27 offset:24576
    ds_read_b64_tr_b16 a[142:143], v27 offset:25088
    ds_read_b64_tr_b16 a[144:145], v28 offset:0
    ds_read_b64_tr_b16 a[146:147], v28 offset:512
    ds_read_b64_tr_b16 a[148:149], v28 offset:8192
    ds_read_b64_tr_b16 a[150:151], v28 offset:8704
    ds_read_b64_tr_b16 a[152:153], v28 offset:16384
    ds_read_b64_tr_b16 a[154:155], v28 offset:16896
    ds_read_b64_tr_b16 a[156:157], v28 offset:24576
    ds_read_b64_tr_b16 a[158:159], v28 offset:25088
    s_waitcnt lgkmcnt(0)
    ds_read_b64_tr_b16 v[96:97], v27 offset:32
    ds_read_b64_tr_b16 v[98:99], v27 offset:544
    ds_read_b64_tr_b16 v[100:101], v27 offset:8224
    ds_read_b64_tr_b16 v[102:103], v27 offset:8736
    ds_read_b64_tr_b16 v[104:105], v27 offset:16416
    ds_read_b64_tr_b16 v[106:107], v27 offset:16928
    ds_read_b64_tr_b16 v[108:109], v27 offset:24608
    ds_read_b64_tr_b16 v[110:111], v27 offset:25120
    ds_read_b64_tr_b16 v[112:113], v28 offset:32
    ds_read_b64_tr_b16 v[114:115], v28 offset:544
    ds_read_b64_tr_b16 v[116:117], v28 offset:8224
    ds_read_b64_tr_b16 v[118:119], v28 offset:8736
    ds_read_b64_tr_b16 v[120:121], v28 offset:16416
    ds_read_b64_tr_b16 v[122:123], v28 offset:16928
    ds_read_b64_tr_b16 v[124:125], v28 offset:24608
    ds_read_b64_tr_b16 v[126:127], v28 offset:25120
    s_waitcnt lgkmcnt(0)
L_ini_j7:
    s_barrier
    s_lshr_b32 s36, s30, 1
    s_xor_b32 s36, s36, 1
    s_lshl_b32 s36, s36, 13
    v_add_u32 v26, s36, v8
    ds_write_b128 v26, v[96:99] offset:0
    ds_write_b128 v26, v[100:103] offset:1024
    ds_write_b128 v26, v[104:107] offset:2048
    ds_write_b128 v26, v[108:111] offset:3072
    ds_write_b128 v26, v[112:115] offset:4096
    ds_write_b128 v26, v[116:119] offset:5120
    ds_write_b128 v26, v[120:123] offset:6144
    ds_write_b128 v26, v[124:127] offset:7168
    ds_write_b128 v9, v[32:35] offset:0
    ds_write_b128 v9, v[36:39] offset:1024
    ds_write_b128 v9, v[40:43] offset:2048
    ds_write_b128 v9, v[44:47] offset:3072
    ds_write_b128 v9, v[48:51] offset:4096
    ds_write_b128 v9, v[52:55] offset:5120
    ds_write_b128 v9, v[56:59] offset:6144
    ds_write_b128 v9, v[60:63] offset:7168
    ds_write_b128 v9, v[64:67] offset:8192
    ds_write_b128 v9, v[68:71] offset:9216
    ds_write_b128 v9, v[72:75] offset:10240
    ds_write_b128 v9, v[76:79] offset:11264
    ds_write_b128 v9, v[80:83] offset:12288
    ds_write_b128 v9, v[84:87] offset:13312
    ds_write_b128 v9, v[88:91] offset:14336
    ds_write_b128 v9, v[92:95] offset:15360
    s_waitcnt lgkmcnt(0)
    v_bfe_u32 v24, v31, 3, 1
    v_mov_b32 v1, 0x44444444
    v_mov_b32 v25, 0xeeeeeeee
    v_cmp_eq_u32 vcc, 1, v24
    s_nop 1
    v_cndmask_b32 v1, v1, v25, vcc
    v_lshrrev_b32 v24, 4, v31
    s_lshl_b32 s36, s30, 3
    v_add_u32 v24, s36, v24
    v_lshlrev_b32 v2, 13, v24
    v_and_b32 v24, 15, v31
    v_lshl_add_u32 v2, v24, 4, v2
    s_lshl_b32 s36, s31, 8
    v_add_u32 v2, s36, v2
    s_lshr_b32 s36, s31, 2
    s_lshl_b32 s36, s36, 10
    s_bfe_u32 s37, s31, 0x10001
    s_lshl_b32 s37, s37, 9
    s_add_u32 s36, s36, s37
    s_and_b32 s37, s31, 1
    s_lshl_b32 s37, s37, 6
    s_add_u32 s36, s36, s37
    v_bfe_u32 v24, v31, 2, 1
    v_lshlrev_b32 v3, 8, v24
    v_bfe_u32 v24, v31, 5, 1
    v_lshl_add_u32 v3, v24, 7, v3
    v_and_b32 v24, 3, v31
    v_lshl_add_u32 v3, v24, 4, v3
    v_bfe_u32 v24, v31, 4, 1
    v_lshl_add_u32 v3, v24, 3, v3
    v_add_u32 v3, s36, v3
    v_lshrrev_b32 v24, 5, v31
    v_lshlrev_b32 v4, 8, v24
    v_and_b32 v24, 15, v31
    v_lshl_add_u32 v4, v24, 4, v4
    v_bfe_u32 v24, v31, 4, 1
    v_lshl_add_u32 v4, v24, 3, v4
    s_lshl_b32 s36, s30, 9
    s_add_u32 s36, s36, 147456
    v_add_u32 v4, s36, v4
    v_lshrrev_b32 v24, 4, v31
    v_lshlrev_b32 v5, 7, v24
    v_bfe_u32 v24, v31, 2, 2
    v_lshl_add_u32 v5, v24, 4, v5
    v_and_b32 v24, 1, v31
    v_lshl_add_u32 v5, v24, 3, v5
    v_add_u32 v5, 147456, v5
    s_lshl_b32 s36, s30, 9
    s_add_u32 s36, s36, 2048
    v_add_u32 v11, s36, v5
    s_lshl_b32 s36, s30, 10
    s_add_u32 s36, s36, 151552
    v_add_u32 v6, s36, v0
    v_lshrrev_b32 v24, 4, v31
    v_lshlrev_b32 v7, 8, v24
    v_and_b32 v24, 7, v31
    v_lshl_add_u32 v7, v24, 4, v7
    v_add_u32 v7, 151552, v7
    v_mov_b32 v10, 0
    v_add_u32 v12, 131072, v0
    v_and_b32 v24, 1, v31
    v_mul_u32_u24 v13, 2048, v24
    v_cmp_gt_u32 s[54:55], 32, v31
    v_and_b32 v24, 15, v31
    v_cmp_gt_u32 s[56:57], 8, v24
    s_mov_b32 s59, 0x3e0293ee
    s_mov_b32 s80, s59
    s_mov_b32 s81, s59
    s_mov_b32 s40, 0
    s_lshl_b32 s36, s32, 15
    s_add_u32 s61, s36, 0x10000
    s_lshl_b32 s36, s32, 19
    s_add_u32 s62, s36, 0x100000
    s_lshl_b32 s36, s32, 24
    s_lshl_b32 s37, s31, 13
    s_add_u32 s36, s36, s37
    s_add_u32 s45, s36, 0x1000000
    s_add_u32 s46, s36, 0x3000000
    s_lshl_b32 s36, s32, 23
    s_lshl_b32 s37, s31, 12
    s_add_u32 s36, s36, s37
    s_add_u32 s47, s36, 0x7000000
    s_lshl_b32 s37, s30, 10
    s_add_u32 s47, s47, s37
    s_lshl_b32 s36, s32, 22
    s_lshl_b32 s37, s31, 11
    s_add_u32 s36, s36, s37
    s_add_u32 s48, s36, 0x8000000
    s_lshl_b32 s37, s30, 9
    s_add_u32 s48, s48, s37
    s_lshl_b32 s36, s32, 7
    s_lshl_b32 s37, s31, 2
    s_add_u32 s36, s36, s37
    s_add_u32 s63, s36, 256
    s_add_u32 s60, s36, 768
    s_mov_b32 s49, 0
    s_mov_b32 s35, 65536
    s_mov_b32 s95, 64
    v_mov_b32 v14, 0x3f803f80
    v_mov_b32 v24, 0x3f803f80
    v_mov_b32 v25, 0x3f803f80
    v_mov_b32 v26, 0x3f803f80
    v_mov_b32 v27, 0x3f803f80
    v_cndmask_b32 v28, 0, v14, s[54:55]
    v_cndmask_b32 v29, 0, v14, s[54:55]
    s_lshl_b32 s36, s30, 11
    s_add_u32 s84, s45, s36
    s_add_u32 s85, s84, 1024
    s_add_u32 s86, s36, 131072
    s_add_u32 s87, s86, 1024
    s_lshl_b32 s36, s30, 11
    s_add_u32 s88, s46, s36
    s_add_u32 s89, s88, 1024
    s_add_u32 s91, s36, 155648
    s_add_u32 s92, s91, 1024
    s_mov_b32 s51, 1
    s_branch L_kvspin_init_enter
L_kvok_init:
    s_mov_b32 m0, s86
    s_nop 0
    buffer_load_dwordx4 v0, s[4:7], s84 offen sc1 lds
    s_mov_b32 m0, s87
    s_nop 0
    buffer_load_dwordx4 v0, s[4:7], s85 offen sc1 lds
    s_mov_b32 m0, s91
    s_nop 0
    buffer_load_dwordx4 v0, s[4:7], s88 offen sc1 lds
    s_mov_b32 m0, s92
    s_nop 0
    buffer_load_dwordx4 v0, s[4:7], s89 offen sc1 lds
    s_waitcnt vmcnt(0)
    s_add_u32 s84, s84, 262144
    s_add_u32 s85, s85, 262144
    s_xor_b32 s86, s86, 8192
    s_xor_b32 s87, s87, 8192
    s_add_u32 s88, s88, 262144
    s_add_u32 s89, s89, 262144
    s_barrier
    v_mov_b64 v[64:65], 0
    v_mov_b64 v[66:67], 0
    v_mov_b64 v[68:69], 0
    v_mov_b64 v[70:71], 0
    v_mov_b64 v[72:73], 0
    v_mov_b64 v[74:75], 0
    v_mov_b64 v[76:77], 0
    v_mov_b64 v[78:79], 0
    v_mov_b64 v[108:109], 0
    v_mov_b64 v[110:111], 0
    v_mov_b64 v[112:113], 0
    v_mov_b64 v[114:115], 0
    s_mov_b32 s41, s61
    s_mov_b32 s44, s62
    s_xor_b32 s90, s30, 1
    s_lshl_b32 s90, s90, 11
    s_xor_b32 s93, s30, 2
    s_lshl_b32 s93, s93, 11
    s_xor_b32 s95, s30, 3
    s_lshl_b32 s95, s95, 11
L_step:
    ds_read_b128 v[80:83], v8 offset:0
    ds_read_b128 v[84:87], v8 offset:1024
    s_lshl_b32 s38, s30, 11
    s_add_u32 s96, s41, s38
    s_and_b32 s36, s40, 1
    s_lshl_b32 s37, s36, 13
    v_add_u32 v15, s37, v12
    s_mov_b32 s37, 147456
    s_add_u32 s38, s38, s37
    v_add_u32 v118, s38, v0
    s_add_u32 s38, s90, s37
    v_add_u32 v119, s38, v0
    s_add_u32 s38, s93, s37
    v_add_u32 v104, s38, v0
    s_add_u32 s38, s95, s37
    v_add_u32 v105, s38, v0
    v_mov_b64 v[64:65], 0
    v_mov_b64 v[66:67], 0
    v_mov_b64 v[68:69], 0
    v_mov_b64 v[70:71], 0
    v_mov_b64 v[72:73], 0
    v_mov_b64 v[74:75], 0
    v_mov_b64 v[76:77], 0
    v_mov_b64 v[78:79], 0
    v_mov_b64 v[108:109], 0
    v_mov_b64 v[110:111], 0
    v_mov_b64 v[112:113], 0
    v_mov_b64 v[114:115], 0
    s_nop 8
L_h2_nodelay:
    s_mov_b32 s58, 0
    buffer_load_dwordx4 v[32:35], v0, s[4:7], s96 offen offset:0 sc1
    buffer_load_dwordx4 v[36:39], v0, s[4:7], s96 offen offset:1024 sc1
    s_add_u32 s36, s40, 1
    s_and_b32 s36, s36, 3
    s_lshl_b32 s36, s36, 13
    s_add_u32 s42, s61, s36
    s_add_u32 s36, s40, 3
    s_and_b32 s36, s36, 3
    s_lshl_b32 s36, s36, 13
    s_add_u32 s43, s61, s36
    s_lshl_b32 s36, s31, 13
    s_add_u32 s97, s44, s36
    s_add_u32 s98, s97, 4096
    s_xor_b32 s99, s97, 0x40000
    s_lshl_b32 s36, s30, 11
    s_add_u32 s99, s99, s36
    s_add_u32 s94, s44, 32768
    v_readlane_b32 s36, v10, 0
    v_readlane_b32 s37, v10, 1
    s_add_u32 s51, s40, 2
    s_min_u32 s51, s51, 64
    v_mov_b32 v96, -1
    v_mov_b32 v97, -1
    v_mov_b32 v98, -1
    v_mov_b32 v99, -1
    s_min_u32 s36, s36, s37
    s_max_u32 s49, s49, s36
L_mpoll1:
    s_waitcnt vmcnt(0)
    v_max_u32 v14, v35, v39
    v_cmp_eq_u32 vcc, -1, v14
    s_cbranch_vccnz L_mfail1
L_mok:
    ds_write_b128 v118, v[32:35]
    ds_write_b128 v118, v[36:39] offset:1024
    ds_read_b128 v[88:91], v8 offset:2048
    ds_read_b128 v[92:95], v8 offset:3072
    ds_read_b128 v[16:19], v8 offset:4096
    ds_read_b128 v[20:23], v8 offset:5120
    v_smfmac_f32_16x16x64_bf16 v[64:67], v[32:35], a[0:7], v1
    v_smfmac_f32_16x16x64_bf16 v[68:71], v[32:35], a[64:71], v1
    v_smfmac_f32_16x16x64_bf16 v[72:75], v[32:35], a[128:135], v1
    s_waitcnt lgkmcnt(6)
    v_smfmac_f32_16x16x64_bf16 v[76:79], v[32:35], v[80:87], v1
    v_smfmac_f32_16x16x64_bf16 v[108:111], v[32:35], v[128:135], v1
    v_smfmac_f32_16x16x64_bf16 v[112:115], v[32:35], v[192:199], v1
    s_waitcnt vmcnt(0) lgkmcnt(4)
    s_barrier
    ds_read_b128 v[40:43], v119 offset:0
    ds_read_b128 v[44:47], v119 offset:1024
    ds_read_b128 v[48:51], v104 offset:0
    ds_read_b128 v[52:55], v104 offset:1024
    ds_read_b128 v[56:59], v105 offset:0
    ds_read_b128 v[60:63], v105 offset:1024
    ds_read_b128 v[80:83], v8 offset:6144
    ds_read_b128 v[84:87], v8 offset:7168
    s_cmp_lg_u32 s30, 3
    s_cbranch_scc1 L_flag_skip
    v_mov_b32 v14, s40
    v_mov_b32 v118, 0
    s_mov_b64 exec, 1
    buffer_store_dword v14, v118, s[4:7], s60 offen sc1
    s_mov_b64 exec, -1
L_flag_skip:
    v_smfmac_f32_16x16x64_bf16 v[64:67], v[36:39], a[8:15], v1
    buffer_store_dwordx4 v[96:99], v0, s[4:7], s99 offen offset:0
    v_smfmac_f32_16x16x64_bf16 v[68:71], v[36:39], a[72:79], v1
    buffer_store_dwordx4 v[96:99], v0, s[4:7], s99 offen offset:1024
    v_smfmac_f32_16x16x64_bf16 v[72:75], v[36:39], a[136:143], v1
    s_waitcnt lgkmcnt(10)
    v_smfmac_f32_16x16x64_bf16 v[76:79], v[36:39], v[88:95], v1
    v_smfmac_f32_16x16x64_bf16 v[108:111], v[36:39], v[136:143], v1
    v_smfmac_f32_16x16x64_bf16 v[112:115], v[36:39], v[200:207], v1
    s_cmp_lt_u32 s49, s51
    s_cbranch_scc1 L_kvspin_loop_enter
L_kvok_loop:
    s_waitcnt lgkmcnt(7)
    s_mov_b32 m0, s86
    v_smfmac_f32_16x16x64_bf16 v[64:67], v[40:43], a[16:23], v1
    buffer_load_dwordx4 v0, s[4:7], s84 offen sc1 lds
    ds_read_b128 v[88:91], v8 offset:8192
    ds_read_b128 v[92:95], v8 offset:9216
    v_smfmac_f32_16x16x64_bf16 v[68:71], v[40:43], a[80:87], v1
    v_smfmac_f32_16x16x64_bf16 v[72:75], v[40:43], a[144:151], v1
    s_waitcnt lgkmcnt(9)
    v_smfmac_f32_16x16x64_bf16 v[76:79], v[40:43], v[16:23], v1
    s_waitcnt lgkmcnt(4)
    s_mov_b32 m0, s87
    v_smfmac_f32_16x16x64_bf16 v[64:67], v[44:47], a[24:31], v1
    buffer_load_dwordx4 v0, s[4:7], s85 offen sc1 lds
    ds_read_b128 v[16:19], v8 offset:10240
    ds_read_b128 v[20:23], v8 offset:11264
    v_smfmac_f32_16x16x64_bf16 v[68:71], v[44:47], a[88:95], v1
    v_smfmac_f32_16x16x64_bf16 v[72:75], v[44:47], a[152:159], v1
    s_waitcnt lgkmcnt(4)
    v_smfmac_f32_16x16x64_bf16 v[76:79], v[44:47], v[80:87], v1
    s_barrier
    v_smfmac_f32_16x16x64_bf16 v[64:67], v[48:51], a[32:39], v1
    buffer_load_dword v10, v13, s[4:7], s63 offen sc1
    ds_read_b128 v[80:83], v8 offset:12288
    ds_read_b128 v[84:87], v8 offset:13312
    v_smfmac_f32_16x16x64_bf16 v[68:71], v[48:51], a[96:103], v1
    v_smfmac_f32_16x16x64_bf16 v[72:75], v[48:51], a[160:167], v1
    s_waitcnt lgkmcnt(4)
    v_smfmac_f32_16x16x64_bf16 v[76:79], v[48:51], v[88:95], v1
    v_smfmac_f32_16x16x64_bf16 v[64:67], v[52:55], a[40:47], v1
    ds_read_b128 v[88:91], v8 offset:14336
    ds_read_b128 v[92:95], v8 offset:15360
    v_smfmac_f32_16x16x64_bf16 v[68:71], v[52:55], a[104:111], v1
    v_smfmac_f32_16x16x64_bf16 v[72:75], v[52:55], a[168:175], v1
    s_waitcnt lgkmcnt(4)
    v_smfmac_f32_16x16x64_bf16 v[76:79], v[52:55], v[16:23], v1
    v_smfmac_f32_16x16x64_bf16 v[64:67], v[56:59], a[48:55], v1
    v_smfmac_f32_16x16x64_bf16 v[68:71], v[56:59], a[112:119], v1
    v_smfmac_f32_16x16x64_bf16 v[72:75], v[56:59], a[176:183], v1
    s_waitcnt lgkmcnt(2)
    v_smfmac_f32_16x16x64_bf16 v[76:79], v[56:59], v[80:87], v1
    v_smfmac_f32_16x16x64_bf16 v[64:67], v[60:63], a[56:63], v1
    v_smfmac_f32_16x16x64_bf16 v[68:71], v[60:63], a[120:127], v1
    v_smfmac_f32_16x16x64_bf16 v[72:75], v[60:63], a[184:191], v1
    s_waitcnt lgkmcnt(0)
    v_smfmac_f32_16x16x64_bf16 v[76:79], v[60:63], v[88:95], v1
    v_smfmac_f32_16x16x64_bf16 v[108:111], v[40:43], v[144:151], v1
    s_lshl_b32 s36, s30, 11
    s_add_u32 s36, s36, 155648
    v_add_u32 v14, s36, v0
    ds_read_b128 v[16:19], v14
    ds_read_b128 v[20:23], v14 offset:1024
    s_nop 2
    v_permlane32_swap_b32 v64, v68
    v_permlane32_swap_b32 v65, v69
    v_permlane32_swap_b32 v66, v70
    v_permlane32_swap_b32 v67, v71
    v_pk_add_f32 v[64:65], v[64:65], v[68:69]
    v_pk_add_f32 v[66:67], v[66:67], v[70:71]
    v_cvt_pk_bf16_f32 v64, v64, v65
    v_cvt_pk_bf16_f32 v65, v66, v67
    ds_write_b64 v4, v[64:65] offset:0
    v_permlane32_swap_b32 v72, v76
    v_permlane32_swap_b32 v73, v77
    v_permlane32_swap_b32 v74, v78
    v_permlane32_swap_b32 v75, v79
    v_pk_add_f32 v[72:73], v[72:73], v[76:77]
    v_pk_add_f32 v[74:75], v[74:75], v[78:79]
    v_cvt_pk_bf16_f32 v72, v72, v73
    v_cvt_pk_bf16_f32 v73, v74, v75
    ds_write_b64 v4, v[72:73] offset:2048
    v_smfmac_f32_16x16x64_bf16 v[112:115], v[40:43], v[208:215], v1
    ds_read_b128 v[80:83], v15 offset:0
    ds_read_b128 v[84:87], v15 offset:4096
    v_smfmac_f32_16x16x64_bf16 v[108:111], v[44:47], v[152:159], v1
    ds_read_b128 v[88:91], v15 offset:1024
    ds_read_b128 v[92:95], v15 offset:5120
    v_smfmac_f32_16x16x64_bf16 v[112:115], v[44:47], v[216:223], v1
    ds_read_b128 v[120:123], v15 offset:3072
    ds_read_b128 v[124:127], v15 offset:7168
    v_smfmac_f32_16x16x64_bf16 v[108:111], v[48:51], v[160:167], v1
    s_waitcnt lgkmcnt(6)
    s_barrier
    ds_read_b64_tr_b16 v[64:65], v5 offset:0
    ds_read_b64_tr_b16 v[66:67], v5 offset:64
    ds_read_b64_tr_b16 v[68:69], v5 offset:2048
    ds_read_b64_tr_b16 v[70:71], v5 offset:2112
    v_smfmac_f32_16x16x64_bf16 v[112:115], v[48:51], v[224:231], v1
    ds_read_b64_tr_b16 v[72:73], v5 offset:512
    ds_read_b64_tr_b16 v[74:75], v5 offset:576
    v_smfmac_f32_16x16x64_bf16 v[108:111], v[52:55], v[168:175], v1
    ds_read_b64_tr_b16 v[76:77], v5 offset:2560
    ds_read_b64_tr_b16 v[78:79], v5 offset:2624
    v_smfmac_f32_16x16x64_bf16 v[112:115], v[52:55], v[232:239], v1
    ds_read_b64_tr_b16 v[32:33], v5 offset:1024
    ds_read_b64_tr_b16 v[34:35], v5 offset:1088
    v_smfmac_f32_16x16x64_bf16 v[108:111], v[56:59], v[176:183], v1
    ds_read_b64_tr_b16 v[36:37], v5 offset:3072
    ds_read_b64_tr_b16 v[38:39], v5 offset:3136
    v_smfmac_f32_16x16x64_bf16 v[112:115], v[56:59], v[240:247], v1
    s_mov_b32 m0, s91
    ds_read_b64_tr_b16 v[40:41], v5 offset:1536
    ds_read_b64_tr_b16 v[42:43], v5 offset:1600
    buffer_load_dwordx4 v0, s[4:7], s88 offen sc1 lds
    s_mov_b32 m0, s92
    ds_read_b64_tr_b16 v[44:45], v5 offset:3584
    ds_read_b64_tr_b16 v[46:47], v5 offset:3648
    buffer_load_dwordx4 v0, s[4:7], s89 offen sc1 lds
    ds_read_b128 v[52:55], v15 offset:2048
    ds_read_b128 v[56:59], v15 offset:6144
    v_smfmac_f32_16x16x64_bf16 v[108:111], v[60:63], v[184:191], v1
    v_smfmac_f32_16x16x64_bf16 v[112:115], v[60:63], v[248:255], v1
    s_add_u32 s84, s84, 262144
    s_add_u32 s85, s85, 262144
    s_xor_b32 s86, s86, 8192
    s_xor_b32 s87, s87, 8192
    s_add_u32 s88, s88, 262144
    s_add_u32 s89, s89, 262144
    s_waitcnt lgkmcnt(14)
    v_mfma_f32_16x16x32_bf16 v[100:103], v[80:83], v[64:67], 0
    ds_read_b64_tr_b16 v[48:49], v11
    ds_read_b64_tr_b16 v[50:51], v11 offset:64
    v_mfma_f32_16x16x32_bf16 v[104:107], v[84:87], v[64:67], 0
    v_mfma_f32_16x16x32_bf16 v[96:99], v[68:71], v[64:67], 0
    s_waitcnt lgkmcnt(12)
    v_mfma_f32_16x16x32_bf16 v[100:103], v[88:91], v[72:75], v[100:103]
    v_permlane32_swap_b32 v108, v112
    v_mfma_f32_16x16x32_bf16 v[104:107], v[92:95], v[72:75], v[104:107]
    v_permlane32_swap_b32 v109, v113
    v_mfma_f32_16x16x32_bf16 v[96:99], v[76:79], v[72:75], v[96:99]
    v_permlane32_swap_b32 v110, v114
    s_waitcnt lgkmcnt(2)
    v_mfma_f32_16x16x32_bf16 v[100:103], v[52:55], v[32:35], v[100:103]
    v_permlane32_swap_b32 v111, v115
    v_mfma_f32_16x16x32_bf16 v[104:107], v[56:59], v[32:35], v[104:107]
    v_add_f32 v108, v108, v112
    v_mfma_f32_16x16x32_bf16 v[96:99], v[36:39], v[32:35], v[96:99]
    v_mfma_f32_16x16x32_bf16 v[100:103], v[120:123], v[40:43], v[100:103]
    v_add_f32 v109, v109, v113
    v_mfma_f32_16x16x32_bf16 v[104:107], v[124:127], v[40:43], v[104:107]
    v_add_f32 v110, v110, v114
    v_mfma_f32_16x16x32_bf16 v[96:99], v[44:47], v[40:43], v[96:99]
    v_add_f32 v111, v111, v115
    v_lshrrev_b32 v118, 1, v0
    v_cvt_pk_bf16_f32 v112, v108, v109
    v_cvt_pk_bf16_f32 v113, v110, v111
    s_waitcnt lgkmcnt(0)
    buffer_store_dwordx2 v[112:113], v118, s[4:7], s48 offen sc1
    buffer_store_dwordx4 v[48:51], v0, s[4:7], s47 offen sc1
    v_max3_f32 v118, v100, v101, v102
    v_max3_f32 v119, v103, v104, v105
    v_max3_f32 v118, v118, v106, v107
    v_max3_f32 v119, v119, v96, v97
    v_max3_f32 v118, v118, v98, v99
    v_max_f32 v118, v118, v119
    v_mov_b32 v119, v118
    v_cndmask_b32 v116, 0, v112, s[54:55]
    v_cndmask_b32 v117, 0, v113, s[54:55]
    v_permlane32_swap_b32 v118, v119
    v_max_f32 v118, v118, v119
    v_mov_b32 v119, v118
    v_cndmask_b32 v30, v112, 0, s[54:55]
    v_cndmask_b32 v31, v113, 0, s[54:55]
    v_permlane16_swap_b32 v118, v119
    v_max_f32 v118, v118, v119
    v_mul_f32 v118, s59, v118
    v_pk_fma_f32 v[100:101], v[100:101], s[80:81], v[118:119] op_sel_hi:[1,1,0] neg_lo:[0,0,1] neg_hi:[0,0,1]
    v_pk_fma_f32 v[102:103], v[102:103], s[80:81], v[118:119] op_sel_hi:[1,1,0] neg_lo:[0,0,1] neg_hi:[0,0,1]
    v_pk_fma_f32 v[104:105], v[104:105], s[80:81], v[118:119] op_sel_hi:[1,1,0] neg_lo:[0,0,1] neg_hi:[0,0,1]
    v_pk_fma_f32 v[106:107], v[106:107], s[80:81], v[118:119] op_sel_hi:[1,1,0] neg_lo:[0,0,1] neg_hi:[0,0,1]
    v_exp_f32 v100, v100
    v_exp_f32 v101, v101
    v_exp_f32 v102, v102
    v_cvt_pk_bf16_f32 v120, v100, v101
    v_exp_f32 v103, v103
    v_exp_f32 v104, v104
    v_cvt_pk_bf16_f32 v121, v102, v103
    v_exp_f32 v105, v105
    v_exp_f32 v106, v106
    v_cvt_pk_bf16_f32 v122, v104, v105
    v_exp_f32 v107, v107
    s_nop 0
    v_cvt_pk_bf16_f32 v123, v106, v107
    v_pk_fma_f32 v[96:97], v[96:97], s[80:81], v[118:119] op_sel_hi:[1,1,0] neg_lo:[0,0,1] neg_hi:[0,0,1]
    v_pk_fma_f32 v[98:99], v[98:99], s[80:81], v[118:119] op_sel_hi:[1,1,0] neg_lo:[0,0,1] neg_hi:[0,0,1]
    v_mfma_f32_16x16x32_bf16 v[108:111], v[16:19], v[120:123], 0
    v_exp_f32 v96, v96
    v_exp_f32 v97, v97
    v_mfma_f32_16x16x32_bf16 v[112:115], v[20:23], v[120:123], 0
    v_exp_f32 v98, v98
    v_exp_f32 v99, v99
    v_mfma_f32_16x16x32_bf16 v[100:103], v[24:27], v[120:123], 0
    v_cvt_pk_bf16_f32 v124, v96, v97
    v_cvt_pk_bf16_f32 v125, v98, v99
    s_nop 1
    v_mfma_f32_16x16x16_bf16 v[108:111], v[116:117], v[124:125], v[108:111]
    v_mfma_f32_16x16x16_bf16 v[112:115], v[30:31], v[124:125], v[112:115]
    v_mfma_f32_16x16x16_bf16 v[100:103], v[28:29], v[124:125], v[100:103]
    v_mov_b64 v[48:49], 0
    v_mov_b64 v[50:51], 0
    v_mov_b64 v[52:53], 0
    v_mov_b64 v[54:55], 0
    v_mov_b64 v[56:57], 0
    v_mov_b64 v[58:59], 0
    v_mov_b64 v[60:61], 0
    v_mov_b64 v[62:63], 0
    v_rcp_f32 v118, v100
    s_nop 0
    v_pk_mul_f32 v[108:109], v[108:109], v[118:119] op_sel_hi:[1,0]
    v_pk_mul_f32 v[110:111], v[110:111], v[118:119] op_sel_hi:[1,0]
    v_pk_mul_f32 v[112:113], v[112:113], v[118:119] op_sel_hi:[1,0]
    v_pk_mul_f32 v[114:115], v[114:115], v[118:119] op_sel_hi:[1,0]
    v_cvt_pk_bf16_f32 v96, v108, v109
    v_cvt_pk_bf16_f32 v97, v110, v111
    v_cvt_pk_bf16_f32 v98, v112, v113
    v_cvt_pk_bf16_f32 v99, v114, v115
    ds_write_b128 v6, v[96:99]
    ds_read_b128 v[64:67], v9 offset:0
    ds_read_b128 v[68:71], v9 offset:1024
    ds_read_b128 v[72:75], v9 offset:8192
    ds_read_b128 v[76:79], v9 offset:9216
    ds_read_b128 v[80:83], v9 offset:2048
    ds_read_b128 v[84:87], v9 offset:3072
    ds_read_b128 v[88:91], v9 offset:10240
    ds_read_b128 v[92:95], v9 offset:11264
    s_waitcnt vmcnt(7) lgkmcnt(8)
    s_barrier
    ds_read_b128 v[32:35], v7 offset:0
    ds_read_b128 v[36:39], v7 offset:1024
    ds_read_b128 v[40:43], v7 offset:2048
    ds_read_b128 v[44:47], v7 offset:3072
    s_waitcnt lgkmcnt(3)
    v_smfmac_f32_16x16x64_bf16 v[48:51], v[32:35], a[192:199], v1
    ds_read_b128 v[16:19], v9 offset:4096
    ds_read_b128 v[20:23], v9 offset:5120
    v_smfmac_f32_16x16x64_bf16 v[52:55], v[32:35], a[224:231], v1
    ds_read_b128 v[120:123], v9 offset:12288
    ds_read_b128 v[124:127], v9 offset:13312
    s_waitcnt lgkmcnt(6)
    v_smfmac_f32_16x16x64_bf16 v[48:51], v[36:39], a[200:207], v1
    ds_read_b128 v[100:103], v9 offset:6144
    ds_read_b128 v[104:107], v9 offset:7168
    v_smfmac_f32_16x16x64_bf16 v[52:55], v[36:39], a[232:239], v1
    ds_read_b128 v[108:111], v9 offset:14336
    ds_read_b128 v[112:115], v9 offset:15360
    s_waitcnt lgkmcnt(9)
    v_smfmac_f32_16x16x64_bf16 v[48:51], v[40:43], a[208:215], v1
    v_smfmac_f32_16x16x64_bf16 v[52:55], v[40:43], a[240:247], v1
    s_waitcnt lgkmcnt(8)
    v_smfmac_f32_16x16x64_bf16 v[48:51], v[44:47], a[216:223], v1
    v_smfmac_f32_16x16x64_bf16 v[52:55], v[44:47], a[248:255], v1
    v_smfmac_f32_16x16x64_bf16 v[56:59], v[32:35], v[64:71], v1
    s_add_u32 s47, s47, 131072
    v_smfmac_f32_16x16x64_bf16 v[60:63], v[32:35], v[72:79], v1
    s_add_u32 s48, s48, 65536
    v_smfmac_f32_16x16x64_bf16 v[56:59], v[36:39], v[80:87], v1
    s_mov_b32 s41, s42
    v_smfmac_f32_16x16x64_bf16 v[60:63], v[36:39], v[88:95], v1
    v_cvt_pk_bf16_f32 v116, v48, v49
    v_cvt_pk_bf16_f32 v117, v50, v51
    s_waitcnt lgkmcnt(6)
    v_smfmac_f32_16x16x64_bf16 v[56:59], v[40:43], v[16:23], v1
    v_cvt_pk_bf16_f32 v118, v52, v53
    v_cvt_pk_bf16_f32 v119, v54, v55
    s_waitcnt lgkmcnt(4)
    v_smfmac_f32_16x16x64_bf16 v[60:63], v[40:43], v[120:127], v1
    v_min_u32 v116, -2, v116
    v_min_u32 v117, -2, v117
    s_waitcnt lgkmcnt(2)
    v_smfmac_f32_16x16x64_bf16 v[56:59], v[44:47], v[100:107], v1
    v_min_u32 v118, -2, v118
    v_min_u32 v119, -2, v119
    s_waitcnt lgkmcnt(0)
    v_smfmac_f32_16x16x64_bf16 v[60:63], v[44:47], v[108:115], v1
    buffer_store_dwordx4 v[116:119], v2, s[4:7], s44 offen
    s_xor_b32 s44, s44, 0x40000
    s_nop 5
    v_cvt_pk_bf16_f32 v116, v56, v57
    v_cvt_pk_bf16_f32 v117, v58, v59
    v_cvt_pk_bf16_f32 v118, v60, v61
    v_cvt_pk_bf16_f32 v119, v62, v63
    v_min_u32 v116, -2, v116
    v_min_u32 v117, -2, v117
    v_min_u32 v118, -2, v118
    v_min_u32 v119, -2, v119
    buffer_store_dwordx4 v[116:119], v2, s[4:7], s94 offen
    s_cmp_lg_u32 s30, 0
    s_cbranch_scc1 L_h1_skip
    v_lshrrev_b32 v14, 4, v0
    v_and_b32 v14, 15, v14
    v_mov_b32 v104, 0x3f80
    v_mov_b32 v105, 0x3f800000
    v_cmp_eq_u32 vcc, 0, v14
    v_cmp_eq_u32 s[36:37], 1, v14
    s_nop 0
    v_cndmask_b32 v100, 0, v104, vcc
    v_cndmask_b32 v100, v100, v105, s[36:37]
    v_cmp_eq_u32 vcc, 2, v14
    v_cmp_eq_u32 s[36:37], 3, v14
    s_nop 0
    v_cndmask_b32 v101, 0, v104, vcc
    v_cndmask_b32 v101, v101, v105, s[36:37]
    v_cmp_eq_u32 vcc, 4, v14
    v_cmp_eq_u32 s[36:37], 5, v14
    s_nop 0
    v_cndmask_b32 v102, 0, v104, vcc
    v_cndmask_b32 v102, v102, v105, s[36:37]
    v_cmp_eq_u32 vcc, 6, v14
    v_cmp_eq_u32 s[36:37], 7, v14
    s_nop 0
    v_cndmask_b32 v103, 0, v104, vcc
    v_cndmask_b32 v103, v103, v105, s[36:37]
    s_bitcmp1_b32 s31, 2
    s_cbranch_scc0 L_h1_early
L_h1_early:
    s_nop 15
    s_nop 15
    s_nop 15
    s_nop 15
    s_nop 10
    s_mov_b32 s58, 0
L_h1_retry:
    buffer_load_dwordx4 v[32:35], v0, s[4:7], s97 offen offset:0 sc1
    buffer_load_dwordx4 v[36:39], v0, s[4:7], s97 offen offset:1024 sc1
    buffer_load_dwordx4 v[40:43], v0, s[4:7], s97 offen offset:2048 sc1
    buffer_load_dwordx4 v[44:47], v0, s[4:7], s97 offen offset:3072 sc1
    buffer_load_dwordx4 v[48:51], v0, s[4:7], s98 offen offset:0 sc1
    buffer_load_dwordx4 v[52:55], v0, s[4:7], s98 offen offset:1024 sc1
    buffer_load_dwordx4 v[56:59], v0, s[4:7], s98 offen offset:2048 sc1
    buffer_load_dwordx4 v[60:63], v0, s[4:7], s98 offen offset:3072 sc1
    s_waitcnt vmcnt(7)
    v_mfma_f32_16x16x32_bf16 v[96:99], v[32:35], v[100:103], 0
    s_waitcnt vmcnt(6)
    v_mfma_f32_16x16x32_bf16 v[96:99], v[36:39], v[100:103], v[96:99]
    s_waitcnt vmcnt(5)
    v_mfma_f32_16x16x32_bf16 v[96:99], v[40:43], v[100:103], v[96:99]
    s_waitcnt vmcnt(4)
    v_mfma_f32_16x16x32_bf16 v[96:99], v[44:47], v[100:103], v[96:99]
    s_waitcnt vmcnt(3)
    v_mfma_f32_16x16x32_bf16 v[96:99], v[48:51], v[100:103], v[96:99]
    s_waitcnt vmcnt(2)
    v_mfma_f32_16x16x32_bf16 v[96:99], v[52:55], v[100:103], v[96:99]
    s_waitcnt vmcnt(1)
    v_mfma_f32_16x16x32_bf16 v[96:99], v[56:59], v[100:103], v[96:99]
    s_waitcnt vmcnt(0)
    v_mfma_f32_16x16x32_bf16 v[96:99], v[60:63], v[100:103], v[96:99]
    s_add_u32 s40, s40, 1
    s_nop 6
    v_cmp_u_f32 vcc, v96, v97
    v_cmp_u_f32 s[36:37], v98, v99
    v_cvt_pk_bf16_f32 v96, v96, v97
    v_cvt_pk_bf16_f32 v97, v98, v99
    s_or_b64 vcc, vcc, s[36:37]
    s_cbranch_vccnz L_h1_slow
L_h1_ok:
    v_min_u32 v96, -2, v96
    v_min_u32 v97, -2, v97
    s_mov_b64 exec, s[56:57]
    buffer_store_dwordx2 v[96:97], v3, s[4:7], s42 offen
    s_mov_b64 exec, -1
    s_barrier
    v_mov_b32 v98, -1
    v_mov_b32 v99, -1
    s_mov_b64 exec, s[56:57]
    buffer_store_dwordx2 v[98:99], v3, s[4:7], s43 offen
    s_mov_b64 exec, -1
    s_branch L_h1_done
L_h1_skip:
    s_add_u32 s40, s40, 1
    s_waitcnt vmcnt(2)
    s_barrier
L_h1_done:
    s_cmp_lt_u32 s40, 64
    s_cbranch_scc1 L_step
    s_waitcnt vmcnt(0)
    s_barrier
    s_cmp_lg_u32 s30, 3
    s_cbranch_scc1 L_end
    v_mov_b32 v14, 64
    v_mov_b32 v118, 0
    s_mov_b64 exec, 1
    buffer_store_dword v14, v118, s[4:7], s60 offen sc1
    s_waitcnt vmcnt(0)
    s_branch L_end
L_h1_slow:
    s_cmp_ge_u32 s58, 8
    s_cbranch_scc1 L_h1_exact
    s_add_u32 s58, s58, 1
    s_sub_u32 s40, s40, 1
    s_branch L_h1_retry
L_h1_exact:
    v_mov_b32 v14, 0
    v_max3_u32 v14, v14, v32, v33
    v_max3_u32 v14, v14, v34, v35
    v_max3_u32 v14, v14, v36, v37
    v_max3_u32 v14, v14, v38, v39
    v_max3_u32 v14, v14, v40, v41
    v_max3_u32 v14, v14, v42, v43
    v_max3_u32 v14, v14, v44, v45
    v_max3_u32 v14, v14, v46, v47
    v_max3_u32 v14, v14, v48, v49
    v_max3_u32 v14, v14, v50, v51
    v_max3_u32 v14, v14, v52, v53
    v_max3_u32 v14, v14, v54, v55
    v_max3_u32 v14, v14, v56, v57
    v_max3_u32 v14, v14, v58, v59
    v_max3_u32 v14, v14, v60, v61
    v_max3_u32 v14, v14, v62, v63
    v_cmp_eq_u32 vcc, -1, v14
    s_cbranch_vccz L_h1_ok
    s_add_u32 s58, s58, 1
    s_sub_u32 s40, s40, 1
    s_cmp_lt_u32 s58, s35
    s_cbranch_scc1 L_h1_retry
    s_add_u32 s40, s40, 1
    s_mov_b32 s33, 1
    s_mov_b32 s35, 0
    s_branch L_h1_ok
L_kvspin_init_enter:
    s_mov_b32 s58, 0
L_kvspin_init:
    buffer_load_dword v14, v13, s[4:7], s63 offen sc1
    s_waitcnt vmcnt(0)
    v_readlane_b32 s36, v14, 0
    v_readlane_b32 s37, v14, 1
    s_nop 3
    s_min_u32 s49, s36, s37
    s_cmp_ge_u32 s49, s51
    s_cbranch_scc1 L_kvok_init
    s_add_u32 s58, s58, 1
    s_cmp_lt_u32 s58, s35
    s_cbranch_scc1 L_kvspin_init
    s_mov_b32 s33, 1
    s_mov_b32 s35, 0
    s_branch L_kvok_init
L_kvspin_loop_enter:
    s_mov_b32 s58, 0
L_kvspin_loop:
    buffer_load_dword v14, v13, s[4:7], s63 offen sc1
    s_waitcnt vmcnt(0)
    v_readlane_b32 s36, v14, 0
    v_readlane_b32 s37, v14, 1
    s_nop 3
    s_min_u32 s49, s36, s37
    s_cmp_ge_u32 s49, s51
    s_cbranch_scc1 L_kvok_loop
    s_add_u32 s58, s58, 1
    s_cmp_lt_u32 s58, s35
    s_cbranch_scc1 L_kvspin_loop
    s_mov_b32 s33, 1
    s_mov_b32 s35, 0
    s_branch L_kvok_loop
L_mfail1:
    buffer_load_dwordx4 v[32:35], v0, s[4:7], s96 offen offset:0 sc1
    buffer_load_dwordx4 v[36:39], v0, s[4:7], s96 offen offset:1024 sc1
    s_add_u32 s58, s58, 1
    s_cmp_lt_u32 s58, s35
    s_cbranch_scc1 L_mpoll1
    s_mov_b32 s33, 1
    s_mov_b32 s35, 0
    s_waitcnt vmcnt(0)
    s_branch L_mok
L_end:
    s_endpgm
.section .rodata,"a"
.p2align 6
.amdhsa_kernel interleave_layers__memory_aug_recurrent_mem_tr__glu_gated_bilinear__prompt_kernel
  .amdhsa_next_free_vgpr 512
  .amdhsa_next_free_sgpr 102
  .amdhsa_accum_offset 256
  .amdhsa_group_segment_fixed_size 0
  .amdhsa_kernarg_size 112
  .amdhsa_user_sgpr_count 2
  .amdhsa_user_sgpr_kernarg_segment_ptr 1
  .amdhsa_system_sgpr_workgroup_id_x 1
  .amdhsa_float_denorm_mode_32 3
.end_amdhsa_kernel
```
